```python
import torch

def _softmax(x, axis=-1):
    return torch.softmax(x, dim=axis)

def _gelu(x):
    return torch.nn.functional.gelu(x, approximate='tanh')

def _silu(x):
    return torch.nn.functional.silu(x)

def _sigmoid(x):
    return torch.sigmoid(x)

def _layernorm(x, axis=-1, eps=1e-05):
    m = x.mean(dim=axis, keepdim=True)
    v = x.var(dim=axis, keepdim=True, unbiased=False)
    return (x - m) / torch.sqrt(v + eps)

def _scatter_add(tgt, idx, src, axis=0):
    return tgt.clone().index_add_(axis, idx, src)

def _segment_sum(src, seg, n):
    out = torch.zeros((n,) + src.shape[1:], dtype=src.dtype)
    return out.index_add_(0, seg, src)

def _pad(x, pw):
    flat = tuple((v for pair in reversed(pw) for v in pair))
    return torch.nn.functional.pad(x, flat)
kernel_name = 'interleave_layers__linear_attn_block__mixer_gmlp__prompt'

def setup_inputs():

    _w = lambda a: (lambda t: t.to(torch.bfloat16) if t.is_floating_point() else t)(torch.as_tensor(a))

    def _A_setup():
        B, S, D = (1, 2048, 640)
        return {'x': _w((lambda *s: torch.randn(*s, dtype=torch.bfloat16) * 0.05)(B, S, D)), 'wqkv': _w((lambda *s: torch.randn(*s, dtype=torch.bfloat16) * 0.05)(D, 3 * D)), 'wo': _w((lambda *s: torch.randn(*s, dtype=torch.bfloat16) * 0.05)(D, D))}
    _A_in = _A_setup()

    def _B_setup():
        B, S, D, F = (1, 2048, 640, 1536)
        Fh = F // 2
        return {'x': _w((lambda *s: torch.randn(*s, dtype=torch.bfloat16) * 0.05)(B, S, D)), 'w_in': _w((lambda *s: torch.randn(*s, dtype=torch.bfloat16) * 0.2)(D, 2 * Fh)), 'w_sp': _w(0.01 * (lambda *s: torch.randn(*s, dtype=torch.bfloat16) * 0.2)(S, S)), 'b_sp': _w(1.0 + 0.01 * (lambda *s: torch.randn(*s, dtype=torch.bfloat16) * 0.05)(S)), 'w_out': _w((lambda *s: torch.randn(*s, dtype=torch.bfloat16) * 0.05)(Fh, D))}
    _B_in = _B_setup()
    return {'A_x': _A_in['x'], 'A_wqkv': _A_in['wqkv'], 'A_wo': _A_in['wo'], 'B_x': _B_in['x'], 'B_w_in': _B_in['w_in'], 'B_w_sp': _B_in['w_sp'], 'B_b_sp': _B_in['b_sp'], 'B_w_out': _B_in['w_out']}

def reference(A_x, A_wqkv, A_wo, B_x, B_w_in, B_w_sp, B_b_sp, B_w_out):

    def _A_ref(x, wqkv, wo):
        B, S, D = x.shape
        H = 32
        Dh = D // H
        qkv = (lambda x, *d: x.permute(*d))((x @ wqkv).reshape(B, S, 3, H, Dh), 2, 0, 3, 1, 4)
        q, k, v = (qkv[0], qkv[1], qkv[2])
        phi = lambda t: torch.where(t > 0, t + 1, torch.exp(t)) + 1e-06
        pq, pk = (phi(q), phi(k))
        kv = torch.einsum('bhsd,bhse->bhde', pk, v)
        z = torch.einsum('bhsd->bhd', pk)
        num = torch.einsum('bhqd,bhde->bhqe', pq, kv)
        den = torch.einsum('bhqd,bhd->bhq', pq, z)[..., None] + 1e-06
        o = num / den
        return (lambda x, *d: x.permute(*d))(o, 0, 2, 1, 3).reshape(B, S, D) @ wo

    def _B_ref(x, w_in, w_sp, b_sp, w_out):
        B, S, D = x.shape
        F = w_in.shape[-1]
        Fh = F // 2
        z = _gelu(torch.einsum('bsd,df->bsf', x, w_in))
        z1 = z[..., :Fh].clone()
        z2 = _layernorm(z[..., Fh:], axis=-1)
        g = torch.einsum('ts,bsf->btf', w_sp, z2) + b_sp[None, :, None]
        return torch.einsum('bsf,fd->bsd', z1 * g, w_out)
    x = A_x
    x = x + _A_ref(_layernorm(x, axis=-1), A_wqkv, A_wo)
    x = x + _B_ref(_layernorm(x, axis=-1), B_w_in, B_w_sp, B_b_sp, B_w_out)
    x = x + _A_ref(_layernorm(x, axis=-1), A_wqkv, A_wo)
    x = x + _B_ref(_layernorm(x, axis=-1), B_w_in, B_w_sp, B_b_sp, B_w_out)
    return x
```

```asm
; @launch grid=(256,1,1) block=(256,1,1) lds=163840
.amdgcn_target "amdgcn-amd-amdhsa--gfx950"
.text
.globl interleave_layers__linear_attn_block__mixer_gmlp__prompt_kernel
.p2align 8
.type interleave_layers__linear_attn_block__mixer_gmlp__prompt_kernel,@function
interleave_layers__linear_attn_block__mixer_gmlp__prompt_kernel:
  s_cmp_ge_u32 s2, 256
  s_cbranch_scc1 L_abort
  s_load_dwordx16 s[8:23], s[0:1], 0
  s_load_dwordx2 s[32:33], s[0:1], 64
  s_load_dwordx2 s[4:5], s[0:1], 80
  s_getpc_b64 s[96:97]
L_base:
  s_mov_b32 s98, L_codeend-L_base
  s_mov_b32 s99, 0x20000
  v_lshrrev_b32 v2, 2, v0
  v_lshlrev_b32 v2, 7, v2
  buffer_load_dword v222, v2, s[96:99], 0 offen
  v_lshrrev_b32 v2, 6, v0
  v_and_b32 v0, 63, v0
  v_readfirstlane_b32 s40, v2
  s_and_b32 s42, s2, 7
  s_lshl_b32 s42, s42, 2
  s_lshr_b32 s3, s2, 6
  s_add_u32 s42, s42, s3
  s_lshr_b32 s41, s2, 3
  s_and_b32 s41, s41, 7
  s_lshl_b32 s2, s42, 2
  s_add_u32 s2, s2, s40
  v_lshrrev_b32 v207, 4, v0
  v_and_b32 v47, 15, v0
  v_lshlrev_b32 v209, 4, v47
  s_lshl_b32 s81, s42, 1
  s_add_u32 s81, s81, s40
  s_lshr_b32 s3, s40, 1
  s_mul_i32 s3, s3, 62
  s_add_u32 s81, s81, s3
  s_mul_i32 s54, s41, 884736
  s_add_u32 s54, s54, 4718592
  s_mul_i32 s77, s81, 6144
  s_add_u32 s77, s77, s54
  s_mul_i32 s58, s81, 3277
  s_lshr_b32 s58, s58, 16
  s_mul_i32 s3, s58, 20
  s_sub_u32 s59, s81, s3
  s_lshl_b32 s64, s59, 1
  s_mul_i32 s3, s59, 13108
  s_lshr_b32 s3, s3, 16
  s_mul_i32 s60, s3, 5
  s_sub_u32 s59, s59, s60
  s_mul_i32 s3, s3, 10
  s_cmp_ge_u32 s59, 2
  s_cselect_b32 s60, 1, 0
  s_add_u32 s3, s3, s60
  s_cmp_eq_u32 s59, 4
  s_cselect_b32 s60, 1, 0
  s_lshl_b32 s59, s59, 1
  s_add_u32 s59, s59, s3
  s_mul_i32 s3, s60, 5
  s_sub_u32 s59, s59, s3
  s_cmp_eq_u32 s58, 6
  s_cselect_b32 s59, s64, s59
  s_cselect_b32 s60, 0, s60
  s_add_u32 s3, s58, 1
  s_mul_i32 s62, s3, 1280
  s_cmp_ge_u32 s58, 2
  s_cselect_b32 s62, 0, s62
  s_cmp_eq_u32 s58, 4
  s_cselect_b32 s62, 1536, s62
  s_mul_i32 s63, s41, 160
  s_add_u32 s62, s62, s63
  s_cmp_ge_u32 s58, 3
  s_cselect_b32 s61, 1, 3
  s_mul_i32 s61, s61, 1280
  s_lshr_b32 s3, s58, 1
  s_cmp_eq_u32 s3, 2
  s_cselect_b32 s61, 3072, s61
  s_cselect_b32 s3, 32, 0
  s_cselect_b32 s78, 0, 0x80000000
  s_add_u32 s78, s78, s77
  s_add_u32 s78, s78, 5120
  s_mul_i32 s3, s3, s41
  s_add_u32 s62, s62, s3
  v_mad_u32_u24 v10, v207, s61, v209
  s_mul_i32 s76, s59, s61
  s_lshl_b32 s76, s76, 4
  s_andn2_b32 s3, s62, 127
  s_add_u32 s76, s76, s3
  s_mul_i32 s79, s60, s61
  s_lshl_b32 s79, s79, 6
  s_lshl_b32 s80, s61, 2
  s_mul_i32 s38, s61, 640
  s_mov_b32 s39, 0x20000
  s_waitcnt lgkmcnt(0)
  s_mov_b32 s36, s10
  s_mov_b32 s37, s11
  s_cmp_ge_u32 s58, 3
  s_cselect_b32 s36, s12, s36
  s_cselect_b32 s37, s13, s37
  s_cmp_ge_u32 s58, 4
  s_cselect_b32 s36, s16, s36
  s_cselect_b32 s37, s17, s37
  s_cmp_ge_u32 s58, 6
  s_cselect_b32 s36, s22, s36
  s_cselect_b32 s37, s23, s37
  s_cselect_b32 s38, 983040, s38
  s_cmp_ge_u32 s40, 2
  s_cbranch_scc1 L_skip1
  s_lshl_b32 s100, s40, 13
  s_add_u32 m0, s100, 81920
  s_add_u32 s76, s76, 0
  buffer_load_dwordx4 v10, s[36:39], s76 offen  lds
  s_lshl_b32 s100, s40, 13
  s_add_u32 m0, s100, 82944
  s_add_u32 s76, s76, s80
  buffer_load_dwordx4 v10, s[36:39], s76 offen  lds
  s_lshl_b32 s100, s40, 13
  s_add_u32 m0, s100, 83968
  s_add_u32 s76, s76, s80
  buffer_load_dwordx4 v10, s[36:39], s76 offen  lds
  s_lshl_b32 s100, s40, 13
  s_add_u32 m0, s100, 84992
  s_add_u32 s76, s76, s80
  buffer_load_dwordx4 v10, s[36:39], s76 offen  lds
  s_lshl_b32 s100, s40, 13
  s_add_u32 m0, s100, 86016
  s_add_u32 s76, s76, s80
  s_add_u32 s76, s76, s79
  buffer_load_dwordx4 v10, s[36:39], s76 offen  lds
  s_lshl_b32 s100, s40, 13
  s_add_u32 m0, s100, 87040
  s_add_u32 s76, s76, s80
  buffer_load_dwordx4 v10, s[36:39], s76 offen  lds
  s_lshl_b32 s100, s40, 13
  s_add_u32 m0, s100, 88064
  s_add_u32 s76, s76, s80
  buffer_load_dwordx4 v10, s[36:39], s76 offen  lds
  s_lshl_b32 s100, s40, 13
  s_add_u32 m0, s100, 89088
  s_add_u32 s76, s76, s80
  buffer_load_dwordx4 v10, s[36:39], s76 offen  lds
L_skip1:
  s_nop 0
  s_mov_b32 s6, 268435456
  s_mov_b32 s7, 0x20000
  v_mov_b32 v25, 0
  buffer_load_dword v25, v25, s[4:7], 0 offen offset:0 sc1
  s_mov_b32 s10, 2621440
  s_mov_b32 s11, 0x20000
  v_lshrrev_b32 v204, 3, v0
  v_and_b32 v205, 7, v0
  v_xor_b32 v205, v205, v204
  v_lshlrev_b32 v205, 4, v205
  v_lshl_add_u32 v29, v204, 12, v205
  v_add_u32 v30, 31744, v29
  v_mul_u32_u24 v204, 1280, v204
  v_add_u32 v9, v204, v205
  v_xor_b32 v11, 16, v9
  v_add_u32 v11, 9216, v11
  s_mov_b32 s24, s18
  s_mov_b32 s25, s19
  s_mov_b32 s26, 8388608
  s_mov_b32 s27, 0x20000
  s_mov_b32 s34, 2621440
  s_mov_b32 s35, 0x20000
  s_mov_b32 s28, s20
  s_mov_b32 s29, s21
  s_mov_b32 s30, 4096
  s_mov_b32 s31, 0x20000
  v_lshlrev_b32 v204, 1, v47
  s_lshl_b32 s0, s2, 5
  buffer_load_ushort v24, v204, s[28:31], s0 offen
  s_mov_b32 s28, s22
  s_mov_b32 s29, s23
  s_mov_b32 s30, 983040
  s_mov_b32 s31, 0x20000
  v_lshrrev_b32 v204, 2, v47
  v_lshl_add_u32 v204, v207, 2, v204
  v_and_b32 v205, 3, v0
  v_lshlrev_b32 v205, 3, v205
  v_lshl_add_u32 v204, v204, 8, v205
  s_lshl_b32 s3, s40, 13
  s_and_b32 s0, s62, 127
  s_add_u32 s0, s0, s3
  s_add_u32 s0, s0, 81920
  v_add_u32 v7, s0, v204
  v_mov_b32 v204, 0x80000000
  v_cmp_eq_u32 vcc, 0, v0
  s_nop 1
  v_cndmask_b32 v13, v204, 0, vcc
  s_lshl_b32 s0, s2, 3
  s_add_u32 s0, s0, s41
  s_lshl_b32 s0, s0, 7
  buffer_load_dword v222, v13, s[96:99], s0 offen
  v_lshlrev_b32 v1, 4, v0
  s_mul_i32 s52, s40, 6144
  s_mul_i32 s43, s40, 5120
  s_add_u32 s75, s52, s54
  s_lshr_b32 s1, s40, 1
  s_mul_i32 s1, s1, 110592
  s_add_u32 s74, s75, s1
  v_mov_b32 v20, 0x3f803f80
  v_mov_b32 v21, 0x3f803f80
  v_mov_b32 v22, 0x3f803f80
  v_mov_b32 v23, 0x3f803f80
  v_add_u32 v2, 0x10000, v1
  v_add_u32 v3, 0x20000, v1
  s_lshl_b32 s89, s41, 10
  s_add_u32 s89, s89, 49152
  s_cmp_lt_u32 s40, 2
  s_cbranch_scc1 L_skip2
  s_sub_u32 s0, s2, 2
  s_mul_i32 s49, s0, 20480
  s_sub_u32 s0, s40, 2
  s_mul_i32 s50, s0, 20480
  s_mov_b32 s51, s41
  s_mov_b32 s1, 0
L_xl3:
  s_lshl_b32 s0, s51, 11
  s_add_u32 m0, s0, s50
  s_lshl_b32 s0, s51, 7
  s_add_u32 s0, s0, s49
  buffer_load_dwordx4 v9, s[8:11], s0 offen offset:0  lds
  buffer_load_dwordx4 v11, s[8:11], s0 offen offset:1024  lds
  s_add_u32 s51, s51, 1
  s_cmp_eq_u32 s51, 10
  s_cselect_b32 s51, 0, s51
  s_add_u32 s1, s1, 1
  s_cmp_eq_u32 s1, 10
  s_cselect_b32 s0, 40960, 0
  s_add_u32 s50, s50, s0
  s_add_u32 s49, s49, s0
  s_cmp_lt_u32 s1, 20
  s_cbranch_scc1 L_xl3
L_skip2:
  s_nop 0
  s_cmp_ge_u32 s40, 2
  s_cbranch_scc1 L_skip4
  s_waitcnt vmcnt(3)
  ds_read_b64_tr_b16 v[164:165], v7 offset:0
  ds_read_b64_tr_b16 v[166:167], v7 offset:4096
  ds_read_b64_tr_b16 v[168:169], v7 offset:32
  ds_read_b64_tr_b16 v[170:171], v7 offset:4128
  ds_read_b64_tr_b16 v[172:173], v7 offset:64
  ds_read_b64_tr_b16 v[174:175], v7 offset:4160
  ds_read_b64_tr_b16 v[176:177], v7 offset:96
  ds_read_b64_tr_b16 v[178:179], v7 offset:4192
  ds_read_b64_tr_b16 v[180:181], v7 offset:128
  ds_read_b64_tr_b16 v[182:183], v7 offset:4224
  s_waitcnt lgkmcnt(8)
  buffer_store_dwordx4 v[164:167], v1, s[4:7], s77 offen offset:0 sc1
  s_waitcnt lgkmcnt(6)
  buffer_store_dwordx4 v[168:171], v1, s[4:7], s77 offen offset:1024 sc1
  s_waitcnt lgkmcnt(4)
  buffer_store_dwordx4 v[172:175], v1, s[4:7], s77 offen offset:2048 sc1
  s_waitcnt lgkmcnt(2)
  buffer_store_dwordx4 v[176:179], v1, s[4:7], s77 offen offset:3072 sc1
  s_add_u32 s77, s77, 4096
  s_waitcnt lgkmcnt(0)
  buffer_store_dwordx4 v[180:183], v1, s[4:7], s77 offen offset:0 sc1
  v_cmp_eq_u32 vcc, 0, v47
  s_nop 1
  v_cndmask_b32 v228, 0, v20, vcc
  v_cndmask_b32 v229, 0, v20, vcc
  v_cndmask_b32 v230, 0, v20, vcc
  v_cndmask_b32 v231, 0, v20, vcc
  v_lshrrev_b32 v232, 4, v0
  v_lshl_add_u32 v232, v47, 2, v232
  v_mfma_f32_16x16x32_bf16 v[224:227], v[164:167], v[228:231], 0
  v_mov_b32_dpp v228, v228 row_ror:1 row_mask:0xf bank_mask:0xf
  v_mov_b32_dpp v229, v229 row_ror:1 row_mask:0xf bank_mask:0xf
  v_mov_b32_dpp v230, v230 row_ror:1 row_mask:0xf bank_mask:0xf
  v_mov_b32_dpp v231, v231 row_ror:1 row_mask:0xf bank_mask:0xf
  s_nop 1
  v_mfma_f32_16x16x32_bf16 v[224:227], v[168:171], v[228:231], v[224:227]
  v_mov_b32_dpp v228, v228 row_ror:1 row_mask:0xf bank_mask:0xf
  v_mov_b32_dpp v229, v229 row_ror:1 row_mask:0xf bank_mask:0xf
  v_mov_b32_dpp v230, v230 row_ror:1 row_mask:0xf bank_mask:0xf
  v_mov_b32_dpp v231, v231 row_ror:1 row_mask:0xf bank_mask:0xf
  s_nop 1
  v_mfma_f32_16x16x32_bf16 v[224:227], v[172:175], v[228:231], v[224:227]
  v_mov_b32_dpp v228, v228 row_ror:1 row_mask:0xf bank_mask:0xf
  v_mov_b32_dpp v229, v229 row_ror:1 row_mask:0xf bank_mask:0xf
  v_mov_b32_dpp v230, v230 row_ror:1 row_mask:0xf bank_mask:0xf
  v_mov_b32_dpp v231, v231 row_ror:1 row_mask:0xf bank_mask:0xf
  s_nop 1
  v_mfma_f32_16x16x32_bf16 v[224:227], v[176:179], v[228:231], v[224:227]
  v_mov_b32_dpp v228, v228 row_ror:1 row_mask:0xf bank_mask:0xf
  v_mov_b32_dpp v229, v229 row_ror:1 row_mask:0xf bank_mask:0xf
  v_mov_b32_dpp v230, v230 row_ror:1 row_mask:0xf bank_mask:0xf
  v_mov_b32_dpp v231, v231 row_ror:1 row_mask:0xf bank_mask:0xf
  s_nop 1
  v_mfma_f32_16x16x32_bf16 v[224:227], v[180:183], v[228:231], v[224:227]
  s_mul_i32 s0, s41, 144
  s_add_u32 s0, s0, s81
  s_lshl_b32 s0, s0, 9
  s_add_u32 s0, s0, 25165824
  v_lshlrev_b32 v232, 4, v232
  v_cmp_lt_u32 vcc, 5, v47
  s_nop 1
  v_cndmask_b32 v232, v232, -1, vcc
  buffer_store_dwordx4 v[224:227], v232, s[4:7], s0 offen sc1
L_skip4:
  s_nop 0
  v_lshrrev_b32 v207, 4, v0
  v_lshrrev_b32 v33, 5, v0
  v_mov_b32 v204, 0x80000000
  v_lshlrev_b32 v6, 4, v207
  v_lshlrev_b32 v205, 3, v47
  v_lshl_add_u32 v5, v207, 8, v205
  v_lshl_add_u32 v205, v33, 2, v205
  v_and_b32 v206, 1, v207
  v_lshl_or_b32 v4, v206, 31, v205
  s_mul_i32 s53, s42, 196608
  s_mul_i32 s0, s40, 24576
  s_add_u32 s53, s53, s0
  s_add_u32 s53, s53, 18874368
  s_lshl_b32 s55, s2, 8
  s_add_u32 s55, s55, 16384
  v_add_u32 v45, 150016, v1
  s_lshl_b32 s0, s40, 2
  s_add_u32 s0, s0, 150016
  v_min_u32 v205, 47, v0
  v_lshl_add_u32 v44, v205, 6, s0
  v_mov_b32 v206, 163712
  v_cmp_gt_u32 vcc, 48, v0
  s_nop 1
  v_cndmask_b32 v44, v206, v44, vcc
  v_cndmask_b32 v46, v204, v1, vcc
  v_add_u32 v206, 9856, v46
  v_cmp_gt_u32 vcc, 24, v0
  s_nop 1
  v_cndmask_b32 v46, v206, v46, vcc
  v_and_b32 v205, 7, v0
  v_bfe_u32 v206, v0, 3, 1
  v_lshlrev_b32 v206, 10, v206
  v_lshl_add_u32 v206, v205, 7, v206
  v_add_u32 v206, s52, v206
  v_add_u32 v31, 0, v207
  v_xor_b32 v31, v31, v205
  v_lshl_add_u32 v31, v31, 4, v206
  v_add_u32 v32, 4, v207
  v_xor_b32 v32, v32, v205
  v_lshl_add_u32 v32, v32, 4, v206
  s_and_b32 s0, s2, 15
  s_lshl_b32 s0, s0, 3
  s_add_u32 s0, s0, s41
  s_lshl_b32 s101, s0, 7
  s_mul_i32 s62, s41, 393216
  s_mul_i32 s0, s40, 98304
  s_add_u32 s62, s62, s0
  s_mov_b32 s0, 0
  s_lshl_b32 s8, s0, 7
  s_mul_i32 s0, s0, 12288
  s_add_u32 s19, s0, s62
  s_mov_b32 s0, 1
  s_lshl_b32 s9, s0, 7
  s_mul_i32 s0, s0, 12288
  s_add_u32 s20, s0, s62
  s_mov_b32 s0, 2
  s_lshl_b32 s10, s0, 7
  s_mul_i32 s0, s0, 12288
  s_add_u32 s21, s0, s62
  s_mov_b32 s0, 3
  s_lshl_b32 s11, s0, 7
  s_mul_i32 s0, s0, 12288
  s_add_u32 s22, s0, s62
  s_xor_b32 s0, s2, 0
  s_lshl_b32 s0, s0, 16
  s_lshl_b32 s1, s40, 10
  s_add_u32 s58, s0, s1
  s_xor_b32 s0, s2, 1
  s_lshl_b32 s0, s0, 16
  s_lshl_b32 s1, s40, 10
  s_add_u32 s59, s0, s1
  s_xor_b32 s0, s2, 2
  s_lshl_b32 s0, s0, 16
  s_lshl_b32 s1, s40, 10
  s_add_u32 s60, s0, s1
  s_xor_b32 s0, s2, 3
  s_lshl_b32 s0, s0, 16
  s_lshl_b32 s1, s40, 10
  s_add_u32 s61, s0, s1
  s_lshr_b32 s0, s41, 1
  s_mul_i32 s0, s0, 5120
  s_add_u32 s0, s0, s53
  s_and_b32 s1, s41, 1
  s_lshl_b32 s3, s1, 3
  s_add_u32 s3, s3, s0
  s_add_u32 s13, s3, 4096
  s_lshl_b32 s1, s1, 11
  s_add_u32 s12, s0, s1
  s_add_u32 s14, s12, 98304
  s_add_u32 s15, s13, 98304
  s_mul_i32 s16, s41, 3072
  s_add_u32 s16, s16, s53
  s_lshl_b32 s17, s41, 7
  s_add_u32 s17, s17, s53
  s_add_u32 s17, s17, 118784
  s_lshl_b32 s18, s41, 2
  s_add_u32 s18, s18, s55
  s_add_u32 s100, s101, L_ph_kv0-L_base
  buffer_load_dword v222, v13, s[96:99], s100 offen
  v_lshrrev_b32 v205, 3, v0
  v_lshlrev_b32 v205, 8, v205
  v_and_b32 v206, 7, v0
  v_lshl_add_u32 v42, v206, 5, v205
  v_bfe_u32 v206, v0, 2, 1
  v_lshl_add_u32 v205, v206, 4, v205
  v_and_b32 v206, 3, v0
  v_cmp_eq_u32 vcc, 0, v206
  s_nop 1
  v_cndmask_b32 v41, v204, v205, vcc
  v_lshlrev_b32 v205, 7, v0
  v_cmp_gt_u32 vcc, 24, v0
  s_nop 1
  v_cndmask_b32 v43, v204, v205, vcc
  s_mul_i32 s0, s41, 2432
  s_sub_u32 s0, 20480, s0
  v_writelane_b32 v43, s0, 24
  v_and_b32 v205, 3, v0
  v_lshlrev_b32 v205, 3, v205
  v_and_b32 v14, 7, v0
  v_lshlrev_b32 v14, 2, v14
  v_mul_u32_u24 v16, 384, v207
  v_lshl_add_u32 v16, v47, 3, v16
  v_add_u32 v16, 153088, v16
  v_lshl_add_u32 v17, v207, 5, v205
  v_add_u32 v17, 160768, v17
  v_and_b32 v205, 1, v207
  v_lshlrev_b32 v205, 10, v205
  v_lshrrev_b32 v206, 1, v207
  v_lshl_add_u32 v205, v206, 8, v205
  v_lshl_add_u32 v26, v47, 4, v205
  v_lshlrev_b32 v28, 4, v207
  v_add_u32 v28, 161408, v28
  v_mov_b32 v15, 0xff
  v_lshlrev_b32 v27, 2, v47
  v_add_u32 v27, 161408, v27
  v_and_b32 v205, 31, v0
  v_mad_u32_u24 v206, v33, 21, v205
  v_lshlrev_b32 v206, 4, v206
  v_cmp_gt_u32 vcc, 21, v205
  s_nop 1
  v_cndmask_b32 v34, v204, v206, vcc
  v_cmp_gt_u32 vcc, 21, v0
  s_nop 1
  v_cndmask_b32 v35, v204, v206, vcc
  v_mul_u32_u24 v38, 144, v47
  v_lshl_add_u32 v38, v207, 3, v38
  s_lshl_b32 s0, s40, 5
  v_add_u32 v38, s0, v38
  s_mul_i32 s0, s40, 20
  v_add_u32 v206, s0, v205
  v_mul_u32_u24 v39, 144, v206
  v_lshl_add_u32 v39, v33, 4, v39
  v_add_u32 v206, 80, v206
  v_mov_b32 v40, 160
  v_cmp_gt_u32 vcc, 20, v205
  s_nop 1
  v_cndmask_b32 v206, v40, v206, vcc
  v_mul_u32_u24 v40, 144, v206
  v_lshl_add_u32 v40, v33, 4, v40
  v_lshrrev_b32 v205, 2, v0
  v_mul_u32_u24 v36, 6784, v205
  v_and_b32 v206, 3, v0
  v_lshl_add_u32 v36, v206, 4, v36
  v_cmp_gt_u32 vcc, 4, v0
  s_nop 1
  v_cndmask_b32 v37, v204, v1, vcc
  s_mov_b32 s56, 0x0c0c0400
  s_mov_b32 s57, 0x04000c0c
  v_add_u32 v205, 0, v0
  v_mul_u32_u24 v206, 3121, v205
  v_lshrrev_b32 v206, 16, v206
  v_mul_u32_u24 v18, 21, v206
  v_sub_u32 v205, v205, v18
  s_mul_i32 s0, s40, 5
  v_add_u32 v206, s0, v206
  v_lshrrev_b32 v18, 2, v206
  v_lshlrev_b32 v18, 4, v18
  v_sub_u32 v18, v205, v18
  s_mul_i32 s0, s40, 20
  s_add_u32 s0, s0, 16
  v_add_u32 v18, s0, v18
  v_lshlrev_b32 v18, 3, v18
  v_mul_u32_u24 v223, 384, v206
  v_add_u32 v18, v18, v223
  v_add_u32 v18, 153088, v18
  s_lshl_b32 s0, s40, 3
  s_add_u32 s0, s0, 160768
  v_lshl_add_u32 v206, v206, 5, s0
  v_cmp_eq_u32 vcc, 20, v205
  s_nop 1
  v_cndmask_b32 v18, v18, v206, vcc
  v_add_u32 v205, 64, v0
  v_mul_u32_u24 v206, 3121, v205
  v_lshrrev_b32 v206, 16, v206
  v_mul_u32_u24 v19, 21, v206
  v_sub_u32 v205, v205, v19
  s_mul_i32 s0, s40, 5
  v_add_u32 v206, s0, v206
  v_lshrrev_b32 v19, 2, v206
  v_lshlrev_b32 v19, 4, v19
  v_sub_u32 v19, v205, v19
  s_mul_i32 s0, s40, 20
  s_add_u32 s0, s0, 16
  v_add_u32 v19, s0, v19
  v_lshlrev_b32 v19, 3, v19
  v_mul_u32_u24 v223, 384, v206
  v_add_u32 v19, v19, v223
  v_add_u32 v19, 153088, v19
  s_lshl_b32 s0, s40, 3
  s_add_u32 s0, s0, 160768
  v_lshl_add_u32 v206, v206, 5, s0
  v_cmp_eq_u32 vcc, 20, v205
  s_nop 1
  v_cndmask_b32 v19, v19, v206, vcc
  v_mov_b32 v206, 163712
  v_cmp_gt_u32 vcc, 41, v0
  s_nop 1
  v_cndmask_b32 v19, v206, v19, vcc
  s_mov_b32 s66, 0xffff0000
  s_mov_b32 s67, 0xffffffff
  s_mov_b32 s68, 0x0
  s_mov_b32 s69, 0xffffffff
  s_mov_b32 s70, 0x0
  s_mov_b32 s71, 0xffff0000
  s_mov_b32 s72, 0xffffffff
  s_mov_b32 s73, 0x1ff
  v_mov_b32 v208, 0
  v_mov_b32 v209, 0
  v_mov_b32 v210, 0
  v_mov_b32 v211, 0
  s_lshl_b32 s0, s40, 10
  s_add_u32 s0, s0, 153088
  v_add_u32 v205, s0, v1
  ds_write_b128 v205, v[208:211] offset:0
  ds_write_b128 v205, v[208:211] offset:4096
  v_lshrrev_b32 v205, 2, v1
  v_add_u32 v205, 161280, v205
  s_mov_b32 exec_hi, 0
  ds_write_b32 v205, v208
  s_mov_b64 exec, -1
  s_waitcnt vmcnt(0)
  s_getreg_b32 s93, hwreg(HW_REG_XCC_ID, 0, 4)
  v_readfirstlane_b32 s44, v25
  s_nop 0
  s_add_u32 s44, s44, 1
  s_lshr_b32 s45, s44, 8
  s_lshr_b32 s46, s44, 16
  s_lshr_b32 s47, s44, 24
  v_mov_b32 v25, s44
  s_cmp_ge_u32 s40, 2
  s_cbranch_scc1 L_skip5
  s_lshl_b32 s0, s81, 2
  s_add_u32 s0, s0, s89
  s_waitcnt vmcnt(0)
  buffer_store_dword v25, v13, s[4:7], s0 offen sc1
L_skip5:
  s_nop 0
  s_lshl_b32 s0, s2, 6
  s_lshl_b32 s1, s41, 3
  s_add_u32 s0, s0, s1
  s_add_u32 s0, s0, 4096
  v_mov_b32 v224, s44
  v_mov_b32 v225, s93
  buffer_store_dwordx2 v[224:225], v13, s[4:7], s0 offen sc1
  s_and_b32 s100, s2, 0x43
  s_cbranch_scc1 L_skip6
  v_lshrrev_b32 v236, 4, v0
  v_mul_u32_u24 v236, 1280, v236
  v_lshl_add_u32 v236, v47, 4, v236
  s_add_u32 s76, s42, 8
  s_mul_i32 s76, s76, 40960
  s_mul_i32 s100, s41, 160
  s_andn2_b32 s100, s100, 127
  s_add_u32 s76, s76, s100
  s_mov_b32 m0, 81920
  s_add_u32 s76, s76, 0
  buffer_load_dwordx4 v236, s[28:31], s76 offen  lds
  s_mov_b32 m0, 82944
  s_add_u32 s76, s76, 5120
  buffer_load_dwordx4 v236, s[28:31], s76 offen  lds
  s_mov_b32 m0, 83968
  s_add_u32 s76, s76, 5120
  buffer_load_dwordx4 v236, s[28:31], s76 offen  lds
  s_mov_b32 m0, 84992
  s_add_u32 s76, s76, 5120
  buffer_load_dwordx4 v236, s[28:31], s76 offen  lds
  s_mov_b32 m0, 86016
  s_add_u32 s76, s76, 5120
  buffer_load_dwordx4 v236, s[28:31], s76 offen  lds
  s_mov_b32 m0, 87040
  s_add_u32 s76, s76, 5120
  buffer_load_dwordx4 v236, s[28:31], s76 offen  lds
  s_mov_b32 m0, 88064
  s_add_u32 s76, s76, 5120
  buffer_load_dwordx4 v236, s[28:31], s76 offen  lds
  s_mov_b32 m0, 89088
  s_add_u32 s76, s76, 5120
  buffer_load_dwordx4 v236, s[28:31], s76 offen  lds
  s_add_u32 s81, s42, 128
  s_mul_i32 s77, s81, 6144
  s_add_u32 s77, s77, s54
  s_mov_b32 s78, 0x80000000
L_skip6:
  s_nop 0
  v_lshrrev_b32 v232, 4, v0
  v_and_b32 v226, 7, v0
  v_lshrrev_b32 v227, 1, v232
  v_xor_b32 v227, v227, v226
  v_lshlrev_b32 v227, 4, v227
  v_lshl_add_u32 v227, v226, 7, v227
  v_bfe_u32 v226, v0, 3, 1
  v_lshl_add_u32 v227, v226, 10, v227
  v_lshlrev_b32 v226, 4, v226
  v_xor_b32 v227, v227, v226
  v_and_b32 v226, 1, v232
  v_lshl_add_u32 v227, v226, 3, v227
  s_mul_i32 s0, s40, 20480
  v_add_u32 v228, s0, v227
  v_xor_b32 v229, 32, v228
  v_xor_b32 v230, 64, v228
  v_xor_b32 v231, 96, v228
  s_mul_i32 s0, s41, 5
  s_add_u32 s0, s0, 0
  s_and_b32 s1, s0, 3
  s_lshl_b32 s1, s1, 5
  s_lshr_b32 s0, s0, 2
  s_lshl_b32 s0, s0, 11
  v_xor_b32 v50, s1, v228
  v_add_u32 v50, s0, v50
  s_mul_i32 s0, s41, 5
  s_add_u32 s0, s0, 1
  s_and_b32 s1, s0, 3
  s_lshl_b32 s1, s1, 5
  s_lshr_b32 s0, s0, 2
  s_lshl_b32 s0, s0, 11
  v_xor_b32 v54, s1, v228
  v_add_u32 v54, s0, v54
  s_mul_i32 s0, s41, 5
  s_add_u32 s0, s0, 2
  s_and_b32 s1, s0, 3
  s_lshl_b32 s1, s1, 5
  s_lshr_b32 s0, s0, 2
  s_lshl_b32 s0, s0, 11
  v_xor_b32 v58, s1, v228
  v_add_u32 v58, s0, v58
  s_mul_i32 s0, s41, 5
  s_add_u32 s0, s0, 3
  s_and_b32 s1, s0, 3
  s_lshl_b32 s1, s1, 5
  s_lshr_b32 s0, s0, 2
  s_lshl_b32 s0, s0, 11
  v_xor_b32 v62, s1, v228
  v_add_u32 v62, s0, v62
  s_mul_i32 s0, s41, 5
  s_add_u32 s0, s0, 4
  s_and_b32 s1, s0, 3
  s_lshl_b32 s1, s1, 5
  s_lshr_b32 s0, s0, 2
  s_lshl_b32 s0, s0, 11
  v_xor_b32 v66, s1, v228
  v_add_u32 v66, s0, v66
  s_barrier
  ds_read_b64 v[68:69], v228 offset:0
  ds_read_b64 v[70:71], v229 offset:0
  ds_read_b64 v[72:73], v230 offset:0
  ds_read_b64 v[74:75], v231 offset:0
  ds_read_b64 v[76:77], v229 offset:2048
  ds_read_b64 v[78:79], v230 offset:2048
  ds_read_b64 v[80:81], v231 offset:2048
  ds_read_b64 v[82:83], v228 offset:4096
  ds_read_b64 v[84:85], v228 offset:2048
  ds_read_b64 v[86:87], v229 offset:4096
  ds_read_b64 v[88:89], v230 offset:4096
  ds_read_b64 v[90:91], v231 offset:4096
  ds_read_b64 v[92:93], v228 offset:6144
  ds_read_b64 v[94:95], v229 offset:6144
  ds_read_b64 v[96:97], v231 offset:6144
  ds_read_b64 v[98:99], v228 offset:8192
  ds_read_b64 v[100:101], v229 offset:8192
  ds_read_b64 v[102:103], v230 offset:8192
  ds_read_b64 v[104:105], v230 offset:6144
  ds_read_b64 v[106:107], v231 offset:8192
  ds_read_b64 v[108:109], v228 offset:10240
  ds_read_b64 v[110:111], v229 offset:10240
  ds_read_b64 v[112:113], v230 offset:10240
  ds_read_b64 v[114:115], v231 offset:10240
  ds_read_b64 v[116:117], v229 offset:12288
  ds_read_b64 v[118:119], v230 offset:12288
  ds_read_b64 v[120:121], v231 offset:12288
  ds_read_b64 v[122:123], v228 offset:14336
  ds_read_b64 v[124:125], v228 offset:12288
  ds_read_b64 v[126:127], v229 offset:14336
  ds_read_b64 v[128:129], v230 offset:14336
  ds_read_b64 v[130:131], v231 offset:14336
  ds_read_b64 v[132:133], v228 offset:16384
  ds_read_b64 v[134:135], v229 offset:16384
  ds_read_b64 v[136:137], v231 offset:16384
  ds_read_b64 v[138:139], v228 offset:18432
  ds_read_b64 v[140:141], v229 offset:18432
  ds_read_b64 v[142:143], v230 offset:18432
  ds_read_b64 v[144:145], v230 offset:16384
  ds_read_b64 v[146:147], v231 offset:18432
  ds_read_b64 v[50:51], v50
  ds_read_b64 v[54:55], v54
  ds_read_b64 v[58:59], v58
  ds_read_b64 v[62:63], v62
  ds_read_b64 v[66:67], v66
  s_and_b32 s100, s2, 0x43
  s_cbranch_scc1 L_skip7
  s_waitcnt vmcnt(0)
  ds_read_b64_tr_b16 a[184:185], v7 offset:0
  ds_read_b64_tr_b16 a[186:187], v7 offset:4096
  ds_read_b64_tr_b16 a[188:189], v7 offset:32
  ds_read_b64_tr_b16 a[190:191], v7 offset:4128
  ds_read_b64_tr_b16 a[192:193], v7 offset:64
  ds_read_b64_tr_b16 a[194:195], v7 offset:4160
  ds_read_b64_tr_b16 a[196:197], v7 offset:96
  ds_read_b64_tr_b16 a[198:199], v7 offset:4192
  ds_read_b64_tr_b16 a[200:201], v7 offset:128
  ds_read_b64_tr_b16 a[202:203], v7 offset:4224
  s_waitcnt lgkmcnt(0)
L_skip7:
  s_nop 0
  s_waitcnt lgkmcnt(0)
  s_barrier
L_ph_kv0:
  v_lshlrev_b32 v234, 2, v0
  s_add_u32 s100, s101, L_ph_q0-L_base
  buffer_load_dword v222, v13, s[96:99], s100 offen
  v_mfma_f32_16x16x32_bf16 v[148:151], v[20:23], v[68:71], 0
  v_mfma_f32_16x16x32_bf16 v[152:155], v[68:71], v[68:71], 0
  v_mfma_f32_16x16x32_bf16 v[148:151], v[20:23], v[72:75], v[148:151]
  v_mfma_f32_16x16x32_bf16 v[152:155], v[72:75], v[72:75], v[152:155]
  v_mfma_f32_16x16x32_bf16 v[148:151], v[20:23], v[76:79], v[148:151]
  v_mfma_f32_16x16x32_bf16 v[152:155], v[76:79], v[76:79], v[152:155]
  v_mfma_f32_16x16x32_bf16 v[148:151], v[20:23], v[80:83], v[148:151]
  v_mfma_f32_16x16x32_bf16 v[152:155], v[80:83], v[80:83], v[152:155]
  v_mfma_f32_16x16x32_bf16 v[148:151], v[20:23], v[84:87], v[148:151]
  v_mfma_f32_16x16x32_bf16 v[152:155], v[84:87], v[84:87], v[152:155]
  v_mfma_f32_16x16x32_bf16 v[148:151], v[20:23], v[88:91], v[148:151]
  v_mfma_f32_16x16x32_bf16 v[152:155], v[88:91], v[88:91], v[152:155]
  v_mfma_f32_16x16x32_bf16 v[148:151], v[20:23], v[92:95], v[148:151]
  v_mfma_f32_16x16x32_bf16 v[152:155], v[92:95], v[92:95], v[152:155]
  v_mfma_f32_16x16x32_bf16 v[148:151], v[20:23], v[96:99], v[148:151]
  v_mfma_f32_16x16x32_bf16 v[152:155], v[96:99], v[96:99], v[152:155]
  v_mfma_f32_16x16x32_bf16 v[148:151], v[20:23], v[100:103], v[148:151]
  v_mfma_f32_16x16x32_bf16 v[152:155], v[100:103], v[100:103], v[152:155]
  v_mfma_f32_16x16x32_bf16 v[148:151], v[20:23], v[104:107], v[148:151]
  v_mfma_f32_16x16x32_bf16 v[152:155], v[104:107], v[104:107], v[152:155]
  v_mfma_f32_16x16x32_bf16 v[148:151], v[20:23], v[108:111], v[148:151]
  v_mfma_f32_16x16x32_bf16 v[152:155], v[108:111], v[108:111], v[152:155]
  v_mfma_f32_16x16x32_bf16 v[148:151], v[20:23], v[112:115], v[148:151]
  v_mfma_f32_16x16x32_bf16 v[152:155], v[112:115], v[112:115], v[152:155]
  v_mfma_f32_16x16x32_bf16 v[148:151], v[20:23], v[116:119], v[148:151]
  v_mfma_f32_16x16x32_bf16 v[152:155], v[116:119], v[116:119], v[152:155]
  v_mfma_f32_16x16x32_bf16 v[148:151], v[20:23], v[120:123], v[148:151]
  v_mfma_f32_16x16x32_bf16 v[152:155], v[120:123], v[120:123], v[152:155]
  v_mfma_f32_16x16x32_bf16 v[148:151], v[20:23], v[124:127], v[148:151]
  v_mfma_f32_16x16x32_bf16 v[152:155], v[124:127], v[124:127], v[152:155]
  v_mfma_f32_16x16x32_bf16 v[148:151], v[20:23], v[128:131], v[148:151]
  v_mfma_f32_16x16x32_bf16 v[152:155], v[128:131], v[128:131], v[152:155]
  v_mfma_f32_16x16x32_bf16 v[148:151], v[20:23], v[132:135], v[148:151]
  v_mfma_f32_16x16x32_bf16 v[152:155], v[132:135], v[132:135], v[152:155]
  v_mfma_f32_16x16x32_bf16 v[148:151], v[20:23], v[136:139], v[148:151]
  v_mfma_f32_16x16x32_bf16 v[152:155], v[136:139], v[136:139], v[152:155]
  v_mfma_f32_16x16x32_bf16 v[148:151], v[20:23], v[140:143], v[148:151]
  v_mfma_f32_16x16x32_bf16 v[152:155], v[140:143], v[140:143], v[152:155]
  v_mfma_f32_16x16x32_bf16 v[148:151], v[20:23], v[144:147], v[148:151]
  v_mfma_f32_16x16x32_bf16 v[152:155], v[144:147], v[144:147], v[152:155]
  v_lshlrev_b32 v48, 16, v50
  v_and_b32 v49, 0xffff0000, v50
  v_lshlrev_b32 v50, 16, v51
  v_and_b32 v51, 0xffff0000, v51
  v_lshlrev_b32 v52, 16, v54
  v_and_b32 v53, 0xffff0000, v54
  v_lshlrev_b32 v54, 16, v55
  v_and_b32 v55, 0xffff0000, v55
  v_lshlrev_b32 v56, 16, v58
  v_and_b32 v57, 0xffff0000, v58
  v_lshlrev_b32 v58, 16, v59
  v_and_b32 v59, 0xffff0000, v59
  v_lshlrev_b32 v60, 16, v62
  v_and_b32 v61, 0xffff0000, v62
  v_lshlrev_b32 v62, 16, v63
  v_and_b32 v63, 0xffff0000, v63
  v_lshlrev_b32 v64, 16, v66
  v_and_b32 v65, 0xffff0000, v66
  v_lshlrev_b32 v66, 16, v67
  v_and_b32 v67, 0xffff0000, v67
  buffer_load_dword v235, v234, s[4:7], s89 offen sc1
  v_lshlrev_b32 v24, 16, v24
  v_lshrrev_b32 v160, 2, v6
  v_sub_u32 v160, v47, v160
  v_mul_f32 v158, 0x3e800000, v148
  v_mov_b32 v159, 0
  v_cmp_eq_u32 vcc, 0, v160
  s_nop 1
  v_cndmask_b32 v159, v159, v152, vcc
  v_cmp_eq_u32 vcc, 1, v160
  s_nop 1
  v_cndmask_b32 v159, v159, v153, vcc
  v_cmp_eq_u32 vcc, 2, v160
  s_nop 1
  v_cndmask_b32 v159, v159, v154, vcc
  v_cmp_eq_u32 vcc, 3, v160
  s_nop 1
  v_cndmask_b32 v159, v159, v155, vcc
  v_mov_b32 v160, v158
  v_mov_b32 v161, v159
  s_nop 0
  v_permlane32_swap_b32 v158, v160
  v_permlane32_swap_b32 v159, v161
  v_pk_add_f32 v[158:159], v[158:159], v[160:161]
  v_mov_b32 v160, v158
  v_mov_b32 v161, v159
  s_nop 0
  v_permlane16_swap_b32 v158, v160
  v_permlane16_swap_b32 v159, v161
  v_pk_add_f32 v[158:159], v[158:159], v[160:161]
  v_mul_f32 v158, 0xbacccccd, v158
  v_mul_f32 v159, 0x3acccccd, v159
  v_fma_f32 v159, -v158, v158, v159
  v_max_f32 v159, 0, v159
  v_add_f32 v159, 0x3727c5ac, v159
  v_rsq_f32 v156, v159
  s_nop 0
  v_mul_f32 v157, v158, v156
  ds_bpermute_b32 v148, v6, v156 offset:0
  ds_bpermute_b32 v152, v6, v157 offset:0
  ds_bpermute_b32 v149, v6, v156 offset:4
  ds_bpermute_b32 v153, v6, v157 offset:4
  ds_bpermute_b32 v150, v6, v156 offset:8
  ds_bpermute_b32 v154, v6, v157 offset:8
  ds_bpermute_b32 v151, v6, v156 offset:12
  ds_bpermute_b32 v155, v6, v157 offset:12
  s_waitcnt vmcnt(0)
  v_cmp_ne_u32 vcc, s44, v235
  s_nop 0
  s_cbranch_vccnz L_spin8
L_back9:
  s_add_u32 s82, s74, 0
  s_add_u32 m0, s43, 0
  s_nop 0
  buffer_load_dwordx4 v1, s[4:7], s82 offen offset:0 lds
  buffer_load_dwordx4 v1, s[4:7], s82 offen offset:1024 lds
  buffer_load_dwordx4 v1, s[4:7], s82 offen offset:2048 lds
  buffer_load_dwordx4 v1, s[4:7], s82 offen offset:3072 lds
  s_add_u32 s82, s82, 4096
  s_add_u32 m0, m0, 4096
  s_nop 0
  buffer_load_dwordx4 v1, s[4:7], s82 offen offset:0 lds
  s_mul_i32 s0, s41, 144
  s_mul_i32 s1, s40, 5
  s_add_u32 s0, s0, s1
  s_lshl_b32 s0, s0, 9
  s_add_u32 s0, s0, 25165824
  buffer_load_dwordx4 a[232:235], v46, s[4:7], s0 offen offset:0
  buffer_load_dwordx4 a[236:239], v46, s[4:7], s0 offen offset:512
  buffer_load_dwordx4 a[240:243], v46, s[4:7], s0 offen offset:1024
  buffer_load_dwordx4 a[244:247], v46, s[4:7], s0 offen offset:1536
  buffer_load_dwordx4 a[248:251], v46, s[4:7], s0 offen offset:2048
  s_mul_i32 s0, s41, 144
  s_mul_i32 s1, s40, 5
  s_add_u32 s0, s0, s1
  s_lshl_b32 s0, s0, 9
  s_add_u32 s0, s0, 25186304
  buffer_load_dwordx4 a[208:211], v46, s[4:7], s0 offen offset:0
  buffer_load_dwordx4 a[212:215], v46, s[4:7], s0 offen offset:512
  buffer_load_dwordx4 a[216:219], v46, s[4:7], s0 offen offset:1024
  buffer_load_dwordx4 a[220:223], v46, s[4:7], s0 offen offset:1536
  buffer_load_dwordx4 a[224:227], v46, s[4:7], s0 offen offset:2048
  s_waitcnt vmcnt(9)
  v_accvgpr_read_b32 v212, a232
  s_add_u32 s82, s74, 12288
  s_add_u32 m0, s43, 20480
  s_nop 0
  buffer_load_dwordx4 v1, s[4:7], s82 offen offset:0 lds
  v_accvgpr_read_b32 v213, a233
  v_accvgpr_read_b32 v214, a234
  v_accvgpr_read_b32 v215, a235
  s_waitcnt vmcnt(9)
  v_accvgpr_read_b32 v216, a236
  buffer_load_dwordx4 v1, s[4:7], s82 offen offset:1024 lds
  v_add_f32 v212, v212, v216
  v_accvgpr_read_b32 v216, a237
  v_add_f32 v213, v213, v216
  v_accvgpr_read_b32 v216, a238
  v_add_f32 v214, v214, v216
  buffer_load_dwordx4 v1, s[4:7], s82 offen offset:2048 lds
  v_accvgpr_read_b32 v216, a239
  v_add_f32 v215, v215, v216
  s_waitcnt vmcnt(10)
  v_accvgpr_read_b32 v216, a240
  v_add_f32 v212, v212, v216
  buffer_load_dwordx4 v1, s[4:7], s82 offen offset:3072 lds
  v_accvgpr_read_b32 v216, a241
  v_add_f32 v213, v213, v216
  v_accvgpr_read_b32 v216, a242
  v_add_f32 v214, v214, v216
  v_accvgpr_read_b32 v216, a243
  s_add_u32 s82, s82, 4096
  s_add_u32 m0, m0, 4096
  s_nop 0
  buffer_load_dwordx4 v1, s[4:7], s82 offen offset:0 lds
  v_add_f32 v215, v215, v216
  s_waitcnt vmcnt(11)
  v_accvgpr_read_b32 v216, a244
  v_add_f32 v212, v212, v216
  v_accvgpr_read_b32 v216, a245
  s_add_u32 s82, s74, 24576
  s_add_u32 m0, s43, 40960
  s_nop 0
  buffer_load_dwordx4 v1, s[4:7], s82 offen offset:0 lds
  v_add_f32 v213, v213, v216
  v_accvgpr_read_b32 v216, a246
  v_add_f32 v214, v214, v216
  v_accvgpr_read_b32 v216, a247
  v_add_f32 v215, v215, v216
  buffer_load_dwordx4 v1, s[4:7], s82 offen offset:1024 lds
  s_waitcnt vmcnt(12)
  v_accvgpr_read_b32 v216, a248
  v_add_f32 v212, v212, v216
  v_accvgpr_read_b32 v216, a249
  v_add_f32 v213, v213, v216
  buffer_load_dwordx4 v1, s[4:7], s82 offen offset:2048 lds
  v_accvgpr_read_b32 v216, a250
  v_add_f32 v214, v214, v216
  v_accvgpr_read_b32 v216, a251
  v_add_f32 v215, v215, v216
  ds_write_b32 v44, v212 offset:0
  ds_write_b32 v44, v213 offset:16
  ds_write_b32 v44, v214 offset:32
  ds_write_b32 v44, v215 offset:48
  s_waitcnt lgkmcnt(0)
  s_barrier
  ds_read_b128 v[224:227], v1 offset:0
  ds_read_b128 v[228:231], v1 offset:1024
  ds_read_b128 v[232:235], v1 offset:2048
  ds_read_b128 v[236:239], v1 offset:3072
  ds_read_b128 v[240:243], v1 offset:4096
  ds_read_b128 v[244:247], v1 offset:10240
  ds_read_b128 v[248:251], v1 offset:11264
  ds_read_b128 v[252:255], v1 offset:12288
  s_waitcnt lgkmcnt(6)
  v_mfma_f32_16x16x32_bf16 v[164:167], v[68:71], v[224:227], 0
  ds_read_b128 v[224:227], v1 offset:13312
  buffer_load_dwordx4 v1, s[4:7], s82 offen offset:3072 lds
  v_mfma_f32_16x16x32_bf16 v[168:171], v[68:71], v[228:231], 0
  ds_read_b128 v[228:231], v1 offset:14336
  v_lshrrev_b32 v216, 2, v1
  s_waitcnt lgkmcnt(6)
  v_mfma_f32_16x16x32_bf16 v[172:175], v[68:71], v[232:235], 0
  s_add_u32 s82, s82, 4096
  s_add_u32 m0, m0, 4096
  ds_read_b128 v[232:235], v1 offset:5120
  buffer_load_dwordx4 v1, s[4:7], s82 offen offset:0 lds
  v_mfma_f32_16x16x32_bf16 v[176:179], v[68:71], v[236:239], 0
  ds_read_b128 v[236:239], v1 offset:6144
  v_add_u32 v216, 161408, v216
  s_waitcnt lgkmcnt(6)
  v_mfma_f32_16x16x32_bf16 v[180:183], v[68:71], v[240:243], 0
  s_add_u32 s82, s74, 36864
  s_add_u32 m0, s43, 61440
  ds_read_b128 v[240:243], v1 offset:7168
  buffer_load_dwordx4 v1, s[4:7], s82 offen offset:0 lds
  v_mfma_f32_16x16x32_bf16 v[184:187], v[68:71], v[244:247], 0
  ds_read_b128 v[244:247], v1 offset:8192
  ds_read_b128 v[212:215], v45 offset:0
  s_waitcnt lgkmcnt(7)
  v_mfma_f32_16x16x32_bf16 v[188:191], v[68:71], v[248:251], 0
  ds_read_b128 v[248:251], v1 offset:9216
  buffer_load_dwordx4 v1, s[4:7], s82 offen offset:1024 lds
  v_mfma_f32_16x16x32_bf16 v[192:195], v[68:71], v[252:255], 0
  ds_read_b128 v[252:255], v1 offset:15360
  s_waitcnt lgkmcnt(2)
  v_pk_add_f32 v[212:213], v[212:213], v[214:215]
  v_mfma_f32_16x16x32_bf16 v[196:199], v[68:71], v[224:227], 0
  ds_read_b128 v[224:227], v1 offset:16384
  s_waitcnt vmcnt(7)
  s_barrier
  v_mfma_f32_16x16x32_bf16 v[200:203], v[68:71], v[228:231], 0
  ds_read_b128 v[228:231], v1 offset:17408
  buffer_load_dwordx4 v1, s[4:7], s82 offen offset:2048 lds
  v_mfma_f32_16x16x32_bf16 v[164:167], v[72:75], v[232:235], v[164:167]
  ds_read_b128 v[232:235], v1 offset:18432
  v_add_f32 v212, v212, v213
  v_mfma_f32_16x16x32_bf16 v[168:171], v[72:75], v[236:239], v[168:171]
  ds_read_b128 v[236:239], v1 offset:19456
  buffer_load_dwordx4 v1, s[4:7], s82 offen offset:3072 lds
  v_mfma_f32_16x16x32_bf16 v[172:175], v[72:75], v[240:243], v[172:175]
  ds_read_b128 v[240:243], v1 offset:20480
  ds_write_b32 v216, v212 offset:0
  v_mfma_f32_16x16x32_bf16 v[176:179], v[72:75], v[244:247], v[176:179]
  s_add_u32 s82, s82, 4096
  s_add_u32 m0, m0, 4096
  ds_read_b128 v[244:247], v1 offset:21504
  buffer_load_dwordx4 v1, s[4:7], s82 offen offset:0 lds
  s_waitcnt lgkmcnt(7)
  v_mfma_f32_16x16x32_bf16 v[180:183], v[72:75], v[248:251], v[180:183]
  ds_read_b128 v[248:251], v1 offset:22528
  ds_read_b128 v[212:215], v45 offset:1024
  v_mfma_f32_16x16x32_bf16 v[184:187], v[72:75], v[252:255], v[184:187]
  s_add_u32 s82, s74, 49152
  s_add_u32 m0, s43, 81920
  ds_read_b128 v[252:255], v1 offset:23552
  buffer_load_dwordx4 v1, s[4:7], s82 offen offset:0 lds
  s_waitcnt lgkmcnt(8)
  v_mfma_f32_16x16x32_bf16 v[188:191], v[72:75], v[224:227], v[188:191]
  ds_read_b128 v[224:227], v1 offset:24576
  s_waitcnt lgkmcnt(2)
  v_pk_add_f32 v[212:213], v[212:213], v[214:215]
  v_mfma_f32_16x16x32_bf16 v[192:195], v[72:75], v[228:231], v[192:195]
  ds_read_b128 v[228:231], v1 offset:30720
  buffer_load_dwordx4 v1, s[4:7], s82 offen offset:1024 lds
  v_mfma_f32_16x16x32_bf16 v[196:199], v[72:75], v[232:235], v[196:199]
  ds_read_b128 v[232:235], v1 offset:31744
  v_add_f32 v212, v212, v213
  v_mfma_f32_16x16x32_bf16 v[200:203], v[72:75], v[236:239], v[200:203]
  ds_read_b128 v[236:239], v1 offset:32768
  buffer_load_dwordx4 v1, s[4:7], s82 offen offset:2048 lds
  v_mfma_f32_16x16x32_bf16 v[164:167], v[76:79], v[240:243], v[164:167]
  ds_read_b128 v[240:243], v1 offset:33792
  ds_write_b32 v216, v212 offset:256
  v_mfma_f32_16x16x32_bf16 v[168:171], v[76:79], v[244:247], v[168:171]
  ds_read_b128 v[244:247], v1 offset:34816
  buffer_load_dwordx4 v1, s[4:7], s82 offen offset:3072 lds
  s_waitcnt lgkmcnt(7)
  v_mfma_f32_16x16x32_bf16 v[172:175], v[76:79], v[248:251], v[172:175]
  ds_read_b128 v[248:251], v1 offset:25600
  ds_read_b128 v[212:215], v45 offset:2048
  v_mfma_f32_16x16x32_bf16 v[176:179], v[76:79], v[252:255], v[176:179]
  s_add_u32 s82, s82, 4096
  s_add_u32 m0, m0, 4096
  ds_read_b128 v[252:255], v1 offset:26624
  buffer_load_dwordx4 v1, s[4:7], s82 offen offset:0 lds
  s_waitcnt lgkmcnt(8)
  v_mfma_f32_16x16x32_bf16 v[180:183], v[76:79], v[224:227], v[180:183]
  ds_read_b128 v[224:227], v1 offset:27648
  s_waitcnt lgkmcnt(2)
  v_pk_add_f32 v[212:213], v[212:213], v[214:215]
  v_mfma_f32_16x16x32_bf16 v[184:187], v[76:79], v[228:231], v[184:187]
  ds_read_b128 v[228:231], v1 offset:28672
  v_add_f32 v212, v212, v213
  v_mfma_f32_16x16x32_bf16 v[188:191], v[76:79], v[232:235], v[188:191]
  ds_read_b128 v[232:235], v1 offset:29696
  ds_write_b32 v216, v212 offset:512
  v_mfma_f32_16x16x32_bf16 v[192:195], v[76:79], v[236:239], v[192:195]
  ds_read_b128 v[236:239], v1 offset:35840
  v_mfma_f32_16x16x32_bf16 v[196:199], v[76:79], v[240:243], v[196:199]
  ds_read_b128 v[240:243], v1 offset:36864
  s_waitcnt vmcnt(10) lgkmcnt(0)
  s_barrier
  v_mfma_f32_16x16x32_bf16 v[200:203], v[76:79], v[244:247], v[200:203]
  s_add_u32 s82, s74, 61440
  s_add_u32 m0, s43, 102400
  ds_read_b128 v[244:247], v1 offset:37888
  buffer_load_dwordx4 v1, s[4:7], s82 offen offset:0 lds
  v_mfma_f32_16x16x32_bf16 v[164:167], v[80:83], v[248:251], v[164:167]
  ds_read_b128 v[248:251], v1 offset:38912
  v_accvgpr_read_b32 v212, a208
  v_mfma_f32_16x16x32_bf16 v[168:171], v[80:83], v[252:255], v[168:171]
  ds_read_b128 v[252:255], v1 offset:39936
  v_accvgpr_read_b32 v213, a209
  v_mfma_f32_16x16x32_bf16 v[172:175], v[80:83], v[224:227], v[172:175]
  ds_read_b128 v[224:227], v1 offset:40960
  buffer_load_dwordx4 v1, s[4:7], s82 offen offset:1024 lds
  v_mfma_f32_16x16x32_bf16 v[176:179], v[80:83], v[228:231], v[176:179]
  ds_read_b128 v[228:231], v1 offset:41984
  v_accvgpr_read_b32 v214, a210
  v_mfma_f32_16x16x32_bf16 v[180:183], v[80:83], v[232:235], v[180:183]
  ds_read_b128 v[232:235], v1 offset:43008
  v_accvgpr_read_b32 v215, a211
  v_mfma_f32_16x16x32_bf16 v[184:187], v[80:83], v[236:239], v[184:187]
  ds_read_b128 v[236:239], v1 offset:44032
  buffer_load_dwordx4 v1, s[4:7], s82 offen offset:2048 lds
  s_waitcnt lgkmcnt(6)
  v_mfma_f32_16x16x32_bf16 v[188:191], v[80:83], v[240:243], v[188:191]
  ds_read_b128 v[240:243], v1 offset:45056
  v_accvgpr_read_b32 v216, a212
  v_mfma_f32_16x16x32_bf16 v[192:195], v[80:83], v[244:247], v[192:195]
  ds_read_b128 v[244:247], v1 offset:51200
  v_add_f32 v212, v212, v216
  s_waitcnt lgkmcnt(6)
  v_mfma_f32_16x16x32_bf16 v[196:199], v[80:83], v[248:251], v[196:199]
  ds_read_b128 v[248:251], v1 offset:52224
  buffer_load_dwordx4 v1, s[4:7], s82 offen offset:3072 lds
  v_mfma_f32_16x16x32_bf16 v[200:203], v[80:83], v[252:255], v[200:203]
  ds_read_b128 v[252:255], v1 offset:53248
  v_accvgpr_read_b32 v216, a213
  s_waitcnt lgkmcnt(6)
  v_mfma_f32_16x16x32_bf16 v[164:167], v[84:87], v[224:227], v[164:167]
  ds_read_b128 v[224:227], v1 offset:54272
  v_add_f32 v213, v213, v216
  v_mfma_f32_16x16x32_bf16 v[168:171], v[84:87], v[228:231], v[168:171]
  s_add_u32 s82, s82, 4096
  s_add_u32 m0, m0, 4096
  ds_read_b128 v[228:231], v1 offset:55296
  buffer_load_dwordx4 v1, s[4:7], s82 offen offset:0 lds
  s_waitcnt lgkmcnt(6)
  v_mfma_f32_16x16x32_bf16 v[172:175], v[84:87], v[232:235], v[172:175]
  ds_read_b128 v[232:235], v1 offset:46080
  v_accvgpr_read_b32 v216, a214
  v_mfma_f32_16x16x32_bf16 v[176:179], v[84:87], v[236:239], v[176:179]
  ds_read_b128 v[236:239], v1 offset:47104
  v_add_f32 v214, v214, v216
  s_waitcnt lgkmcnt(6)
  v_mfma_f32_16x16x32_bf16 v[180:183], v[84:87], v[240:243], v[180:183]
  s_add_u32 s82, s74, 73728
  s_add_u32 m0, s43, 122880
  ds_read_b128 v[240:243], v1 offset:48128
  buffer_load_dwordx4 v1, s[4:7], s82 offen offset:0 lds
  v_mfma_f32_16x16x32_bf16 v[184:187], v[84:87], v[244:247], v[184:187]
  ds_read_b128 v[244:247], v1 offset:49152
  v_accvgpr_read_b32 v216, a215
  s_waitcnt lgkmcnt(6)
  v_mfma_f32_16x16x32_bf16 v[188:191], v[84:87], v[248:251], v[188:191]
  ds_read_b128 v[248:251], v1 offset:50176
  v_add_f32 v215, v215, v216
  v_mfma_f32_16x16x32_bf16 v[192:195], v[84:87], v[252:255], v[192:195]
  ds_read_b128 v[252:255], v1 offset:56320
  buffer_load_dwordx4 v1, s[4:7], s82 offen offset:1024 lds
  s_waitcnt lgkmcnt(6)
  v_mfma_f32_16x16x32_bf16 v[196:199], v[84:87], v[224:227], v[196:199]
  ds_read_b128 v[224:227], v1 offset:57344
  s_waitcnt vmcnt(12)
  s_barrier
  v_mfma_f32_16x16x32_bf16 v[200:203], v[84:87], v[228:231], v[200:203]
  ds_read_b128 v[228:231], v1 offset:58368
  buffer_load_dwordx4 v1, s[4:7], s82 offen offset:2048 lds
  s_waitcnt lgkmcnt(6)
  v_mfma_f32_16x16x32_bf16 v[164:167], v[88:91], v[232:235], v[164:167]
  ds_read_b128 v[232:235], v1 offset:59392
  v_accvgpr_read_b32 v216, a216
  v_mfma_f32_16x16x32_bf16 v[168:171], v[88:91], v[236:239], v[168:171]
  ds_read_b128 v[236:239], v1 offset:60416
  buffer_load_dwordx4 v1, s[4:7], s82 offen offset:3072 lds
  s_waitcnt lgkmcnt(6)
  v_mfma_f32_16x16x32_bf16 v[172:175], v[88:91], v[240:243], v[172:175]
  ds_read_b128 v[240:243], v1 offset:61440
  v_add_f32 v212, v212, v216
  v_mfma_f32_16x16x32_bf16 v[176:179], v[88:91], v[244:247], v[176:179]
  ds_read_b128 v[244:247], v1 offset:62464
  v_accvgpr_read_b32 v216, a217
  s_waitcnt lgkmcnt(6)
  v_mfma_f32_16x16x32_bf16 v[180:183], v[88:91], v[248:251], v[180:183]
  s_add_u32 s82, s82, 4096
  s_add_u32 m0, m0, 4096
  ds_read_b128 v[248:251], v1 offset:63488
  buffer_load_dwordx4 v1, s[4:7], s82 offen offset:0 lds
  v_mfma_f32_16x16x32_bf16 v[184:187], v[88:91], v[252:255], v[184:187]
  ds_read_b128 v[252:255], v1 offset:64512
  v_add_f32 v213, v213, v216
  s_waitcnt lgkmcnt(6)
  v_mfma_f32_16x16x32_bf16 v[188:191], v[88:91], v[224:227], v[188:191]
  ds_read_b128 v[224:227], v2 offset:0
  v_accvgpr_read_b32 v216, a218
  v_mfma_f32_16x16x32_bf16 v[192:195], v[88:91], v[228:231], v[192:195]
  s_add_u32 s82, s74, 86016
  s_add_u32 m0, s43, 0
  ds_read_b128 v[228:231], v2 offset:6144
  buffer_load_dwordx4 v1, s[4:7], s82 offen offset:0 lds
  s_waitcnt lgkmcnt(6)
  v_mfma_f32_16x16x32_bf16 v[196:199], v[88:91], v[232:235], v[196:199]
  ds_read_b128 v[232:235], v2 offset:7168
  v_add_f32 v214, v214, v216
  v_mfma_f32_16x16x32_bf16 v[200:203], v[88:91], v[236:239], v[200:203]
  ds_read_b128 v[236:239], v2 offset:8192
  v_accvgpr_read_b32 v216, a219
  s_waitcnt lgkmcnt(6)
  v_mfma_f32_16x16x32_bf16 v[164:167], v[92:95], v[240:243], v[164:167]
  ds_read_b128 v[240:243], v2 offset:9216
  buffer_load_dwordx4 v1, s[4:7], s82 offen offset:1024 lds
  v_mfma_f32_16x16x32_bf16 v[168:171], v[92:95], v[244:247], v[168:171]
  ds_read_b128 v[244:247], v2 offset:10240
  v_add_f32 v215, v215, v216
  s_waitcnt lgkmcnt(6)
  v_mfma_f32_16x16x32_bf16 v[172:175], v[92:95], v[248:251], v[172:175]
  ds_read_b128 v[248:251], v2 offset:1024
  v_accvgpr_read_b32 v216, a220
  v_mfma_f32_16x16x32_bf16 v[176:179], v[92:95], v[252:255], v[176:179]
  ds_read_b128 v[252:255], v2 offset:2048
  v_add_f32 v212, v212, v216
  s_waitcnt lgkmcnt(6)
  v_mfma_f32_16x16x32_bf16 v[180:183], v[92:95], v[224:227], v[180:183]
  ds_read_b128 v[224:227], v2 offset:3072
  buffer_load_dwordx4 v1, s[4:7], s82 offen offset:2048 lds
  v_mfma_f32_16x16x32_bf16 v[184:187], v[92:95], v[228:231], v[184:187]
  ds_read_b128 v[228:231], v2 offset:4096
  v_accvgpr_read_b32 v216, a221
  s_waitcnt lgkmcnt(6)
  v_mfma_f32_16x16x32_bf16 v[188:191], v[92:95], v[232:235], v[188:191]
  ds_read_b128 v[232:235], v2 offset:5120
  v_add_f32 v213, v213, v216
  v_mfma_f32_16x16x32_bf16 v[192:195], v[92:95], v[236:239], v[192:195]
  ds_read_b128 v[236:239], v2 offset:11264
  v_accvgpr_read_b32 v216, a222
  s_waitcnt lgkmcnt(6)
  v_mfma_f32_16x16x32_bf16 v[196:199], v[92:95], v[240:243], v[196:199]
  ds_read_b128 v[240:243], v2 offset:12288
  s_waitcnt vmcnt(13)
  s_barrier
  buffer_load_dwordx4 v1, s[4:7], s82 offen offset:3072 lds
  s_add_u32 s82, s82, 4096
  s_add_u32 m0, m0, 4096
  s_nop 0
  buffer_load_dwordx4 v1, s[4:7], s82 offen offset:0 lds
  v_lshlrev_b32 v223, 7, v33
  buffer_load_dword v222, v223, s[4:7], s55 offen sc1
  v_lshrrev_b32 v9, 3, v0
  v_min_u32 v9, 1, v9
  v_lshlrev_b32 v9, 24, v9
  v_or_b32 v9, v9, v0
  v_lshlrev_b32 v9, 7, v9
  s_mul_i32 s100, s41, 3072
  s_add_u32 s100, s100, s53
  s_add_u32 s100, s100, 0
  buffer_load_dword v222, v9, s[4:7], s100 offen sc1
  s_mul_i32 s100, s41, 3072
  s_add_u32 s100, s100, s53
  s_add_u32 s100, s100, 1024
  buffer_load_dword v222, v9, s[4:7], s100 offen sc1
  s_mul_i32 s100, s41, 3072
  s_add_u32 s100, s100, s53
  s_add_u32 s100, s100, 2048
  buffer_load_dword v222, v9, s[4:7], s100 offen sc1
  v_mfma_f32_16x16x32_bf16 v[200:203], v[92:95], v[244:247], v[200:203]
  ds_read_b128 v[244:247], v2 offset:13312
  v_add_f32 v214, v214, v216
  s_waitcnt lgkmcnt(6)
  v_mfma_f32_16x16x32_bf16 v[164:167], v[96:99], v[248:251], v[164:167]
  ds_read_b128 v[248:251], v2 offset:14336
  v_accvgpr_read_b32 v216, a223
  v_mfma_f32_16x16x32_bf16 v[168:171], v[96:99], v[252:255], v[168:171]
  ds_read_b128 v[252:255], v2 offset:15360
  v_add_f32 v215, v215, v216
  s_waitcnt lgkmcnt(6)
  v_mfma_f32_16x16x32_bf16 v[172:175], v[96:99], v[224:227], v[172:175]
  ds_read_b128 v[224:227], v2 offset:16384
  v_accvgpr_read_b32 v216, a224
  v_mfma_f32_16x16x32_bf16 v[176:179], v[96:99], v[228:231], v[176:179]
  s_add_u32 s82, s74, 98304
  s_add_u32 m0, s43, 36864
  ds_read_b128 v[228:231], v2 offset:17408
  buffer_load_dwordx4 v1, s[4:7], s82 offen offset:0 lds
  s_waitcnt lgkmcnt(6)
  v_mfma_f32_16x16x32_bf16 v[180:183], v[96:99], v[232:235], v[180:183]
  ds_read_b128 v[232:235], v2 offset:18432
  v_add_f32 v212, v212, v216
  v_mfma_f32_16x16x32_bf16 v[184:187], v[96:99], v[236:239], v[184:187]
  ds_read_b128 v[236:239], v2 offset:19456
  v_accvgpr_read_b32 v216, a225
  s_waitcnt lgkmcnt(6)
  v_mfma_f32_16x16x32_bf16 v[188:191], v[96:99], v[240:243], v[188:191]
  ds_read_b128 v[240:243], v2 offset:20480
  v_add_f32 v213, v213, v216
  v_mfma_f32_16x16x32_bf16 v[192:195], v[96:99], v[244:247], v[192:195]
  ds_read_b128 v[244:247], v2 offset:26624
  buffer_load_dwordx4 v1, s[4:7], s82 offen offset:1024 lds
  s_waitcnt lgkmcnt(6)
  v_mfma_f32_16x16x32_bf16 v[196:199], v[96:99], v[248:251], v[196:199]
  ds_read_b128 v[248:251], v2 offset:27648
  v_accvgpr_read_b32 v216, a226
  v_mfma_f32_16x16x32_bf16 v[200:203], v[96:99], v[252:255], v[200:203]
  ds_read_b128 v[252:255], v2 offset:28672
  v_add_f32 v214, v214, v216
  s_waitcnt lgkmcnt(6)
  v_mfma_f32_16x16x32_bf16 v[164:167], v[100:103], v[224:227], v[164:167]
  ds_read_b128 v[224:227], v2 offset:29696
  v_accvgpr_read_b32 v216, a227
  v_mfma_f32_16x16x32_bf16 v[168:171], v[100:103], v[228:231], v[168:171]
  ds_read_b128 v[228:231], v2 offset:30720
  buffer_load_dwordx4 v1, s[4:7], s82 offen offset:2048 lds
  s_waitcnt lgkmcnt(6)
  v_mfma_f32_16x16x32_bf16 v[172:175], v[100:103], v[232:235], v[172:175]
  ds_read_b128 v[232:235], v2 offset:21504
  v_add_f32 v215, v215, v216
  v_mfma_f32_16x16x32_bf16 v[176:179], v[100:103], v[236:239], v[176:179]
  ds_read_b128 v[236:239], v2 offset:22528
  ds_write_b32 v44, v212 offset:0
  s_waitcnt lgkmcnt(7)
  v_mfma_f32_16x16x32_bf16 v[180:183], v[100:103], v[240:243], v[180:183]
  ds_read_b128 v[240:243], v2 offset:23552
  ds_write_b32 v44, v213 offset:16
  v_mfma_f32_16x16x32_bf16 v[184:187], v[100:103], v[244:247], v[184:187]
  ds_read_b128 v[244:247], v2 offset:24576
  buffer_load_dwordx4 v1, s[4:7], s82 offen offset:3072 lds
  s_waitcnt lgkmcnt(8)
  v_mfma_f32_16x16x32_bf16 v[188:191], v[100:103], v[248:251], v[188:191]
  ds_read_b128 v[248:251], v2 offset:25600
  ds_write_b32 v44, v214 offset:32
  v_mfma_f32_16x16x32_bf16 v[192:195], v[100:103], v[252:255], v[192:195]
  ds_read_b128 v[252:255], v2 offset:31744
  ds_write_b32 v44, v215 offset:48
  s_waitcnt lgkmcnt(10)
  v_mfma_f32_16x16x32_bf16 v[196:199], v[100:103], v[224:227], v[196:199]
  ds_read_b128 v[224:227], v2 offset:32768
  s_waitcnt vmcnt(18)
  s_barrier
  v_mfma_f32_16x16x32_bf16 v[200:203], v[100:103], v[228:231], v[200:203]
  s_add_u32 s82, s82, 4096
  s_add_u32 m0, m0, 4096
  ds_read_b128 v[228:231], v2 offset:33792
  buffer_load_dwordx4 v1, s[4:7], s82 offen offset:0 lds
  s_waitcnt lgkmcnt(10)
  v_mfma_f32_16x16x32_bf16 v[164:167], v[104:107], v[232:235], v[164:167]
  ds_read_b128 v[232:235], v2 offset:34816
  v_mfma_f32_16x16x32_bf16 v[168:171], v[104:107], v[236:239], v[168:171]
  s_add_u32 s82, s74, 110592
  s_add_u32 m0, s43, 57344
  ds_read_b128 v[236:239], v2 offset:35840
  buffer_load_dwordx4 v1, s[4:7], s82 offen offset:0 lds
  s_waitcnt lgkmcnt(8)
  v_mfma_f32_16x16x32_bf16 v[172:175], v[104:107], v[240:243], v[172:175]
  ds_read_b128 v[240:243], v2 offset:36864
  v_mfma_f32_16x16x32_bf16 v[176:179], v[104:107], v[244:247], v[176:179]
  ds_read_b128 v[244:247], v2 offset:37888
  s_waitcnt lgkmcnt(7)
  v_mfma_f32_16x16x32_bf16 v[180:183], v[104:107], v[248:251], v[180:183]
  ds_read_b128 v[248:251], v2 offset:38912
  buffer_load_dwordx4 v1, s[4:7], s82 offen offset:1024 lds
  v_mfma_f32_16x16x32_bf16 v[184:187], v[104:107], v[252:255], v[184:187]
  ds_read_b128 v[252:255], v2 offset:39936
  s_waitcnt lgkmcnt(6)
  v_mfma_f32_16x16x32_bf16 v[188:191], v[104:107], v[224:227], v[188:191]
  ds_read_b128 v[224:227], v2 offset:40960
  v_mfma_f32_16x16x32_bf16 v[192:195], v[104:107], v[228:231], v[192:195]
  ds_read_b128 v[228:231], v2 offset:47104
  s_waitcnt lgkmcnt(6)
  v_mfma_f32_16x16x32_bf16 v[196:199], v[104:107], v[232:235], v[196:199]
  ds_read_b128 v[232:235], v2 offset:48128
  buffer_load_dwordx4 v1, s[4:7], s82 offen offset:2048 lds
  v_mfma_f32_16x16x32_bf16 v[200:203], v[104:107], v[236:239], v[200:203]
  ds_read_b128 v[236:239], v2 offset:49152
  s_waitcnt lgkmcnt(6)
  v_mfma_f32_16x16x32_bf16 v[164:167], v[108:111], v[240:243], v[164:167]
  ds_read_b128 v[240:243], v2 offset:50176
  v_mfma_f32_16x16x32_bf16 v[168:171], v[108:111], v[244:247], v[168:171]
  ds_read_b128 v[244:247], v2 offset:51200
  s_waitcnt lgkmcnt(6)
  v_mfma_f32_16x16x32_bf16 v[172:175], v[108:111], v[248:251], v[172:175]
  ds_read_b128 v[248:251], v2 offset:41984
  buffer_load_dwordx4 v1, s[4:7], s82 offen offset:3072 lds
  v_mfma_f32_16x16x32_bf16 v[176:179], v[108:111], v[252:255], v[176:179]
  ds_read_b128 v[252:255], v2 offset:43008
  s_waitcnt lgkmcnt(6)
  v_mfma_f32_16x16x32_bf16 v[180:183], v[108:111], v[224:227], v[180:183]
  ds_read_b128 v[224:227], v2 offset:44032
  v_mfma_f32_16x16x32_bf16 v[184:187], v[108:111], v[228:231], v[184:187]
  ds_read_b128 v[228:231], v2 offset:45056
  s_waitcnt lgkmcnt(6)
  v_mfma_f32_16x16x32_bf16 v[188:191], v[108:111], v[232:235], v[188:191]
  ds_read_b128 v[232:235], v2 offset:46080
  v_mfma_f32_16x16x32_bf16 v[192:195], v[108:111], v[236:239], v[192:195]
  ds_read_b128 v[236:239], v2 offset:52224
  s_waitcnt lgkmcnt(6)
  v_mfma_f32_16x16x32_bf16 v[196:199], v[108:111], v[240:243], v[196:199]
  ds_read_b128 v[240:243], v2 offset:53248
  s_waitcnt vmcnt(18) lgkmcnt(0)
  s_barrier
  s_add_u32 s82, s82, 4096
  s_add_u32 m0, m0, 4096
  s_nop 0
  buffer_load_dwordx4 v1, s[4:7], s82 offen offset:0 lds
  s_cmp_lt_u32 s40, 2
  s_cbranch_scc1 L_skip11
  s_lshl_b32 s100, s40, 13
  s_add_u32 m0, s100, 4096
  s_add_u32 s76, s76, 0
  buffer_load_dwordx4 v10, s[36:39], s76 offen  lds
  s_lshl_b32 s100, s40, 13
  s_add_u32 m0, s100, 5120
  s_add_u32 s76, s76, s80
  buffer_load_dwordx4 v10, s[36:39], s76 offen  lds
  s_lshl_b32 s100, s40, 13
  s_add_u32 m0, s100, 6144
  s_add_u32 s76, s76, s80
  buffer_load_dwordx4 v10, s[36:39], s76 offen  lds
  s_lshl_b32 s100, s40, 13
  s_add_u32 m0, s100, 7168
  s_add_u32 s76, s76, s80
  buffer_load_dwordx4 v10, s[36:39], s76 offen  lds
  s_lshl_b32 s100, s40, 13
  s_add_u32 m0, s100, 8192
  s_add_u32 s76, s76, s80
  s_add_u32 s76, s76, s79
  buffer_load_dwordx4 v10, s[36:39], s76 offen  lds
  s_lshl_b32 s100, s40, 13
  s_add_u32 m0, s100, 9216
  s_add_u32 s76, s76, s80
  buffer_load_dwordx4 v10, s[36:39], s76 offen  lds
  s_lshl_b32 s100, s40, 13
  s_add_u32 m0, s100, 10240
  s_add_u32 s76, s76, s80
  buffer_load_dwordx4 v10, s[36:39], s76 offen  lds
  s_lshl_b32 s100, s40, 13
  s_add_u32 m0, s100, 11264
  s_add_u32 s76, s76, s80
  buffer_load_dwordx4 v10, s[36:39], s76 offen  lds
L_skip11:
  s_nop 0
  v_mfma_f32_16x16x32_bf16 v[200:203], v[108:111], v[244:247], v[200:203]
  ds_read_b128 v[244:247], v2 offset:54272
  v_lshrrev_b32 v216, 2, v1
  v_mfma_f32_16x16x32_bf16 v[164:167], v[112:115], v[248:251], v[164:167]
  ds_read_b128 v[248:251], v2 offset:55296
  v_add_u32 v216, 162176, v216
  v_mfma_f32_16x16x32_bf16 v[168:171], v[112:115], v[252:255], v[168:171]
  ds_read_b128 v[252:255], v2 offset:56320
  ds_read_b128 v[212:215], v45 offset:0
  v_mfma_f32_16x16x32_bf16 v[172:175], v[112:115], v[224:227], v[172:175]
  ds_read_b128 v[224:227], v2 offset:57344
  s_waitcnt lgkmcnt(1)
  v_pk_add_f32 v[212:213], v[212:213], v[214:215]
  v_mfma_f32_16x16x32_bf16 v[176:179], v[112:115], v[228:231], v[176:179]
  ds_read_b128 v[228:231], v2 offset:58368
  v_add_f32 v212, v212, v213
  v_mfma_f32_16x16x32_bf16 v[180:183], v[112:115], v[232:235], v[180:183]
  ds_read_b128 v[232:235], v2 offset:59392
  ds_write_b32 v216, v212 offset:0
  v_mfma_f32_16x16x32_bf16 v[184:187], v[112:115], v[236:239], v[184:187]
  ds_read_b128 v[236:239], v2 offset:60416
  ds_read_b128 v[212:215], v45 offset:1024
  v_mfma_f32_16x16x32_bf16 v[188:191], v[112:115], v[240:243], v[188:191]
  ds_read_b128 v[240:243], v2 offset:61440
  s_waitcnt lgkmcnt(1)
  v_pk_add_f32 v[212:213], v[212:213], v[214:215]
  v_mfma_f32_16x16x32_bf16 v[192:195], v[112:115], v[244:247], v[192:195]
  ds_read_b128 v[244:247], v3 offset:2048
  v_add_f32 v212, v212, v213
  v_mfma_f32_16x16x32_bf16 v[196:199], v[112:115], v[248:251], v[196:199]
  ds_read_b128 v[248:251], v3 offset:3072
  ds_write_b32 v216, v212 offset:256
  v_mfma_f32_16x16x32_bf16 v[200:203], v[112:115], v[252:255], v[200:203]
  ds_read_b128 v[252:255], v3 offset:4096
  ds_read_b128 v[212:215], v45 offset:2048
  v_mfma_f32_16x16x32_bf16 v[164:167], v[116:119], v[224:227], v[164:167]
  ds_read_b128 v[224:227], v3 offset:5120
  s_waitcnt lgkmcnt(1)
  v_pk_add_f32 v[212:213], v[212:213], v[214:215]
  v_mfma_f32_16x16x32_bf16 v[168:171], v[116:119], v[228:231], v[168:171]
  ds_read_b128 v[228:231], v3 offset:6144
  v_add_f32 v212, v212, v213
  v_mfma_f32_16x16x32_bf16 v[172:175], v[116:119], v[232:235], v[172:175]
  ds_read_b128 v[232:235], v2 offset:62464
  ds_write_b32 v216, v212 offset:512
  v_mfma_f32_16x16x32_bf16 v[176:179], v[116:119], v[236:239], v[176:179]
  ds_read_b128 v[236:239], v2 offset:63488
  ds_read_b32 v204, v27 offset:0
  v_mfma_f32_16x16x32_bf16 v[180:183], v[116:119], v[240:243], v[180:183]
  ds_read_b128 v[240:243], v2 offset:64512
  ds_read_b32 v205, v27 offset:64
  v_mfma_f32_16x16x32_bf16 v[184:187], v[116:119], v[244:247], v[184:187]
  ds_read_b128 v[244:247], v3 offset:0
  ds_read_b32 v206, v27 offset:128
  v_mfma_f32_16x16x32_bf16 v[188:191], v[116:119], v[248:251], v[188:191]
  ds_read_b128 v[248:251], v3 offset:1024
  ds_read_b32 v207, v27 offset:192
  v_mfma_f32_16x16x32_bf16 v[192:195], v[116:119], v[252:255], v[192:195]
  ds_read_b128 v[252:255], v3 offset:7168
  ds_read_b32 v208, v27 offset:256
  s_waitcnt lgkmcnt(12)
  v_mfma_f32_16x16x32_bf16 v[196:199], v[116:119], v[224:227], v[196:199]
  ds_read_b128 v[224:227], v3 offset:8192
  s_waitcnt vmcnt(14)
  s_barrier
  v_mfma_f32_16x16x32_bf16 v[200:203], v[116:119], v[228:231], v[200:203]
  ds_read_b128 v[228:231], v3 offset:9216
  ds_read_b32 v209, v27 offset:384
  s_waitcnt lgkmcnt(12)
  v_mfma_f32_16x16x32_bf16 v[164:167], v[120:123], v[232:235], v[164:167]
  ds_read_b128 v[232:235], v3 offset:10240
  ds_read_b32 v210, v27 offset:448
  v_mfma_f32_16x16x32_bf16 v[168:171], v[120:123], v[236:239], v[168:171]
  ds_read_b128 v[236:239], v3 offset:11264
  ds_read_b32 v211, v27 offset:512
  s_waitcnt lgkmcnt(12)
  v_mfma_f32_16x16x32_bf16 v[172:175], v[120:123], v[240:243], v[172:175]
  ds_read_b128 v[240:243], v1 offset:0
  ds_read_b32 v162, v27 offset:576
  v_mfma_f32_16x16x32_bf16 v[176:179], v[120:123], v[244:247], v[176:179]
  ds_read_b128 v[244:247], v1 offset:1024
  ds_read_b32 v163, v27 offset:640
  s_waitcnt lgkmcnt(12)
  v_mfma_f32_16x16x32_bf16 v[180:183], v[120:123], v[248:251], v[180:183]
  s_add_u32 s82, s75, 245760
  s_add_u32 m0, s43, 101120
  ds_read_b128 v[248:251], v1 offset:2048
  buffer_load_dwordx4 v1, s[4:7], s82 offen offset:0 lds
  v_mfma_f32_16x16x32_bf16 v[184:187], v[120:123], v[252:255], v[184:187]
  ds_read_b128 v[252:255], v1 offset:3072
  s_waitcnt lgkmcnt(11)
  v_mfma_f32_16x16x32_bf16 v[188:191], v[120:123], v[224:227], v[188:191]
  ds_read_b128 v[224:227], v1 offset:4096
  v_mfma_f32_16x16x32_bf16 v[192:195], v[120:123], v[228:231], v[192:195]
  ds_read_b128 v[228:231], v1 offset:10240
  buffer_load_dwordx4 v1, s[4:7], s82 offen offset:1024 lds
  s_waitcnt lgkmcnt(9)
  v_mfma_f32_16x16x32_bf16 v[196:199], v[120:123], v[232:235], v[196:199]
  ds_read_b128 v[232:235], v1 offset:11264
  v_mfma_f32_16x16x32_bf16 v[200:203], v[120:123], v[236:239], v[200:203]
  ds_read_b128 v[236:239], v1 offset:12288
  s_waitcnt lgkmcnt(7)
  v_mfma_f32_16x16x32_bf16 v[164:167], v[124:127], v[240:243], v[164:167]
  ds_read_b128 v[240:243], v1 offset:13312
  buffer_load_dwordx4 v1, s[4:7], s82 offen offset:2048 lds
  v_mfma_f32_16x16x32_bf16 v[168:171], v[124:127], v[244:247], v[168:171]
  ds_read_b128 v[244:247], v1 offset:14336
  s_waitcnt lgkmcnt(6)
  v_mfma_f32_16x16x32_bf16 v[172:175], v[124:127], v[248:251], v[172:175]
  ds_read_b128 v[248:251], v1 offset:5120
  v_mfma_f32_16x16x32_bf16 v[176:179], v[124:127], v[252:255], v[176:179]
  ds_read_b128 v[252:255], v1 offset:6144
  s_waitcnt lgkmcnt(6)
  v_mfma_f32_16x16x32_bf16 v[180:183], v[124:127], v[224:227], v[180:183]
  ds_read_b128 v[224:227], v1 offset:7168
  buffer_load_dwordx4 v1, s[4:7], s82 offen offset:3072 lds
  v_mfma_f32_16x16x32_bf16 v[184:187], v[124:127], v[228:231], v[184:187]
  ds_read_b128 v[228:231], v1 offset:8192
  s_waitcnt lgkmcnt(6)
  v_mfma_f32_16x16x32_bf16 v[188:191], v[124:127], v[232:235], v[188:191]
  ds_read_b128 v[232:235], v1 offset:9216
  v_mfma_f32_16x16x32_bf16 v[192:195], v[124:127], v[236:239], v[192:195]
  s_add_u32 s82, s82, 4096
  s_add_u32 m0, m0, 4096
  ds_read_b128 v[236:239], v1 offset:15360
  buffer_load_dwordx4 v1, s[4:7], s82 offen offset:0 lds
  s_waitcnt lgkmcnt(6)
  v_mfma_f32_16x16x32_bf16 v[196:199], v[124:127], v[240:243], v[196:199]
  ds_read_b128 v[240:243], v1 offset:16384
  s_waitcnt vmcnt(10)
  s_barrier
  v_mfma_f32_16x16x32_bf16 v[200:203], v[124:127], v[244:247], v[200:203]
  s_add_u32 s82, s75, 270336
  s_add_u32 m0, s43, 121600
  ds_read_b128 v[244:247], v1 offset:17408
  buffer_load_dwordx4 v1, s[4:7], s82 offen offset:0 lds
  s_waitcnt lgkmcnt(6)
  v_mfma_f32_16x16x32_bf16 v[164:167], v[128:131], v[248:251], v[164:167]
  ds_read_b128 v[248:251], v1 offset:18432
  v_mfma_f32_16x16x32_bf16 v[168:171], v[128:131], v[252:255], v[168:171]
  ds_read_b128 v[252:255], v1 offset:19456
  buffer_load_dwordx4 v1, s[4:7], s82 offen offset:1024 lds
  s_waitcnt lgkmcnt(6)
  v_mfma_f32_16x16x32_bf16 v[172:175], v[128:131], v[224:227], v[172:175]
  ds_read_b128 v[224:227], v1 offset:36864
  v_mfma_f32_16x16x32_bf16 v[176:179], v[128:131], v[228:231], v[176:179]
  ds_read_b128 v[228:231], v1 offset:37888
  s_waitcnt lgkmcnt(6)
  v_mfma_f32_16x16x32_bf16 v[180:183], v[128:131], v[232:235], v[180:183]
  ds_read_b128 v[232:235], v1 offset:38912
  v_mfma_f32_16x16x32_bf16 v[184:187], v[128:131], v[236:239], v[184:187]
  ds_read_b128 v[236:239], v1 offset:39936
  buffer_load_dwordx4 v1, s[4:7], s82 offen offset:2048 lds
  s_waitcnt lgkmcnt(6)
  v_mfma_f32_16x16x32_bf16 v[188:191], v[128:131], v[240:243], v[188:191]
  ds_read_b128 v[240:243], v1 offset:40960
  v_mfma_f32_16x16x32_bf16 v[192:195], v[128:131], v[244:247], v[192:195]
  ds_read_b128 v[244:247], v1 offset:47104
  s_waitcnt lgkmcnt(6)
  v_mfma_f32_16x16x32_bf16 v[196:199], v[128:131], v[248:251], v[196:199]
  ds_read_b128 v[248:251], v1 offset:48128
  buffer_load_dwordx4 v1, s[4:7], s82 offen offset:3072 lds
  v_mfma_f32_16x16x32_bf16 v[200:203], v[128:131], v[252:255], v[200:203]
  ds_read_b128 v[252:255], v1 offset:49152
  s_waitcnt lgkmcnt(6)
  v_mfma_f32_16x16x32_bf16 v[164:167], v[132:135], v[224:227], v[164:167]
  ds_read_b128 v[224:227], v1 offset:50176
  v_mfma_f32_16x16x32_bf16 v[168:171], v[132:135], v[228:231], v[168:171]
  s_add_u32 s82, s82, 4096
  s_add_u32 m0, m0, 4096
  ds_read_b128 v[228:231], v1 offset:51200
  buffer_load_dwordx4 v1, s[4:7], s82 offen offset:0 lds
  s_waitcnt lgkmcnt(6)
  v_mfma_f32_16x16x32_bf16 v[172:175], v[132:135], v[232:235], v[172:175]
  ds_read_b128 v[232:235], v1 offset:41984
  v_mfma_f32_16x16x32_bf16 v[176:179], v[132:135], v[236:239], v[176:179]
  ds_read_b128 v[236:239], v1 offset:43008
  s_waitcnt lgkmcnt(6)
  v_mfma_f32_16x16x32_bf16 v[180:183], v[132:135], v[240:243], v[180:183]
  ds_read_b128 v[240:243], v1 offset:44032
  v_mfma_f32_16x16x32_bf16 v[184:187], v[132:135], v[244:247], v[184:187]
  ds_read_b128 v[244:247], v1 offset:45056
  s_waitcnt lgkmcnt(6)
  v_mfma_f32_16x16x32_bf16 v[188:191], v[132:135], v[248:251], v[188:191]
  ds_read_b128 v[248:251], v1 offset:46080
  v_mfma_f32_16x16x32_bf16 v[192:195], v[132:135], v[252:255], v[192:195]
  ds_read_b128 v[252:255], v1 offset:52224
  s_waitcnt lgkmcnt(6)
  v_mfma_f32_16x16x32_bf16 v[196:199], v[132:135], v[224:227], v[196:199]
  ds_read_b128 v[224:227], v1 offset:53248
  s_waitcnt vmcnt(10)
  s_barrier
  v_mfma_f32_16x16x32_bf16 v[200:203], v[132:135], v[228:231], v[200:203]
  s_add_u32 s82, s75, 294912
  s_add_u32 m0, s43, 0
  ds_read_b128 v[228:231], v1 offset:54272
  buffer_load_dwordx4 v1, s[4:7], s82 offen offset:0 lds
  s_waitcnt lgkmcnt(6)
  v_mfma_f32_16x16x32_bf16 v[164:167], v[136:139], v[232:235], v[164:167]
  ds_read_b128 v[232:235], v1 offset:55296
  v_mfma_f32_16x16x32_bf16 v[168:171], v[136:139], v[236:239], v[168:171]
  ds_read_b128 v[236:239], v1 offset:56320
  buffer_load_dwordx4 v1, s[4:7], s82 offen offset:1024 lds
  s_waitcnt lgkmcnt(6)
  v_mfma_f32_16x16x32_bf16 v[172:175], v[136:139], v[240:243], v[172:175]
  ds_read_b128 v[240:243], v1 offset:57344
  v_mfma_f32_16x16x32_bf16 v[176:179], v[136:139], v[244:247], v[176:179]
  ds_read_b128 v[244:247], v1 offset:58368
  s_waitcnt lgkmcnt(6)
  v_mfma_f32_16x16x32_bf16 v[180:183], v[136:139], v[248:251], v[180:183]
  ds_read_b128 v[248:251], v1 offset:59392
  v_mfma_f32_16x16x32_bf16 v[184:187], v[136:139], v[252:255], v[184:187]
  ds_read_b128 v[252:255], v1 offset:60416
  buffer_load_dwordx4 v1, s[4:7], s82 offen offset:2048 lds
  s_waitcnt lgkmcnt(6)
  v_mfma_f32_16x16x32_bf16 v[188:191], v[136:139], v[224:227], v[188:191]
  ds_read_b128 v[224:227], v1 offset:61440
  v_mfma_f32_16x16x32_bf16 v[192:195], v[136:139], v[228:231], v[192:195]
  ds_read_b128 v[228:231], v2 offset:2048
  s_waitcnt lgkmcnt(6)
  v_mfma_f32_16x16x32_bf16 v[196:199], v[136:139], v[232:235], v[196:199]
  ds_read_b128 v[232:235], v2 offset:3072
  buffer_load_dwordx4 v1, s[4:7], s82 offen offset:3072 lds
  v_mfma_f32_16x16x32_bf16 v[200:203], v[136:139], v[236:239], v[200:203]
  ds_read_b128 v[236:239], v2 offset:4096
  s_waitcnt lgkmcnt(6)
  v_mfma_f32_16x16x32_bf16 v[164:167], v[140:143], v[240:243], v[164:167]
  ds_read_b128 v[240:243], v2 offset:5120
  v_mfma_f32_16x16x32_bf16 v[168:171], v[140:143], v[244:247], v[168:171]
  s_add_u32 s82, s82, 4096
  s_add_u32 m0, m0, 4096
  ds_read_b128 v[244:247], v2 offset:6144
  buffer_load_dwordx4 v1, s[4:7], s82 offen offset:0 lds
  s_waitcnt lgkmcnt(6)
  v_mfma_f32_16x16x32_bf16 v[172:175], v[140:143], v[248:251], v[172:175]
  ds_read_b128 v[248:251], v1 offset:62464
  v_mfma_f32_16x16x32_bf16 v[176:179], v[140:143], v[252:255], v[176:179]
  ds_read_b128 v[252:255], v1 offset:63488
  s_waitcnt lgkmcnt(6)
  v_mfma_f32_16x16x32_bf16 v[180:183], v[140:143], v[224:227], v[180:183]
  ds_read_b128 v[224:227], v1 offset:64512
  v_mfma_f32_16x16x32_bf16 v[184:187], v[140:143], v[228:231], v[184:187]
  ds_read_b128 v[228:231], v2 offset:0
  s_waitcnt lgkmcnt(6)
  v_mfma_f32_16x16x32_bf16 v[188:191], v[140:143], v[232:235], v[188:191]
  ds_read_b128 v[232:235], v2 offset:1024
  v_mfma_f32_16x16x32_bf16 v[192:195], v[140:143], v[236:239], v[192:195]
  ds_read_b128 v[236:239], v2 offset:7168
  s_waitcnt lgkmcnt(6)
  v_mfma_f32_16x16x32_bf16 v[196:199], v[140:143], v[240:243], v[196:199]
  ds_read_b128 v[240:243], v2 offset:8192
  s_barrier
  s_cmp_lt_u32 s40, 2
  s_cbranch_scc1 L_skip12
  v_add_u32 v7, 4294889472, v7
  s_waitcnt vmcnt(15)
  ds_read_b64_tr_b16 a[208:209], v7 offset:0
  ds_read_b64_tr_b16 a[210:211], v7 offset:4096
  ds_read_b64_tr_b16 a[212:213], v7 offset:32
  ds_read_b64_tr_b16 a[214:215], v7 offset:4128
  ds_read_b64_tr_b16 a[216:217], v7 offset:64
  ds_read_b64_tr_b16 a[218:219], v7 offset:4160
  ds_read_b64_tr_b16 a[220:221], v7 offset:96
  ds_read_b64_tr_b16 a[222:223], v7 offset:4192
  ds_read_b64_tr_b16 a[224:225], v7 offset:128
  ds_read_b64_tr_b16 a[226:227], v7 offset:4224
  ds_read_b64_tr_b16 a[228:229], v7 offset:160
  ds_read_b64_tr_b16 a[230:231], v7 offset:4256
  s_waitcnt lgkmcnt(10)
  buffer_store_dwordx4 a[208:211], v1, s[4:7], s77 offen offset:0 sc1
  s_waitcnt lgkmcnt(8)
  buffer_store_dwordx4 a[212:215], v1, s[4:7], s77 offen offset:1024 sc1
  s_waitcnt lgkmcnt(6)
  buffer_store_dwordx4 a[216:219], v1, s[4:7], s77 offen offset:2048 sc1
  s_waitcnt lgkmcnt(4)
  buffer_store_dwordx4 a[220:223], v1, s[4:7], s77 offen offset:3072 sc1
  s_add_u32 s77, s77, 4096
  s_waitcnt lgkmcnt(2)
  buffer_store_dwordx4 a[224:227], v1, s[4:7], s77 offen offset:0 sc1
  s_waitcnt lgkmcnt(0)
  buffer_store_dwordx4 a[228:231], v1, s[4:7], s78 offen offset:0 sc1
  v_cmp_eq_u32 vcc, 0, v47
  s_nop 1
  v_cndmask_b32 v216, 0, v20, vcc
  v_cndmask_b32 v217, 0, v20, vcc
  v_cndmask_b32 v218, 0, v20, vcc
  v_cndmask_b32 v219, 0, v20, vcc
  v_lshrrev_b32 v220, 4, v0
  v_lshl_add_u32 v220, v47, 2, v220
  v_mfma_f32_16x16x32_bf16 v[212:215], a[208:211], v[216:219], 0
  v_mov_b32_dpp v216, v216 row_ror:1 row_mask:0xf bank_mask:0xf
  v_mov_b32_dpp v217, v217 row_ror:1 row_mask:0xf bank_mask:0xf
  v_mov_b32_dpp v218, v218 row_ror:1 row_mask:0xf bank_mask:0xf
  v_mov_b32_dpp v219, v219 row_ror:1 row_mask:0xf bank_mask:0xf
  s_nop 1
  v_mfma_f32_16x16x32_bf16 v[212:215], a[212:215], v[216:219], v[212:215]
  v_mov_b32_dpp v216, v216 row_ror:1 row_mask:0xf bank_mask:0xf
  v_mov_b32_dpp v217, v217 row_ror:1 row_mask:0xf bank_mask:0xf
  v_mov_b32_dpp v218, v218 row_ror:1 row_mask:0xf bank_mask:0xf
  v_mov_b32_dpp v219, v219 row_ror:1 row_mask:0xf bank_mask:0xf
  s_nop 1
  v_mfma_f32_16x16x32_bf16 v[212:215], a[216:219], v[216:219], v[212:215]
  v_mov_b32_dpp v216, v216 row_ror:1 row_mask:0xf bank_mask:0xf
  v_mov_b32_dpp v217, v217 row_ror:1 row_mask:0xf bank_mask:0xf
  v_mov_b32_dpp v218, v218 row_ror:1 row_mask:0xf bank_mask:0xf
  v_mov_b32_dpp v219, v219 row_ror:1 row_mask:0xf bank_mask:0xf
  s_nop 1
  v_mfma_f32_16x16x32_bf16 v[212:215], a[220:223], v[216:219], v[212:215]
  v_mov_b32_dpp v216, v216 row_ror:1 row_mask:0xf bank_mask:0xf
  v_mov_b32_dpp v217, v217 row_ror:1 row_mask:0xf bank_mask:0xf
  v_mov_b32_dpp v218, v218 row_ror:1 row_mask:0xf bank_mask:0xf
  v_mov_b32_dpp v219, v219 row_ror:1 row_mask:0xf bank_mask:0xf
  s_nop 1
  v_mfma_f32_16x16x32_bf16 v[212:215], a[224:227], v[216:219], v[212:215]
  v_mov_b32_dpp v216, v216 row_ror:1 row_mask:0xf bank_mask:0xf
  v_mov_b32_dpp v217, v217 row_ror:1 row_mask:0xf bank_mask:0xf
  v_mov_b32_dpp v218, v218 row_ror:1 row_mask:0xf bank_mask:0xf
  v_mov_b32_dpp v219, v219 row_ror:1 row_mask:0xf bank_mask:0xf
  s_nop 1
  v_mfma_f32_16x16x32_bf16 v[212:215], a[228:231], v[216:219], v[212:215]
  s_mul_i32 s0, s41, 144
  s_add_u32 s0, s0, s81
  s_lshl_b32 s0, s0, 9
  s_add_u32 s0, s0, 25165824
  v_lshlrev_b32 v220, 4, v220
  v_cmp_lt_u32 vcc, 5, v47
  s_nop 1
  v_cndmask_b32 v220, v220, -1, vcc
  buffer_store_dwordx4 v[212:215], v220, s[4:7], s0 offen sc1
L_skip12:
  s_nop 0
  s_and_b32 s100, s2, 0x43
  s_cbranch_scc1 L_skip13
  buffer_store_dwordx4 a[184:187], v1, s[4:7], s77 offen offset:0 sc1
  buffer_store_dwordx4 a[188:191], v1, s[4:7], s77 offen offset:1024 sc1
  buffer_store_dwordx4 a[192:195], v1, s[4:7], s77 offen offset:2048 sc1
  buffer_store_dwordx4 a[196:199], v1, s[4:7], s77 offen offset:3072 sc1
  s_add_u32 s77, s77, 4096
  buffer_store_dwordx4 a[200:203], v1, s[4:7], s77 offen offset:0 sc1
L_skip13:
  s_nop 0
  v_mfma_f32_16x16x32_bf16 v[200:203], v[140:143], v[244:247], v[200:203]
  ds_read_b128 v[244:247], v2 offset:9216
  s_waitcnt lgkmcnt(6)
  v_mfma_f32_16x16x32_bf16 v[164:167], v[144:147], v[248:251], v[164:167]
  ds_read_b128 v[248:251], v2 offset:10240
  v_mfma_f32_16x16x32_bf16 v[168:171], v[144:147], v[252:255], v[168:171]
  ds_read_b128 v[252:255], v2 offset:11264
  s_waitcnt lgkmcnt(6)
  v_mfma_f32_16x16x32_bf16 v[172:175], v[144:147], v[224:227], v[172:175]
  v_mfma_f32_16x16x32_bf16 v[176:179], v[144:147], v[228:231], v[176:179]
  s_waitcnt lgkmcnt(4)
  v_mfma_f32_16x16x32_bf16 v[180:183], v[144:147], v[232:235], v[180:183]
  v_mfma_f32_16x16x32_bf16 v[184:187], v[144:147], v[236:239], v[184:187]
  s_waitcnt lgkmcnt(2)
  v_mfma_f32_16x16x32_bf16 v[188:191], v[144:147], v[240:243], v[188:191]
  v_mfma_f32_16x16x32_bf16 v[192:195], v[144:147], v[244:247], v[192:195]
  s_waitcnt lgkmcnt(0)
  v_mfma_f32_16x16x32_bf16 v[196:199], v[144:147], v[248:251], v[196:199]
  v_mfma_f32_16x16x32_bf16 v[200:203], v[144:147], v[252:255], v[200:203]
  s_barrier
  v_add_u32 v220, 77824, v38
  v_mov_b32 v212, 0x358637bd
  v_mov_b32 v213, 0x3fb8aa3b
  v_pk_mul_f32 v[240:241], v[152:153], v[208:209] op_sel:[0,1] op_sel_hi:[1,1]
  v_pk_mul_f32 v[242:243], v[154:155], v[208:209] op_sel:[0,1] op_sel_hi:[1,1]
  v_pk_fma_f32 v[184:185], v[184:185], v[148:149], v[240:241]
  v_pk_fma_f32 v[186:187], v[186:187], v[150:151], v[242:243]
  v_cvt_pk_bf16_f32 v226, v184, v185
  v_cvt_pk_bf16_f32 v227, v186, v187
  ds_write_b64 v220, v[226:227] offset:11520
  v_pk_mul_f32 v[240:241], v[152:153], v[210:211] op_sel:[0,0] op_sel_hi:[1,0]
  v_pk_mul_f32 v[242:243], v[154:155], v[210:211] op_sel:[0,0] op_sel_hi:[1,0]
  v_pk_fma_f32 v[188:189], v[188:189], v[148:149], v[240:241]
  v_pk_fma_f32 v[190:191], v[190:191], v[150:151], v[242:243]
  v_cvt_pk_bf16_f32 v228, v188, v189
  v_cvt_pk_bf16_f32 v229, v190, v191
  ds_write_b64 v220, v[228:229] offset:13824
  v_pk_mul_f32 v[240:241], v[152:153], v[210:211] op_sel:[0,1] op_sel_hi:[1,1]
  v_pk_mul_f32 v[242:243], v[154:155], v[210:211] op_sel:[0,1] op_sel_hi:[1,1]
  v_pk_fma_f32 v[192:193], v[192:193], v[148:149], v[240:241]
  v_pk_fma_f32 v[194:195], v[194:195], v[150:151], v[242:243]
  v_cvt_pk_bf16_f32 v230, v192, v193
  v_cvt_pk_bf16_f32 v231, v194, v195
  ds_write_b64 v220, v[230:231] offset:16128
  v_pk_mul_f32 v[240:241], v[152:153], v[162:163] op_sel:[0,0] op_sel_hi:[1,0]
  v_pk_mul_f32 v[242:243], v[154:155], v[162:163] op_sel:[0,0] op_sel_hi:[1,0]
  v_pk_fma_f32 v[196:197], v[196:197], v[148:149], v[240:241]
  v_pk_fma_f32 v[198:199], v[198:199], v[150:151], v[242:243]
  v_cvt_pk_bf16_f32 v224, v196, v197
  v_cvt_pk_bf16_f32 v225, v198, v199
  ds_write_b64 v220, v[224:225] offset:18432
  v_pk_mul_f32 v[240:241], v[152:153], v[162:163] op_sel:[0,1] op_sel_hi:[1,1]
  s_add_u32 s82, s75, 319488
  s_add_u32 m0, s43, 36864
  s_nop 0
  buffer_load_dwordx4 v1, s[4:7], s82 offen offset:0 lds
  v_pk_mul_f32 v[242:243], v[154:155], v[162:163] op_sel:[0,1] op_sel_hi:[1,1]
  v_pk_fma_f32 v[200:201], v[200:201], v[148:149], v[240:241]
  v_pk_fma_f32 v[202:203], v[202:203], v[150:151], v[242:243]
  v_cvt_pk_bf16_f32 v226, v200, v201
  v_cvt_pk_bf16_f32 v227, v202, v203
  ds_write_b64 v220, v[226:227] offset:20736
  v_pk_fma_f32 v[240:241], v[152:153], v[204:205], v[212:213] op_sel:[0,0,0] op_sel_hi:[1,0,0]
  v_pk_fma_f32 v[242:243], v[154:155], v[204:205], v[212:213] op_sel:[0,0,0] op_sel_hi:[1,0,0]
  v_pk_fma_f32 v[164:165], v[164:165], v[148:149], v[240:241]
  v_pk_fma_f32 v[166:167], v[166:167], v[150:151], v[242:243]
  buffer_load_dwordx4 v1, s[4:7], s82 offen offset:1024 lds
  v_pk_mul_f32 v[232:233], v[164:165], v[212:213] op_sel:[0,1] op_sel_hi:[1,1]
  v_pk_mul_f32 v[234:235], v[166:167], v[212:213] op_sel:[0,1] op_sel_hi:[1,1]
  v_exp_f32 v232, v232 clamp
  v_exp_f32 v233, v233 clamp
  v_exp_f32 v234, v234 clamp
  v_exp_f32 v235, v235 clamp
  v_max_f32 v164, v212, v164
  v_max_f32 v165, v212, v165
  v_max_f32 v166, v212, v166
  v_max_f32 v167, v212, v167
  v_pk_add_f32 v[164:165], v[164:165], v[232:233]
  v_pk_add_f32 v[166:167], v[166:167], v[234:235]
  v_cvt_pk_bf16_f32 v224, v164, v165
  buffer_load_dwordx4 v1, s[4:7], s82 offen offset:2048 lds
  v_cvt_pk_bf16_f32 v225, v166, v167
  ds_write_b64 v220, v[224:225] offset:0
  v_pk_fma_f32 v[240:241], v[152:153], v[204:205], v[212:213] op_sel:[0,1,0] op_sel_hi:[1,1,0]
  v_pk_fma_f32 v[242:243], v[154:155], v[204:205], v[212:213] op_sel:[0,1,0] op_sel_hi:[1,1,0]
  v_pk_fma_f32 v[168:169], v[168:169], v[148:149], v[240:241]
  v_pk_fma_f32 v[170:171], v[170:171], v[150:151], v[242:243]
  v_pk_mul_f32 v[236:237], v[168:169], v[212:213] op_sel:[0,1] op_sel_hi:[1,1]
  v_pk_mul_f32 v[238:239], v[170:171], v[212:213] op_sel:[0,1] op_sel_hi:[1,1]
  v_exp_f32 v236, v236 clamp
  v_exp_f32 v237, v237 clamp
  v_exp_f32 v238, v238 clamp
  v_exp_f32 v239, v239 clamp
  v_max_f32 v168, v212, v168
  buffer_load_dwordx4 v1, s[4:7], s82 offen offset:3072 lds
  v_max_f32 v169, v212, v169
  v_max_f32 v170, v212, v170
  v_max_f32 v171, v212, v171
  v_pk_add_f32 v[168:169], v[168:169], v[236:237]
  v_pk_add_f32 v[170:171], v[170:171], v[238:239]
  v_cvt_pk_bf16_f32 v226, v168, v169
  v_cvt_pk_bf16_f32 v227, v170, v171
  ds_write_b64 v220, v[226:227] offset:2304
  v_pk_fma_f32 v[240:241], v[152:153], v[206:207], v[212:213] op_sel:[0,0,0] op_sel_hi:[1,0,0]
  v_pk_fma_f32 v[242:243], v[154:155], v[206:207], v[212:213] op_sel:[0,0,0] op_sel_hi:[1,0,0]
  v_pk_fma_f32 v[172:173], v[172:173], v[148:149], v[240:241]
  v_pk_fma_f32 v[174:175], v[174:175], v[150:151], v[242:243]
  v_pk_mul_f32 v[232:233], v[172:173], v[212:213] op_sel:[0,1] op_sel_hi:[1,1]
  s_add_u32 s82, s82, 4096
  s_add_u32 m0, m0, 4096
  s_nop 0
  buffer_load_dwordx4 v1, s[4:7], s82 offen offset:0 lds
  v_pk_mul_f32 v[234:235], v[174:175], v[212:213] op_sel:[0,1] op_sel_hi:[1,1]
  v_exp_f32 v232, v232 clamp
  v_exp_f32 v233, v233 clamp
  v_exp_f32 v234, v234 clamp
  v_exp_f32 v235, v235 clamp
  v_max_f32 v172, v212, v172
  v_max_f32 v173, v212, v173
  v_max_f32 v174, v212, v174
  v_max_f32 v175, v212, v175
  v_pk_add_f32 v[172:173], v[172:173], v[232:233]
  s_add_u32 s82, s75, 344064
  s_add_u32 m0, s43, 57344
  s_nop 0
  buffer_load_dwordx4 v1, s[4:7], s82 offen offset:0 lds
  v_pk_add_f32 v[174:175], v[174:175], v[234:235]
  v_cvt_pk_bf16_f32 v228, v172, v173
  v_cvt_pk_bf16_f32 v229, v174, v175
  ds_write_b64 v220, v[228:229] offset:4608
  v_pk_fma_f32 v[240:241], v[152:153], v[206:207], v[212:213] op_sel:[0,1,0] op_sel_hi:[1,1,0]
  v_pk_fma_f32 v[242:243], v[154:155], v[206:207], v[212:213] op_sel:[0,1,0] op_sel_hi:[1,1,0]
  v_pk_fma_f32 v[176:177], v[176:177], v[148:149], v[240:241]
  v_pk_fma_f32 v[178:179], v[178:179], v[150:151], v[242:243]
  v_pk_mul_f32 v[236:237], v[176:177], v[212:213] op_sel:[0,1] op_sel_hi:[1,1]
  v_pk_mul_f32 v[238:239], v[178:179], v[212:213] op_sel:[0,1] op_sel_hi:[1,1]
  buffer_load_dwordx4 v1, s[4:7], s82 offen offset:1024 lds
  v_exp_f32 v236, v236 clamp
  v_exp_f32 v237, v237 clamp
  v_exp_f32 v238, v238 clamp
  v_exp_f32 v239, v239 clamp
  v_max_f32 v176, v212, v176
  v_max_f32 v177, v212, v177
  v_max_f32 v178, v212, v178
  v_max_f32 v179, v212, v179
  v_pk_add_f32 v[176:177], v[176:177], v[236:237]
  v_pk_add_f32 v[178:179], v[178:179], v[238:239]
  v_cvt_pk_bf16_f32 v230, v176, v177
  v_cvt_pk_bf16_f32 v231, v178, v179
  ds_write_b64 v220, v[230:231] offset:6912
  v_pk_fma_f32 v[240:241], v[152:153], v[208:209], v[212:213] op_sel:[0,0,0] op_sel_hi:[1,0,0]
  v_pk_fma_f32 v[242:243], v[154:155], v[208:209], v[212:213] op_sel:[0,0,0] op_sel_hi:[1,0,0]
  v_pk_fma_f32 v[180:181], v[180:181], v[148:149], v[240:241]
  v_pk_fma_f32 v[182:183], v[182:183], v[150:151], v[242:243]
  v_pk_mul_f32 v[232:233], v[180:181], v[212:213] op_sel:[0,1] op_sel_hi:[1,1]
  v_pk_mul_f32 v[234:235], v[182:183], v[212:213] op_sel:[0,1] op_sel_hi:[1,1]
  v_exp_f32 v232, v232 clamp
  v_exp_f32 v233, v233 clamp
  v_exp_f32 v234, v234 clamp
  v_exp_f32 v235, v235 clamp
  v_max_f32 v180, v212, v180
  v_max_f32 v181, v212, v181
  v_max_f32 v182, v212, v182
  v_max_f32 v183, v212, v183
  v_pk_add_f32 v[180:181], v[180:181], v[232:233]
  v_pk_add_f32 v[182:183], v[182:183], v[234:235]
  v_cvt_pk_bf16_f32 v224, v180, v181
  v_cvt_pk_bf16_f32 v225, v182, v183
  ds_write_b64 v220, v[224:225] offset:9216
  s_mov_b32 exec_lo, 0x10001
  s_mov_b32 exec_hi, 0x10001
  ds_write_b64 v220, v[20:21] offset:23040
  s_mov_b64 exec, -1
  v_add_u32 v220, 77824, v39
  v_add_u32 v221, 77824, v40
  s_waitcnt lgkmcnt(0)
  s_barrier
  ds_read_b128 v[224:227], v220 offset:0
  ds_read_b128 v[228:231], v221 offset:0
  ds_read_b128 v[232:235], v220 offset:32
  ds_read_b128 v[236:239], v221 offset:32
  ds_read_b128 v[240:243], v220 offset:64
  ds_read_b128 v[244:247], v221 offset:64
  ds_read_b128 v[248:251], v220 offset:96
  ds_read_b128 v[252:255], v221 offset:96
  s_waitcnt lgkmcnt(6)
  v_mfma_f32_32x32x16_bf16 v[164:179], v[224:227], v[228:231], 0
  s_waitcnt lgkmcnt(4)
  v_mfma_f32_32x32x16_bf16 v[164:179], v[232:235], v[236:239], v[164:179]
  s_waitcnt lgkmcnt(2)
  v_mfma_f32_32x32x16_bf16 v[164:179], v[240:243], v[244:247], v[164:179]
  s_waitcnt lgkmcnt(0)
  v_mfma_f32_32x32x16_bf16 v[164:179], v[248:251], v[252:255], v[164:179]
  s_lshl_b32 s84, s41, 5
  s_add_u32 s84, s84, s42
  s_mul_i32 s84, s84, 6784
  s_mul_i32 s85, s40, 1680
  s_add_u32 s84, s84, s85
  s_add_u32 s84, s84, 1048576
  s_nop 5
  v_bfi_b32 v164, v15, s44, v164
  v_bfi_b32 v165, v15, s45, v165
  v_bfi_b32 v166, v15, s46, v166
  v_bfi_b32 v167, v15, s47, v167
  buffer_store_dwordx4 v[164:167], v34, s[4:7], s84 offen offset:0 sc1
  v_bfi_b32 v168, v15, s44, v168
  v_bfi_b32 v169, v15, s45, v169
  v_bfi_b32 v170, v15, s46, v170
  v_bfi_b32 v171, v15, s47, v171
  buffer_store_dwordx4 v[168:171], v34, s[4:7], s84 offen offset:672 sc1
  v_bfi_b32 v172, v15, s44, v172
  buffer_load_dwordx4 v1, s[4:7], s82 offen offset:2048 lds
  v_bfi_b32 v173, v15, s45, v173
  v_bfi_b32 v174, v15, s46, v174
  v_bfi_b32 v175, v15, s47, v175
  buffer_store_dwordx4 v[172:175], v35, s[4:7], s84 offen offset:1344 sc1
  buffer_load_dwordx4 v1, s[4:7], s82 offen offset:3072 lds
  s_add_u32 s82, s82, 4096
  s_add_u32 m0, m0, 4096
  s_nop 0
  buffer_load_dwordx4 v1, s[4:7], s82 offen offset:0 lds
  s_cmp_lt_u32 s40, 2
  s_cbranch_scc1 L_skip14
  s_lshl_b32 s0, s81, 2
  s_add_u32 s0, s0, s89
  s_waitcnt vmcnt(13)
  buffer_store_dword v25, v13, s[4:7], s0 offen sc1
L_skip14:
  s_nop 0
  s_and_b32 s100, s2, 0x43
  s_cbranch_scc1 L_skip15
  s_lshl_b32 s0, s81, 2
  s_add_u32 s0, s0, s89
  s_waitcnt vmcnt(13)
  buffer_store_dword v25, v13, s[4:7], s0 offen sc1
L_skip15:
  s_nop 0
L_ph_q0:
  s_waitcnt vmcnt(23)
  s_barrier
  ds_read_b128 v[224:227], v2 offset:35584
  ds_read_b128 v[228:231], v2 offset:36608
  ds_read_b128 v[232:235], v2 offset:37632
  ds_read_b128 v[236:239], v2 offset:38656
  ds_read_b128 v[240:243], v2 offset:39680
  ds_read_b128 v[244:247], v2 offset:40704
  ds_read_b128 v[248:251], v2 offset:41728
  ds_read_b128 v[252:255], v2 offset:42752
  ds_read_b128 v[196:199], v2 offset:43776
  ds_read_b128 v[200:203], v2 offset:44800
  ds_read_b128 v[204:207], v2 offset:45824
  ds_read_b128 v[208:211], v2 offset:46848
  s_waitcnt lgkmcnt(8)
  v_mfma_f32_16x16x32_bf16 v[164:167], v[224:227], v[68:71], 0
  ds_read_b128 v[224:227], v2 offset:47872
  s_add_u32 s100, s101, L_ph_wo0-L_base
  buffer_load_dword v222, v13, s[96:99], s100 offen
  v_mfma_f32_16x16x32_bf16 v[168:171], v[228:231], v[68:71], 0
  ds_read_b128 v[228:231], v2 offset:48896
  v_mfma_f32_16x16x32_bf16 v[172:175], v[232:235], v[68:71], 0
  ds_read_b128 v[232:235], v2 offset:49920
  v_mfma_f32_16x16x32_bf16 v[176:179], v[236:239], v[68:71], 0
  ds_read_b128 v[236:239], v2 offset:50944
  s_waitcnt lgkmcnt(8)
  v_mfma_f32_16x16x32_bf16 v[180:183], v[240:243], v[68:71], 0
  ds_read_b128 v[240:243], v2 offset:51968
  v_mfma_f32_16x16x32_bf16 v[164:167], v[244:247], v[72:75], v[164:167]
  ds_read_b128 v[244:247], v2 offset:52992
  v_mfma_f32_16x16x32_bf16 v[168:171], v[248:251], v[72:75], v[168:171]
  ds_read_b128 v[248:251], v2 offset:54016
  s_waitcnt vmcnt(19)
  s_barrier
  v_mfma_f32_16x16x32_bf16 v[172:175], v[252:255], v[72:75], v[172:175]
  ds_read_b128 v[252:255], v2 offset:55040
  s_waitcnt lgkmcnt(8)
  v_mfma_f32_16x16x32_bf16 v[176:179], v[196:199], v[72:75], v[176:179]
  ds_read_b128 v[196:199], v2 offset:56064
  v_mfma_f32_16x16x32_bf16 v[180:183], v[200:203], v[72:75], v[180:183]
  ds_read_b128 v[200:203], v2 offset:57088
  v_mfma_f32_16x16x32_bf16 v[164:167], v[204:207], v[76:79], v[164:167]
  ds_read_b128 v[204:207], v2 offset:58112
  v_mfma_f32_16x16x32_bf16 v[168:171], v[208:211], v[76:79], v[168:171]
  ds_read_b128 v[208:211], v2 offset:59136
  s_waitcnt lgkmcnt(8)
  v_mfma_f32_16x16x32_bf16 v[172:175], v[224:227], v[76:79], v[172:175]
  ds_read_b128 v[224:227], v2 offset:60160
  v_mfma_f32_16x16x32_bf16 v[176:179], v[228:231], v[76:79], v[176:179]
  ds_read_b128 v[228:231], v2 offset:61184
  v_mfma_f32_16x16x32_bf16 v[180:183], v[232:235], v[76:79], v[180:183]
  ds_read_b128 v[232:235], v2 offset:62208
  v_mfma_f32_16x16x32_bf16 v[164:167], v[236:239], v[80:83], v[164:167]
  ds_read_b128 v[236:239], v2 offset:63232
  s_waitcnt lgkmcnt(8)
  v_mfma_f32_16x16x32_bf16 v[168:171], v[240:243], v[80:83], v[168:171]
  ds_read_b128 v[240:243], v2 offset:64256
  v_mfma_f32_16x16x32_bf16 v[172:175], v[244:247], v[80:83], v[172:175]
  ds_read_b128 v[244:247], v2 offset:65280
  v_mfma_f32_16x16x32_bf16 v[176:179], v[248:251], v[80:83], v[176:179]
  ds_read_b128 v[248:251], v3 offset:768
  v_mfma_f32_16x16x32_bf16 v[180:183], v[252:255], v[80:83], v[180:183]
  ds_read_b128 v[252:255], v3 offset:1792
  s_waitcnt lgkmcnt(8)
  v_mfma_f32_16x16x32_bf16 v[164:167], v[196:199], v[84:87], v[164:167]
  ds_read_b128 v[196:199], v3 offset:2816
  v_mfma_f32_16x16x32_bf16 v[168:171], v[200:203], v[84:87], v[168:171]
  ds_read_b128 v[200:203], v3 offset:3840
  v_mfma_f32_16x16x32_bf16 v[172:175], v[204:207], v[84:87], v[172:175]
  ds_read_b128 v[204:207], v3 offset:4864
  v_mfma_f32_16x16x32_bf16 v[176:179], v[208:211], v[84:87], v[176:179]
  ds_read_b128 v[208:211], v3 offset:5888
  s_waitcnt lgkmcnt(8)
  v_mfma_f32_16x16x32_bf16 v[180:183], v[224:227], v[84:87], v[180:183]
  ds_read_b128 v[224:227], v3 offset:6912
  v_mfma_f32_16x16x32_bf16 v[164:167], v[228:231], v[88:91], v[164:167]
  ds_read_b128 v[228:231], v3 offset:7936
  v_mfma_f32_16x16x32_bf16 v[168:171], v[232:235], v[88:91], v[168:171]
  ds_read_b128 v[232:235], v3 offset:8960
  s_waitcnt vmcnt(14)
  s_barrier
  s_mul_i32 s100, s41, 3072
  s_add_u32 s100, s100, s53
  s_add_u32 s100, s100, 98304
  buffer_load_dword v222, v9, s[4:7], s100 offen sc1
  s_mul_i32 s100, s41, 3072
  s_add_u32 s100, s100, s53
  s_add_u32 s100, s100, 99328
  buffer_load_dword v222, v9, s[4:7], s100 offen sc1
  s_mul_i32 s100, s41, 3072
  s_add_u32 s100, s100, s53
  s_add_u32 s100, s100, 100352
  buffer_load_dword v222, v9, s[4:7], s100 offen sc1
  s_lshl_b32 s100, s2, 11
  s_add_u32 s100, s100, 65536
  buffer_load_dword v222, v42, s[4:7], s100 offen sc1
  v_mfma_f32_16x16x32_bf16 v[172:175], v[236:239], v[88:91], v[172:175]
  ds_read_b128 v[236:239], v3 offset:9984
  s_waitcnt lgkmcnt(8)
  v_mfma_f32_16x16x32_bf16 v[176:179], v[240:243], v[88:91], v[176:179]
  ds_read_b128 v[240:243], v1 offset:0
  v_mfma_f32_16x16x32_bf16 v[180:183], v[244:247], v[88:91], v[180:183]
  ds_read_b128 v[244:247], v1 offset:1024
  v_mfma_f32_16x16x32_bf16 v[164:167], v[248:251], v[92:95], v[164:167]
  ds_read_b128 v[248:251], v1 offset:2048
  v_mfma_f32_16x16x32_bf16 v[168:171], v[252:255], v[92:95], v[168:171]
  ds_read_b128 v[252:255], v1 offset:3072
  s_waitcnt lgkmcnt(8)
  v_mfma_f32_16x16x32_bf16 v[172:175], v[196:199], v[92:95], v[172:175]
  ds_read_b128 v[196:199], v1 offset:4096
  v_mfma_f32_16x16x32_bf16 v[176:179], v[200:203], v[92:95], v[176:179]
  ds_read_b128 v[200:203], v1 offset:5120
  v_mfma_f32_16x16x32_bf16 v[180:183], v[204:207], v[92:95], v[180:183]
  ds_read_b128 v[204:207], v1 offset:6144
  v_mfma_f32_16x16x32_bf16 v[164:167], v[208:211], v[96:99], v[164:167]
  ds_read_b128 v[208:211], v1 offset:7168
  s_waitcnt lgkmcnt(8)
  v_mfma_f32_16x16x32_bf16 v[168:171], v[224:227], v[96:99], v[168:171]
  ds_read_b128 v[224:227], v1 offset:8192
  v_mfma_f32_16x16x32_bf16 v[172:175], v[228:231], v[96:99], v[172:175]
  ds_read_b128 v[228:231], v1 offset:9216
  v_mfma_f32_16x16x32_bf16 v[176:179], v[232:235], v[96:99], v[176:179]
  ds_read_b128 v[232:235], v1 offset:10240
  v_mfma_f32_16x16x32_bf16 v[180:183], v[236:239], v[96:99], v[180:183]
  ds_read_b128 v[236:239], v1 offset:11264
  s_waitcnt lgkmcnt(8)
  v_mfma_f32_16x16x32_bf16 v[164:167], v[240:243], v[100:103], v[164:167]
  ds_read_b128 v[240:243], v1 offset:12288
  v_mfma_f32_16x16x32_bf16 v[168:171], v[244:247], v[100:103], v[168:171]
  ds_read_b128 v[244:247], v1 offset:13312
  v_mfma_f32_16x16x32_bf16 v[172:175], v[248:251], v[100:103], v[172:175]
  ds_read_b128 v[248:251], v1 offset:14336
  v_mfma_f32_16x16x32_bf16 v[176:179], v[252:255], v[100:103], v[176:179]
  ds_read_b128 v[252:255], v1 offset:15360
  s_waitcnt lgkmcnt(8)
  v_mfma_f32_16x16x32_bf16 v[180:183], v[196:199], v[100:103], v[180:183]
  ds_read_b128 v[196:199], v1 offset:16384
  v_mfma_f32_16x16x32_bf16 v[164:167], v[200:203], v[104:107], v[164:167]
  ds_read_b128 v[200:203], v1 offset:17408
  v_mfma_f32_16x16x32_bf16 v[168:171], v[204:207], v[104:107], v[168:171]
  ds_read_b128 v[204:207], v1 offset:18432
  s_waitcnt vmcnt(13)
  s_barrier
  v_and_b32 v7, 0x80000180, v9
  v_bfe_u32 v223, v0, 2, 1
  v_lshl_or_b32 v7, v223, 12, v7
  s_lshl_b32 s100, s2, 7
  s_add_u32 s100, s100, s41
  s_lshl_b32 s100, s100, 9
  s_add_u32 s100, s100, 0
  buffer_load_dword v222, v7, s[24:27], s100 offen
  s_lshl_b32 s100, s2, 7
  s_add_u32 s100, s100, s41
  s_lshl_b32 s100, s100, 9
  s_add_u32 s100, s100, 8192
  buffer_load_dword v222, v7, s[24:27], s100 offen
  v_mfma_f32_16x16x32_bf16 v[172:175], v[208:211], v[104:107], v[172:175]
  ds_read_b128 v[208:211], v1 offset:19456
  s_waitcnt lgkmcnt(8)
  v_mfma_f32_16x16x32_bf16 v[176:179], v[224:227], v[104:107], v[176:179]
  ds_read_b128 v[224:227], v1 offset:36864
  v_mfma_f32_16x16x32_bf16 v[180:183], v[228:231], v[104:107], v[180:183]
  ds_read_b128 v[228:231], v1 offset:37888
  v_mfma_f32_16x16x32_bf16 v[164:167], v[232:235], v[108:111], v[164:167]
  ds_read_b128 v[232:235], v1 offset:38912
  v_mfma_f32_16x16x32_bf16 v[168:171], v[236:239], v[108:111], v[168:171]
  s_add_u32 s82, s58, s8
  s_add_u32 m0, s52, 77824
  ds_read_b128 v[236:239], v1 offset:39936
  buffer_load_dwordx4 v29, s[24:27], s82 offen offset:0  lds
  s_waitcnt lgkmcnt(8)
  v_mfma_f32_16x16x32_bf16 v[172:175], v[240:243], v[108:111], v[172:175]
  ds_read_b128 v[240:243], v1 offset:40960
  v_mfma_f32_16x16x32_bf16 v[176:179], v[244:247], v[108:111], v[176:179]
  ds_read_b128 v[244:247], v1 offset:41984
  v_mfma_f32_16x16x32_bf16 v[180:183], v[248:251], v[108:111], v[180:183]
  ds_read_b128 v[248:251], v1 offset:43008
  buffer_load_dwordx4 v30, s[24:27], s82 offen offset:1024  lds
  v_mfma_f32_16x16x32_bf16 v[164:167], v[252:255], v[112:115], v[164:167]
  ds_read_b128 v[252:255], v1 offset:44032
  s_waitcnt lgkmcnt(8)
  v_mfma_f32_16x16x32_bf16 v[168:171], v[196:199], v[112:115], v[168:171]
  ds_read_b128 v[196:199], v1 offset:45056
  v_mfma_f32_16x16x32_bf16 v[172:175], v[200:203], v[112:115], v[172:175]
  s_add_u32 s82, s59, s8
  s_add_u32 m0, s52, 79872
  ds_read_b128 v[200:203], v1 offset:46080
  buffer_load_dwordx4 v29, s[24:27], s82 offen offset:0  lds
  v_mfma_f32_16x16x32_bf16 v[176:179], v[204:207], v[112:115], v[176:179]
  ds_read_b128 v[204:207], v1 offset:47104
  v_mfma_f32_16x16x32_bf16 v[180:183], v[208:211], v[112:115], v[180:183]
  ds_read_b128 v[208:211], v1 offset:48128
  s_waitcnt lgkmcnt(8)
  v_mfma_f32_16x16x32_bf16 v[164:167], v[224:227], v[116:119], v[164:167]
  ds_read_b128 v[224:227], v1 offset:49152
  buffer_load_dwordx4 v30, s[24:27], s82 offen offset:1024  lds
  v_mfma_f32_16x16x32_bf16 v[168:171], v[228:231], v[116:119], v[168:171]
  ds_read_b128 v[228:231], v1 offset:50176
  v_mfma_f32_16x16x32_bf16 v[172:175], v[232:235], v[116:119], v[172:175]
  ds_read_b128 v[232:235], v1 offset:51200
  v_mfma_f32_16x16x32_bf16 v[176:179], v[236:239], v[116:119], v[176:179]
  ds_read_b128 v[236:239], v1 offset:52224
  s_waitcnt lgkmcnt(8)
  v_mfma_f32_16x16x32_bf16 v[180:183], v[240:243], v[116:119], v[180:183]
  s_add_u32 s82, s60, s8
  s_add_u32 m0, s52, 81920
  ds_read_b128 v[240:243], v1 offset:53248
  buffer_load_dwordx4 v29, s[24:27], s82 offen offset:0  lds
  v_mfma_f32_16x16x32_bf16 v[164:167], v[244:247], v[120:123], v[164:167]
  ds_read_b128 v[244:247], v1 offset:54272
  v_mfma_f32_16x16x32_bf16 v[168:171], v[248:251], v[120:123], v[168:171]
  ds_read_b128 v[248:251], v1 offset:55296
  s_waitcnt vmcnt(12)
  s_barrier
  buffer_load_dwordx4 v30, s[24:27], s82 offen offset:1024  lds
  s_lshl_b32 s91, s2, 6
  s_add_u32 s91, s91, 4096
  v_min_u32 v162, 39, v0
  v_lshlrev_b32 v162, 3, v162
  v_lshlrev_b32 v163, 1, v14
  buffer_load_dwordx2 v[158:159], v162, s[4:7], s89 offen offset:256 sc1
  buffer_load_dwordx2 v[160:161], v163, s[4:7], s91 offen sc1
  s_lshl_b32 s100, s2, 7
  s_add_u32 s100, s100, s41
  s_lshl_b32 s100, s100, 9
  s_add_u32 s100, s100, 16384
  buffer_load_dword v222, v7, s[24:27], s100 offen
  s_lshl_b32 s100, s2, 7
  s_add_u32 s100, s100, s41
  s_lshl_b32 s100, s100, 9
  s_add_u32 s100, s100, 24576
  buffer_load_dword v222, v7, s[24:27], s100 offen
  v_mfma_f32_16x16x32_bf16 v[172:175], v[252:255], v[120:123], v[172:175]
  ds_read_b128 v[252:255], v1 offset:56320
  s_min_u32 s84, s2, 104
  s_lshl_b32 s84, s84, 6
  s_mul_i32 s85, s41, 217088
  s_add_u32 s85, s85, s84
  s_add_u32 s85, s85, 1048576
  s_add_u32 s86, s85, 108544
  buffer_load_dwordx4 v[184:187], v36, s[4:7], s85 offen sc1
  buffer_load_dwordx4 v[188:191], v36, s[4:7], s86 offen sc1
  s_mul_i32 s87, s41, 6784
  s_add_u32 s84, s84, s87
  s_add_u32 s84, s84, 917504
  s_cmp_gt_u32 s2, 104
  s_cselect_b32 s84, 0x80000000, s84
  s_mov_b32 s87, 0
  s_waitcnt lgkmcnt(8)
  v_mfma_f32_16x16x32_bf16 v[176:179], v[196:199], v[120:123], v[176:179]
  ds_read_b128 v[196:199], v1 offset:57344
  v_mfma_f32_16x16x32_bf16 v[180:183], v[200:203], v[120:123], v[180:183]
  ds_read_b128 v[200:203], v1 offset:58368
  v_mfma_f32_16x16x32_bf16 v[164:167], v[204:207], v[124:127], v[164:167]
  ds_read_b128 v[204:207], v1 offset:59392
  v_mfma_f32_16x16x32_bf16 v[168:171], v[208:211], v[124:127], v[168:171]
  s_add_u32 s82, s61, s8
  s_add_u32 m0, s52, 102400
  ds_read_b128 v[208:211], v1 offset:60416
  buffer_load_dwordx4 v29, s[24:27], s82 offen offset:0  lds
  s_waitcnt lgkmcnt(8)
  v_mfma_f32_16x16x32_bf16 v[172:175], v[224:227], v[124:127], v[172:175]
  ds_read_b128 v[224:227], v1 offset:61440
  v_mfma_f32_16x16x32_bf16 v[176:179], v[228:231], v[124:127], v[176:179]
  ds_read_b128 v[228:231], v1 offset:62464
  v_mfma_f32_16x16x32_bf16 v[180:183], v[232:235], v[124:127], v[180:183]
  ds_read_b128 v[232:235], v1 offset:63488
  buffer_load_dwordx4 v30, s[24:27], s82 offen offset:1024  lds
  v_mfma_f32_16x16x32_bf16 v[164:167], v[236:239], v[128:131], v[164:167]
  ds_read_b128 v[236:239], v1 offset:64512
  s_waitcnt lgkmcnt(8)
  v_mfma_f32_16x16x32_bf16 v[168:171], v[240:243], v[128:131], v[168:171]
  ds_read_b128 v[240:243], v2 offset:0
  v_mfma_f32_16x16x32_bf16 v[172:175], v[244:247], v[128:131], v[172:175]
  ds_read_b128 v[244:247], v2 offset:1024
  v_mfma_f32_16x16x32_bf16 v[176:179], v[248:251], v[128:131], v[176:179]
  ds_read_b128 v[248:251], v2 offset:2048
  v_mfma_f32_16x16x32_bf16 v[180:183], v[252:255], v[128:131], v[180:183]
  s_add_u32 s82, s58, s9
  s_add_u32 m0, s52, 104448
  ds_read_b128 v[252:255], v2 offset:3072
  buffer_load_dwordx4 v29, s[24:27], s82 offen offset:0  lds
  s_waitcnt lgkmcnt(8)
  v_mfma_f32_16x16x32_bf16 v[164:167], v[196:199], v[132:135], v[164:167]
  ds_read_b128 v[196:199], v2 offset:4096
  v_mfma_f32_16x16x32_bf16 v[168:171], v[200:203], v[132:135], v[168:171]
  ds_read_b128 v[200:203], v2 offset:5120
  v_mfma_f32_16x16x32_bf16 v[172:175], v[204:207], v[132:135], v[172:175]
  ds_read_b128 v[204:207], v2 offset:6144
  buffer_load_dwordx4 v30, s[24:27], s82 offen offset:1024  lds
  v_mfma_f32_16x16x32_bf16 v[176:179], v[208:211], v[132:135], v[176:179]
  ds_read_b128 v[208:211], v2 offset:7168
  s_waitcnt lgkmcnt(8)
  v_mfma_f32_16x16x32_bf16 v[180:183], v[224:227], v[132:135], v[180:183]
  ds_read_b128 v[224:227], v2 offset:8192
  v_mfma_f32_16x16x32_bf16 v[164:167], v[228:231], v[136:139], v[164:167]
  ds_read_b128 v[228:231], v2 offset:9216
  v_mfma_f32_16x16x32_bf16 v[168:171], v[232:235], v[136:139], v[168:171]
  ds_read_b128 v[232:235], v2 offset:10240
  s_barrier
  s_add_u32 s82, s59, s9
  s_add_u32 m0, s52, 106496
  s_nop 0
  buffer_load_dwordx4 v29, s[24:27], s82 offen offset:0  lds
  buffer_load_dwordx4 v30, s[24:27], s82 offen offset:1024  lds
  s_waitcnt vmcnt(11)
  v_cmp_ne_u32 s[94:95], s44, v158
  v_cmp_ne_u32 vcc, s44, v159
  s_nop 0
  s_or_b64 s[94:95], vcc, s[94:95]
  s_waitcnt vmcnt(10)
  v_cmp_ne_u32 vcc, s44, v160
  s_nop 0
  s_or_b64 vcc, vcc, s[94:95]
  s_cbranch_vccnz L_spin16
L_back17:
  v_cmp_ne_u32 vcc, s93, v161
  s_nop 0
  s_cmp_eq_u64 vcc, 0
  s_cselect_b32 s48, 1, 0
  s_lshl_b32 s100, s2, 7
  s_add_u32 s100, s100, s41
  s_lshl_b32 s100, s100, 9
  s_add_u32 s100, s100, 32768
  buffer_load_dword v222, v7, s[24:27], s100 offen
  s_lshl_b32 s100, s2, 7
  s_add_u32 s100, s100, s41
  s_lshl_b32 s100, s100, 9
  s_add_u32 s100, s100, 40960
  buffer_load_dword v222, v7, s[24:27], s100 offen
  v_mfma_f32_16x16x32_bf16 v[172:175], v[236:239], v[136:139], v[172:175]
  ds_read_b128 v[236:239], v2 offset:11264
  s_waitcnt lgkmcnt(8)
  v_mfma_f32_16x16x32_bf16 v[176:179], v[240:243], v[136:139], v[176:179]
  s_add_u32 s82, s60, s9
  s_add_u32 m0, s52, 0
  v_mfma_f32_16x16x32_bf16 v[180:183], v[244:247], v[136:139], v[180:183]
  buffer_load_dwordx4 v29, s[24:27], s82 offen offset:0  lds
  v_mfma_f32_16x16x32_bf16 v[164:167], v[248:251], v[140:143], v[164:167]
  v_mfma_f32_16x16x32_bf16 v[168:171], v[252:255], v[140:143], v[168:171]
  s_waitcnt lgkmcnt(4)
  v_mfma_f32_16x16x32_bf16 v[172:175], v[196:199], v[140:143], v[172:175]
  v_mfma_f32_16x16x32_bf16 v[176:179], v[200:203], v[140:143], v[176:179]
  v_mfma_f32_16x16x32_bf16 v[180:183], v[204:207], v[140:143], v[180:183]
  v_mfma_f32_16x16x32_bf16 v[164:167], v[208:211], v[144:147], v[164:167]
  s_waitcnt lgkmcnt(0)
  v_mfma_f32_16x16x32_bf16 v[168:171], v[224:227], v[144:147], v[168:171]
  v_mfma_f32_16x16x32_bf16 v[172:175], v[228:231], v[144:147], v[172:175]
  v_mfma_f32_16x16x32_bf16 v[176:179], v[232:235], v[144:147], v[176:179]
  v_mfma_f32_16x16x32_bf16 v[180:183], v[236:239], v[144:147], v[180:183]
  s_barrier
  s_cmp_eq_u32 s87, 1
  s_cbranch_scc1 L_skip19
  s_waitcnt vmcnt(10)
  v_perm_b32 v192, v185, v184, s56
  v_perm_b32 v193, v187, v186, s57
  v_or_b32 v192, v192, v193
  v_cmp_ne_u32 s[94:95], s44, v192
  s_waitcnt vmcnt(9)
  v_perm_b32 v194, v189, v188, s56
  v_perm_b32 v195, v191, v190, s57
  v_or_b32 v194, v194, v195
  v_cmp_ne_u32 vcc, s44, v194
  s_nop 0
  s_or_b64 vcc, vcc, s[94:95]
  s_cbranch_vccnz L_again20
  v_and_b32 v184, 0xffffff00, v184
  v_and_b32 v185, 0xffffff00, v185
  v_and_b32 v186, 0xffffff00, v186
  v_and_b32 v187, 0xffffff00, v187
  v_and_b32 v188, 0xffffff00, v188
  v_and_b32 v189, 0xffffff00, v189
  v_and_b32 v190, 0xffffff00, v190
  v_and_b32 v191, 0xffffff00, v191
  v_pk_add_f32 v[184:185], v[184:185], v[188:189]
  v_pk_add_f32 v[186:187], v[186:187], v[190:191]
  s_nop 0
  v_add_f32_dpp v184, v184, v184 row_ror:8 row_mask:0xf bank_mask:0xf
  v_add_f32_dpp v185, v185, v185 row_ror:8 row_mask:0xf bank_mask:0xf
  v_add_f32_dpp v186, v186, v186 row_ror:8 row_mask:0xf bank_mask:0xf
  v_add_f32_dpp v187, v187, v187 row_ror:8 row_mask:0xf bank_mask:0xf
  v_add_f32_dpp v184, v184, v184 row_ror:4 row_mask:0xf bank_mask:0xf
  v_add_f32_dpp v185, v185, v185 row_ror:4 row_mask:0xf bank_mask:0xf
  v_add_f32_dpp v186, v186, v186 row_ror:4 row_mask:0xf bank_mask:0xf
  v_add_f32_dpp v187, v187, v187 row_ror:4 row_mask:0xf bank_mask:0xf
  v_pk_mov_b32 v[188:189], v[184:185], v[184:185] op_sel:[0,1]
  v_pk_mov_b32 v[190:191], v[186:187], v[186:187] op_sel:[0,1]
  s_nop 0
  v_permlane32_swap_b32 v184, v188
  v_permlane32_swap_b32 v185, v189
  v_permlane32_swap_b32 v186, v190
  v_permlane32_swap_b32 v187, v191
  v_pk_add_f32 v[184:185], v[184:185], v[188:189]
  v_pk_add_f32 v[186:187], v[186:187], v[190:191]
  v_pk_mov_b32 v[188:189], v[184:185], v[184:185] op_sel:[0,1]
  v_pk_mov_b32 v[190:191], v[186:187], v[186:187] op_sel:[0,1]
  s_nop 0
  v_permlane16_swap_b32 v184, v188
  v_permlane16_swap_b32 v185, v189
  v_permlane16_swap_b32 v186, v190
  v_permlane16_swap_b32 v187, v191
  v_pk_add_f32 v[184:185], v[184:185], v[188:189]
  v_pk_add_f32 v[186:187], v[186:187], v[190:191]
  v_bfi_b32 v184, v15, s44, v184
  v_bfi_b32 v185, v15, s45, v185
  v_bfi_b32 v186, v15, s46, v186
  v_bfi_b32 v187, v15, s47, v187
  buffer_store_dwordx4 v[184:187], v37, s[4:7], s84 offen sc1
  s_mov_b32 s87, 1
  s_branch L_skip19
L_again20:
  buffer_load_dwordx4 v[184:187], v36, s[4:7], s85 offen sc1
  buffer_load_dwordx4 v[188:191], v36, s[4:7], s86 offen sc1
L_skip19:
  s_nop 1
  s_mul_i32 s0, s40, 1680
  s_mul_i32 s1, s41, 6784
  s_add_u32 s0, s0, s1
  s_add_u32 s90, s0, 917504
  buffer_load_dwordx4 v30, s[24:27], s82 offen offset:1024  lds
  s_add_u32 s82, s61, s9
  s_add_u32 m0, s52, 2048
  s_nop 0
  buffer_load_dwordx4 v29, s[24:27], s82 offen offset:0  lds
  buffer_load_dwordx4 v30, s[24:27], s82 offen offset:1024  lds
  s_add_u32 s82, s58, s10
  s_add_u32 m0, s52, 4096
  s_nop 0
  buffer_load_dwordx4 v29, s[24:27], s82 offen offset:0  lds
  buffer_load_dwordx4 v30, s[24:27], s82 offen offset:1024  lds
  s_lshl_b32 s100, s2, 7
  s_add_u32 s100, s100, s41
  s_lshl_b32 s100, s100, 9
  s_add_u32 s100, s100, 49152
  buffer_load_dword v222, v7, s[24:27], s100 offen
  s_lshl_b32 s100, s2, 7
  s_add_u32 s100, s100, s41
  s_lshl_b32 s100, s100, 9
  s_add_u32 s100, s100, 57344
  buffer_load_dword v222, v7, s[24:27], s100 offen
  v_mov_b32 v212, 0x358637bd
  s_add_u32 s82, s59, s10
  s_add_u32 m0, s52, 24576
  s_nop 0
  buffer_load_dwordx4 v29, s[24:27], s82 offen offset:0  lds
  v_mov_b32 v213, 0x3fb8aa3b
  ds_read_b128 v[224:227], v28 offset:768
  ds_read_b128 v[228:231], v28 offset:832
  ds_read_b128 v[232:235], v28 offset:896
  ds_read_b128 v[236:239], v28 offset:960
  ds_read_b128 v[240:243], v28 offset:1024
  s_waitcnt lgkmcnt(4)
  v_pk_fma_f32 v[224:225], v[224:225], v[156:157], v[212:213] op_sel:[0,1,0] op_sel_hi:[1,1,0]
  buffer_load_dwordx4 v30, s[24:27], s82 offen offset:1024  lds
  v_pk_fma_f32 v[226:227], v[226:227], v[156:157], v[212:213] op_sel:[0,1,0] op_sel_hi:[1,1,0]
  v_pk_fma_f32 v[164:165], v[164:165], v[156:157], v[224:225] op_sel_hi:[1,0,1]
  v_pk_fma_f32 v[166:167], v[166:167], v[156:157], v[226:227] op_sel_hi:[1,0,1]
  s_waitcnt lgkmcnt(3)
  v_pk_fma_f32 v[228:229], v[228:229], v[156:157], v[212:213] op_sel:[0,1,0] op_sel_hi:[1,1,0]
  s_add_u32 s82, s60, s10
  s_add_u32 m0, s52, 26624
  s_nop 0
  buffer_load_dwordx4 v29, s[24:27], s82 offen offset:0  lds
  v_pk_fma_f32 v[230:231], v[230:231], v[156:157], v[212:213] op_sel:[0,1,0] op_sel_hi:[1,1,0]
  v_pk_fma_f32 v[168:169], v[168:169], v[156:157], v[228:229] op_sel_hi:[1,0,1]
  v_pk_fma_f32 v[170:171], v[170:171], v[156:157], v[230:231] op_sel_hi:[1,0,1]
  s_waitcnt lgkmcnt(2)
  v_pk_fma_f32 v[232:233], v[232:233], v[156:157], v[212:213] op_sel:[0,1,0] op_sel_hi:[1,1,0]
  buffer_load_dwordx4 v30, s[24:27], s82 offen offset:1024  lds
  v_pk_fma_f32 v[234:235], v[234:235], v[156:157], v[212:213] op_sel:[0,1,0] op_sel_hi:[1,1,0]
  v_pk_fma_f32 v[172:173], v[172:173], v[156:157], v[232:233] op_sel_hi:[1,0,1]
  v_pk_fma_f32 v[174:175], v[174:175], v[156:157], v[234:235] op_sel_hi:[1,0,1]
  s_waitcnt lgkmcnt(1)
  v_pk_fma_f32 v[236:237], v[236:237], v[156:157], v[212:213] op_sel:[0,1,0] op_sel_hi:[1,1,0]
  s_add_u32 s82, s61, s10
  s_add_u32 m0, s52, 28672
  s_nop 0
  buffer_load_dwordx4 v29, s[24:27], s82 offen offset:0  lds
  v_pk_fma_f32 v[238:239], v[238:239], v[156:157], v[212:213] op_sel:[0,1,0] op_sel_hi:[1,1,0]
  v_pk_fma_f32 v[176:177], v[176:177], v[156:157], v[236:237] op_sel_hi:[1,0,1]
  v_pk_fma_f32 v[178:179], v[178:179], v[156:157], v[238:239] op_sel_hi:[1,0,1]
  s_waitcnt lgkmcnt(0)
  v_pk_fma_f32 v[240:241], v[240:241], v[156:157], v[212:213] op_sel:[0,1,0] op_sel_hi:[1,1,0]
  buffer_load_dwordx4 v30, s[24:27], s82 offen offset:1024  lds
  v_pk_fma_f32 v[242:243], v[242:243], v[156:157], v[212:213] op_sel:[0,1,0] op_sel_hi:[1,1,0]
  v_pk_fma_f32 v[180:181], v[180:181], v[156:157], v[240:241] op_sel_hi:[1,0,1]
  v_pk_fma_f32 v[182:183], v[182:183], v[156:157], v[242:243] op_sel_hi:[1,0,1]
  v_pk_mul_f32 v[224:225], v[164:165], v[212:213] op_sel:[0,1] op_sel_hi:[1,1]
  v_pk_mul_f32 v[226:227], v[166:167], v[212:213] op_sel:[0,1] op_sel_hi:[1,1]
  v_exp_f32 v224, v224 clamp
  v_exp_f32 v225, v225 clamp
  v_exp_f32 v226, v226 clamp
  v_exp_f32 v227, v227 clamp
  v_max_f32 v164, v212, v164
  v_max_f32 v165, v212, v165
  v_max_f32 v166, v212, v166
  v_max_f32 v167, v212, v167
  v_pk_add_f32 v[164:165], v[164:165], v[224:225]
  v_pk_add_f32 v[166:167], v[166:167], v[226:227]
  v_pk_mul_f32 v[228:229], v[168:169], v[212:213] op_sel:[0,1] op_sel_hi:[1,1]
  v_pk_mul_f32 v[230:231], v[170:171], v[212:213] op_sel:[0,1] op_sel_hi:[1,1]
  v_exp_f32 v228, v228 clamp
  v_exp_f32 v229, v229 clamp
  v_exp_f32 v230, v230 clamp
  v_exp_f32 v231, v231 clamp
  v_max_f32 v168, v212, v168
  v_max_f32 v169, v212, v169
  v_max_f32 v170, v212, v170
  v_max_f32 v171, v212, v171
  v_pk_add_f32 v[168:169], v[168:169], v[228:229]
  v_pk_add_f32 v[170:171], v[170:171], v[230:231]
  v_pk_mul_f32 v[224:225], v[172:173], v[212:213] op_sel:[0,1] op_sel_hi:[1,1]
  v_pk_mul_f32 v[226:227], v[174:175], v[212:213] op_sel:[0,1] op_sel_hi:[1,1]
  v_exp_f32 v224, v224 clamp
  v_exp_f32 v225, v225 clamp
  v_exp_f32 v226, v226 clamp
  v_exp_f32 v227, v227 clamp
  s_add_u32 s82, s75, 368640
  s_add_u32 m0, s43, 126976
  s_nop 0
  buffer_load_dwordx4 v1, s[4:7], s82 offen offset:0 lds
  v_max_f32 v172, v212, v172
  v_max_f32 v173, v212, v173
  v_max_f32 v174, v212, v174
  v_max_f32 v175, v212, v175
  v_pk_add_f32 v[172:173], v[172:173], v[224:225]
  v_pk_add_f32 v[174:175], v[174:175], v[226:227]
  v_pk_mul_f32 v[228:229], v[176:177], v[212:213] op_sel:[0,1] op_sel_hi:[1,1]
  v_pk_mul_f32 v[230:231], v[178:179], v[212:213] op_sel:[0,1] op_sel_hi:[1,1]
  v_exp_f32 v228, v228 clamp
  v_exp_f32 v229, v229 clamp
  buffer_load_dwordx4 v1, s[4:7], s82 offen offset:1024 lds
  v_exp_f32 v230, v230 clamp
  v_exp_f32 v231, v231 clamp
  v_max_f32 v176, v212, v176
  v_max_f32 v177, v212, v177
  v_max_f32 v178, v212, v178
  v_max_f32 v179, v212, v179
  v_pk_add_f32 v[176:177], v[176:177], v[228:229]
  v_pk_add_f32 v[178:179], v[178:179], v[230:231]
  v_pk_mul_f32 v[224:225], v[180:181], v[212:213] op_sel:[0,1] op_sel_hi:[1,1]
  v_pk_mul_f32 v[226:227], v[182:183], v[212:213] op_sel:[0,1] op_sel_hi:[1,1]
  v_exp_f32 v224, v224 clamp
  v_exp_f32 v225, v225 clamp
  v_exp_f32 v226, v226 clamp
  buffer_load_dwordx4 v1, s[4:7], s82 offen offset:2048 lds
  v_exp_f32 v227, v227 clamp
  v_max_f32 v180, v212, v180
  v_max_f32 v181, v212, v181
  v_max_f32 v182, v212, v182
  v_max_f32 v183, v212, v183
  v_pk_add_f32 v[180:181], v[180:181], v[224:225]
  v_pk_add_f32 v[182:183], v[182:183], v[226:227]
  v_cvt_pk_bf16_f32 v196, v164, v165
  v_cvt_pk_bf16_f32 v197, v166, v167
  v_cvt_pk_bf16_f32 v198, v168, v169
  v_cvt_pk_bf16_f32 v199, v170, v171
  v_cvt_pk_bf16_f32 v200, v172, v173
  v_cvt_pk_bf16_f32 v201, v174, v175
  v_cvt_pk_bf16_f32 v202, v176, v177
  v_cvt_pk_bf16_f32 v203, v178, v179
  v_cvt_pk_bf16_f32 v204, v180, v181
  buffer_load_dwordx4 v1, s[4:7], s82 offen offset:3072 lds
  v_cvt_pk_bf16_f32 v205, v182, v183
  s_cmp_eq_u32 s87, 1
  s_cbranch_scc1 L_skip21
  s_waitcnt vmcnt(17)
  v_perm_b32 v192, v185, v184, s56
  v_perm_b32 v193, v187, v186, s57
  v_or_b32 v192, v192, v193
  v_cmp_ne_u32 s[94:95], s44, v192
  s_waitcnt vmcnt(17)
  v_perm_b32 v194, v189, v188, s56
  v_perm_b32 v195, v191, v190, s57
  v_or_b32 v194, v194, v195
  v_cmp_ne_u32 vcc, s44, v194
  s_nop 0
  s_or_b64 vcc, vcc, s[94:95]
  s_cbranch_vccnz L_spin23
L_back24:
  v_and_b32 v184, 0xffffff00, v184
  v_and_b32 v185, 0xffffff00, v185
  v_and_b32 v186, 0xffffff00, v186
  v_and_b32 v187, 0xffffff00, v187
  v_and_b32 v188, 0xffffff00, v188
  v_and_b32 v189, 0xffffff00, v189
  v_and_b32 v190, 0xffffff00, v190
  v_and_b32 v191, 0xffffff00, v191
  v_pk_add_f32 v[184:185], v[184:185], v[188:189]
  v_pk_add_f32 v[186:187], v[186:187], v[190:191]
  s_nop 0
  v_add_f32_dpp v184, v184, v184 row_ror:8 row_mask:0xf bank_mask:0xf
  v_add_f32_dpp v185, v185, v185 row_ror:8 row_mask:0xf bank_mask:0xf
  v_add_f32_dpp v186, v186, v186 row_ror:8 row_mask:0xf bank_mask:0xf
  v_add_f32_dpp v187, v187, v187 row_ror:8 row_mask:0xf bank_mask:0xf
  v_add_f32_dpp v184, v184, v184 row_ror:4 row_mask:0xf bank_mask:0xf
  v_add_f32_dpp v185, v185, v185 row_ror:4 row_mask:0xf bank_mask:0xf
  v_add_f32_dpp v186, v186, v186 row_ror:4 row_mask:0xf bank_mask:0xf
  v_add_f32_dpp v187, v187, v187 row_ror:4 row_mask:0xf bank_mask:0xf
  v_pk_mov_b32 v[188:189], v[184:185], v[184:185] op_sel:[0,1]
  v_pk_mov_b32 v[190:191], v[186:187], v[186:187] op_sel:[0,1]
  s_nop 0
  v_permlane32_swap_b32 v184, v188
  v_permlane32_swap_b32 v185, v189
  v_permlane32_swap_b32 v186, v190
  v_permlane32_swap_b32 v187, v191
  v_pk_add_f32 v[184:185], v[184:185], v[188:189]
  v_pk_add_f32 v[186:187], v[186:187], v[190:191]
  v_pk_mov_b32 v[188:189], v[184:185], v[184:185] op_sel:[0,1]
  v_pk_mov_b32 v[190:191], v[186:187], v[186:187] op_sel:[0,1]
  s_nop 0
  v_permlane16_swap_b32 v184, v188
  v_permlane16_swap_b32 v185, v189
  v_permlane16_swap_b32 v186, v190
  v_permlane16_swap_b32 v187, v191
  v_pk_add_f32 v[184:185], v[184:185], v[188:189]
  v_pk_add_f32 v[186:187], v[186:187], v[190:191]
  v_bfi_b32 v184, v15, s44, v184
  v_bfi_b32 v185, v15, s45, v185
  v_bfi_b32 v186, v15, s46, v186
  v_bfi_b32 v187, v15, s47, v187
  buffer_store_dwordx4 v[184:187], v37, s[4:7], s84 offen sc1
  s_mov_b32 s87, 1
L_skip21:
  s_nop 1
  v_add_u32 v214, 77824, v31
  v_add_u32 v220, 77824, v32
  ds_read_b128 a[0:3], v214 offset:0
  ds_read_b128 a[16:19], v220 offset:0
  ds_read_b128 a[4:7], v214 offset:2048
  ds_read_b128 a[20:23], v220 offset:2048
  ds_read_b128 a[8:11], v214 offset:4096
  s_add_u32 s82, s82, 4096
  s_add_u32 m0, m0, 4096
  ds_read_b128 a[24:27], v220 offset:4096
  buffer_load_dwordx4 v1, s[4:7], s82 offen offset:0 lds
  s_add_u32 s82, s75, 393216
  s_add_u32 m0, s43, 49152
  s_nop 0
  buffer_load_dwordx4 v1, s[4:7], s82 offen offset:0 lds
  buffer_load_dwordx4 v1, s[4:7], s82 offen offset:1024 lds
  buffer_load_dwordx4 v1, s[4:7], s82 offen offset:2048 lds
  buffer_load_dwordx4 v1, s[4:7], s82 offen offset:3072 lds
  s_add_u32 s82, s82, 4096
  s_add_u32 m0, m0, 4096
  s_nop 0
  buffer_load_dwordx4 v1, s[4:7], s82 offen offset:0 lds
  s_waitcnt vmcnt(26) lgkmcnt(0)
  v_add_u32 v214, 102400, v31
  v_add_u32 v220, 102400, v32
  ds_read_b128 a[12:15], v214 offset:0
  ds_read_b128 a[28:31], v220 offset:0
  ds_read_b128 a[32:35], v214 offset:2048
  ds_read_b128 a[48:51], v220 offset:2048
  ds_read_b128 a[36:39], v214 offset:4096
  ds_read_b128 a[52:55], v220 offset:4096
  s_waitcnt vmcnt(18) lgkmcnt(0)
  v_add_u32 v214, 0, v31
  v_add_u32 v220, 0, v32
  ds_read_b128 a[40:43], v214 offset:0
  ds_read_b128 a[56:59], v220 offset:0
  ds_read_b128 a[44:47], v214 offset:2048
  ds_read_b128 a[60:63], v220 offset:2048
  ds_read_b128 a[64:67], v214 offset:4096
  ds_read_b128 a[80:83], v220 offset:4096
  s_waitcnt vmcnt(10) lgkmcnt(0)
  v_add_u32 v214, 24576, v31
  v_add_u32 v220, 24576, v32
  ds_read_b128 a[68:71], v214 offset:0
  ds_read_b128 a[84:87], v220 offset:0
  ds_read_b128 a[72:75], v214 offset:2048
  ds_read_b128 a[88:91], v220 offset:2048
  ds_read_b128 a[76:79], v214 offset:4096
  ds_read_b128 a[92:95], v220 offset:4096
  s_waitcnt lgkmcnt(0)
  s_mov_b32 s88, 0
L_poll26:
  buffer_load_dwordx4 v[124:127], v1, s[4:7], s90 offen sc1
  buffer_load_dwordx4 v[128:131], v1, s[4:7], s90 offen offset:1024 sc1
  s_add_u32 s88, s88, 1
  s_cmp_gt_u32 s88, 65536
  s_cbranch_scc1 L_abort
  s_waitcnt vmcnt(0)
  v_perm_b32 v132, v129, v128, s56
  v_perm_b32 v133, v131, v130, s57
  v_or_b32 v132, v132, v133
  v_cmp_ne_u32 s[94:95], s44, v132
  v_perm_b32 v134, v125, v124, s56
  v_perm_b32 v135, v127, v126, s57
  v_or_b32 v134, v134, v135
  v_cmp_ne_u32 vcc, s44, v134
  s_and_b64 s[94:95], s[94:95], s[72:73]
  s_or_b64 vcc, vcc, s[94:95]
  s_cbranch_vccnz L_poll26
  s_mul_i32 s0, s41, 144
  s_mul_i32 s1, s40, 5
  s_add_u32 s0, s0, s1
  s_lshl_b32 s0, s0, 9
  s_add_u32 s0, s0, 25206784
  buffer_load_dwordx4 a[232:235], v46, s[4:7], s0 offen offset:0
  buffer_load_dwordx4 a[236:239], v46, s[4:7], s0 offen offset:512
  buffer_load_dwordx4 a[240:243], v46, s[4:7], s0 offen offset:1024
  buffer_load_dwordx4 a[244:247], v46, s[4:7], s0 offen offset:1536
  buffer_load_dwordx4 a[248:251], v46, s[4:7], s0 offen offset:2048
  v_and_b32 v124, 0xffffff00, v124
  v_and_b32 v125, 0xffffff00, v125
  v_and_b32 v126, 0xffffff00, v126
  v_and_b32 v127, 0xffffff00, v127
  v_and_b32 v128, 0xffffff00, v128
  v_and_b32 v129, 0xffffff00, v129
  v_and_b32 v130, 0xffffff00, v130
  v_and_b32 v131, 0xffffff00, v131
  v_cvt_pk_bf16_f32 v124, v124, v125
  v_cvt_pk_bf16_f32 v125, v126, v127
  ds_write_b64 v18, v[124:125]
  v_cvt_pk_bf16_f32 v128, v128, v129
  v_cvt_pk_bf16_f32 v129, v130, v131
  ds_write_b64 v19, v[128:129]
  s_waitcnt lgkmcnt(0)
  s_barrier
  ds_read_b64 v[68:69], v17 offset:0
  ds_read_b64 v[70:71], v17 offset:128
  ds_read_b64 v[72:73], v17 offset:256
  ds_read_b64 v[74:75], v17 offset:384
  ds_read_b64 v[76:77], v17 offset:512
  ds_read_b64 v[78:79], v16 offset:128
  ds_read_b64 v[80:81], v16 offset:1536
  ds_read_b64 v[82:83], v16 offset:256
  ds_read_b64 v[84:85], v16 offset:1664
  ds_read_b64 v[86:87], v16 offset:3072
  ds_read_b64 v[88:89], v16 offset:1792
  ds_read_b64 v[90:91], v16 offset:3200
  ds_read_b64 v[92:93], v16 offset:4608
  ds_read_b64 v[94:95], v16 offset:3328
  ds_read_b64 v[96:97], v16 offset:4736
  ds_read_b64 v[98:99], v16 offset:6144
  ds_read_b64 v[100:101], v16 offset:4864
  ds_read_b64 v[102:103], v16 offset:6272
  s_waitcnt lgkmcnt(15)
  v_mfma_f32_16x16x16_bf16 v[108:111], v[68:69], v[196:197], 0
  s_waitcnt lgkmcnt(15)
  v_mfma_f32_16x16x16_bf16 v[108:111], v[70:71], v[198:199], v[108:111]
  s_waitcnt lgkmcnt(15)
  v_mfma_f32_16x16x16_bf16 v[108:111], v[72:73], v[200:201], v[108:111]
  s_waitcnt lgkmcnt(14)
  v_mfma_f32_16x16x16_bf16 v[108:111], v[74:75], v[202:203], v[108:111]
  s_waitcnt lgkmcnt(13)
  v_mfma_f32_16x16x16_bf16 v[108:111], v[76:77], v[204:205], v[108:111]
  s_waitcnt lgkmcnt(12)
  v_mfma_f32_16x16x16_bf16 v[164:167], v[78:79], v[196:197], 0
  s_waitcnt lgkmcnt(11)
  v_mfma_f32_16x16x16_bf16 v[164:167], v[80:81], v[198:199], v[164:167]
  s_waitcnt lgkmcnt(10)
  v_mfma_f32_16x16x16_bf16 v[168:171], v[82:83], v[196:197], 0
  s_waitcnt lgkmcnt(9)
  v_mfma_f32_16x16x16_bf16 v[168:171], v[84:85], v[198:199], v[168:171]
  s_waitcnt lgkmcnt(8)
  v_mfma_f32_16x16x16_bf16 v[168:171], v[86:87], v[200:201], v[168:171]
  s_waitcnt lgkmcnt(7)
  v_mfma_f32_16x16x16_bf16 v[172:175], v[88:89], v[198:199], 0
  s_waitcnt lgkmcnt(6)
  v_mfma_f32_16x16x16_bf16 v[172:175], v[90:91], v[200:201], v[172:175]
  s_waitcnt lgkmcnt(5)
  v_mfma_f32_16x16x16_bf16 v[172:175], v[92:93], v[202:203], v[172:175]
  s_waitcnt lgkmcnt(4)
  v_mfma_f32_16x16x16_bf16 v[176:179], v[94:95], v[200:201], 0
  s_waitcnt lgkmcnt(3)
  v_mfma_f32_16x16x16_bf16 v[176:179], v[96:97], v[202:203], v[176:179]
  s_waitcnt lgkmcnt(2)
  v_mfma_f32_16x16x16_bf16 v[176:179], v[98:99], v[204:205], v[176:179]
  s_waitcnt lgkmcnt(1)
  v_mfma_f32_16x16x16_bf16 v[180:183], v[100:101], v[202:203], 0
  s_waitcnt lgkmcnt(0)
  v_mfma_f32_16x16x16_bf16 v[180:183], v[102:103], v[204:205], v[180:183]
  v_add_f32 v108, 0x358637bd, v108
  s_add_u32 s82, s75, 417792
  s_add_u32 m0, s43, 0
  s_nop 0
  buffer_load_dwordx4 v1, s[4:7], s82 offen offset:0 lds
  v_add_f32 v109, 0x358637bd, v109
  v_add_f32 v110, 0x358637bd, v110
  v_add_f32 v111, 0x358637bd, v111
  v_rcp_f32 v108, v108
  v_rcp_f32 v109, v109
  v_rcp_f32 v110, v110
  buffer_load_dwordx4 v1, s[4:7], s82 offen offset:1024 lds
  v_rcp_f32 v111, v111
  v_mov_b32 v112, v108
  v_cndmask_b32 v114, v108, v109, s[66:67]
  v_cndmask_b32 v116, v109, v110, s[68:69]
  v_cndmask_b32 v118, v110, v111, s[70:71]
  v_mov_b32 v120, v111
  v_pk_mul_f32 v[164:165], v[164:165], v[112:113] op_sel_hi:[1,0]
  v_pk_mul_f32 v[166:167], v[166:167], v[112:113] op_sel_hi:[1,0]
  v_pk_mul_f32 v[168:169], v[168:169], v[114:115] op_sel_hi:[1,0]
  v_pk_mul_f32 v[170:171], v[170:171], v[114:115] op_sel_hi:[1,0]
  v_pk_mul_f32 v[172:173], v[172:173], v[116:117] op_sel_hi:[1,0]
  buffer_load_dwordx4 v1, s[4:7], s82 offen offset:2048 lds
  v_pk_mul_f32 v[174:175], v[174:175], v[116:117] op_sel_hi:[1,0]
  v_pk_mul_f32 v[176:177], v[176:177], v[118:119] op_sel_hi:[1,0]
  v_pk_mul_f32 v[178:179], v[178:179], v[118:119] op_sel_hi:[1,0]
  v_pk_mul_f32 v[180:181], v[180:181], v[120:121] op_sel_hi:[1,0]
  v_pk_mul_f32 v[182:183], v[182:183], v[120:121] op_sel_hi:[1,0]
  v_cvt_pk_bf16_f32 v224, v164, v165
  v_cvt_pk_bf16_f32 v225, v166, v167
  v_cvt_pk_bf16_f32 v226, v168, v169
  v_cvt_pk_bf16_f32 v227, v170, v171
  v_cvt_pk_bf16_f32 v228, v172, v173
  v_cvt_pk_bf16_f32 v229, v174, v175
  v_cvt_pk_bf16_f32 v230, v176, v177
  v_cvt_pk_bf16_f32 v231, v178, v179
  v_cvt_pk_bf16_f32 v232, v180, v181
  v_cvt_pk_bf16_f32 v233, v182, v183
  s_cmp_eq_u32 s48, 1
  s_cbranch_scc0 L_slow27
  buffer_store_dwordx4 v[224:227], v1, s[4:7], s12 offen
  buffer_store_dwordx4 v[228:231], v1, s[4:7], s12 offen offset:1024
  buffer_store_dwordx2 v[232:233], v1, s[4:7], s13 offen
L_back28:
  buffer_load_dwordx4 v1, s[4:7], s82 offen offset:3072 lds
  s_add_u32 s82, s82, 4096
  s_add_u32 m0, m0, 4096
  s_nop 0
  buffer_load_dwordx4 v1, s[4:7], s82 offen offset:0 lds
  s_add_u32 s82, s75, 442368
  s_add_u32 m0, s43, 20480
  s_nop 0
  buffer_load_dwordx4 v1, s[4:7], s82 offen offset:0 lds
  buffer_load_dwordx4 v1, s[4:7], s82 offen offset:1024 lds
  buffer_load_dwordx4 v1, s[4:7], s82 offen offset:2048 lds
  buffer_load_dwordx4 v1, s[4:7], s82 offen offset:3072 lds
  s_add_u32 s82, s82, 4096
  s_add_u32 m0, m0, 4096
  s_nop 0
  buffer_load_dwordx4 v1, s[4:7], s82 offen offset:0 lds
  s_waitcnt vmcnt(7)
  s_cmp_eq_u32 s48, 1
  s_cbranch_scc0 L_slow29
  buffer_store_dword v25, v13, s[4:7], s18 offen offset:0
L_back30:
L_ph_wo0:
  v_accvgpr_read_b32 v212, a232
  v_accvgpr_read_b32 v213, a233
  v_accvgpr_read_b32 v214, a234
  v_accvgpr_read_b32 v215, a235
  v_accvgpr_read_b32 v216, a236
  v_add_f32 v212, v212, v216
  v_accvgpr_read_b32 v216, a237
  v_add_f32 v213, v213, v216
  s_add_u32 s100, s101, L_ph_z20-L_base
  buffer_load_dword v222, v13, s[96:99], s100 offen
  v_accvgpr_read_b32 v216, a238
  s_add_u32 s82, s75, 466944
  s_add_u32 m0, s43, 69632
  s_nop 0
  buffer_load_dwordx4 v1, s[4:7], s82 offen offset:0 lds
  v_add_f32 v214, v214, v216
  v_accvgpr_read_b32 v216, a239
  v_add_f32 v215, v215, v216
  v_accvgpr_read_b32 v216, a240
  v_add_f32 v212, v212, v216
  v_accvgpr_read_b32 v216, a241
  v_add_f32 v213, v213, v216
  v_accvgpr_read_b32 v216, a242
  v_add_f32 v214, v214, v216
  buffer_load_dwordx4 v1, s[4:7], s82 offen offset:1024 lds
  v_accvgpr_read_b32 v216, a243
  v_add_f32 v215, v215, v216
  v_accvgpr_read_b32 v216, a244
  v_add_f32 v212, v212, v216
  v_accvgpr_read_b32 v216, a245
  v_add_f32 v213, v213, v216
  v_accvgpr_read_b32 v216, a246
  v_add_f32 v214, v214, v216
  v_accvgpr_read_b32 v216, a247
  v_add_f32 v215, v215, v216
  v_accvgpr_read_b32 v216, a248
  v_add_f32 v212, v212, v216
  v_accvgpr_read_b32 v216, a249
  buffer_load_dwordx4 v1, s[4:7], s82 offen offset:2048 lds
  v_add_f32 v213, v213, v216
  v_accvgpr_read_b32 v216, a250
  v_add_f32 v214, v214, v216
  v_accvgpr_read_b32 v216, a251
  v_add_f32 v215, v215, v216
  ds_write_b32 v44, v212 offset:0
  ds_write_b32 v44, v213 offset:16
  ds_write_b32 v44, v214 offset:32
  ds_write_b32 v44, v215 offset:48
  s_waitcnt lgkmcnt(0)
  s_barrier
  v_lshrrev_b32 v216, 2, v1
  buffer_load_dwordx4 v1, s[4:7], s82 offen offset:3072 lds
  v_add_u32 v216, 162944, v216
  ds_read_b128 v[212:215], v45 offset:0
  s_waitcnt lgkmcnt(0)
  v_pk_add_f32 v[212:213], v[212:213], v[214:215]
  v_add_f32 v212, v212, v213
  ds_write_b32 v216, v212 offset:0
  ds_read_b128 v[212:215], v45 offset:1024
  s_waitcnt lgkmcnt(0)
  v_pk_add_f32 v[212:213], v[212:213], v[214:215]
  s_add_u32 s82, s82, 4096
  s_add_u32 m0, m0, 4096
  s_nop 0
  buffer_load_dwordx4 v1, s[4:7], s82 offen offset:0 lds
  v_add_f32 v212, v212, v213
  ds_write_b32 v216, v212 offset:256
  ds_read_b128 v[212:215], v45 offset:2048
  s_waitcnt lgkmcnt(0)
  v_pk_add_f32 v[212:213], v[212:213], v[214:215]
  v_add_f32 v212, v212, v213
  ds_write_b32 v216, v212 offset:512
  s_add_u32 s86, s53, 0
  s_mov_b32 s88, 0
  buffer_load_dword v223, v14, s[4:7], s55 offen offset:0 sc1
  ds_read_b128 v[224:227], v2 offset:61440
  ds_read_b128 v[228:231], v2 offset:62464
  ds_read_b128 v[232:235], v2 offset:63488
  ds_read_b128 v[236:239], v2 offset:64512
  ds_read_b128 v[240:243], v3 offset:0
  ds_read_b128 v[244:247], v3 offset:1024
  ds_read_b128 v[248:251], v3 offset:2048
  ds_read_b128 v[252:255], v3 offset:3072
  ds_read_b128 v[164:167], v3 offset:4096
  ds_read_b128 v[168:171], v3 offset:5120
  ds_read_b128 v[172:175], v3 offset:6144
  ds_read_b128 v[176:179], v3 offset:7168
L_poll31:
  buffer_load_dword v221, v14, s[4:7], s55 offen offset:0 sc1
  s_waitcnt vmcnt(1)
  v_cmp_ne_u32 vcc, s44, v223
  s_cbranch_vccz L_seen32
  buffer_load_dword v223, v14, s[4:7], s55 offen offset:0 sc1
  s_add_u32 s88, s88, 1
  s_cmp_gt_u32 s88, 65536
  s_cbranch_scc1 L_abort
  s_waitcnt vmcnt(1)
  v_cmp_ne_u32 vcc, s44, v221
  s_cbranch_vccnz L_poll31
L_seen32:
  buffer_load_dwordx4 v[68:71], v1, s[4:7], s86 offen offset:0 sc1
  buffer_load_dwordx4 v[72:75], v1, s[4:7], s86 offen offset:1024 sc1
  buffer_load_dwordx4 v[76:79], v1, s[4:7], s86 offen offset:2048 sc1
  buffer_load_dwordx4 v[80:83], v1, s[4:7], s86 offen offset:3072 sc1
  s_add_u32 s86, s86, 4096
  buffer_load_dwordx4 v[84:87], v1, s[4:7], s86 offen offset:0 sc1
  buffer_load_dwordx4 v[88:91], v1, s[4:7], s86 offen offset:1024 sc1
  buffer_load_dwordx4 v[92:95], v1, s[4:7], s86 offen offset:2048 sc1
  buffer_load_dwordx4 v[96:99], v1, s[4:7], s86 offen offset:3072 sc1
  s_waitcnt vmcnt(7) lgkmcnt(8)
  v_mfma_f32_16x16x32_bf16 v[48:51], v[224:227], v[68:71], v[48:51]
  ds_read_b128 v[224:227], v3 offset:8192
  v_mfma_f32_16x16x32_bf16 v[52:55], v[228:231], v[68:71], v[52:55]
  ds_read_b128 v[228:231], v3 offset:9216
  v_mfma_f32_16x16x32_bf16 v[56:59], v[232:235], v[68:71], v[56:59]
  ds_read_b128 v[232:235], v3 offset:10240
  v_mfma_f32_16x16x32_bf16 v[60:63], v[236:239], v[68:71], v[60:63]
  ds_read_b128 v[236:239], v3 offset:11264
  s_waitcnt lgkmcnt(8)
  v_mfma_f32_16x16x32_bf16 v[64:67], v[240:243], v[68:71], v[64:67]
  ds_read_b128 v[240:243], v3 offset:12288
  s_waitcnt vmcnt(6)
  v_mfma_f32_16x16x32_bf16 v[48:51], v[244:247], v[72:75], v[48:51]
  ds_read_b128 v[244:247], v3 offset:13312
  s_mul_i32 s100, s41, 2560
  s_add_u32 s100, s100, s53
  s_add_u32 s100, s100, 98304
  buffer_load_dword v222, v43, s[4:7], s100 offen sc1
  v_mfma_f32_16x16x32_bf16 v[52:55], v[248:251], v[72:75], v[52:55]
  ds_read_b128 v[248:251], v3 offset:14336
  s_barrier
  v_mfma_f32_16x16x32_bf16 v[56:59], v[252:255], v[72:75], v[56:59]
  ds_read_b128 v[252:255], v3 offset:15360
  s_waitcnt lgkmcnt(8)
  v_mfma_f32_16x16x32_bf16 v[60:63], v[164:167], v[72:75], v[60:63]
  ds_read_b128 v[164:167], v1 offset:49152
  v_mfma_f32_16x16x32_bf16 v[64:67], v[168:171], v[72:75], v[64:67]
  s_add_u32 s82, s75, 491520
  s_add_u32 m0, s52, 90112
  ds_read_b128 v[168:171], v1 offset:50176
  buffer_load_dwordx4 v1, s[4:7], s82 offen offset:0 lds
  s_waitcnt vmcnt(7)
  v_mfma_f32_16x16x32_bf16 v[48:51], v[172:175], v[76:79], v[48:51]
  ds_read_b128 v[172:175], v1 offset:51200
  v_mfma_f32_16x16x32_bf16 v[52:55], v[176:179], v[76:79], v[52:55]
  ds_read_b128 v[176:179], v1 offset:52224
  s_waitcnt lgkmcnt(8)
  v_mfma_f32_16x16x32_bf16 v[56:59], v[224:227], v[76:79], v[56:59]
  ds_read_b128 v[224:227], v1 offset:53248
  s_add_u32 s86, s86, 4096
  buffer_load_dwordx4 v[100:103], v1, s[4:7], s86 offen offset:0 sc1
  v_mfma_f32_16x16x32_bf16 v[60:63], v[228:231], v[76:79], v[60:63]
  ds_read_b128 v[228:231], v1 offset:54272
  v_mfma_f32_16x16x32_bf16 v[64:67], v[232:235], v[76:79], v[64:67]
  ds_read_b128 v[232:235], v1 offset:55296
  s_waitcnt vmcnt(7)
  v_mfma_f32_16x16x32_bf16 v[48:51], v[236:239], v[80:83], v[48:51]
  ds_read_b128 v[236:239], v1 offset:56320
  buffer_load_dwordx4 v[104:107], v1, s[4:7], s86 offen offset:1024 sc1
  s_waitcnt lgkmcnt(8)
  v_mfma_f32_16x16x32_bf16 v[52:55], v[240:243], v[80:83], v[52:55]
  ds_read_b128 v[240:243], v1 offset:57344
  v_mfma_f32_16x16x32_bf16 v[56:59], v[244:247], v[80:83], v[56:59]
  ds_read_b128 v[244:247], v1 offset:58368
  v_mfma_f32_16x16x32_bf16 v[60:63], v[248:251], v[80:83], v[60:63]
  ds_read_b128 v[248:251], v1 offset:59392
  v_mfma_f32_16x16x32_bf16 v[64:67], v[252:255], v[80:83], v[64:67]
  ds_read_b128 v[252:255], v1 offset:60416
  buffer_load_dwordx4 v1, s[4:7], s82 offen offset:1024 lds
  s_waitcnt vmcnt(8) lgkmcnt(8)
  v_mfma_f32_16x16x32_bf16 v[48:51], v[164:167], v[84:87], v[48:51]
  ds_read_b128 v[164:167], v1 offset:61440
  v_mfma_f32_16x16x32_bf16 v[52:55], v[168:171], v[84:87], v[52:55]
  ds_read_b128 v[168:171], v1 offset:62464
  v_mfma_f32_16x16x32_bf16 v[56:59], v[172:175], v[84:87], v[56:59]
  ds_read_b128 v[172:175], v1 offset:63488
  buffer_load_dwordx4 v[108:111], v1, s[4:7], s86 offen offset:2048 sc1
  v_mfma_f32_16x16x32_bf16 v[60:63], v[176:179], v[84:87], v[60:63]
  ds_read_b128 v[176:179], v1 offset:64512
  s_waitcnt lgkmcnt(8)
  v_mfma_f32_16x16x32_bf16 v[64:67], v[224:227], v[84:87], v[64:67]
  ds_read_b128 v[224:227], v2 offset:0
  s_waitcnt vmcnt(8)
  v_mfma_f32_16x16x32_bf16 v[48:51], v[228:231], v[88:91], v[48:51]
  ds_read_b128 v[228:231], v2 offset:1024
  buffer_load_dwordx4 v[112:115], v1, s[4:7], s86 offen offset:3072 sc1
  v_mfma_f32_16x16x32_bf16 v[52:55], v[232:235], v[88:91], v[52:55]
  ds_read_b128 v[232:235], v2 offset:2048
  s_barrier
  v_mfma_f32_16x16x32_bf16 v[56:59], v[236:239], v[88:91], v[56:59]
  ds_read_b128 v[236:239], v2 offset:3072
  buffer_load_dwordx4 v1, s[4:7], s82 offen offset:2048 lds
  s_waitcnt lgkmcnt(8)
  v_mfma_f32_16x16x32_bf16 v[60:63], v[240:243], v[88:91], v[60:63]
  ds_read_b128 v[240:243], v1 offset:0
  v_mfma_f32_16x16x32_bf16 v[64:67], v[244:247], v[88:91], v[64:67]
  ds_read_b128 v[244:247], v1 offset:1024
  s_waitcnt vmcnt(9)
  v_mfma_f32_16x16x32_bf16 v[48:51], v[248:251], v[92:95], v[48:51]
  ds_read_b128 v[248:251], v1 offset:2048
  v_mfma_f32_16x16x32_bf16 v[52:55], v[252:255], v[92:95], v[52:55]
  ds_read_b128 v[252:255], v1 offset:3072
  s_waitcnt lgkmcnt(8)
  v_mfma_f32_16x16x32_bf16 v[56:59], v[164:167], v[92:95], v[56:59]
  ds_read_b128 v[164:167], v1 offset:4096
  v_mfma_f32_16x16x32_bf16 v[60:63], v[168:171], v[92:95], v[60:63]
  ds_read_b128 v[168:171], v1 offset:5120
  v_mfma_f32_16x16x32_bf16 v[64:67], v[172:175], v[92:95], v[64:67]
  ds_read_b128 v[172:175], v1 offset:6144
  s_waitcnt vmcnt(8)
  v_mfma_f32_16x16x32_bf16 v[48:51], v[176:179], v[96:99], v[48:51]
  ds_read_b128 v[176:179], v1 offset:7168
  s_waitcnt lgkmcnt(8)
  v_mfma_f32_16x16x32_bf16 v[52:55], v[224:227], v[96:99], v[52:55]
  ds_read_b128 v[224:227], v1 offset:8192
  v_mfma_f32_16x16x32_bf16 v[56:59], v[228:231], v[96:99], v[56:59]
  ds_read_b128 v[228:231], v1 offset:9216
  v_mfma_f32_16x16x32_bf16 v[60:63], v[232:235], v[96:99], v[60:63]
  ds_read_b128 v[232:235], v1 offset:10240
  v_mfma_f32_16x16x32_bf16 v[64:67], v[236:239], v[96:99], v[64:67]
  ds_read_b128 v[236:239], v1 offset:11264
  s_waitcnt vmcnt(5) lgkmcnt(8)
  v_mfma_f32_16x16x32_bf16 v[48:51], v[240:243], v[100:103], v[48:51]
  ds_read_b128 v[240:243], v1 offset:12288
  s_add_u32 s86, s86, 4096
  buffer_load_dwordx4 v[116:119], v1, s[4:7], s86 offen offset:0 sc1
  v_mfma_f32_16x16x32_bf16 v[52:55], v[244:247], v[100:103], v[52:55]
  ds_read_b128 v[244:247], v1 offset:13312
  v_mfma_f32_16x16x32_bf16 v[56:59], v[248:251], v[100:103], v[56:59]
  ds_read_b128 v[248:251], v1 offset:14336
  v_mfma_f32_16x16x32_bf16 v[60:63], v[252:255], v[100:103], v[60:63]
  ds_read_b128 v[252:255], v1 offset:15360
  buffer_load_dwordx4 v[120:123], v1, s[4:7], s86 offen offset:1024 sc1
  s_waitcnt lgkmcnt(8)
  v_mfma_f32_16x16x32_bf16 v[64:67], v[164:167], v[100:103], v[64:67]
  ds_read_b128 v[164:167], v1 offset:16384
  s_waitcnt vmcnt(6)
  v_mfma_f32_16x16x32_bf16 v[48:51], v[168:171], v[104:107], v[48:51]
  ds_read_b128 v[168:171], v1 offset:17408
  v_mfma_f32_16x16x32_bf16 v[52:55], v[172:175], v[104:107], v[52:55]
  ds_read_b128 v[172:175], v1 offset:18432
  s_barrier
  v_mfma_f32_16x16x32_bf16 v[56:59], v[176:179], v[104:107], v[56:59]
  ds_read_b128 v[176:179], v1 offset:19456
  buffer_load_dwordx4 v[124:127], v1, s[4:7], s86 offen offset:2048 sc1
  s_waitcnt lgkmcnt(8)
  v_mfma_f32_16x16x32_bf16 v[60:63], v[224:227], v[104:107], v[60:63]
  ds_read_b128 v[224:227], v1 offset:20480
  v_mfma_f32_16x16x32_bf16 v[64:67], v[228:231], v[104:107], v[64:67]
  ds_read_b128 v[228:231], v1 offset:21504
  buffer_load_dwordx4 v[128:131], v1, s[4:7], s86 offen offset:3072 sc1
  s_waitcnt vmcnt(6)
  v_mfma_f32_16x16x32_bf16 v[48:51], v[232:235], v[108:111], v[48:51]
  ds_read_b128 v[232:235], v1 offset:22528
  v_mfma_f32_16x16x32_bf16 v[52:55], v[236:239], v[108:111], v[52:55]
  ds_read_b128 v[236:239], v1 offset:23552
  s_waitcnt lgkmcnt(8)
  v_mfma_f32_16x16x32_bf16 v[56:59], v[240:243], v[108:111], v[56:59]
  ds_read_b128 v[240:243], v1 offset:24576
  v_mfma_f32_16x16x32_bf16 v[60:63], v[244:247], v[108:111], v[60:63]
  ds_read_b128 v[244:247], v1 offset:25600
  s_add_u32 s86, s86, 4096
  buffer_load_dwordx4 v[132:135], v1, s[4:7], s86 offen offset:0 sc1
  v_mfma_f32_16x16x32_bf16 v[64:67], v[248:251], v[108:111], v[64:67]
  ds_read_b128 v[248:251], v1 offset:26624
  s_waitcnt vmcnt(6)
  v_mfma_f32_16x16x32_bf16 v[48:51], v[252:255], v[112:115], v[48:51]
  ds_read_b128 v[252:255], v1 offset:27648
  s_waitcnt lgkmcnt(8)
  v_mfma_f32_16x16x32_bf16 v[52:55], v[164:167], v[112:115], v[52:55]
  ds_read_b128 v[164:167], v1 offset:28672
  buffer_load_dwordx4 v[136:139], v1, s[4:7], s86 offen offset:1024 sc1
  v_mfma_f32_16x16x32_bf16 v[56:59], v[168:171], v[112:115], v[56:59]
  ds_read_b128 v[168:171], v1 offset:29696
  v_mfma_f32_16x16x32_bf16 v[60:63], v[172:175], v[112:115], v[60:63]
  ds_read_b128 v[172:175], v1 offset:30720
  v_mfma_f32_16x16x32_bf16 v[64:67], v[176:179], v[112:115], v[64:67]
  ds_read_b128 v[176:179], v1 offset:31744
  buffer_load_dwordx4 v1, s[4:7], s82 offen offset:3072 lds
  s_waitcnt vmcnt(6) lgkmcnt(8)
  v_mfma_f32_16x16x32_bf16 v[48:51], v[224:227], v[116:119], v[48:51]
  ds_read_b128 v[224:227], v1 offset:32768
  v_mfma_f32_16x16x32_bf16 v[52:55], v[228:231], v[116:119], v[52:55]
  ds_read_b128 v[228:231], v1 offset:33792
  v_mfma_f32_16x16x32_bf16 v[56:59], v[232:235], v[116:119], v[56:59]
  ds_read_b128 v[232:235], v1 offset:34816
  v_mfma_f32_16x16x32_bf16 v[60:63], v[236:239], v[116:119], v[60:63]
  ds_read_b128 v[236:239], v1 offset:35840
  buffer_load_dwordx4 v[140:143], v1, s[4:7], s86 offen offset:2048 sc1
  s_waitcnt lgkmcnt(8)
  v_mfma_f32_16x16x32_bf16 v[64:67], v[240:243], v[116:119], v[64:67]
  ds_read_b128 v[240:243], v1 offset:36864
  s_waitcnt vmcnt(6)
  v_mfma_f32_16x16x32_bf16 v[48:51], v[244:247], v[120:123], v[48:51]
  ds_read_b128 v[244:247], v1 offset:37888
  v_mfma_f32_16x16x32_bf16 v[52:55], v[248:251], v[120:123], v[52:55]
  ds_read_b128 v[248:251], v1 offset:38912
  s_barrier
  v_mfma_f32_16x16x32_bf16 v[56:59], v[252:255], v[120:123], v[56:59]
  ds_read_b128 v[252:255], v1 offset:39936
  buffer_load_dwordx4 v[144:147], v1, s[4:7], s86 offen offset:3072 sc1
  s_waitcnt lgkmcnt(8)
  v_mfma_f32_16x16x32_bf16 v[60:63], v[164:167], v[120:123], v[60:63]
  ds_read_b128 v[164:167], v2 offset:4096
  v_mfma_f32_16x16x32_bf16 v[64:67], v[168:171], v[120:123], v[64:67]
  s_add_u32 s82, s82, 4096
  s_add_u32 m0, m0, 4096
  ds_read_b128 v[168:171], v2 offset:5120
  buffer_load_dwordx4 v1, s[4:7], s82 offen offset:0 lds
  s_waitcnt vmcnt(7)
  v_mfma_f32_16x16x32_bf16 v[48:51], v[172:175], v[124:127], v[48:51]
  ds_read_b128 v[172:175], v2 offset:6144
  v_mfma_f32_16x16x32_bf16 v[52:55], v[176:179], v[124:127], v[52:55]
  ds_read_b128 v[176:179], v2 offset:7168
  s_waitcnt lgkmcnt(8)
  v_mfma_f32_16x16x32_bf16 v[56:59], v[224:227], v[124:127], v[56:59]
  ds_read_b128 v[224:227], v2 offset:8192
  buffer_load_dwordx4 v1, s[4:7], s82 offen offset:1024 lds
  v_mfma_f32_16x16x32_bf16 v[60:63], v[228:231], v[124:127], v[60:63]
  ds_read_b128 v[228:231], v2 offset:9216
  v_mfma_f32_16x16x32_bf16 v[64:67], v[232:235], v[124:127], v[64:67]
  ds_read_b128 v[232:235], v2 offset:10240
  s_waitcnt vmcnt(7)
  v_mfma_f32_16x16x32_bf16 v[48:51], v[236:239], v[128:131], v[48:51]
  ds_read_b128 v[236:239], v2 offset:11264
  s_waitcnt lgkmcnt(8)
  v_mfma_f32_16x16x32_bf16 v[52:55], v[240:243], v[128:131], v[52:55]
  s_add_u32 s82, s75, 516096
  s_add_u32 m0, s52, 114688
  ds_read_b128 v[240:243], v2 offset:12288
  buffer_load_dwordx4 v1, s[4:7], s82 offen offset:0 lds
  v_mfma_f32_16x16x32_bf16 v[56:59], v[244:247], v[128:131], v[56:59]
  ds_read_b128 v[244:247], v2 offset:13312
  v_mfma_f32_16x16x32_bf16 v[60:63], v[248:251], v[128:131], v[60:63]
  ds_read_b128 v[248:251], v2 offset:14336
  v_mfma_f32_16x16x32_bf16 v[64:67], v[252:255], v[128:131], v[64:67]
  ds_read_b128 v[252:255], v2 offset:15360
  buffer_load_dwordx4 v1, s[4:7], s82 offen offset:1024 lds
  s_waitcnt vmcnt(8) lgkmcnt(8)
  v_mfma_f32_16x16x32_bf16 v[48:51], v[164:167], v[132:135], v[48:51]
  ds_read_b128 v[164:167], v2 offset:16384
  v_mfma_f32_16x16x32_bf16 v[52:55], v[168:171], v[132:135], v[52:55]
  ds_read_b128 v[168:171], v2 offset:17408
  v_mfma_f32_16x16x32_bf16 v[56:59], v[172:175], v[132:135], v[56:59]
  ds_read_b128 v[172:175], v2 offset:18432
  buffer_load_dwordx4 v1, s[4:7], s82 offen offset:2048 lds
  v_mfma_f32_16x16x32_bf16 v[60:63], v[176:179], v[132:135], v[60:63]
  ds_read_b128 v[176:179], v2 offset:19456
  s_waitcnt lgkmcnt(8)
  v_mfma_f32_16x16x32_bf16 v[64:67], v[224:227], v[132:135], v[64:67]
  ds_read_b128 v[224:227], v2 offset:20480
  s_waitcnt vmcnt(8)
  v_mfma_f32_16x16x32_bf16 v[48:51], v[228:231], v[136:139], v[48:51]
  ds_read_b128 v[228:231], v2 offset:21504
  buffer_load_dwordx4 v1, s[4:7], s82 offen offset:3072 lds
  v_mfma_f32_16x16x32_bf16 v[52:55], v[232:235], v[136:139], v[52:55]
  ds_read_b128 v[232:235], v2 offset:22528
  s_barrier
  v_mfma_f32_16x16x32_bf16 v[56:59], v[236:239], v[136:139], v[56:59]
  s_add_u32 s82, s82, 4096
  s_add_u32 m0, m0, 4096
  ds_read_b128 v[236:239], v2 offset:23552
  buffer_load_dwordx4 v1, s[4:7], s82 offen offset:0 lds
  s_waitcnt lgkmcnt(8)
  v_mfma_f32_16x16x32_bf16 v[60:63], v[240:243], v[136:139], v[60:63]
  v_mfma_f32_16x16x32_bf16 v[64:67], v[244:247], v[136:139], v[64:67]
  s_waitcnt vmcnt(8)
  v_mfma_f32_16x16x32_bf16 v[48:51], v[248:251], v[140:143], v[48:51]
  buffer_load_dwordx4 v1, s[4:7], s82 offen offset:1024 lds
  v_mfma_f32_16x16x32_bf16 v[52:55], v[252:255], v[140:143], v[52:55]
  s_waitcnt lgkmcnt(4)
  v_mfma_f32_16x16x32_bf16 v[56:59], v[164:167], v[140:143], v[56:59]
  s_add_u32 s82, s75, 540672
  s_add_u32 m0, s52, 40960
  v_mfma_f32_16x16x32_bf16 v[60:63], v[168:171], v[140:143], v[60:63]
  buffer_load_dwordx4 v1, s[4:7], s82 offen offset:0 lds
  v_mfma_f32_16x16x32_bf16 v[64:67], v[172:175], v[140:143], v[64:67]
  s_waitcnt vmcnt(9)
  v_mfma_f32_16x16x32_bf16 v[48:51], v[176:179], v[144:147], v[48:51]
  s_waitcnt lgkmcnt(0)
  v_mfma_f32_16x16x32_bf16 v[52:55], v[224:227], v[144:147], v[52:55]
  v_mfma_f32_16x16x32_bf16 v[56:59], v[228:231], v[144:147], v[56:59]
  buffer_load_dwordx4 v1, s[4:7], s82 offen offset:1024 lds
  v_mfma_f32_16x16x32_bf16 v[60:63], v[232:235], v[144:147], v[60:63]
  v_mfma_f32_16x16x32_bf16 v[64:67], v[236:239], v[144:147], v[64:67]
  s_nop 1
  v_cvt_pk_bf16_f32 v224, v48, v49
  v_cvt_pk_bf16_f32 v225, v50, v51
  v_cvt_pk_bf16_f32 v226, v52, v53
  v_cvt_pk_bf16_f32 v227, v54, v55
  v_cvt_pk_bf16_f32 v228, v56, v57
  v_cvt_pk_bf16_f32 v229, v58, v59
  v_cvt_pk_bf16_f32 v230, v60, v61
  v_cvt_pk_bf16_f32 v231, v62, v63
  v_cvt_pk_bf16_f32 v232, v64, v65
  v_cvt_pk_bf16_f32 v233, v66, v67
  s_cmp_eq_u32 s48, 1
  s_cbranch_scc0 L_slow33
  buffer_store_dwordx4 v[224:227], v1, s[4:7], s14 offen
  buffer_store_dwordx4 v[228:231], v1, s[4:7], s14 offen offset:1024
  buffer_store_dwordx2 v[232:233], v1, s[4:7], s15 offen
L_back34:
  v_pk_add_f32 v[236:237], v[48:49], v[50:51]
  v_pk_mul_f32 v[238:239], v[48:49], v[48:49]
  v_pk_fma_f32 v[238:239], v[50:51], v[50:51], v[238:239]
  v_pk_add_f32 v[236:237], v[236:237], v[52:53]
  v_pk_fma_f32 v[238:239], v[52:53], v[52:53], v[238:239]
  v_pk_add_f32 v[236:237], v[236:237], v[54:55]
  v_pk_fma_f32 v[238:239], v[54:55], v[54:55], v[238:239]
  v_pk_add_f32 v[236:237], v[236:237], v[56:57]
  v_pk_fma_f32 v[238:239], v[56:57], v[56:57], v[238:239]
  v_pk_add_f32 v[236:237], v[236:237], v[58:59]
  v_pk_fma_f32 v[238:239], v[58:59], v[58:59], v[238:239]
  v_pk_add_f32 v[236:237], v[236:237], v[60:61]
  v_pk_fma_f32 v[238:239], v[60:61], v[60:61], v[238:239]
  v_pk_add_f32 v[236:237], v[236:237], v[62:63]
  v_pk_fma_f32 v[238:239], v[62:63], v[62:63], v[238:239]
  v_pk_add_f32 v[236:237], v[236:237], v[64:65]
  v_pk_fma_f32 v[238:239], v[64:65], v[64:65], v[238:239]
  v_pk_add_f32 v[236:237], v[236:237], v[66:67]
  v_pk_fma_f32 v[238:239], v[66:67], v[66:67], v[238:239]
  v_add_f32 v236, v236, v237
  v_add_f32 v238, v238, v239
  s_nop 1
  v_permlane32_swap_b32 v236, v238
  v_add_f32 v236, v236, v238
  v_mov_b32 v238, v236
  s_nop 1
  v_permlane16_swap_b32 v236, v238
  v_add_f32 v236, v236, v238
  s_cmp_eq_u32 s48, 1
  s_cbranch_scc0 L_slow35
  buffer_store_dword v236, v4, s[4:7], s17 offen
L_back36:
  s_barrier
  buffer_load_dwordx4 v1, s[4:7], s82 offen offset:2048 lds
  buffer_load_dwordx4 v1, s[4:7], s82 offen offset:3072 lds
  s_waitcnt vmcnt(2)
  s_cmp_eq_u32 s48, 1
  s_cbranch_scc0 L_slow37
  buffer_store_dword v25, v13, s[4:7], s18 offen offset:32
L_back38:
L_ph_z20:
  s_barrier
  s_add_u32 s86, s53, 98304
  s_mov_b32 s88, 0
  buffer_load_dword v223, v14, s[4:7], s55 offen offset:32 sc1
  ds_read_b128 v[224:227], v2 offset:24576
  ds_read_b128 v[228:231], v2 offset:25600
  ds_read_b128 v[232:235], v2 offset:26624
  ds_read_b128 v[236:239], v2 offset:27648
  ds_read_b128 v[240:243], v2 offset:28672
  ds_read_b128 v[244:247], v2 offset:29696
  ds_read_b128 v[248:251], v2 offset:30720
  ds_read_b128 v[252:255], v2 offset:31744
  ds_read_b128 v[188:191], v2 offset:32768
  ds_read_b128 v[192:195], v2 offset:33792
  ds_read_b128 v[196:199], v2 offset:34816
  ds_read_b128 v[200:203], v2 offset:35840
L_poll39:
  buffer_load_dword v221, v14, s[4:7], s55 offen offset:32 sc1
  s_waitcnt vmcnt(1)
  v_cmp_ne_u32 vcc, s44, v223
  s_cbranch_vccz L_seen40
  buffer_load_dword v223, v14, s[4:7], s55 offen offset:32 sc1
  s_add_u32 s88, s88, 1
  s_cmp_gt_u32 s88, 65536
  s_cbranch_scc1 L_abort
  s_waitcnt vmcnt(1)
  v_cmp_ne_u32 vcc, s44, v221
  s_cbranch_vccnz L_poll39
L_seen40:
  buffer_load_dwordx4 v[68:71], v1, s[4:7], s86 offen offset:0 sc1
  buffer_load_dwordx4 v[72:75], v1, s[4:7], s86 offen offset:1024 sc1
  buffer_load_dwordx4 v[76:79], v1, s[4:7], s86 offen offset:2048 sc1
  buffer_load_dwordx4 v[80:83], v1, s[4:7], s86 offen offset:3072 sc1
  s_add_u32 s86, s86, 4096
  buffer_load_dwordx4 v[84:87], v1, s[4:7], s86 offen offset:0 sc1
  buffer_load_dwordx4 v[88:91], v1, s[4:7], s86 offen offset:1024 sc1
  buffer_load_dwordx4 v[92:95], v1, s[4:7], s86 offen offset:2048 sc1
  buffer_load_dwordx4 v[96:99], v1, s[4:7], s86 offen offset:3072 sc1
  s_waitcnt vmcnt(7) lgkmcnt(8)
  v_mfma_f32_16x16x32_bf16 v[164:167], v[68:71], v[224:227], 0
  ds_read_b128 v[224:227], v2 offset:36864
  s_add_u32 s84, s53, 118784
  buffer_load_dwordx2 v[158:159], v5, s[4:7], s84 offen sc1
  buffer_load_dwordx2 v[160:161], v5, s[4:7], s84 offen offset:128 sc1
  v_mfma_f32_16x16x32_bf16 v[168:171], v[68:71], v[228:231], 0
  s_add_u32 s82, s82, 4096
  s_add_u32 m0, m0, 4096
  ds_read_b128 v[228:231], v2 offset:37888
  buffer_load_dwordx4 v1, s[4:7], s82 offen offset:0 lds
  v_mfma_f32_16x16x32_bf16 v[172:175], v[68:71], v[232:235], 0
  ds_read_b128 v[232:235], v2 offset:38912
  v_mfma_f32_16x16x32_bf16 v[176:179], v[68:71], v[236:239], 0
  ds_read_b128 v[236:239], v2 offset:39936
  s_waitcnt lgkmcnt(8)
  v_mfma_f32_16x16x32_bf16 v[180:183], v[68:71], v[240:243], 0
  ds_read_b128 v[240:243], v2 offset:40960
  buffer_load_dwordx4 v1, s[4:7], s82 offen offset:1024 lds
  v_mfma_f32_16x16x32_bf16 v[184:187], v[68:71], v[244:247], 0
  ds_read_b128 v[244:247], v2 offset:41984
  s_waitcnt vmcnt(10)
  v_mfma_f32_16x16x32_bf16 v[164:167], v[72:75], v[248:251], v[164:167]
  s_add_u32 s82, s75, 565248
  s_add_u32 m0, s52, 0
  ds_read_b128 v[248:251], v2 offset:43008
  buffer_load_dwordx4 v1, s[4:7], s82 offen offset:0 lds
  v_mfma_f32_16x16x32_bf16 v[168:171], v[72:75], v[252:255], v[168:171]
  ds_read_b128 v[252:255], v2 offset:44032
  s_waitcnt lgkmcnt(8)
  v_mfma_f32_16x16x32_bf16 v[172:175], v[72:75], v[188:191], v[172:175]
  ds_read_b128 v[188:191], v2 offset:45056
  s_barrier
  v_mfma_f32_16x16x32_bf16 v[176:179], v[72:75], v[192:195], v[176:179]
  ds_read_b128 v[192:195], v2 offset:46080
  buffer_load_dwordx4 v1, s[4:7], s82 offen offset:1024 lds
  v_mfma_f32_16x16x32_bf16 v[180:183], v[72:75], v[196:199], v[180:183]
  ds_read_b128 v[196:199], v2 offset:47104
  v_mfma_f32_16x16x32_bf16 v[184:187], v[72:75], v[200:203], v[184:187]
  ds_read_b128 v[200:203], v2 offset:48128
  s_waitcnt vmcnt(11) lgkmcnt(8)
  v_mfma_f32_16x16x32_bf16 v[164:167], v[76:79], v[224:227], v[164:167]
  ds_read_b128 v[224:227], v2 offset:49152
  buffer_load_dwordx4 v1, s[4:7], s82 offen offset:2048 lds
  v_mfma_f32_16x16x32_bf16 v[168:171], v[76:79], v[228:231], v[168:171]
  ds_read_b128 v[228:231], v2 offset:50176
  v_mfma_f32_16x16x32_bf16 v[172:175], v[76:79], v[232:235], v[172:175]
  ds_read_b128 v[232:235], v2 offset:51200
  v_mfma_f32_16x16x32_bf16 v[176:179], v[76:79], v[236:239], v[176:179]
  ds_read_b128 v[236:239], v2 offset:52224
  buffer_load_dwordx4 v1, s[4:7], s82 offen offset:3072 lds
  s_waitcnt lgkmcnt(8)
  v_mfma_f32_16x16x32_bf16 v[180:183], v[76:79], v[240:243], v[180:183]
  ds_read_b128 v[240:243], v2 offset:53248
  v_mfma_f32_16x16x32_bf16 v[184:187], v[76:79], v[244:247], v[184:187]
  s_add_u32 s82, s82, 4096
  s_add_u32 m0, m0, 4096
  ds_read_b128 v[244:247], v2 offset:54272
  buffer_load_dwordx4 v1, s[4:7], s82 offen offset:0 lds
  s_waitcnt vmcnt(13)
  v_mfma_f32_16x16x32_bf16 v[164:167], v[80:83], v[248:251], v[164:167]
  ds_read_b128 v[248:251], v2 offset:55296
  v_mfma_f32_16x16x32_bf16 v[168:171], v[80:83], v[252:255], v[168:171]
  ds_read_b128 v[252:255], v2 offset:56320
  s_waitcnt lgkmcnt(8)
  v_mfma_f32_16x16x32_bf16 v[172:175], v[80:83], v[188:191], v[172:175]
  ds_read_b128 v[188:191], v2 offset:57344
  v_mfma_f32_16x16x32_bf16 v[176:179], v[80:83], v[192:195], v[176:179]
  ds_read_b128 v[192:195], v2 offset:58368
  v_mfma_f32_16x16x32_bf16 v[180:183], v[80:83], v[196:199], v[180:183]
  ds_read_b128 v[196:199], v2 offset:59392
  v_mfma_f32_16x16x32_bf16 v[184:187], v[80:83], v[200:203], v[184:187]
  ds_read_b128 v[200:203], v2 offset:60416
  s_waitcnt vmcnt(12) lgkmcnt(8)
  v_mfma_f32_16x16x32_bf16 v[164:167], v[84:87], v[224:227], v[164:167]
  ds_read_b128 v[224:227], v2 offset:61440
  s_add_u32 s86, s86, 4096
  buffer_load_dwordx4 v[100:103], v1, s[4:7], s86 offen offset:0 sc1
  v_mfma_f32_16x16x32_bf16 v[168:171], v[84:87], v[228:231], v[168:171]
  ds_read_b128 v[228:231], v2 offset:62464
  v_mfma_f32_16x16x32_bf16 v[172:175], v[84:87], v[232:235], v[172:175]
  ds_read_b128 v[232:235], v2 offset:63488
  v_mfma_f32_16x16x32_bf16 v[176:179], v[84:87], v[236:239], v[176:179]
  ds_read_b128 v[236:239], v2 offset:64512
  s_waitcnt lgkmcnt(8)
  v_mfma_f32_16x16x32_bf16 v[180:183], v[84:87], v[240:243], v[180:183]
  ds_read_b128 v[240:243], v3 offset:0
  v_mfma_f32_16x16x32_bf16 v[184:187], v[84:87], v[244:247], v[184:187]
  ds_read_b128 v[244:247], v3 offset:1024
  buffer_load_dwordx4 v[104:107], v1, s[4:7], s86 offen offset:1024 sc1
  s_waitcnt vmcnt(13)
  v_mfma_f32_16x16x32_bf16 v[164:167], v[88:91], v[248:251], v[164:167]
  ds_read_b128 v[248:251], v3 offset:2048
  v_mfma_f32_16x16x32_bf16 v[168:171], v[88:91], v[252:255], v[168:171]
  ds_read_b128 v[252:255], v3 offset:3072
  s_waitcnt lgkmcnt(8)
  v_mfma_f32_16x16x32_bf16 v[172:175], v[88:91], v[188:191], v[172:175]
  ds_read_b128 v[188:191], v3 offset:4096
  s_waitcnt vmcnt(7)
  s_barrier
  v_mfma_f32_16x16x32_bf16 v[176:179], v[88:91], v[192:195], v[176:179]
  ds_read_b128 v[192:195], v3 offset:5120
  buffer_load_dwordx4 v[108:111], v1, s[4:7], s86 offen offset:2048 sc1
  v_mfma_f32_16x16x32_bf16 v[180:183], v[88:91], v[196:199], v[180:183]
  ds_read_b128 v[196:199], v3 offset:6144
  v_mfma_f32_16x16x32_bf16 v[184:187], v[88:91], v[200:203], v[184:187]
  ds_read_b128 v[200:203], v3 offset:7168
  buffer_load_dwordx4 v1, s[4:7], s82 offen offset:1024 lds
  s_waitcnt lgkmcnt(8)
  v_mfma_f32_16x16x32_bf16 v[164:167], v[92:95], v[224:227], v[164:167]
  ds_read_b128 v[224:227], v1 offset:40960
  v_pk_add_f32 v[158:159], v[158:159], v[160:161]
  v_mfma_f32_16x16x32_bf16 v[168:171], v[92:95], v[228:231], v[168:171]
  ds_read_b128 v[228:231], v1 offset:41984
  v_mov_b32 v160, v158
  v_mfma_f32_16x16x32_bf16 v[172:175], v[92:95], v[232:235], v[172:175]
  ds_read_b128 v[232:235], v1 offset:43008
  v_mov_b32 v161, v159
  v_mfma_f32_16x16x32_bf16 v[176:179], v[92:95], v[236:239], v[176:179]
  ds_read_b128 v[236:239], v1 offset:44032
  buffer_load_dwordx4 v[112:115], v1, s[4:7], s86 offen offset:3072 sc1
  s_waitcnt lgkmcnt(8)
  v_mfma_f32_16x16x32_bf16 v[180:183], v[92:95], v[240:243], v[180:183]
  s_add_u32 s82, s75, 589824
  s_add_u32 m0, s52, 65536
  ds_read_b128 v[240:243], v1 offset:45056
  buffer_load_dwordx4 v1, s[4:7], s82 offen offset:0 lds
  v_mfma_f32_16x16x32_bf16 v[184:187], v[92:95], v[244:247], v[184:187]
  ds_read_b128 v[244:247], v1 offset:46080
  v_permlane32_swap_b32 v158, v160
  v_mfma_f32_16x16x32_bf16 v[164:167], v[96:99], v[248:251], v[164:167]
  ds_read_b128 v[248:251], v1 offset:47104
  v_permlane32_swap_b32 v159, v161
  v_mfma_f32_16x16x32_bf16 v[168:171], v[96:99], v[252:255], v[168:171]
  ds_read_b128 v[252:255], v1 offset:48128
  v_pk_add_f32 v[158:159], v[158:159], v[160:161]
  s_waitcnt lgkmcnt(8)
  v_mfma_f32_16x16x32_bf16 v[172:175], v[96:99], v[188:191], v[172:175]
  ds_read_b128 v[188:191], v1 offset:49152
  v_mov_b32 v160, v158
  v_mfma_f32_16x16x32_bf16 v[176:179], v[96:99], v[192:195], v[176:179]
  ds_read_b128 v[192:195], v1 offset:50176
  s_add_u32 s86, s86, 4096
  buffer_load_dwordx4 v[116:119], v1, s[4:7], s86 offen offset:0 sc1
  v_mfma_f32_16x16x32_bf16 v[180:183], v[96:99], v[196:199], v[180:183]
  ds_read_b128 v[196:199], v1 offset:51200
  buffer_load_dwordx4 v1, s[4:7], s82 offen offset:1024 lds
  v_mfma_f32_16x16x32_bf16 v[184:187], v[96:99], v[200:203], v[184:187]
  ds_read_b128 v[200:203], v1 offset:52224
  v_mov_b32 v161, v159
  s_waitcnt vmcnt(7) lgkmcnt(8)
  v_mfma_f32_16x16x32_bf16 v[164:167], v[100:103], v[224:227], v[164:167]
  ds_read_b128 v[224:227], v1 offset:53248
  buffer_load_dwordx4 v[120:123], v1, s[4:7], s86 offen offset:1024 sc1
  v_mfma_f32_16x16x32_bf16 v[168:171], v[100:103], v[228:231], v[168:171]
  ds_read_b128 v[228:231], v1 offset:54272
  buffer_load_dwordx4 v1, s[4:7], s82 offen offset:2048 lds
  v_mfma_f32_16x16x32_bf16 v[172:175], v[100:103], v[232:235], v[172:175]
  ds_read_b128 v[232:235], v1 offset:55296
  v_permlane16_swap_b32 v158, v160
  v_mfma_f32_16x16x32_bf16 v[176:179], v[100:103], v[236:239], v[176:179]
  ds_read_b128 v[236:239], v1 offset:56320
  buffer_load_dwordx4 v1, s[4:7], s82 offen offset:3072 lds
  s_waitcnt lgkmcnt(8)
  v_mfma_f32_16x16x32_bf16 v[180:183], v[100:103], v[240:243], v[180:183]
  ds_read_b128 v[240:243], v1 offset:57344
  v_mfma_f32_16x16x32_bf16 v[184:187], v[100:103], v[244:247], v[184:187]
  s_add_u32 s82, s82, 4096
  s_add_u32 m0, m0, 4096
  ds_read_b128 v[244:247], v1 offset:58368
  buffer_load_dwordx4 v1, s[4:7], s82 offen offset:0 lds
  s_waitcnt vmcnt(10)
  v_mfma_f32_16x16x32_bf16 v[164:167], v[104:107], v[248:251], v[164:167]
  ds_read_b128 v[248:251], v1 offset:59392
  v_permlane16_swap_b32 v159, v161
  v_mfma_f32_16x16x32_bf16 v[168:171], v[104:107], v[252:255], v[168:171]
  ds_read_b128 v[252:255], v1 offset:60416
  v_pk_add_f32 v[158:159], v[158:159], v[160:161]
  s_waitcnt lgkmcnt(8)
  v_mfma_f32_16x16x32_bf16 v[172:175], v[104:107], v[188:191], v[172:175]
  ds_read_b128 v[188:191], v1 offset:61440
  s_waitcnt vmcnt(8)
  s_barrier
  v_mfma_f32_16x16x32_bf16 v[176:179], v[104:107], v[192:195], v[176:179]
  ds_read_b128 v[192:195], v1 offset:62464
  buffer_load_dwordx4 v[124:127], v1, s[4:7], s86 offen offset:2048 sc1
  v_mfma_f32_16x16x32_bf16 v[180:183], v[104:107], v[196:199], v[180:183]
  ds_read_b128 v[196:199], v1 offset:63488
  buffer_load_dwordx4 v1, s[4:7], s82 offen offset:1024 lds
  v_mfma_f32_16x16x32_bf16 v[184:187], v[104:107], v[200:203], v[184:187]
  ds_read_b128 v[200:203], v1 offset:64512
  v_mul_f32 v158, 0xbacccccd, v158
  s_waitcnt lgkmcnt(8)
  v_mfma_f32_16x16x32_bf16 v[164:167], v[108:111], v[224:227], v[164:167]
  ds_read_b128 v[224:227], v1 offset:0
  v_mul_f32 v159, 0x3acccccd, v159
  v_mfma_f32_16x16x32_bf16 v[168:171], v[108:111], v[228:231], v[168:171]
  ds_read_b128 v[228:231], v1 offset:1024
  v_fma_f32 v159, -v158, v158, v159
  v_mfma_f32_16x16x32_bf16 v[172:175], v[108:111], v[232:235], v[172:175]
  ds_read_b128 v[232:235], v1 offset:2048
  v_max_f32 v159, 0, v159
  v_mfma_f32_16x16x32_bf16 v[176:179], v[108:111], v[236:239], v[176:179]
  ds_read_b128 v[236:239], v1 offset:3072
  buffer_load_dwordx4 v[128:131], v1, s[4:7], s86 offen offset:3072 sc1
  s_waitcnt lgkmcnt(8)
  v_mfma_f32_16x16x32_bf16 v[180:183], v[108:111], v[240:243], v[180:183]
  ds_read_b128 v[240:243], v1 offset:4096
  v_add_f32 v159, 0x3727c5ac, v159
  v_mfma_f32_16x16x32_bf16 v[184:187], v[108:111], v[244:247], v[184:187]
  ds_read_b128 v[244:247], v1 offset:5120
  v_rsq_f32 v156, v159
  s_waitcnt vmcnt(10)
  v_mfma_f32_16x16x32_bf16 v[164:167], v[112:115], v[248:251], v[164:167]
  ds_read_b128 v[248:251], v1 offset:6144
  s_add_u32 s86, s86, 4096
  buffer_load_dwordx4 v[132:135], v1, s[4:7], s86 offen offset:0 sc1
  v_mfma_f32_16x16x32_bf16 v[168:171], v[112:115], v[252:255], v[168:171]
  ds_read_b128 v[252:255], v1 offset:7168
  v_mul_f32 v157, v158, v156
  s_waitcnt lgkmcnt(8)
  v_mfma_f32_16x16x32_bf16 v[172:175], v[112:115], v[188:191], v[172:175]
  ds_read_b128 v[188:191], v1 offset:8192
  ds_bpermute_b32 v148, v6, v156 offset:0
  v_mfma_f32_16x16x32_bf16 v[176:179], v[112:115], v[192:195], v[176:179]
  ds_read_b128 v[192:195], v1 offset:9216
  s_add_u32 s100, s101, L_ph_z10-L_base
  buffer_load_dword v222, v13, s[96:99], s100 offen
  v_mfma_f32_16x16x32_bf16 v[180:183], v[112:115], v[196:199], v[180:183]
  s_add_u32 s82, s75, 614400
  s_add_u32 m0, s52, 90112
  ds_read_b128 v[196:199], v1 offset:10240
  buffer_load_dwordx4 v1, s[4:7], s82 offen offset:0 lds
  v_mfma_f32_16x16x32_bf16 v[184:187], v[112:115], v[200:203], v[184:187]
  ds_read_b128 v[200:203], v1 offset:11264
  ds_bpermute_b32 v152, v6, v157 offset:0
  s_waitcnt vmcnt(11) lgkmcnt(10)
  v_mfma_f32_16x16x32_bf16 v[164:167], v[116:119], v[224:227], v[164:167]
  ds_read_b128 v[224:227], v1 offset:12288
  buffer_load_dwordx4 v[136:139], v1, s[4:7], s86 offen offset:1024 sc1
  v_mfma_f32_16x16x32_bf16 v[168:171], v[116:119], v[228:231], v[168:171]
  ds_read_b128 v[228:231], v1 offset:13312
  ds_bpermute_b32 v149, v6, v156 offset:4
  v_mfma_f32_16x16x32_bf16 v[172:175], v[116:119], v[232:235], v[172:175]
  ds_read_b128 v[232:235], v1 offset:14336
  ds_bpermute_b32 v153, v6, v157 offset:4
  v_mfma_f32_16x16x32_bf16 v[176:179], v[116:119], v[236:239], v[176:179]
  ds_read_b128 v[236:239], v1 offset:15360
  ds_bpermute_b32 v150, v6, v156 offset:8
  s_waitcnt lgkmcnt(13)
  v_mfma_f32_16x16x32_bf16 v[180:183], v[116:119], v[240:243], v[180:183]
  ds_read_b128 v[240:243], v1 offset:16384
  buffer_load_dwordx4 v1, s[4:7], s82 offen offset:1024 lds
  v_mfma_f32_16x16x32_bf16 v[184:187], v[116:119], v[244:247], v[184:187]
  ds_read_b128 v[244:247], v1 offset:17408
  ds_bpermute_b32 v154, v6, v157 offset:8
  s_waitcnt vmcnt(11)
  v_mfma_f32_16x16x32_bf16 v[164:167], v[120:123], v[248:251], v[164:167]
  ds_read_b128 v[248:251], v1 offset:18432
  ds_bpermute_b32 v151, v6, v156 offset:12
  v_mfma_f32_16x16x32_bf16 v[168:171], v[120:123], v[252:255], v[168:171]
  ds_read_b128 v[252:255], v1 offset:19456
  ds_bpermute_b32 v155, v6, v157 offset:12
  s_waitcnt lgkmcnt(15)
  v_mfma_f32_16x16x32_bf16 v[172:175], v[120:123], v[188:191], v[172:175]
  ds_read_b128 v[188:191], v1 offset:20480
  s_waitcnt vmcnt(6)
  s_barrier
  v_mfma_f32_16x16x32_bf16 v[176:179], v[120:123], v[192:195], v[176:179]
  ds_read_b128 v[192:195], v1 offset:21504
  buffer_load_dwordx4 v[140:143], v1, s[4:7], s86 offen offset:2048 sc1
  v_mfma_f32_16x16x32_bf16 v[180:183], v[120:123], v[196:199], v[180:183]
  ds_read_b128 v[196:199], v1 offset:22528
  ds_read_b32 v204, v27 offset:1536
  v_mfma_f32_16x16x32_bf16 v[184:187], v[120:123], v[200:203], v[184:187]
  ds_read_b128 v[200:203], v1 offset:23552
  ds_read_b32 v205, v27 offset:1600
  s_waitcnt lgkmcnt(14)
  v_mfma_f32_16x16x32_bf16 v[164:167], v[124:127], v[224:227], v[164:167]
  ds_read_b128 v[224:227], v2 offset:0
  buffer_load_dwordx4 v[144:147], v1, s[4:7], s86 offen offset:3072 sc1
  v_mfma_f32_16x16x32_bf16 v[168:171], v[124:127], v[228:231], v[168:171]
  ds_read_b128 v[228:231], v2 offset:1024
  ds_read_b32 v206, v27 offset:1664
  v_mfma_f32_16x16x32_bf16 v[172:175], v[124:127], v[232:235], v[172:175]
  ds_read_b128 v[232:235], v2 offset:2048
  ds_read_b32 v207, v27 offset:1728
  v_mfma_f32_16x16x32_bf16 v[176:179], v[124:127], v[236:239], v[176:179]
  ds_read_b128 v[236:239], v2 offset:3072
  buffer_load_dwordx4 v1, s[4:7], s82 offen offset:2048 lds
  s_waitcnt lgkmcnt(13)
  v_mfma_f32_16x16x32_bf16 v[180:183], v[124:127], v[240:243], v[180:183]
  ds_read_b128 v[240:243], v2 offset:4096
  ds_read_b32 v208, v27 offset:1792
  v_mfma_f32_16x16x32_bf16 v[184:187], v[124:127], v[244:247], v[184:187]
  ds_read_b128 v[244:247], v2 offset:5120
  ds_read_b32 v209, v27 offset:1856
  s_waitcnt vmcnt(8)
  v_mfma_f32_16x16x32_bf16 v[164:167], v[128:131], v[248:251], v[164:167]
  ds_read_b128 v[248:251], v2 offset:6144
  buffer_load_dwordx4 v1, s[4:7], s82 offen offset:3072 lds
  v_mfma_f32_16x16x32_bf16 v[168:171], v[128:131], v[252:255], v[168:171]
  ds_read_b128 v[252:255], v2 offset:7168
  s_waitcnt lgkmcnt(13)
  v_mfma_f32_16x16x32_bf16 v[172:175], v[128:131], v[188:191], v[172:175]
  ds_read_b128 v[188:191], v2 offset:8192
  v_mfma_f32_16x16x32_bf16 v[176:179], v[128:131], v[192:195], v[176:179]
  s_add_u32 s82, s82, 4096
  s_add_u32 m0, m0, 4096
  ds_read_b128 v[192:195], v2 offset:9216
  buffer_load_dwordx4 v1, s[4:7], s82 offen offset:0 lds
  v_mfma_f32_16x16x32_bf16 v[180:183], v[128:131], v[196:199], v[180:183]
  ds_read_b128 v[196:199], v2 offset:10240
  v_mfma_f32_16x16x32_bf16 v[184:187], v[128:131], v[200:203], v[184:187]
  ds_read_b128 v[200:203], v2 offset:11264
  s_waitcnt vmcnt(9) lgkmcnt(10)
  v_mfma_f32_16x16x32_bf16 v[164:167], v[132:135], v[224:227], v[164:167]
  ds_read_b128 v[224:227], v2 offset:12288
  buffer_load_dwordx4 v1, s[4:7], s82 offen offset:1024 lds
  v_mfma_f32_16x16x32_bf16 v[168:171], v[132:135], v[228:231], v[168:171]
  ds_read_b128 v[228:231], v2 offset:13312
  v_mfma_f32_16x16x32_bf16 v[172:175], v[132:135], v[232:235], v[172:175]
  ds_read_b128 v[232:235], v2 offset:14336
  v_mfma_f32_16x16x32_bf16 v[176:179], v[132:135], v[236:239], v[176:179]
  ds_read_b128 v[236:239], v2 offset:15360
  s_waitcnt lgkmcnt(8)
  v_mfma_f32_16x16x32_bf16 v[180:183], v[132:135], v[240:243], v[180:183]
  s_add_u32 s82, s75, 638976
  s_add_u32 m0, s52, 114688
  ds_read_b128 v[240:243], v2 offset:16384
  buffer_load_dwordx4 v1, s[4:7], s82 offen offset:0 lds
  v_mfma_f32_16x16x32_bf16 v[184:187], v[132:135], v[244:247], v[184:187]
  ds_read_b128 v[244:247], v2 offset:17408
  s_waitcnt vmcnt(8)
  v_mfma_f32_16x16x32_bf16 v[164:167], v[136:139], v[248:251], v[164:167]
  ds_read_b128 v[248:251], v2 offset:18432
  v_mfma_f32_16x16x32_bf16 v[168:171], v[136:139], v[252:255], v[168:171]
  ds_read_b128 v[252:255], v2 offset:19456
  buffer_load_dwordx4 v1, s[4:7], s82 offen offset:1024 lds
  s_waitcnt lgkmcnt(8)
  v_mfma_f32_16x16x32_bf16 v[172:175], v[136:139], v[188:191], v[172:175]
  ds_read_b128 v[188:191], v2 offset:20480
  s_barrier
  v_mfma_f32_16x16x32_bf16 v[176:179], v[136:139], v[192:195], v[176:179]
  ds_read_b128 v[192:195], v2 offset:21504
  buffer_load_dwordx4 v1, s[4:7], s82 offen offset:2048 lds
  v_mfma_f32_16x16x32_bf16 v[180:183], v[136:139], v[196:199], v[180:183]
  ds_read_b128 v[196:199], v2 offset:22528
  v_mfma_f32_16x16x32_bf16 v[184:187], v[136:139], v[200:203], v[184:187]
  ds_read_b128 v[200:203], v2 offset:23552
  s_waitcnt vmcnt(8) lgkmcnt(8)
  v_mfma_f32_16x16x32_bf16 v[164:167], v[140:143], v[224:227], v[164:167]
  buffer_load_dwordx4 v1, s[4:7], s82 offen offset:3072 lds
  v_mfma_f32_16x16x32_bf16 v[168:171], v[140:143], v[228:231], v[168:171]
  v_mfma_f32_16x16x32_bf16 v[172:175], v[140:143], v[232:235], v[172:175]
  v_mfma_f32_16x16x32_bf16 v[176:179], v[140:143], v[236:239], v[176:179]
  s_waitcnt lgkmcnt(4)
  s_add_u32 s82, s82, 4096
  s_add_u32 m0, m0, 4096
  v_mfma_f32_16x16x32_bf16 v[180:183], v[140:143], v[240:243], v[180:183]
  buffer_load_dwordx4 v1, s[4:7], s82 offen offset:0 lds
  v_mfma_f32_16x16x32_bf16 v[184:187], v[140:143], v[244:247], v[184:187]
  s_waitcnt vmcnt(9)
  v_mfma_f32_16x16x32_bf16 v[164:167], v[144:147], v[248:251], v[164:167]
  v_mfma_f32_16x16x32_bf16 v[168:171], v[144:147], v[252:255], v[168:171]
  buffer_load_dwordx4 v1, s[4:7], s82 offen offset:1024 lds
  s_waitcnt lgkmcnt(0)
  v_mfma_f32_16x16x32_bf16 v[172:175], v[144:147], v[188:191], v[172:175]
  v_mfma_f32_16x16x32_bf16 v[176:179], v[144:147], v[192:195], v[176:179]
  s_add_u32 s82, s75, 663552
  s_add_u32 m0, s52, 24576
  v_mfma_f32_16x16x32_bf16 v[180:183], v[144:147], v[196:199], v[180:183]
  buffer_load_dwordx4 v1, s[4:7], s82 offen offset:0 lds
  v_mfma_f32_16x16x32_bf16 v[184:187], v[144:147], v[200:203], v[184:187]
  s_barrier
  v_pk_mul_f32 v[240:241], v[152:153], v[204:205] op_sel:[0,0] op_sel_hi:[1,0]
  buffer_load_dwordx4 v1, s[4:7], s82 offen offset:1024 lds
  v_pk_mul_f32 v[242:243], v[154:155], v[204:205] op_sel:[0,0] op_sel_hi:[1,0]
  v_pk_fma_f32 v[164:165], v[164:165], v[148:149], v[240:241]
  v_pk_fma_f32 v[166:167], v[166:167], v[150:151], v[242:243]
  v_pk_mul_f32 v[240:241], v[152:153], v[204:205] op_sel:[0,1] op_sel_hi:[1,1]
  v_pk_mul_f32 v[242:243], v[154:155], v[204:205] op_sel:[0,1] op_sel_hi:[1,1]
  v_pk_fma_f32 v[168:169], v[168:169], v[148:149], v[240:241]
  v_pk_fma_f32 v[170:171], v[170:171], v[150:151], v[242:243]
  v_pk_mul_f32 v[240:241], v[152:153], v[206:207] op_sel:[0,0] op_sel_hi:[1,0]
  v_pk_mul_f32 v[242:243], v[154:155], v[206:207] op_sel:[0,0] op_sel_hi:[1,0]
  v_pk_fma_f32 v[172:173], v[172:173], v[148:149], v[240:241]
  buffer_load_dwordx4 v1, s[4:7], s82 offen offset:2048 lds
  v_pk_fma_f32 v[174:175], v[174:175], v[150:151], v[242:243]
  v_pk_mul_f32 v[240:241], v[152:153], v[206:207] op_sel:[0,1] op_sel_hi:[1,1]
  v_pk_mul_f32 v[242:243], v[154:155], v[206:207] op_sel:[0,1] op_sel_hi:[1,1]
  v_pk_fma_f32 v[176:177], v[176:177], v[148:149], v[240:241]
  v_pk_fma_f32 v[178:179], v[178:179], v[150:151], v[242:243]
  v_pk_mul_f32 v[240:241], v[152:153], v[208:209] op_sel:[0,0] op_sel_hi:[1,0]
  v_pk_mul_f32 v[242:243], v[154:155], v[208:209] op_sel:[0,0] op_sel_hi:[1,0]
  v_pk_fma_f32 v[180:181], v[180:181], v[148:149], v[240:241]
  v_pk_fma_f32 v[182:183], v[182:183], v[150:151], v[242:243]
  v_pk_mul_f32 v[240:241], v[152:153], v[208:209] op_sel:[0,1] op_sel_hi:[1,1]
  v_pk_mul_f32 v[242:243], v[154:155], v[208:209] op_sel:[0,1] op_sel_hi:[1,1]
  v_pk_fma_f32 v[184:185], v[184:185], v[148:149], v[240:241]
  v_pk_fma_f32 v[186:187], v[186:187], v[150:151], v[242:243]
  buffer_load_dwordx4 v1, s[4:7], s82 offen offset:3072 lds
  v_mov_b32 v212, 0xbdd2d3e8
  v_mov_b32 v213, 0xc0135761
  v_pk_mul_f32 v[224:225], v[164:165], v[164:165]
  v_pk_mul_f32 v[226:227], v[166:167], v[166:167]
  v_pk_mul_f32 v[228:229], v[168:169], v[168:169]
  v_pk_mul_f32 v[230:231], v[170:171], v[170:171]
  v_pk_fma_f32 v[224:225], v[224:225], v[212:213], v[212:213] op_sel:[0,0,1] op_sel_hi:[1,0,1]
  v_pk_fma_f32 v[226:227], v[226:227], v[212:213], v[212:213] op_sel:[0,0,1] op_sel_hi:[1,0,1]
  v_pk_fma_f32 v[228:229], v[228:229], v[212:213], v[212:213] op_sel:[0,0,1] op_sel_hi:[1,0,1]
  v_pk_fma_f32 v[230:231], v[230:231], v[212:213], v[212:213] op_sel:[0,0,1] op_sel_hi:[1,0,1]
  v_pk_mul_f32 v[224:225], v[224:225], v[164:165]
  v_pk_mul_f32 v[226:227], v[226:227], v[166:167]
  v_pk_mul_f32 v[228:229], v[228:229], v[168:169]
  s_add_u32 s82, s82, 4096
  s_add_u32 m0, m0, 4096
  s_nop 0
  buffer_load_dwordx4 v1, s[4:7], s82 offen offset:0 lds
  v_pk_mul_f32 v[230:231], v[230:231], v[170:171]
  v_exp_f32 v224, v224
  v_exp_f32 v225, v225
  v_exp_f32 v226, v226
  v_exp_f32 v227, v227
  v_exp_f32 v228, v228
  v_exp_f32 v229, v229
  v_exp_f32 v230, v230
  v_exp_f32 v231, v231
  v_pk_add_f32 v[224:225], v[224:225], 1.0 op_sel_hi:[1,0]
  buffer_load_dwordx4 v1, s[4:7], s82 offen offset:1024 lds
  v_pk_add_f32 v[226:227], v[226:227], 1.0 op_sel_hi:[1,0]
  v_pk_add_f32 v[228:229], v[228:229], 1.0 op_sel_hi:[1,0]
  v_pk_add_f32 v[230:231], v[230:231], 1.0 op_sel_hi:[1,0]
  v_rcp_f32 v224, v224
  v_rcp_f32 v225, v225
  v_rcp_f32 v226, v226
  v_rcp_f32 v227, v227
  v_rcp_f32 v228, v228
  s_add_u32 s82, s75, 688128
  s_add_u32 m0, s52, 0
  s_nop 0
  buffer_load_dwordx4 v1, s[4:7], s82 offen offset:0 lds
  v_rcp_f32 v229, v229
  v_rcp_f32 v230, v230
  v_rcp_f32 v231, v231
  v_pk_mul_f32 v[164:165], v[164:165], v[224:225]
  v_pk_mul_f32 v[166:167], v[166:167], v[226:227]
  v_pk_mul_f32 v[168:169], v[168:169], v[228:229]
  v_pk_mul_f32 v[170:171], v[170:171], v[230:231]
  buffer_load_dwordx4 v1, s[4:7], s82 offen offset:1024 lds
  v_pk_mul_f32 v[232:233], v[172:173], v[172:173]
  v_pk_mul_f32 v[234:235], v[174:175], v[174:175]
  v_pk_mul_f32 v[236:237], v[176:177], v[176:177]
  v_pk_mul_f32 v[238:239], v[178:179], v[178:179]
  v_pk_fma_f32 v[232:233], v[232:233], v[212:213], v[212:213] op_sel:[0,0,1] op_sel_hi:[1,0,1]
  v_pk_fma_f32 v[234:235], v[234:235], v[212:213], v[212:213] op_sel:[0,0,1] op_sel_hi:[1,0,1]
  v_pk_fma_f32 v[236:237], v[236:237], v[212:213], v[212:213] op_sel:[0,0,1] op_sel_hi:[1,0,1]
  v_pk_fma_f32 v[238:239], v[238:239], v[212:213], v[212:213] op_sel:[0,0,1] op_sel_hi:[1,0,1]
  v_pk_mul_f32 v[232:233], v[232:233], v[172:173]
  v_pk_mul_f32 v[234:235], v[234:235], v[174:175]
  v_pk_mul_f32 v[236:237], v[236:237], v[176:177]
  v_pk_mul_f32 v[238:239], v[238:239], v[178:179]
  v_exp_f32 v232, v232
  v_exp_f32 v233, v233
  v_exp_f32 v234, v234
  v_exp_f32 v235, v235
  v_exp_f32 v236, v236
  v_exp_f32 v237, v237
  v_exp_f32 v238, v238
  v_exp_f32 v239, v239
  v_pk_add_f32 v[232:233], v[232:233], 1.0 op_sel_hi:[1,0]
  v_pk_add_f32 v[234:235], v[234:235], 1.0 op_sel_hi:[1,0]
  v_pk_add_f32 v[236:237], v[236:237], 1.0 op_sel_hi:[1,0]
  v_pk_add_f32 v[238:239], v[238:239], 1.0 op_sel_hi:[1,0]
  v_rcp_f32 v232, v232
  v_rcp_f32 v233, v233
  v_rcp_f32 v234, v234
  v_rcp_f32 v235, v235
  v_rcp_f32 v236, v236
  v_rcp_f32 v237, v237
  v_rcp_f32 v238, v238
  v_rcp_f32 v239, v239
  v_pk_mul_f32 v[172:173], v[172:173], v[232:233]
  v_pk_mul_f32 v[174:175], v[174:175], v[234:235]
  v_pk_mul_f32 v[176:177], v[176:177], v[236:237]
  v_pk_mul_f32 v[178:179], v[178:179], v[238:239]
  v_pk_mul_f32 v[224:225], v[180:181], v[180:181]
  v_pk_mul_f32 v[226:227], v[182:183], v[182:183]
  v_pk_mul_f32 v[228:229], v[184:185], v[184:185]
  v_pk_mul_f32 v[230:231], v[186:187], v[186:187]
  v_pk_fma_f32 v[224:225], v[224:225], v[212:213], v[212:213] op_sel:[0,0,1] op_sel_hi:[1,0,1]
  v_pk_fma_f32 v[226:227], v[226:227], v[212:213], v[212:213] op_sel:[0,0,1] op_sel_hi:[1,0,1]
  v_pk_fma_f32 v[228:229], v[228:229], v[212:213], v[212:213] op_sel:[0,0,1] op_sel_hi:[1,0,1]
  v_pk_fma_f32 v[230:231], v[230:231], v[212:213], v[212:213] op_sel:[0,0,1] op_sel_hi:[1,0,1]
  v_pk_mul_f32 v[224:225], v[224:225], v[180:181]
  v_pk_mul_f32 v[226:227], v[226:227], v[182:183]
  v_pk_mul_f32 v[228:229], v[228:229], v[184:185]
  v_pk_mul_f32 v[230:231], v[230:231], v[186:187]
  v_exp_f32 v224, v224
  v_exp_f32 v225, v225
  v_exp_f32 v226, v226
  v_exp_f32 v227, v227
  v_exp_f32 v228, v228
  v_exp_f32 v229, v229
  v_exp_f32 v230, v230
  v_exp_f32 v231, v231
  v_pk_add_f32 v[224:225], v[224:225], 1.0 op_sel_hi:[1,0]
  v_pk_add_f32 v[226:227], v[226:227], 1.0 op_sel_hi:[1,0]
  v_pk_add_f32 v[228:229], v[228:229], 1.0 op_sel_hi:[1,0]
  v_pk_add_f32 v[230:231], v[230:231], 1.0 op_sel_hi:[1,0]
  v_rcp_f32 v224, v224
  v_rcp_f32 v225, v225
  v_rcp_f32 v226, v226
  v_rcp_f32 v227, v227
  v_rcp_f32 v228, v228
  v_rcp_f32 v229, v229
  v_rcp_f32 v230, v230
  v_rcp_f32 v231, v231
  v_pk_mul_f32 v[180:181], v[180:181], v[224:225]
  v_pk_mul_f32 v[182:183], v[182:183], v[226:227]
  v_pk_mul_f32 v[184:185], v[184:185], v[228:229]
  v_pk_mul_f32 v[186:187], v[186:187], v[230:231]
  v_pk_add_f32 v[224:225], v[164:165], v[168:169]
  v_pk_mul_f32 v[228:229], v[164:165], v[164:165]
  v_pk_add_f32 v[226:227], v[166:167], v[170:171]
  v_pk_mul_f32 v[230:231], v[166:167], v[166:167]
  v_pk_fma_f32 v[228:229], v[168:169], v[168:169], v[228:229]
  v_pk_fma_f32 v[230:231], v[170:171], v[170:171], v[230:231]
  v_pk_add_f32 v[224:225], v[224:225], v[172:173]
  v_pk_fma_f32 v[228:229], v[172:173], v[172:173], v[228:229]
  v_pk_add_f32 v[226:227], v[226:227], v[174:175]
  v_pk_fma_f32 v[230:231], v[174:175], v[174:175], v[230:231]
  v_pk_add_f32 v[224:225], v[224:225], v[176:177]
  v_pk_fma_f32 v[228:229], v[176:177], v[176:177], v[228:229]
  v_pk_add_f32 v[226:227], v[226:227], v[178:179]
  v_pk_fma_f32 v[230:231], v[178:179], v[178:179], v[230:231]
  v_pk_add_f32 v[224:225], v[224:225], v[180:181]
  v_pk_fma_f32 v[228:229], v[180:181], v[180:181], v[228:229]
  v_pk_add_f32 v[226:227], v[226:227], v[182:183]
  v_pk_fma_f32 v[230:231], v[182:183], v[182:183], v[230:231]
  v_pk_add_f32 v[224:225], v[224:225], v[184:185]
  v_pk_fma_f32 v[228:229], v[184:185], v[184:185], v[228:229]
  v_pk_add_f32 v[226:227], v[226:227], v[186:187]
  v_pk_fma_f32 v[230:231], v[186:187], v[186:187], v[230:231]
  v_add_f32_dpp v236, v224, v224 row_ror:8 row_mask:0xf bank_mask:0x3
  v_add_f32_dpp v236, v226, v226 row_ror:8 row_mask:0xf bank_mask:0xc
  v_add_f32_dpp v237, v225, v225 row_ror:8 row_mask:0xf bank_mask:0x3
  v_add_f32_dpp v237, v227, v227 row_ror:8 row_mask:0xf bank_mask:0xc
  v_add_f32_dpp v238, v228, v228 row_ror:8 row_mask:0xf bank_mask:0x3
  v_add_f32_dpp v238, v230, v230 row_ror:8 row_mask:0xf bank_mask:0xc
  v_add_f32_dpp v239, v229, v229 row_ror:8 row_mask:0xf bank_mask:0x3
  v_add_f32_dpp v239, v231, v231 row_ror:8 row_mask:0xf bank_mask:0xc
  v_add_f32_dpp v232, v236, v236 row_shl:4 row_mask:0xf bank_mask:0x5
  v_add_f32_dpp v232, v237, v237 row_shr:4 row_mask:0xf bank_mask:0xa
  v_add_f32_dpp v233, v238, v238 row_shl:4 row_mask:0xf bank_mask:0x5
  v_add_f32_dpp v233, v239, v239 row_shr:4 row_mask:0xf bank_mask:0xa
  v_add_f32_dpp v232, v232, v232 quad_perm:[1,0,3,2] row_mask:0xf bank_mask:0xf
  s_nop 0
  v_add_f32_dpp v233, v233, v233 quad_perm:[1,0,3,2] row_mask:0xf bank_mask:0xf
  v_add_f32_dpp v232, v232, v232 quad_perm:[2,3,0,1] row_mask:0xf bank_mask:0xf
  s_nop 0
  v_add_f32_dpp v233, v233, v233 quad_perm:[2,3,0,1] row_mask:0xf bank_mask:0xf
  v_mov_b32 v234, s44
  s_lshl_b32 s84, s2, 11
  s_add_u32 s84, s84, 65536
  s_lshl_b32 s85, s41, 5
  s_add_u32 s85, s85, s84
  s_cmp_eq_u32 s48, 1
  s_cbranch_scc0 L_slow41
  buffer_store_dwordx4 v[232:235], v41, s[4:7], s85 offen
L_back42:
  s_mov_b32 s88, 0
L_poll43:
  buffer_load_dwordx4 v[212:215], v42, s[4:7], s84 offen sc1
  buffer_load_dwordx4 v[216:219], v42, s[4:7], s84 offen offset:16 sc1
  s_add_u32 s88, s88, 1
  s_cmp_gt_u32 s88, 65536
  s_cbranch_scc1 L_abort
  s_waitcnt vmcnt(0)
  v_cmp_ne_u32 s[94:95], s44, v214
  v_cmp_ne_u32 vcc, s44, v218
  s_nop 0
  s_or_b64 vcc, vcc, s[94:95]
  s_cbranch_vccnz L_poll43
  v_add_f32_dpp v212, v212, v212 quad_perm:[1,0,3,2] row_mask:0xf bank_mask:0xf
  buffer_load_dwordx4 v1, s[4:7], s82 offen offset:2048 lds
  v_add_f32_dpp v213, v213, v213 quad_perm:[1,0,3,2] row_mask:0xf bank_mask:0xf
  v_add_f32_dpp v216, v216, v216 quad_perm:[1,0,3,2] row_mask:0xf bank_mask:0xf
  v_add_f32_dpp v217, v217, v217 quad_perm:[1,0,3,2] row_mask:0xf bank_mask:0xf
  v_add_f32_dpp v212, v212, v212 quad_perm:[2,3,0,1] row_mask:0xf bank_mask:0xf
  v_add_f32_dpp v213, v213, v213 quad_perm:[2,3,0,1] row_mask:0xf bank_mask:0xf
  v_add_f32_dpp v216, v216, v216 quad_perm:[2,3,0,1] row_mask:0xf bank_mask:0xf
  v_add_f32_dpp v217, v217, v217 quad_perm:[2,3,0,1] row_mask:0xf bank_mask:0xf
  v_add_f32_dpp v212, v212, v212 row_half_mirror row_mask:0xf bank_mask:0xf
  buffer_load_dwordx4 v1, s[4:7], s82 offen offset:3072 lds
  v_add_f32_dpp v213, v213, v213 row_half_mirror row_mask:0xf bank_mask:0xf
  v_add_f32_dpp v216, v216, v216 row_half_mirror row_mask:0xf bank_mask:0xf
  v_add_f32_dpp v217, v217, v217 row_half_mirror row_mask:0xf bank_mask:0xf
  v_mov_b32_dpp v158, v212 row_ror:8 row_mask:0xf bank_mask:0xf
  v_mov_b32_dpp v159, v213 row_ror:8 row_mask:0xf bank_mask:0xf
  v_mov_b32_dpp v160, v216 row_ror:8 row_mask:0xf bank_mask:0xf
  v_mov_b32_dpp v161, v217 row_ror:8 row_mask:0xf bank_mask:0xf
  v_cmp_gt_u32 vcc, 8, v47
  s_nop 1
  v_cndmask_b32 v148, v158, v212, vcc
  v_cndmask_b32 v150, v212, v158, vcc
  v_cndmask_b32 v152, v159, v213, vcc
  s_add_u32 s82, s82, 4096
  s_add_u32 m0, m0, 4096
  s_nop 0
  buffer_load_dwordx4 v1, s[4:7], s82 offen offset:0 lds
  v_cndmask_b32 v154, v213, v159, vcc
  v_cndmask_b32 v149, v160, v216, vcc
  v_cndmask_b32 v151, v216, v160, vcc
  v_cndmask_b32 v153, v161, v217, vcc
  v_cndmask_b32 v155, v217, v161, vcc
  s_mov_b32 s87, 0x3aaaaaab
  v_mul_f32 v212, 0xbaaaaaab, v148
  v_mul_f32 v213, 0xbaaaaaab, v149
  v_mul_f32 v214, 0xbaaaaaab, v150
  v_mul_f32 v215, 0xbaaaaaab, v151
  buffer_load_dwordx4 v1, s[4:7], s82 offen offset:1024 lds
  v_mul_f32 v152, s87, v152
  v_mul_f32 v153, s87, v153
  v_mul_f32 v154, s87, v154
  v_mul_f32 v155, s87, v155
  v_fma_f32 v152, -v212, v212, v152
  v_fma_f32 v153, -v213, v213, v153
  v_fma_f32 v154, -v214, v214, v154
  v_fma_f32 v155, -v215, v215, v155
  v_max_f32 v152, 0, v152
  v_max_f32 v153, 0, v153
  v_max_f32 v154, 0, v154
  v_max_f32 v155, 0, v155
  v_add_f32 v152, 0x3727c5ac, v152
  s_add_u32 s82, s75, 712704
  s_add_u32 m0, s52, 49152
  s_nop 0
  buffer_load_dwordx4 v1, s[4:7], s82 offen offset:0 lds
  v_add_f32 v153, 0x3727c5ac, v153
  v_add_f32 v154, 0x3727c5ac, v154
  v_add_f32 v155, 0x3727c5ac, v155
  v_rsq_f32 v148, v152
  v_rsq_f32 v149, v153
  v_rsq_f32 v150, v154
  v_rsq_f32 v151, v155
  buffer_load_dwordx4 v1, s[4:7], s82 offen offset:1024 lds
  v_mul_f32 v212, v212, v148
  v_mul_f32 v213, v213, v149
  v_mul_f32 v214, v214, v150
  v_mul_f32 v215, v215, v151
  s_lshr_b32 s84, s2, 1
  s_mul_i32 s84, s84, 6144
  s_and_b32 s85, s40, 1
  s_lshl_b32 s85, s85, 9
  s_add_u32 s84, s84, s85
  s_mul_i32 s85, s41, 393216
  s_add_u32 s84, s84, s85
  s_add_u32 s84, s84, 12058624
  s_add_u32 s85, s84, 4096
  v_pk_fma_f32 v[164:165], v[164:165], v[148:149], v[212:213]
  buffer_load_dwordx4 v1, s[4:7], s82 offen offset:2048 lds
  v_pk_fma_f32 v[166:167], v[166:167], v[150:151], v[214:215]
  v_pk_fma_f32 v[168:169], v[168:169], v[148:149], v[212:213]
  v_pk_fma_f32 v[170:171], v[170:171], v[150:151], v[214:215]
  v_cvt_pk_bf16_f32 v164, v164, v165
  v_cvt_pk_bf16_f32 v165, v166, v167
  v_cvt_pk_bf16_f32 v166, v168, v169
  v_cvt_pk_bf16_f32 v167, v170, v171
  s_nop 0
  v_permlane16_swap_b32 v164, v166
  v_permlane16_swap_b32 v165, v167
  buffer_store_dwordx4 v[164:167], v26, s[4:7], s84 offen offset:0 sc1
  v_pk_fma_f32 v[172:173], v[172:173], v[148:149], v[212:213]
  v_pk_fma_f32 v[174:175], v[174:175], v[150:151], v[214:215]
  v_pk_fma_f32 v[176:177], v[176:177], v[148:149], v[212:213]
  v_pk_fma_f32 v[178:179], v[178:179], v[150:151], v[214:215]
  v_cvt_pk_bf16_f32 v172, v172, v173
  v_cvt_pk_bf16_f32 v173, v174, v175
  v_cvt_pk_bf16_f32 v174, v176, v177
  v_cvt_pk_bf16_f32 v175, v178, v179
  s_nop 0
  v_permlane16_swap_b32 v172, v174
  v_permlane16_swap_b32 v173, v175
  buffer_store_dwordx4 v[172:175], v26, s[4:7], s84 offen offset:2048 sc1
  v_pk_fma_f32 v[180:181], v[180:181], v[148:149], v[212:213]
  v_pk_fma_f32 v[182:183], v[182:183], v[150:151], v[214:215]
  v_pk_fma_f32 v[184:185], v[184:185], v[148:149], v[212:213]
  v_pk_fma_f32 v[186:187], v[186:187], v[150:151], v[214:215]
  v_cvt_pk_bf16_f32 v180, v180, v181
  v_cvt_pk_bf16_f32 v181, v182, v183
  v_cvt_pk_bf16_f32 v182, v184, v185
  v_cvt_pk_bf16_f32 v183, v186, v187
  s_nop 0
  v_permlane16_swap_b32 v180, v182
  v_permlane16_swap_b32 v181, v183
  buffer_store_dwordx4 v[180:183], v26, s[4:7], s85 offen offset:0 sc1
L_ph_z10:
  s_barrier
  ds_read_b128 v[224:227], v2 offset:24576
  ds_read_b128 v[228:231], v2 offset:25600
  ds_read_b128 v[232:235], v2 offset:26624
  ds_read_b128 v[236:239], v2 offset:27648
  ds_read_b128 v[240:243], v2 offset:28672
  ds_read_b128 v[244:247], v2 offset:29696
  ds_read_b128 v[248:251], v2 offset:30720
  ds_read_b128 v[252:255], v2 offset:31744
  ds_read_b128 v[168:171], v2 offset:32768
  ds_read_b128 v[176:179], v2 offset:33792
  ds_read_b128 v[184:187], v2 offset:34816
  s_waitcnt lgkmcnt(7)
  v_mfma_f32_16x16x32_bf16 v[188:191], v[224:227], v[68:71], 0
  ds_read_b128 v[224:227], v2 offset:35840
  s_add_u32 s100, s101, L_ph_sp0-L_base
  buffer_load_dword v222, v13, s[96:99], s100 offen
  v_mfma_f32_16x16x32_bf16 v[192:195], v[228:231], v[68:71], 0
  ds_read_b128 v[228:231], v2 offset:36864
  buffer_load_dwordx4 v1, s[4:7], s82 offen offset:3072 lds
  v_mfma_f32_16x16x32_bf16 v[196:199], v[232:235], v[68:71], 0
  ds_read_b128 v[232:235], v2 offset:37888
  v_mfma_f32_16x16x32_bf16 v[200:203], v[236:239], v[68:71], 0
  ds_read_b128 v[236:239], v2 offset:38912
  s_waitcnt lgkmcnt(7)
  v_mfma_f32_16x16x32_bf16 v[204:207], v[240:243], v[68:71], 0
  s_add_u32 s82, s82, 4096
  s_add_u32 m0, m0, 4096
  ds_read_b128 v[240:243], v2 offset:39936
  buffer_load_dwordx4 v1, s[4:7], s82 offen offset:0 lds
  v_mfma_f32_16x16x32_bf16 v[208:211], v[244:247], v[68:71], 0
  ds_read_b128 v[244:247], v2 offset:40960
  v_mfma_f32_16x16x32_bf16 v[188:191], v[248:251], v[72:75], v[188:191]
  ds_read_b128 v[248:251], v2 offset:41984
  v_mfma_f32_16x16x32_bf16 v[192:195], v[252:255], v[72:75], v[192:195]
  ds_read_b128 v[252:255], v2 offset:43008
  buffer_load_dwordx4 v1, s[4:7], s82 offen offset:1024 lds
  s_waitcnt lgkmcnt(7)
  v_mfma_f32_16x16x32_bf16 v[196:199], v[168:171], v[72:75], v[196:199]
  ds_read_b128 v[168:171], v2 offset:44032
  s_barrier
  v_mfma_f32_16x16x32_bf16 v[200:203], v[176:179], v[72:75], v[200:203]
  ds_read_b128 v[176:179], v2 offset:45056
  v_mfma_f32_16x16x32_bf16 v[204:207], v[184:187], v[72:75], v[204:207]
  ds_read_b128 v[184:187], v2 offset:46080
  v_mfma_f32_16x16x32_bf16 v[208:211], v[224:227], v[72:75], v[208:211]
  ds_read_b128 v[224:227], v2 offset:47104
  s_waitcnt lgkmcnt(7)
  v_mfma_f32_16x16x32_bf16 v[188:191], v[228:231], v[76:79], v[188:191]
  ds_read_b128 v[228:231], v2 offset:48128
  v_mfma_f32_16x16x32_bf16 v[192:195], v[232:235], v[76:79], v[192:195]
  ds_read_b128 v[232:235], v2 offset:49152
  v_mfma_f32_16x16x32_bf16 v[196:199], v[236:239], v[76:79], v[196:199]
  ds_read_b128 v[236:239], v2 offset:50176
  v_mfma_f32_16x16x32_bf16 v[200:203], v[240:243], v[76:79], v[200:203]
  ds_read_b128 v[240:243], v2 offset:51200
  s_waitcnt lgkmcnt(7)
  v_mfma_f32_16x16x32_bf16 v[204:207], v[244:247], v[76:79], v[204:207]
  ds_read_b128 v[244:247], v2 offset:52224
  v_mfma_f32_16x16x32_bf16 v[208:211], v[248:251], v[76:79], v[208:211]
  ds_read_b128 v[248:251], v2 offset:53248
  v_mfma_f32_16x16x32_bf16 v[188:191], v[252:255], v[80:83], v[188:191]
  ds_read_b128 v[252:255], v2 offset:54272
  v_mfma_f32_16x16x32_bf16 v[192:195], v[168:171], v[80:83], v[192:195]
  ds_read_b128 v[168:171], v2 offset:55296
  s_waitcnt lgkmcnt(7)
  v_mfma_f32_16x16x32_bf16 v[196:199], v[176:179], v[80:83], v[196:199]
  ds_read_b128 v[176:179], v2 offset:56320
  v_mfma_f32_16x16x32_bf16 v[200:203], v[184:187], v[80:83], v[200:203]
  ds_read_b128 v[184:187], v2 offset:57344
  v_mfma_f32_16x16x32_bf16 v[204:207], v[224:227], v[80:83], v[204:207]
  ds_read_b128 v[224:227], v2 offset:58368
  v_mfma_f32_16x16x32_bf16 v[208:211], v[228:231], v[80:83], v[208:211]
  ds_read_b128 v[228:231], v2 offset:59392
  s_waitcnt lgkmcnt(7)
  v_mfma_f32_16x16x32_bf16 v[188:191], v[232:235], v[84:87], v[188:191]
  ds_read_b128 v[232:235], v2 offset:60416
  v_mfma_f32_16x16x32_bf16 v[192:195], v[236:239], v[84:87], v[192:195]
  ds_read_b128 v[236:239], v2 offset:61440
  v_mfma_f32_16x16x32_bf16 v[196:199], v[240:243], v[84:87], v[196:199]
  ds_read_b128 v[240:243], v2 offset:62464
  v_mfma_f32_16x16x32_bf16 v[200:203], v[244:247], v[84:87], v[200:203]
  ds_read_b128 v[244:247], v2 offset:63488
  s_waitcnt lgkmcnt(7)
  v_mfma_f32_16x16x32_bf16 v[204:207], v[248:251], v[84:87], v[204:207]
  ds_read_b128 v[248:251], v2 offset:64512
  v_mfma_f32_16x16x32_bf16 v[208:211], v[252:255], v[84:87], v[208:211]
  ds_read_b128 v[252:255], v3 offset:0
  v_mfma_f32_16x16x32_bf16 v[188:191], v[168:171], v[88:91], v[188:191]
  ds_read_b128 v[168:171], v3 offset:1024
  v_mfma_f32_16x16x32_bf16 v[192:195], v[176:179], v[88:91], v[192:195]
  ds_read_b128 v[176:179], v3 offset:2048
  s_waitcnt lgkmcnt(7)
  v_mfma_f32_16x16x32_bf16 v[196:199], v[184:187], v[88:91], v[196:199]
  ds_read_b128 v[184:187], v3 offset:3072
  s_barrier
  v_mfma_f32_16x16x32_bf16 v[200:203], v[224:227], v[88:91], v[200:203]
  s_add_u32 s82, s58, s11
  s_add_u32 m0, s52, 73728
  ds_read_b128 v[224:227], v3 offset:4096
  buffer_load_dwordx4 v29, s[24:27], s82 offen offset:0  lds
  v_mfma_f32_16x16x32_bf16 v[204:207], v[228:231], v[88:91], v[204:207]
  ds_read_b128 v[228:231], v3 offset:5120
  v_mfma_f32_16x16x32_bf16 v[208:211], v[232:235], v[88:91], v[208:211]
  ds_read_b128 v[232:235], v3 offset:6144
  s_waitcnt lgkmcnt(7)
  v_mfma_f32_16x16x32_bf16 v[188:191], v[236:239], v[92:95], v[188:191]
  ds_read_b128 v[236:239], v3 offset:7168
  buffer_load_dwordx4 v30, s[24:27], s82 offen offset:1024  lds
  v_mfma_f32_16x16x32_bf16 v[192:195], v[240:243], v[92:95], v[192:195]
  ds_read_b128 v[240:243], v1 offset:24576
  v_mfma_f32_16x16x32_bf16 v[196:199], v[244:247], v[92:95], v[196:199]
  ds_read_b128 v[244:247], v1 offset:25600
  v_mfma_f32_16x16x32_bf16 v[200:203], v[248:251], v[92:95], v[200:203]
  s_add_u32 s82, s59, s11
  s_add_u32 m0, s52, 75776
  ds_read_b128 v[248:251], v1 offset:26624
  buffer_load_dwordx4 v29, s[24:27], s82 offen offset:0  lds
  s_waitcnt lgkmcnt(7)
  v_mfma_f32_16x16x32_bf16 v[204:207], v[252:255], v[92:95], v[204:207]
  ds_read_b128 v[252:255], v1 offset:27648
  v_mfma_f32_16x16x32_bf16 v[208:211], v[168:171], v[92:95], v[208:211]
  ds_read_b128 v[168:171], v1 offset:28672
  v_mfma_f32_16x16x32_bf16 v[188:191], v[176:179], v[96:99], v[188:191]
  ds_read_b128 v[176:179], v1 offset:29696
  buffer_load_dwordx4 v30, s[24:27], s82 offen offset:1024  lds
  v_mfma_f32_16x16x32_bf16 v[192:195], v[184:187], v[96:99], v[192:195]
  ds_read_b128 v[184:187], v1 offset:30720
  s_waitcnt lgkmcnt(7)
  v_mfma_f32_16x16x32_bf16 v[196:199], v[224:227], v[96:99], v[196:199]
  ds_read_b128 v[224:227], v1 offset:31744
  v_mfma_f32_16x16x32_bf16 v[200:203], v[228:231], v[96:99], v[200:203]
  ds_read_b128 v[228:231], v1 offset:32768
  s_waitcnt vmcnt(8)
  s_lshl_b32 s84, s41, 9
  s_lshl_b32 s85, s2, 2
  s_add_u32 s84, s84, s85
  s_add_u32 s84, s84, 57344
  buffer_store_dword v25, v13, s[4:7], s84 offen sc1
  v_mfma_f32_16x16x32_bf16 v[204:207], v[232:235], v[96:99], v[204:207]
  s_add_u32 s82, s60, s11
  s_add_u32 m0, s52, 77824
  ds_read_b128 v[232:235], v1 offset:33792
  buffer_load_dwordx4 v29, s[24:27], s82 offen offset:0  lds
  v_mfma_f32_16x16x32_bf16 v[208:211], v[236:239], v[96:99], v[208:211]
  ds_read_b128 v[236:239], v1 offset:34816
  s_waitcnt lgkmcnt(7)
  v_mfma_f32_16x16x32_bf16 v[188:191], v[240:243], v[100:103], v[188:191]
  ds_read_b128 v[240:243], v1 offset:35840
  buffer_load_dwordx4 v30, s[24:27], s82 offen offset:1024  lds
  v_mfma_f32_16x16x32_bf16 v[192:195], v[244:247], v[100:103], v[192:195]
  ds_read_b128 v[244:247], v1 offset:36864
  v_mfma_f32_16x16x32_bf16 v[196:199], v[248:251], v[100:103], v[196:199]
  ds_read_b128 v[248:251], v1 offset:37888
  v_mfma_f32_16x16x32_bf16 v[200:203], v[252:255], v[100:103], v[200:203]
  ds_read_b128 v[252:255], v1 offset:38912
  s_waitcnt lgkmcnt(7)
  v_mfma_f32_16x16x32_bf16 v[204:207], v[168:171], v[100:103], v[204:207]
  ds_read_b128 v[168:171], v1 offset:39936
  v_mfma_f32_16x16x32_bf16 v[208:211], v[176:179], v[100:103], v[208:211]
  ds_read_b128 v[176:179], v1 offset:40960
  v_mfma_f32_16x16x32_bf16 v[188:191], v[184:187], v[104:107], v[188:191]
  ds_read_b128 v[184:187], v1 offset:41984
  v_mfma_f32_16x16x32_bf16 v[192:195], v[224:227], v[104:107], v[192:195]
  ds_read_b128 v[224:227], v1 offset:43008
  s_waitcnt lgkmcnt(7)
  v_mfma_f32_16x16x32_bf16 v[196:199], v[228:231], v[104:107], v[196:199]
  ds_read_b128 v[228:231], v1 offset:44032
  s_barrier
  v_mfma_f32_16x16x32_bf16 v[200:203], v[232:235], v[104:107], v[200:203]
  s_add_u32 s82, s61, s11
  s_add_u32 m0, s52, 98304
  ds_read_b128 v[232:235], v1 offset:45056
  buffer_load_dwordx4 v29, s[24:27], s82 offen offset:0  lds
  v_mfma_f32_16x16x32_bf16 v[204:207], v[236:239], v[104:107], v[204:207]
  ds_read_b128 v[236:239], v1 offset:46080
  v_mfma_f32_16x16x32_bf16 v[208:211], v[240:243], v[104:107], v[208:211]
  ds_read_b128 v[240:243], v1 offset:47104
  s_waitcnt lgkmcnt(7)
  v_mfma_f32_16x16x32_bf16 v[188:191], v[244:247], v[108:111], v[188:191]
  ds_read_b128 v[244:247], v1 offset:48128
  buffer_load_dwordx4 v30, s[24:27], s82 offen offset:1024  lds
  v_mfma_f32_16x16x32_bf16 v[192:195], v[248:251], v[108:111], v[192:195]
  ds_read_b128 v[248:251], v1 offset:0
  v_mfma_f32_16x16x32_bf16 v[196:199], v[252:255], v[108:111], v[196:199]
  ds_read_b128 v[252:255], v1 offset:1024
  v_mfma_f32_16x16x32_bf16 v[200:203], v[168:171], v[108:111], v[200:203]
  s_add_u32 s82, s58, s8
  s_add_u32 s82, s82, 512
  s_add_u32 m0, s52, 100352
  ds_read_b128 v[168:171], v1 offset:2048
  buffer_load_dwordx4 v29, s[24:27], s82 offen offset:0  lds
  s_waitcnt lgkmcnt(7)
  v_mfma_f32_16x16x32_bf16 v[204:207], v[176:179], v[108:111], v[204:207]
  ds_read_b128 v[176:179], v1 offset:3072
  v_mfma_f32_16x16x32_bf16 v[208:211], v[184:187], v[108:111], v[208:211]
  ds_read_b128 v[184:187], v1 offset:4096
  buffer_load_dwordx4 v30, s[24:27], s82 offen offset:1024  lds
  v_mfma_f32_16x16x32_bf16 v[188:191], v[224:227], v[112:115], v[188:191]
  ds_read_b128 v[224:227], v1 offset:5120
  v_mfma_f32_16x16x32_bf16 v[192:195], v[228:231], v[112:115], v[192:195]
  ds_read_b128 v[228:231], v1 offset:6144
  s_waitcnt lgkmcnt(7)
  v_mfma_f32_16x16x32_bf16 v[196:199], v[232:235], v[112:115], v[196:199]
  s_add_u32 s82, s59, s8
  s_add_u32 s82, s82, 512
  s_add_u32 m0, s52, 102400
  ds_read_b128 v[232:235], v1 offset:7168
  buffer_load_dwordx4 v29, s[24:27], s82 offen offset:0  lds
  v_mfma_f32_16x16x32_bf16 v[200:203], v[236:239], v[112:115], v[200:203]
  ds_read_b128 v[236:239], v1 offset:8192
  v_mfma_f32_16x16x32_bf16 v[204:207], v[240:243], v[112:115], v[204:207]
  ds_read_b128 v[240:243], v1 offset:9216
  v_mfma_f32_16x16x32_bf16 v[208:211], v[244:247], v[112:115], v[208:211]
  ds_read_b128 v[244:247], v1 offset:10240
  buffer_load_dwordx4 v30, s[24:27], s82 offen offset:1024  lds
  s_waitcnt lgkmcnt(7)
  v_mfma_f32_16x16x32_bf16 v[188:191], v[248:251], v[116:119], v[188:191]
  ds_read_b128 v[248:251], v1 offset:11264
  v_mfma_f32_16x16x32_bf16 v[192:195], v[252:255], v[116:119], v[192:195]
  s_add_u32 s82, s60, s8
  s_add_u32 s82, s82, 512
  s_add_u32 m0, s52, 122880
  ds_read_b128 v[252:255], v1 offset:12288
  buffer_load_dwordx4 v29, s[24:27], s82 offen offset:0  lds
  v_mfma_f32_16x16x32_bf16 v[196:199], v[168:171], v[116:119], v[196:199]
  ds_read_b128 v[168:171], v1 offset:13312
  v_mfma_f32_16x16x32_bf16 v[200:203], v[176:179], v[116:119], v[200:203]
  ds_read_b128 v[176:179], v1 offset:14336
  s_waitcnt lgkmcnt(7)
  v_mfma_f32_16x16x32_bf16 v[204:207], v[184:187], v[116:119], v[204:207]
  ds_read_b128 v[184:187], v1 offset:15360
  buffer_load_dwordx4 v30, s[24:27], s82 offen offset:1024  lds
  v_mfma_f32_16x16x32_bf16 v[208:211], v[224:227], v[116:119], v[208:211]
  ds_read_b128 v[224:227], v1 offset:16384
  v_mfma_f32_16x16x32_bf16 v[188:191], v[228:231], v[120:123], v[188:191]
  ds_read_b128 v[228:231], v1 offset:17408
  v_mfma_f32_16x16x32_bf16 v[192:195], v[232:235], v[120:123], v[192:195]
  s_add_u32 s82, s61, s8
  s_add_u32 s82, s82, 512
  s_add_u32 m0, s52, 124928
  ds_read_b128 v[232:235], v1 offset:18432
  buffer_load_dwordx4 v29, s[24:27], s82 offen offset:0  lds
  s_waitcnt lgkmcnt(7)
  v_mfma_f32_16x16x32_bf16 v[196:199], v[236:239], v[120:123], v[196:199]
  ds_read_b128 v[236:239], v1 offset:19456
  s_waitcnt vmcnt(16)
  s_barrier
  v_mfma_f32_16x16x32_bf16 v[200:203], v[240:243], v[120:123], v[200:203]
  ds_read_b128 v[240:243], v1 offset:20480
  buffer_load_dwordx4 v30, s[24:27], s82 offen offset:1024  lds
  v_mfma_f32_16x16x32_bf16 v[204:207], v[244:247], v[120:123], v[204:207]
  ds_read_b128 v[244:247], v1 offset:21504
  v_mfma_f32_16x16x32_bf16 v[208:211], v[248:251], v[120:123], v[208:211]
  ds_read_b128 v[248:251], v1 offset:22528
  s_waitcnt lgkmcnt(7)
  v_mfma_f32_16x16x32_bf16 v[188:191], v[252:255], v[124:127], v[188:191]
  s_add_u32 s82, s58, s9
  s_add_u32 s82, s82, 512
  s_add_u32 m0, s52, 126976
  ds_read_b128 v[252:255], v1 offset:23552
  buffer_load_dwordx4 v29, s[24:27], s82 offen offset:0  lds
  v_mfma_f32_16x16x32_bf16 v[192:195], v[168:171], v[124:127], v[192:195]
  ds_read_b128 v[168:171], v1 offset:49152
  s_waitcnt vmcnt(11)
  v_add_u32 v214, 73728, v31
  v_add_u32 v220, 73728, v32
  ds_read_b128 a[96:99], v214 offset:0
  ds_read_b128 a[112:115], v220 offset:0
  ds_read_b128 a[100:103], v214 offset:2048
  ds_read_b128 a[116:119], v220 offset:2048
  ds_read_b128 a[104:107], v214 offset:4096
  ds_read_b128 a[120:123], v220 offset:4096
  v_mfma_f32_16x16x32_bf16 v[196:199], v[176:179], v[124:127], v[196:199]
  ds_read_b128 v[176:179], v1 offset:50176
  buffer_load_dwordx4 v30, s[24:27], s82 offen offset:1024  lds
  v_mfma_f32_16x16x32_bf16 v[200:203], v[184:187], v[124:127], v[200:203]
  ds_read_b128 v[184:187], v1 offset:51200
  s_waitcnt lgkmcnt(13)
  v_mfma_f32_16x16x32_bf16 v[204:207], v[224:227], v[124:127], v[204:207]
  s_add_u32 s82, s59, s9
  s_add_u32 s82, s82, 512
  s_add_u32 m0, s52, 24576
  ds_read_b128 v[224:227], v1 offset:52224
  buffer_load_dwordx4 v29, s[24:27], s82 offen offset:0  lds
  v_mfma_f32_16x16x32_bf16 v[208:211], v[228:231], v[124:127], v[208:211]
  ds_read_b128 v[228:231], v1 offset:53248
  v_mfma_f32_16x16x32_bf16 v[188:191], v[232:235], v[128:131], v[188:191]
  ds_read_b128 v[232:235], v1 offset:54272
  s_waitcnt lgkmcnt(5)
  v_mfma_f32_16x16x32_bf16 v[192:195], v[236:239], v[128:131], v[192:195]
  ds_read_b128 v[236:239], v1 offset:55296
  buffer_load_dwordx4 v30, s[24:27], s82 offen offset:1024  lds
  v_mfma_f32_16x16x32_bf16 v[196:199], v[240:243], v[128:131], v[196:199]
  ds_read_b128 v[240:243], v1 offset:56320
  v_mfma_f32_16x16x32_bf16 v[200:203], v[244:247], v[128:131], v[200:203]
  ds_read_b128 v[244:247], v1 offset:57344
  v_mfma_f32_16x16x32_bf16 v[204:207], v[248:251], v[128:131], v[204:207]
  s_add_u32 s82, s60, s9
  s_add_u32 s82, s82, 512
  s_add_u32 m0, s52, 26624
  ds_read_b128 v[248:251], v1 offset:58368
  buffer_load_dwordx4 v29, s[24:27], s82 offen offset:0  lds
  v_mfma_f32_16x16x32_bf16 v[208:211], v[252:255], v[128:131], v[208:211]
  ds_read_b128 v[252:255], v1 offset:59392
  s_waitcnt lgkmcnt(7)
  v_mfma_f32_16x16x32_bf16 v[188:191], v[168:171], v[132:135], v[188:191]
  ds_read_b128 v[168:171], v1 offset:60416
  buffer_load_dwordx4 v30, s[24:27], s82 offen offset:1024  lds
  v_mfma_f32_16x16x32_bf16 v[192:195], v[176:179], v[132:135], v[192:195]
  ds_read_b128 v[176:179], v1 offset:61440
  v_mfma_f32_16x16x32_bf16 v[196:199], v[184:187], v[132:135], v[196:199]
  ds_read_b128 v[184:187], v1 offset:62464
  v_mfma_f32_16x16x32_bf16 v[200:203], v[224:227], v[132:135], v[200:203]
  s_add_u32 s82, s61, s9
  s_add_u32 s82, s82, 512
  s_add_u32 m0, s52, 28672
  ds_read_b128 v[224:227], v1 offset:63488
  buffer_load_dwordx4 v29, s[24:27], s82 offen offset:0  lds
  s_waitcnt lgkmcnt(7)
  v_mfma_f32_16x16x32_bf16 v[204:207], v[228:231], v[132:135], v[204:207]
  ds_read_b128 v[228:231], v1 offset:64512
  s_waitcnt vmcnt(11)
  v_add_u32 v214, 98304, v31
  v_add_u32 v220, 98304, v32
  ds_read_b128 a[108:111], v214 offset:0
  ds_read_b128 a[124:127], v220 offset:0
  ds_read_b128 a[128:131], v214 offset:2048
  ds_read_b128 a[144:147], v220 offset:2048
  ds_read_b128 a[132:135], v214 offset:4096
  ds_read_b128 a[148:151], v220 offset:4096
  v_mfma_f32_16x16x32_bf16 v[208:211], v[232:235], v[132:135], v[208:211]
  ds_read_b128 v[232:235], v2 offset:0
  buffer_load_dwordx4 v30, s[24:27], s82 offen offset:1024  lds
  v_mfma_f32_16x16x32_bf16 v[188:191], v[236:239], v[136:139], v[188:191]
  ds_read_b128 v[236:239], v2 offset:1024
  v_mfma_f32_16x16x32_bf16 v[192:195], v[240:243], v[136:139], v[192:195]
  ds_read_b128 v[240:243], v2 offset:2048
  s_waitcnt lgkmcnt(13)
  v_mfma_f32_16x16x32_bf16 v[196:199], v[244:247], v[136:139], v[196:199]
  ds_read_b128 v[244:247], v2 offset:3072
  s_barrier
  v_mfma_f32_16x16x32_bf16 v[200:203], v[248:251], v[136:139], v[200:203]
  s_add_u32 s82, s58, s10
  s_add_u32 s82, s82, 512
  s_add_u32 m0, s52, 73728
  ds_read_b128 v[248:251], v2 offset:4096
  buffer_load_dwordx4 v29, s[24:27], s82 offen offset:0  lds
  v_mfma_f32_16x16x32_bf16 v[204:207], v[252:255], v[136:139], v[204:207]
  ds_read_b128 v[252:255], v2 offset:5120
  s_waitcnt lgkmcnt(6)
  v_mfma_f32_16x16x32_bf16 v[208:211], v[168:171], v[136:139], v[208:211]
  ds_read_b128 v[168:171], v2 offset:6144
  buffer_load_dwordx4 v30, s[24:27], s82 offen offset:1024  lds
  v_mfma_f32_16x16x32_bf16 v[188:191], v[176:179], v[140:143], v[188:191]
  ds_read_b128 v[176:179], v2 offset:7168
  v_mfma_f32_16x16x32_bf16 v[192:195], v[184:187], v[140:143], v[192:195]
  v_mfma_f32_16x16x32_bf16 v[196:199], v[224:227], v[140:143], v[196:199]
  s_add_u32 s82, s59, s10
  s_add_u32 s82, s82, 512
  s_add_u32 m0, s52, 75776
  v_mfma_f32_16x16x32_bf16 v[200:203], v[228:231], v[140:143], v[200:203]
  buffer_load_dwordx4 v29, s[24:27], s82 offen offset:0  lds
  s_waitcnt lgkmcnt(4)
  v_mfma_f32_16x16x32_bf16 v[204:207], v[232:235], v[140:143], v[204:207]
  v_mfma_f32_16x16x32_bf16 v[208:211], v[236:239], v[140:143], v[208:211]
  v_mfma_f32_16x16x32_bf16 v[188:191], v[240:243], v[144:147], v[188:191]
  v_mfma_f32_16x16x32_bf16 v[192:195], v[244:247], v[144:147], v[192:195]
  buffer_load_dwordx4 v30, s[24:27], s82 offen offset:1024  lds
  s_waitcnt lgkmcnt(0)
  v_mfma_f32_16x16x32_bf16 v[196:199], v[248:251], v[144:147], v[196:199]
  v_mfma_f32_16x16x32_bf16 v[200:203], v[252:255], v[144:147], v[200:203]
  v_mfma_f32_16x16x32_bf16 v[204:207], v[168:171], v[144:147], v[204:207]
  s_add_u32 s82, s60, s10
  s_add_u32 s82, s82, 512
  s_add_u32 m0, s52, 77824
  v_mfma_f32_16x16x32_bf16 v[208:211], v[176:179], v[144:147], v[208:211]
  buffer_load_dwordx4 v29, s[24:27], s82 offen offset:0  lds
  s_barrier
  ds_read_b128 v[224:227], v28 offset:1920
  ds_read_b128 v[228:231], v28 offset:1984
  ds_read_b128 v[232:235], v28 offset:2048
  ds_read_b128 v[236:239], v28 offset:2112
  ds_read_b128 v[240:243], v28 offset:2176
  ds_read_b128 v[244:247], v28 offset:2240
  s_waitcnt lgkmcnt(5)
  v_pk_mul_f32 v[224:225], v[224:225], v[156:157] op_sel:[0,1] op_sel_hi:[1,1]
  buffer_load_dwordx4 v30, s[24:27], s82 offen offset:1024  lds
  v_pk_mul_f32 v[226:227], v[226:227], v[156:157] op_sel:[0,1] op_sel_hi:[1,1]
  s_waitcnt vmcnt(12)
  v_add_u32 v214, 122880, v31
  v_add_u32 v220, 122880, v32
  ds_read_b128 a[136:139], v214 offset:0
  ds_read_b128 a[152:155], v220 offset:0
  ds_read_b128 a[140:143], v214 offset:2048
  ds_read_b128 a[156:159], v220 offset:2048
  ds_read_b128 a[160:163], v214 offset:4096
  ds_read_b128 a[176:179], v220 offset:4096
  v_pk_fma_f32 v[188:189], v[188:189], v[156:157], v[224:225] op_sel_hi:[1,0,1]
  s_add_u32 s82, s61, s10
  s_add_u32 s82, s82, 512
  s_add_u32 m0, s52, 0
  s_nop 0
  buffer_load_dwordx4 v29, s[24:27], s82 offen offset:0  lds
  v_pk_fma_f32 v[190:191], v[190:191], v[156:157], v[226:227] op_sel_hi:[1,0,1]
  s_waitcnt lgkmcnt(10)
  v_pk_mul_f32 v[228:229], v[228:229], v[156:157] op_sel:[0,1] op_sel_hi:[1,1]
  v_pk_mul_f32 v[230:231], v[230:231], v[156:157] op_sel:[0,1] op_sel_hi:[1,1]
  v_pk_fma_f32 v[192:193], v[192:193], v[156:157], v[228:229] op_sel_hi:[1,0,1]
  buffer_load_dwordx4 v30, s[24:27], s82 offen offset:1024  lds
  v_pk_fma_f32 v[194:195], v[194:195], v[156:157], v[230:231] op_sel_hi:[1,0,1]
  s_waitcnt lgkmcnt(9)
  v_pk_mul_f32 v[232:233], v[232:233], v[156:157] op_sel:[0,1] op_sel_hi:[1,1]
  v_pk_mul_f32 v[234:235], v[234:235], v[156:157] op_sel:[0,1] op_sel_hi:[1,1]
  v_pk_fma_f32 v[196:197], v[196:197], v[156:157], v[232:233] op_sel_hi:[1,0,1]
  s_add_u32 s82, s58, s11
  s_add_u32 s82, s82, 512
  s_add_u32 m0, s52, 2048
  s_nop 0
  buffer_load_dwordx4 v29, s[24:27], s82 offen offset:0  lds
  v_pk_fma_f32 v[198:199], v[198:199], v[156:157], v[234:235] op_sel_hi:[1,0,1]
  s_waitcnt lgkmcnt(0)
  v_pk_mul_f32 v[236:237], v[236:237], v[156:157] op_sel:[0,1] op_sel_hi:[1,1]
  v_pk_mul_f32 v[238:239], v[238:239], v[156:157] op_sel:[0,1] op_sel_hi:[1,1]
  v_pk_fma_f32 v[200:201], v[200:201], v[156:157], v[236:237] op_sel_hi:[1,0,1]
  buffer_load_dwordx4 v30, s[24:27], s82 offen offset:1024  lds
  v_pk_fma_f32 v[202:203], v[202:203], v[156:157], v[238:239] op_sel_hi:[1,0,1]
  v_pk_mul_f32 v[240:241], v[240:241], v[156:157] op_sel:[0,1] op_sel_hi:[1,1]
  v_pk_mul_f32 v[242:243], v[242:243], v[156:157] op_sel:[0,1] op_sel_hi:[1,1]
  v_pk_fma_f32 v[204:205], v[204:205], v[156:157], v[240:241] op_sel_hi:[1,0,1]
  v_pk_fma_f32 v[206:207], v[206:207], v[156:157], v[242:243] op_sel_hi:[1,0,1]
  s_add_u32 s82, s59, s11
  s_add_u32 s82, s82, 512
  s_add_u32 m0, s52, 4096
  s_nop 0
  buffer_load_dwordx4 v29, s[24:27], s82 offen offset:0  lds
  v_pk_mul_f32 v[244:245], v[244:245], v[156:157] op_sel:[0,1] op_sel_hi:[1,1]
  s_waitcnt vmcnt(11)
  v_add_u32 v214, 24576, v31
  v_add_u32 v220, 24576, v32
  ds_read_b128 a[164:167], v214 offset:0
  ds_read_b128 a[180:183], v220 offset:0
  ds_read_b128 a[168:171], v214 offset:2048
  ds_read_b128 a[184:187], v220 offset:2048
  ds_read_b128 a[172:175], v214 offset:4096
  ds_read_b128 a[188:191], v220 offset:4096
  v_pk_mul_f32 v[246:247], v[246:247], v[156:157] op_sel:[0,1] op_sel_hi:[1,1]
  buffer_load_dwordx4 v30, s[24:27], s82 offen offset:1024  lds
  v_pk_fma_f32 v[208:209], v[208:209], v[156:157], v[244:245] op_sel_hi:[1,0,1]
  v_pk_fma_f32 v[210:211], v[210:211], v[156:157], v[246:247] op_sel_hi:[1,0,1]
  v_mov_b32 v212, 0xbdd2d3e8
  v_mov_b32 v213, 0xc0135761
  v_pk_mul_f32 v[224:225], v[188:189], v[188:189]
  s_add_u32 s82, s60, s11
  s_add_u32 s82, s82, 512
  s_add_u32 m0, s52, 98304
  s_nop 0
  buffer_load_dwordx4 v29, s[24:27], s82 offen offset:0  lds
  v_pk_mul_f32 v[226:227], v[190:191], v[190:191]
  v_pk_mul_f32 v[228:229], v[192:193], v[192:193]
  s_waitcnt lgkmcnt(0)
  v_pk_mul_f32 v[230:231], v[194:195], v[194:195]
  v_pk_fma_f32 v[224:225], v[224:225], v[212:213], v[212:213] op_sel:[0,0,1] op_sel_hi:[1,0,1]
  buffer_load_dwordx4 v30, s[24:27], s82 offen offset:1024  lds
  v_pk_fma_f32 v[226:227], v[226:227], v[212:213], v[212:213] op_sel:[0,0,1] op_sel_hi:[1,0,1]
  v_pk_fma_f32 v[228:229], v[228:229], v[212:213], v[212:213] op_sel:[0,0,1] op_sel_hi:[1,0,1]
  v_pk_fma_f32 v[230:231], v[230:231], v[212:213], v[212:213] op_sel:[0,0,1] op_sel_hi:[1,0,1]
  v_pk_mul_f32 v[224:225], v[224:225], v[188:189]
  v_pk_mul_f32 v[226:227], v[226:227], v[190:191]
  s_add_u32 s82, s61, s11
  s_add_u32 s82, s82, 512
  s_add_u32 m0, s52, 100352
  s_nop 0
  buffer_load_dwordx4 v29, s[24:27], s82 offen offset:0  lds
  v_pk_mul_f32 v[228:229], v[228:229], v[192:193]
  v_pk_mul_f32 v[230:231], v[230:231], v[194:195]
  v_exp_f32 v224, v224
  v_exp_f32 v225, v225
  v_exp_f32 v226, v226
  buffer_load_dwordx4 v30, s[24:27], s82 offen offset:1024  lds
  v_exp_f32 v227, v227
  v_exp_f32 v228, v228
  v_exp_f32 v229, v229
  v_exp_f32 v230, v230
  v_exp_f32 v231, v231
  v_pk_add_f32 v[224:225], v[224:225], 1.0 op_sel_hi:[1,0]
  v_pk_add_f32 v[226:227], v[226:227], 1.0 op_sel_hi:[1,0]
  v_pk_add_f32 v[228:229], v[228:229], 1.0 op_sel_hi:[1,0]
  v_pk_add_f32 v[230:231], v[230:231], 1.0 op_sel_hi:[1,0]
  v_rcp_f32 v224, v224
  v_rcp_f32 v225, v225
  v_rcp_f32 v226, v226
  v_rcp_f32 v227, v227
  v_rcp_f32 v228, v228
  s_waitcnt vmcnt(10)
  v_add_u32 v214, 73728, v31
  v_add_u32 v220, 73728, v32
  ds_read_b128 a[192:195], v214 offset:0
  ds_read_b128 a[208:211], v220 offset:0
  ds_read_b128 a[196:199], v214 offset:2048
  ds_read_b128 a[212:215], v220 offset:2048
  ds_read_b128 a[200:203], v214 offset:4096
  ds_read_b128 a[216:219], v220 offset:4096
  v_rcp_f32 v229, v229
  s_add_u32 s82, s75, 737280
  s_add_u32 m0, s43, 49152
  s_nop 0
  buffer_load_dwordx4 v1, s[4:7], s82 offen offset:0 lds
  v_rcp_f32 v230, v230
  v_rcp_f32 v231, v231
  v_pk_mul_f32 v[188:189], v[188:189], v[224:225]
  v_pk_mul_f32 v[190:191], v[190:191], v[226:227]
  v_pk_mul_f32 v[192:193], v[192:193], v[228:229]
  v_pk_mul_f32 v[194:195], v[194:195], v[230:231]
  buffer_load_dwordx4 v1, s[4:7], s82 offen offset:1024 lds
  v_pk_mul_f32 v[232:233], v[196:197], v[196:197]
  v_pk_mul_f32 v[234:235], v[198:199], v[198:199]
  v_pk_mul_f32 v[236:237], v[200:201], v[200:201]
  v_pk_mul_f32 v[238:239], v[202:203], v[202:203]
  v_pk_fma_f32 v[232:233], v[232:233], v[212:213], v[212:213] op_sel:[0,0,1] op_sel_hi:[1,0,1]
  v_pk_fma_f32 v[234:235], v[234:235], v[212:213], v[212:213] op_sel:[0,0,1] op_sel_hi:[1,0,1]
  v_pk_fma_f32 v[236:237], v[236:237], v[212:213], v[212:213] op_sel:[0,0,1] op_sel_hi:[1,0,1]
  v_pk_fma_f32 v[238:239], v[238:239], v[212:213], v[212:213] op_sel:[0,0,1] op_sel_hi:[1,0,1]
  v_pk_mul_f32 v[232:233], v[232:233], v[196:197]
  v_pk_mul_f32 v[234:235], v[234:235], v[198:199]
  v_pk_mul_f32 v[236:237], v[236:237], v[200:201]
  s_waitcnt lgkmcnt(0)
  v_pk_mul_f32 v[238:239], v[238:239], v[202:203]
  buffer_load_dwordx4 v1, s[4:7], s82 offen offset:2048 lds
  v_exp_f32 v232, v232
  v_exp_f32 v233, v233
  v_exp_f32 v234, v234
  v_exp_f32 v235, v235
  v_exp_f32 v236, v236
  v_exp_f32 v237, v237
  v_exp_f32 v238, v238
  v_exp_f32 v239, v239
  v_pk_add_f32 v[232:233], v[232:233], 1.0 op_sel_hi:[1,0]
  v_pk_add_f32 v[234:235], v[234:235], 1.0 op_sel_hi:[1,0]
  v_pk_add_f32 v[236:237], v[236:237], 1.0 op_sel_hi:[1,0]
  v_pk_add_f32 v[238:239], v[238:239], 1.0 op_sel_hi:[1,0]
  v_rcp_f32 v232, v232
  buffer_load_dwordx4 v1, s[4:7], s82 offen offset:3072 lds
  v_rcp_f32 v233, v233
  v_rcp_f32 v234, v234
  v_rcp_f32 v235, v235
  v_rcp_f32 v236, v236
  v_rcp_f32 v237, v237
  v_rcp_f32 v238, v238
  v_rcp_f32 v239, v239
  v_pk_mul_f32 v[196:197], v[196:197], v[232:233]
  v_pk_mul_f32 v[198:199], v[198:199], v[234:235]
  v_pk_mul_f32 v[200:201], v[200:201], v[236:237]
  v_pk_mul_f32 v[202:203], v[202:203], v[238:239]
  v_pk_mul_f32 v[224:225], v[204:205], v[204:205]
  v_pk_mul_f32 v[226:227], v[206:207], v[206:207]
  v_pk_mul_f32 v[228:229], v[208:209], v[208:209]
  v_pk_mul_f32 v[230:231], v[210:211], v[210:211]
  v_pk_fma_f32 v[224:225], v[224:225], v[212:213], v[212:213] op_sel:[0,0,1] op_sel_hi:[1,0,1]
  v_pk_fma_f32 v[226:227], v[226:227], v[212:213], v[212:213] op_sel:[0,0,1] op_sel_hi:[1,0,1]
  v_pk_fma_f32 v[228:229], v[228:229], v[212:213], v[212:213] op_sel:[0,0,1] op_sel_hi:[1,0,1]
  v_pk_fma_f32 v[230:231], v[230:231], v[212:213], v[212:213] op_sel:[0,0,1] op_sel_hi:[1,0,1]
  v_pk_mul_f32 v[224:225], v[224:225], v[204:205]
  v_pk_mul_f32 v[226:227], v[226:227], v[206:207]
  v_pk_mul_f32 v[228:229], v[228:229], v[208:209]
  v_pk_mul_f32 v[230:231], v[230:231], v[210:211]
  v_exp_f32 v224, v224
  v_exp_f32 v225, v225
  v_exp_f32 v226, v226
  v_exp_f32 v227, v227
  v_exp_f32 v228, v228
  v_exp_f32 v229, v229
  v_exp_f32 v230, v230
  v_exp_f32 v231, v231
  v_pk_add_f32 v[224:225], v[224:225], 1.0 op_sel_hi:[1,0]
  v_pk_add_f32 v[226:227], v[226:227], 1.0 op_sel_hi:[1,0]
  v_pk_add_f32 v[228:229], v[228:229], 1.0 op_sel_hi:[1,0]
  v_pk_add_f32 v[230:231], v[230:231], 1.0 op_sel_hi:[1,0]
  v_rcp_f32 v224, v224
  v_rcp_f32 v225, v225
  v_rcp_f32 v226, v226
  v_rcp_f32 v227, v227
  v_rcp_f32 v228, v228
  v_rcp_f32 v229, v229
  v_rcp_f32 v230, v230
  s_waitcnt vmcnt(8)
  v_add_u32 v214, 0, v31
  v_add_u32 v220, 0, v32
  ds_read_b128 a[204:207], v214 offset:0
  ds_read_b128 a[220:223], v220 offset:0
  ds_read_b128 a[224:227], v214 offset:2048
  ds_read_b128 a[240:243], v220 offset:2048
  ds_read_b128 a[228:231], v214 offset:4096
  ds_read_b128 a[244:247], v220 offset:4096
  v_rcp_f32 v231, v231
  v_pk_mul_f32 v[204:205], v[204:205], v[224:225]
  v_pk_mul_f32 v[206:207], v[206:207], v[226:227]
  v_pk_mul_f32 v[208:209], v[208:209], v[228:229]
  v_pk_mul_f32 v[210:211], v[210:211], v[230:231]
  s_waitcnt lgkmcnt(0)
  s_add_u32 s82, s82, 4096
  s_add_u32 m0, m0, 4096
  s_nop 0
  buffer_load_dwordx4 v1, s[4:7], s82 offen offset:0 lds
  s_waitcnt vmcnt(5)
  v_add_u32 v214, 98304, v31
  v_add_u32 v220, 98304, v32
  ds_read_b128 a[232:235], v214 offset:0
  ds_read_b128 a[248:251], v220 offset:0
  ds_read_b128 a[236:239], v214 offset:2048
  ds_read_b128 a[252:255], v220 offset:2048
  s_waitcnt lgkmcnt(0)
  s_barrier
  s_lshl_b32 s84, s41, 9
  s_lshl_b32 s85, s40, 7
  s_add_u32 s84, s84, s85
  s_add_u32 s84, s84, 57344
  v_and_b32 v226, 31, v0
  s_add_u32 s82, s75, 761856
  s_add_u32 m0, s43, 0
  s_nop 0
  buffer_load_dwordx4 v1, s[4:7], s82 offen offset:0 lds
  v_lshlrev_b32 v226, 2, v226
  v_mov_b32 v228, v24
  v_mov_b32 v229, v24
  v_mov_b32 v230, v24
  v_mov_b32 v231, v24
  s_mov_b32 s88, 0
L_poll44:
  buffer_load_dword v224, v226, s[4:7], s84 offen sc1
  s_add_u32 s88, s88, 1
  s_cmp_gt_u32 s88, 65536
  s_cbranch_scc1 L_abort
  s_waitcnt vmcnt(0)
  v_cmp_ne_u32 vcc, s44, v224
  s_nop 0
  s_cbranch_vccnz L_poll44
L_ph_sp0:
  s_add_u32 s85, s19, 12058624
  s_add_u32 s86, s85, 4096
  buffer_load_dwordx4 v[232:235], v1, s[4:7], s85 offen offset:0 sc1
  buffer_load_dwordx4 v[236:239], v1, s[4:7], s85 offen offset:1024 sc1
  buffer_load_dwordx4 v[240:243], v1, s[4:7], s85 offen offset:2048 sc1
  buffer_load_dwordx4 v[244:247], v1, s[4:7], s85 offen offset:3072 sc1
  buffer_load_dwordx4 v[248:251], v1, s[4:7], s86 offen offset:0 sc1
  buffer_load_dwordx4 v[252:255], v1, s[4:7], s86 offen offset:1024 sc1
  s_add_u32 s85, s19, 12064768
  s_add_u32 s86, s85, 4096
  buffer_load_dwordx4 v[164:167], v1, s[4:7], s85 offen offset:0 sc1
  buffer_load_dwordx4 v[168:171], v1, s[4:7], s85 offen offset:1024 sc1
  buffer_load_dwordx4 v[172:175], v1, s[4:7], s85 offen offset:2048 sc1
  buffer_load_dwordx4 v[176:179], v1, s[4:7], s85 offen offset:3072 sc1
  buffer_load_dwordx4 v[180:183], v1, s[4:7], s86 offen offset:0 sc1
  buffer_load_dwordx4 v[184:187], v1, s[4:7], s86 offen offset:1024 sc1
  s_add_u32 s85, s20, 12058624
  s_add_u32 s86, s85, 4096
  buffer_load_dwordx4 v[224:227], v1, s[4:7], s85 offen offset:0 sc1
  s_and_b32 s0, s40, 1
  s_mul_i32 s0, s0, 12288
  s_cmp_ge_u32 s40, 2
  s_cselect_b32 s1, 40960, 0
  s_xor_b32 s3, s1, 114688
  s_xor_b32 s1, s1, 90112
  v_add3_u32 v212, v1, s0, 0
  v_add_u32 v213, s3, v212
  v_add_u32 v212, s1, v212
  s_sub_u32 s0, 12288, s0
  s_add_u32 s0, s0, s3
  v_add_u32 v214, s0, v1
  s_waitcnt vmcnt(12)
  v_mfma_f32_16x16x32_bf16 v[68:71], v[232:235], a[0:3], v[228:231]
  v_mfma_f32_16x16x32_bf16 v[92:95], v[232:235], a[4:7], 0
  v_mfma_f32_16x16x32_bf16 v[116:119], v[232:235], a[8:11], 0
  v_mfma_f32_16x16x32_bf16 v[140:143], v[232:235], a[12:15], 0
  s_waitcnt vmcnt(11)
  v_mfma_f32_16x16x32_bf16 v[72:75], v[236:239], a[0:3], v[228:231]
  v_mfma_f32_16x16x32_bf16 v[96:99], v[236:239], a[4:7], 0
  v_mfma_f32_16x16x32_bf16 v[120:123], v[236:239], a[8:11], 0
  s_add_u32 s100, s101, L_ph_wout0-L_base
  buffer_load_dword v222, v13, s[96:99], s100 offen
  v_mfma_f32_16x16x32_bf16 v[144:147], v[236:239], a[12:15], 0
  s_waitcnt vmcnt(11)
  v_mfma_f32_16x16x32_bf16 v[76:79], v[240:243], a[0:3], v[228:231]
  v_mfma_f32_16x16x32_bf16 v[100:103], v[240:243], a[4:7], 0
  v_mfma_f32_16x16x32_bf16 v[124:127], v[240:243], a[8:11], 0
  buffer_load_dwordx4 v1, s[4:7], s82 offen offset:1024 lds
  v_mfma_f32_16x16x32_bf16 v[148:151], v[240:243], a[12:15], 0
  s_waitcnt vmcnt(11)
  v_mfma_f32_16x16x32_bf16 v[80:83], v[244:247], a[0:3], v[228:231]
  v_mfma_f32_16x16x32_bf16 v[104:107], v[244:247], a[4:7], 0
  v_mfma_f32_16x16x32_bf16 v[128:131], v[244:247], a[8:11], 0
  buffer_load_dwordx4 v1, s[4:7], s82 offen offset:2048 lds
  v_mfma_f32_16x16x32_bf16 v[152:155], v[244:247], a[12:15], 0
  s_waitcnt vmcnt(11)
  v_mfma_f32_16x16x32_bf16 v[84:87], v[248:251], a[0:3], v[228:231]
  v_mfma_f32_16x16x32_bf16 v[108:111], v[248:251], a[4:7], 0
  v_mfma_f32_16x16x32_bf16 v[132:135], v[248:251], a[8:11], 0
  buffer_load_dwordx4 v1, s[4:7], s82 offen offset:3072 lds
  v_mfma_f32_16x16x32_bf16 v[156:159], v[248:251], a[12:15], 0
  s_waitcnt vmcnt(11)
  v_mfma_f32_16x16x32_bf16 v[88:91], v[252:255], a[0:3], v[228:231]
  v_mfma_f32_16x16x32_bf16 v[112:115], v[252:255], a[4:7], 0
  s_nop 1
  buffer_load_dwordx4 v[228:231], v1, s[4:7], s85 offen offset:1024 sc1
  buffer_load_dwordx4 v[232:235], v1, s[4:7], s85 offen offset:2048 sc1
  buffer_load_dwordx4 v[236:239], v1, s[4:7], s85 offen offset:3072 sc1
  buffer_load_dwordx4 v[240:243], v1, s[4:7], s86 offen offset:0 sc1
  buffer_load_dwordx4 v[244:247], v1, s[4:7], s86 offen offset:1024 sc1
  s_add_u32 s85, s20, 12064768
  s_add_u32 s86, s85, 4096
  buffer_load_dwordx4 v[248:251], v1, s[4:7], s85 offen offset:0 sc1
  v_mfma_f32_16x16x32_bf16 v[136:139], v[252:255], a[8:11], 0
  v_mfma_f32_16x16x32_bf16 v[160:163], v[252:255], a[12:15], 0
  s_waitcnt vmcnt(16)
  v_mfma_f32_16x16x32_bf16 v[68:71], v[164:167], a[16:19], v[68:71]
  v_mfma_f32_16x16x32_bf16 v[92:95], v[164:167], a[20:23], v[92:95]
  buffer_load_dwordx4 v[252:255], v1, s[4:7], s85 offen offset:1024 sc1
  v_mfma_f32_16x16x32_bf16 v[116:119], v[164:167], a[24:27], v[116:119]
  v_mfma_f32_16x16x32_bf16 v[140:143], v[164:167], a[28:31], v[140:143]
  s_waitcnt vmcnt(16)
  v_mfma_f32_16x16x32_bf16 v[72:75], v[168:171], a[16:19], v[72:75]
  v_mfma_f32_16x16x32_bf16 v[96:99], v[168:171], a[20:23], v[96:99]
  buffer_load_dwordx4 v[164:167], v1, s[4:7], s85 offen offset:2048 sc1
  v_mfma_f32_16x16x32_bf16 v[120:123], v[168:171], a[24:27], v[120:123]
  v_mfma_f32_16x16x32_bf16 v[144:147], v[168:171], a[28:31], v[144:147]
  s_waitcnt vmcnt(16)
  v_mfma_f32_16x16x32_bf16 v[76:79], v[172:175], a[16:19], v[76:79]
  v_mfma_f32_16x16x32_bf16 v[100:103], v[172:175], a[20:23], v[100:103]
  buffer_load_dwordx4 v[168:171], v1, s[4:7], s85 offen offset:3072 sc1
  v_mfma_f32_16x16x32_bf16 v[124:127], v[172:175], a[24:27], v[124:127]
  v_mfma_f32_16x16x32_bf16 v[148:151], v[172:175], a[28:31], v[148:151]
  s_waitcnt vmcnt(16)
  v_mfma_f32_16x16x32_bf16 v[80:83], v[176:179], a[16:19], v[80:83]
  v_mfma_f32_16x16x32_bf16 v[104:107], v[176:179], a[20:23], v[104:107]
  buffer_load_dwordx4 v[172:175], v1, s[4:7], s86 offen offset:0 sc1
  v_mfma_f32_16x16x32_bf16 v[128:131], v[176:179], a[24:27], v[128:131]
  v_mfma_f32_16x16x32_bf16 v[152:155], v[176:179], a[28:31], v[152:155]
  s_waitcnt vmcnt(16)
  v_mfma_f32_16x16x32_bf16 v[84:87], v[180:183], a[16:19], v[84:87]
  v_mfma_f32_16x16x32_bf16 v[108:111], v[180:183], a[20:23], v[108:111]
  buffer_load_dwordx4 v[176:179], v1, s[4:7], s86 offen offset:1024 sc1
  v_mfma_f32_16x16x32_bf16 v[132:135], v[180:183], a[24:27], v[132:135]
  v_mfma_f32_16x16x32_bf16 v[156:159], v[180:183], a[28:31], v[156:159]
  s_waitcnt vmcnt(16)
  v_mfma_f32_16x16x32_bf16 v[88:91], v[184:187], a[16:19], v[88:91]
  v_mfma_f32_16x16x32_bf16 v[112:115], v[184:187], a[20:23], v[112:115]
  s_add_u32 s85, s21, 12058624
  s_add_u32 s86, s85, 4096
  buffer_load_dwordx4 v[180:183], v1, s[4:7], s85 offen offset:0 sc1
  v_mfma_f32_16x16x32_bf16 v[136:139], v[184:187], a[24:27], v[136:139]
  v_mfma_f32_16x16x32_bf16 v[160:163], v[184:187], a[28:31], v[160:163]
  s_waitcnt vmcnt(16)
  v_mfma_f32_16x16x32_bf16 v[68:71], v[224:227], a[32:35], v[68:71]
  v_mfma_f32_16x16x32_bf16 v[92:95], v[224:227], a[36:39], v[92:95]
  buffer_load_dwordx4 v[184:187], v1, s[4:7], s85 offen offset:1024 sc1
  v_mfma_f32_16x16x32_bf16 v[116:119], v[224:227], a[40:43], v[116:119]
  v_mfma_f32_16x16x32_bf16 v[140:143], v[224:227], a[44:47], v[140:143]
  s_waitcnt vmcnt(12)
  v_mfma_f32_16x16x32_bf16 v[72:75], v[228:231], a[32:35], v[72:75]
  v_mfma_f32_16x16x32_bf16 v[96:99], v[228:231], a[36:39], v[96:99]
  buffer_load_dwordx4 v[224:227], v1, s[4:7], s85 offen offset:2048 sc1
  v_mfma_f32_16x16x32_bf16 v[120:123], v[228:231], a[40:43], v[120:123]
  v_mfma_f32_16x16x32_bf16 v[144:147], v[228:231], a[44:47], v[144:147]
  s_waitcnt vmcnt(12)
  v_mfma_f32_16x16x32_bf16 v[76:79], v[232:235], a[32:35], v[76:79]
  v_mfma_f32_16x16x32_bf16 v[100:103], v[232:235], a[36:39], v[100:103]
  buffer_load_dwordx4 v[228:231], v1, s[4:7], s85 offen offset:3072 sc1
  v_mfma_f32_16x16x32_bf16 v[124:127], v[232:235], a[40:43], v[124:127]
  v_mfma_f32_16x16x32_bf16 v[148:151], v[232:235], a[44:47], v[148:151]
  s_waitcnt vmcnt(12)
  v_mfma_f32_16x16x32_bf16 v[80:83], v[236:239], a[32:35], v[80:83]
  v_mfma_f32_16x16x32_bf16 v[104:107], v[236:239], a[36:39], v[104:107]
  buffer_load_dwordx4 v[232:235], v1, s[4:7], s86 offen offset:0 sc1
  v_mfma_f32_16x16x32_bf16 v[128:131], v[236:239], a[40:43], v[128:131]
  v_mfma_f32_16x16x32_bf16 v[152:155], v[236:239], a[44:47], v[152:155]
  s_waitcnt vmcnt(12)
  v_mfma_f32_16x16x32_bf16 v[84:87], v[240:243], a[32:35], v[84:87]
  v_mfma_f32_16x16x32_bf16 v[108:111], v[240:243], a[36:39], v[108:111]
  buffer_load_dwordx4 v[236:239], v1, s[4:7], s86 offen offset:1024 sc1
  v_mfma_f32_16x16x32_bf16 v[132:135], v[240:243], a[40:43], v[132:135]
  v_mfma_f32_16x16x32_bf16 v[156:159], v[240:243], a[44:47], v[156:159]
  s_waitcnt vmcnt(12)
  v_mfma_f32_16x16x32_bf16 v[88:91], v[244:247], a[32:35], v[88:91]
  v_mfma_f32_16x16x32_bf16 v[112:115], v[244:247], a[36:39], v[112:115]
  s_add_u32 s85, s21, 12064768
  s_add_u32 s86, s85, 4096
  buffer_load_dwordx4 v[240:243], v1, s[4:7], s85 offen offset:0 sc1
  v_mfma_f32_16x16x32_bf16 v[136:139], v[244:247], a[40:43], v[136:139]
  v_mfma_f32_16x16x32_bf16 v[160:163], v[244:247], a[44:47], v[160:163]
  s_waitcnt vmcnt(12)
  v_mfma_f32_16x16x32_bf16 v[68:71], v[248:251], a[48:51], v[68:71]
  v_mfma_f32_16x16x32_bf16 v[92:95], v[248:251], a[52:55], v[92:95]
  buffer_load_dwordx4 v[244:247], v1, s[4:7], s85 offen offset:1024 sc1
  v_mfma_f32_16x16x32_bf16 v[116:119], v[248:251], a[56:59], v[116:119]
  v_mfma_f32_16x16x32_bf16 v[140:143], v[248:251], a[60:63], v[140:143]
  s_waitcnt vmcnt(12)
  v_mfma_f32_16x16x32_bf16 v[72:75], v[252:255], a[48:51], v[72:75]
  v_mfma_f32_16x16x32_bf16 v[96:99], v[252:255], a[52:55], v[96:99]
  buffer_load_dwordx4 v[248:251], v1, s[4:7], s85 offen offset:2048 sc1
  v_mfma_f32_16x16x32_bf16 v[120:123], v[252:255], a[56:59], v[120:123]
  v_mfma_f32_16x16x32_bf16 v[144:147], v[252:255], a[60:63], v[144:147]
  s_waitcnt vmcnt(12)
  v_mfma_f32_16x16x32_bf16 v[76:79], v[164:167], a[48:51], v[76:79]
  v_mfma_f32_16x16x32_bf16 v[100:103], v[164:167], a[52:55], v[100:103]
  buffer_load_dwordx4 v[252:255], v1, s[4:7], s85 offen offset:3072 sc1
  v_mfma_f32_16x16x32_bf16 v[124:127], v[164:167], a[56:59], v[124:127]
  v_mfma_f32_16x16x32_bf16 v[148:151], v[164:167], a[60:63], v[148:151]
  s_waitcnt vmcnt(12)
  v_mfma_f32_16x16x32_bf16 v[80:83], v[168:171], a[48:51], v[80:83]
  v_mfma_f32_16x16x32_bf16 v[104:107], v[168:171], a[52:55], v[104:107]
  buffer_load_dwordx4 v[164:167], v1, s[4:7], s86 offen offset:0 sc1
  v_mfma_f32_16x16x32_bf16 v[128:131], v[168:171], a[56:59], v[128:131]
  v_mfma_f32_16x16x32_bf16 v[152:155], v[168:171], a[60:63], v[152:155]
  s_waitcnt vmcnt(12)
  v_mfma_f32_16x16x32_bf16 v[84:87], v[172:175], a[48:51], v[84:87]
  v_mfma_f32_16x16x32_bf16 v[108:111], v[172:175], a[52:55], v[108:111]
  buffer_load_dwordx4 v[168:171], v1, s[4:7], s86 offen offset:1024 sc1
  v_mfma_f32_16x16x32_bf16 v[132:135], v[172:175], a[56:59], v[132:135]
  v_mfma_f32_16x16x32_bf16 v[156:159], v[172:175], a[60:63], v[156:159]
  s_waitcnt vmcnt(12)
  v_mfma_f32_16x16x32_bf16 v[88:91], v[176:179], a[48:51], v[88:91]
  v_mfma_f32_16x16x32_bf16 v[112:115], v[176:179], a[52:55], v[112:115]
  s_add_u32 s85, s22, 12058624
  s_add_u32 s86, s85, 4096
  buffer_load_dwordx4 v[172:175], v1, s[4:7], s85 offen offset:0 sc1
  v_mfma_f32_16x16x32_bf16 v[136:139], v[176:179], a[56:59], v[136:139]
  v_mfma_f32_16x16x32_bf16 v[160:163], v[176:179], a[60:63], v[160:163]
  s_waitcnt vmcnt(12)
  v_mfma_f32_16x16x32_bf16 v[68:71], v[180:183], a[64:67], v[68:71]
  v_mfma_f32_16x16x32_bf16 v[92:95], v[180:183], a[68:71], v[92:95]
  buffer_load_dwordx4 v[176:179], v1, s[4:7], s85 offen offset:1024 sc1
  v_mfma_f32_16x16x32_bf16 v[116:119], v[180:183], a[72:75], v[116:119]
  v_mfma_f32_16x16x32_bf16 v[140:143], v[180:183], a[76:79], v[140:143]
  s_waitcnt vmcnt(12)
  v_mfma_f32_16x16x32_bf16 v[72:75], v[184:187], a[64:67], v[72:75]
  v_mfma_f32_16x16x32_bf16 v[96:99], v[184:187], a[68:71], v[96:99]
  buffer_load_dwordx4 v[180:183], v1, s[4:7], s85 offen offset:2048 sc1
  v_mfma_f32_16x16x32_bf16 v[120:123], v[184:187], a[72:75], v[120:123]
  v_mfma_f32_16x16x32_bf16 v[144:147], v[184:187], a[76:79], v[144:147]
  s_waitcnt vmcnt(12)
  v_mfma_f32_16x16x32_bf16 v[76:79], v[224:227], a[64:67], v[76:79]
  v_mfma_f32_16x16x32_bf16 v[100:103], v[224:227], a[68:71], v[100:103]
  buffer_load_dwordx4 v[184:187], v1, s[4:7], s85 offen offset:3072 sc1
  v_mfma_f32_16x16x32_bf16 v[124:127], v[224:227], a[72:75], v[124:127]
  v_mfma_f32_16x16x32_bf16 v[148:151], v[224:227], a[76:79], v[148:151]
  s_waitcnt vmcnt(12)
  v_mfma_f32_16x16x32_bf16 v[80:83], v[228:231], a[64:67], v[80:83]
  v_mfma_f32_16x16x32_bf16 v[104:107], v[228:231], a[68:71], v[104:107]
  buffer_load_dwordx4 v[224:227], v1, s[4:7], s86 offen offset:0 sc1
  v_mfma_f32_16x16x32_bf16 v[128:131], v[228:231], a[72:75], v[128:131]
  v_mfma_f32_16x16x32_bf16 v[152:155], v[228:231], a[76:79], v[152:155]
  s_waitcnt vmcnt(12)
  v_mfma_f32_16x16x32_bf16 v[84:87], v[232:235], a[64:67], v[84:87]
  v_mfma_f32_16x16x32_bf16 v[108:111], v[232:235], a[68:71], v[108:111]
  buffer_load_dwordx4 v[228:231], v1, s[4:7], s86 offen offset:1024 sc1
  v_mfma_f32_16x16x32_bf16 v[132:135], v[232:235], a[72:75], v[132:135]
  v_mfma_f32_16x16x32_bf16 v[156:159], v[232:235], a[76:79], v[156:159]
  s_waitcnt vmcnt(12)
  v_mfma_f32_16x16x32_bf16 v[88:91], v[236:239], a[64:67], v[88:91]
  v_mfma_f32_16x16x32_bf16 v[112:115], v[236:239], a[68:71], v[112:115]
  s_add_u32 s85, s22, 12064768
  s_add_u32 s86, s85, 4096
  buffer_load_dwordx4 v[232:235], v1, s[4:7], s85 offen offset:0 sc1
  v_mfma_f32_16x16x32_bf16 v[136:139], v[236:239], a[72:75], v[136:139]
  v_mfma_f32_16x16x32_bf16 v[160:163], v[236:239], a[76:79], v[160:163]
  s_waitcnt vmcnt(12)
  v_mfma_f32_16x16x32_bf16 v[68:71], v[240:243], a[80:83], v[68:71]
  v_mfma_f32_16x16x32_bf16 v[92:95], v[240:243], a[84:87], v[92:95]
  buffer_load_dwordx4 v[236:239], v1, s[4:7], s85 offen offset:1024 sc1
  v_mfma_f32_16x16x32_bf16 v[116:119], v[240:243], a[88:91], v[116:119]
  v_mfma_f32_16x16x32_bf16 v[140:143], v[240:243], a[92:95], v[140:143]
  s_waitcnt vmcnt(12)
  v_mfma_f32_16x16x32_bf16 v[72:75], v[244:247], a[80:83], v[72:75]
  v_mfma_f32_16x16x32_bf16 v[96:99], v[244:247], a[84:87], v[96:99]
  buffer_load_dwordx4 v[240:243], v1, s[4:7], s85 offen offset:2048 sc1
  v_mfma_f32_16x16x32_bf16 v[120:123], v[244:247], a[88:91], v[120:123]
  v_mfma_f32_16x16x32_bf16 v[144:147], v[244:247], a[92:95], v[144:147]
  s_waitcnt vmcnt(12)
  v_mfma_f32_16x16x32_bf16 v[76:79], v[248:251], a[80:83], v[76:79]
  v_mfma_f32_16x16x32_bf16 v[100:103], v[248:251], a[84:87], v[100:103]
  buffer_load_dwordx4 v[244:247], v1, s[4:7], s85 offen offset:3072 sc1
  v_mfma_f32_16x16x32_bf16 v[124:127], v[248:251], a[88:91], v[124:127]
  v_mfma_f32_16x16x32_bf16 v[148:151], v[248:251], a[92:95], v[148:151]
  s_waitcnt vmcnt(12)
  v_mfma_f32_16x16x32_bf16 v[80:83], v[252:255], a[80:83], v[80:83]
  v_mfma_f32_16x16x32_bf16 v[104:107], v[252:255], a[84:87], v[104:107]
  buffer_load_dwordx4 v[248:251], v1, s[4:7], s86 offen offset:0 sc1
  v_mfma_f32_16x16x32_bf16 v[128:131], v[252:255], a[88:91], v[128:131]
  v_mfma_f32_16x16x32_bf16 v[152:155], v[252:255], a[92:95], v[152:155]
  s_waitcnt vmcnt(12)
  v_mfma_f32_16x16x32_bf16 v[84:87], v[164:167], a[80:83], v[84:87]
  v_mfma_f32_16x16x32_bf16 v[108:111], v[164:167], a[84:87], v[108:111]
  buffer_load_dwordx4 v[252:255], v1, s[4:7], s86 offen offset:1024 sc1
  v_mfma_f32_16x16x32_bf16 v[132:135], v[164:167], a[88:91], v[132:135]
  v_mfma_f32_16x16x32_bf16 v[156:159], v[164:167], a[92:95], v[156:159]
  s_waitcnt vmcnt(12)
  v_mfma_f32_16x16x32_bf16 v[88:91], v[168:171], a[80:83], v[88:91]
  v_mfma_f32_16x16x32_bf16 v[112:115], v[168:171], a[84:87], v[112:115]
  s_add_u32 s85, s19, 12107776
  s_add_u32 s86, s85, 4096
  buffer_load_dwordx4 v[164:167], v1, s[4:7], s85 offen offset:0 sc1
  v_mfma_f32_16x16x32_bf16 v[136:139], v[168:171], a[88:91], v[136:139]
  v_mfma_f32_16x16x32_bf16 v[160:163], v[168:171], a[92:95], v[160:163]
  s_waitcnt vmcnt(12)
  v_mfma_f32_16x16x32_bf16 v[68:71], v[172:175], a[96:99], v[68:71]
  v_mfma_f32_16x16x32_bf16 v[92:95], v[172:175], a[100:103], v[92:95]
  buffer_load_dwordx4 v[168:171], v1, s[4:7], s85 offen offset:1024 sc1
  v_mfma_f32_16x16x32_bf16 v[116:119], v[172:175], a[104:107], v[116:119]
  v_mfma_f32_16x16x32_bf16 v[140:143], v[172:175], a[108:111], v[140:143]
  s_waitcnt vmcnt(12)
  v_mfma_f32_16x16x32_bf16 v[72:75], v[176:179], a[96:99], v[72:75]
  v_mfma_f32_16x16x32_bf16 v[96:99], v[176:179], a[100:103], v[96:99]
  buffer_load_dwordx4 v[172:175], v1, s[4:7], s85 offen offset:2048 sc1
  v_mfma_f32_16x16x32_bf16 v[120:123], v[176:179], a[104:107], v[120:123]
  v_mfma_f32_16x16x32_bf16 v[144:147], v[176:179], a[108:111], v[144:147]
  s_waitcnt vmcnt(12)
  v_mfma_f32_16x16x32_bf16 v[76:79], v[180:183], a[96:99], v[76:79]
  v_mfma_f32_16x16x32_bf16 v[100:103], v[180:183], a[100:103], v[100:103]
  buffer_load_dwordx4 v[176:179], v1, s[4:7], s85 offen offset:3072 sc1
  v_mfma_f32_16x16x32_bf16 v[124:127], v[180:183], a[104:107], v[124:127]
  v_mfma_f32_16x16x32_bf16 v[148:151], v[180:183], a[108:111], v[148:151]
  s_waitcnt vmcnt(12)
  v_mfma_f32_16x16x32_bf16 v[80:83], v[184:187], a[96:99], v[80:83]
  v_mfma_f32_16x16x32_bf16 v[104:107], v[184:187], a[100:103], v[104:107]
  buffer_load_dwordx4 v[180:183], v1, s[4:7], s86 offen offset:0 sc1
  v_mfma_f32_16x16x32_bf16 v[128:131], v[184:187], a[104:107], v[128:131]
  v_mfma_f32_16x16x32_bf16 v[152:155], v[184:187], a[108:111], v[152:155]
  s_waitcnt vmcnt(12)
  v_mfma_f32_16x16x32_bf16 v[84:87], v[224:227], a[96:99], v[84:87]
  v_mfma_f32_16x16x32_bf16 v[108:111], v[224:227], a[100:103], v[108:111]
  buffer_load_dwordx4 v[184:187], v1, s[4:7], s86 offen offset:1024 sc1
  v_mfma_f32_16x16x32_bf16 v[132:135], v[224:227], a[104:107], v[132:135]
  v_mfma_f32_16x16x32_bf16 v[156:159], v[224:227], a[108:111], v[156:159]
  s_waitcnt vmcnt(12)
  v_mfma_f32_16x16x32_bf16 v[88:91], v[228:231], a[96:99], v[88:91]
  v_mfma_f32_16x16x32_bf16 v[112:115], v[228:231], a[100:103], v[112:115]
  s_add_u32 s85, s19, 12113920
  s_add_u32 s86, s85, 4096
  buffer_load_dwordx4 v[224:227], v1, s[4:7], s85 offen offset:0 sc1
  v_mfma_f32_16x16x32_bf16 v[136:139], v[228:231], a[104:107], v[136:139]
  v_mfma_f32_16x16x32_bf16 v[160:163], v[228:231], a[108:111], v[160:163]
  s_waitcnt vmcnt(12)
  v_mfma_f32_16x16x32_bf16 v[68:71], v[232:235], a[112:115], v[68:71]
  v_mfma_f32_16x16x32_bf16 v[92:95], v[232:235], a[116:119], v[92:95]
  buffer_load_dwordx4 v[228:231], v1, s[4:7], s85 offen offset:1024 sc1
  v_mfma_f32_16x16x32_bf16 v[116:119], v[232:235], a[120:123], v[116:119]
  v_mfma_f32_16x16x32_bf16 v[140:143], v[232:235], a[124:127], v[140:143]
  s_waitcnt vmcnt(12)
  v_mfma_f32_16x16x32_bf16 v[72:75], v[236:239], a[112:115], v[72:75]
  v_mfma_f32_16x16x32_bf16 v[96:99], v[236:239], a[116:119], v[96:99]
  buffer_load_dwordx4 v[232:235], v1, s[4:7], s85 offen offset:2048 sc1
  v_mfma_f32_16x16x32_bf16 v[120:123], v[236:239], a[120:123], v[120:123]
  v_mfma_f32_16x16x32_bf16 v[144:147], v[236:239], a[124:127], v[144:147]
  s_waitcnt vmcnt(12)
  v_mfma_f32_16x16x32_bf16 v[76:79], v[240:243], a[112:115], v[76:79]
  v_mfma_f32_16x16x32_bf16 v[100:103], v[240:243], a[116:119], v[100:103]
  buffer_load_dwordx4 v[236:239], v1, s[4:7], s85 offen offset:3072 sc1
  v_mfma_f32_16x16x32_bf16 v[124:127], v[240:243], a[120:123], v[124:127]
  v_mfma_f32_16x16x32_bf16 v[148:151], v[240:243], a[124:127], v[148:151]
  s_waitcnt vmcnt(12)
  v_mfma_f32_16x16x32_bf16 v[80:83], v[244:247], a[112:115], v[80:83]
  v_mfma_f32_16x16x32_bf16 v[104:107], v[244:247], a[116:119], v[104:107]
  buffer_load_dwordx4 v[240:243], v1, s[4:7], s86 offen offset:0 sc1
  v_mfma_f32_16x16x32_bf16 v[128:131], v[244:247], a[120:123], v[128:131]
  v_mfma_f32_16x16x32_bf16 v[152:155], v[244:247], a[124:127], v[152:155]
  s_waitcnt vmcnt(12)
  v_mfma_f32_16x16x32_bf16 v[84:87], v[248:251], a[112:115], v[84:87]
  v_mfma_f32_16x16x32_bf16 v[108:111], v[248:251], a[116:119], v[108:111]
  buffer_load_dwordx4 v[244:247], v1, s[4:7], s86 offen offset:1024 sc1
  v_mfma_f32_16x16x32_bf16 v[132:135], v[248:251], a[120:123], v[132:135]
  v_mfma_f32_16x16x32_bf16 v[156:159], v[248:251], a[124:127], v[156:159]
  s_waitcnt vmcnt(12)
  v_mfma_f32_16x16x32_bf16 v[88:91], v[252:255], a[112:115], v[88:91]
  v_mfma_f32_16x16x32_bf16 v[112:115], v[252:255], a[116:119], v[112:115]
  s_add_u32 s85, s20, 12107776
  s_add_u32 s86, s85, 4096
  buffer_load_dwordx4 v[248:251], v1, s[4:7], s85 offen offset:0 sc1
  v_mfma_f32_16x16x32_bf16 v[136:139], v[252:255], a[120:123], v[136:139]
  v_mfma_f32_16x16x32_bf16 v[160:163], v[252:255], a[124:127], v[160:163]
  s_waitcnt vmcnt(12)
  v_mfma_f32_16x16x32_bf16 v[68:71], v[164:167], a[128:131], v[68:71]
  v_mfma_f32_16x16x32_bf16 v[92:95], v[164:167], a[132:135], v[92:95]
  buffer_load_dwordx4 v[252:255], v1, s[4:7], s85 offen offset:1024 sc1
  v_mfma_f32_16x16x32_bf16 v[116:119], v[164:167], a[136:139], v[116:119]
  v_mfma_f32_16x16x32_bf16 v[140:143], v[164:167], a[140:143], v[140:143]
  s_waitcnt vmcnt(12)
  v_mfma_f32_16x16x32_bf16 v[72:75], v[168:171], a[128:131], v[72:75]
  v_mfma_f32_16x16x32_bf16 v[96:99], v[168:171], a[132:135], v[96:99]
  buffer_load_dwordx4 v[164:167], v1, s[4:7], s85 offen offset:2048 sc1
  v_mfma_f32_16x16x32_bf16 v[120:123], v[168:171], a[136:139], v[120:123]
  v_mfma_f32_16x16x32_bf16 v[144:147], v[168:171], a[140:143], v[144:147]
  s_waitcnt vmcnt(12)
  v_mfma_f32_16x16x32_bf16 v[76:79], v[172:175], a[128:131], v[76:79]
  v_mfma_f32_16x16x32_bf16 v[100:103], v[172:175], a[132:135], v[100:103]
  buffer_load_dwordx4 v[168:171], v1, s[4:7], s85 offen offset:3072 sc1
  v_mfma_f32_16x16x32_bf16 v[124:127], v[172:175], a[136:139], v[124:127]
  v_mfma_f32_16x16x32_bf16 v[148:151], v[172:175], a[140:143], v[148:151]
  s_waitcnt vmcnt(12)
  v_mfma_f32_16x16x32_bf16 v[80:83], v[176:179], a[128:131], v[80:83]
  v_mfma_f32_16x16x32_bf16 v[104:107], v[176:179], a[132:135], v[104:107]
  buffer_load_dwordx4 v[172:175], v1, s[4:7], s86 offen offset:0 sc1
  v_mfma_f32_16x16x32_bf16 v[128:131], v[176:179], a[136:139], v[128:131]
  v_mfma_f32_16x16x32_bf16 v[152:155], v[176:179], a[140:143], v[152:155]
  s_waitcnt vmcnt(12)
  v_mfma_f32_16x16x32_bf16 v[84:87], v[180:183], a[128:131], v[84:87]
  v_mfma_f32_16x16x32_bf16 v[108:111], v[180:183], a[132:135], v[108:111]
  buffer_load_dwordx4 v[176:179], v1, s[4:7], s86 offen offset:1024 sc1
  v_mfma_f32_16x16x32_bf16 v[132:135], v[180:183], a[136:139], v[132:135]
  v_mfma_f32_16x16x32_bf16 v[156:159], v[180:183], a[140:143], v[156:159]
  s_waitcnt vmcnt(12)
  v_mfma_f32_16x16x32_bf16 v[88:91], v[184:187], a[128:131], v[88:91]
  v_mfma_f32_16x16x32_bf16 v[112:115], v[184:187], a[132:135], v[112:115]
  s_add_u32 s85, s20, 12113920
  s_add_u32 s86, s85, 4096
  buffer_load_dwordx4 v[180:183], v1, s[4:7], s85 offen offset:0 sc1
  v_mfma_f32_16x16x32_bf16 v[136:139], v[184:187], a[136:139], v[136:139]
  v_mfma_f32_16x16x32_bf16 v[160:163], v[184:187], a[140:143], v[160:163]
  s_waitcnt vmcnt(12)
  v_mfma_f32_16x16x32_bf16 v[68:71], v[224:227], a[144:147], v[68:71]
  v_mfma_f32_16x16x32_bf16 v[92:95], v[224:227], a[148:151], v[92:95]
  buffer_load_dwordx4 v[184:187], v1, s[4:7], s85 offen offset:1024 sc1
  v_mfma_f32_16x16x32_bf16 v[116:119], v[224:227], a[152:155], v[116:119]
  v_mfma_f32_16x16x32_bf16 v[140:143], v[224:227], a[156:159], v[140:143]
  s_waitcnt vmcnt(12)
  v_mfma_f32_16x16x32_bf16 v[72:75], v[228:231], a[144:147], v[72:75]
  v_mfma_f32_16x16x32_bf16 v[96:99], v[228:231], a[148:151], v[96:99]
  buffer_load_dwordx4 v[224:227], v1, s[4:7], s85 offen offset:2048 sc1
  v_mfma_f32_16x16x32_bf16 v[120:123], v[228:231], a[152:155], v[120:123]
  v_mfma_f32_16x16x32_bf16 v[144:147], v[228:231], a[156:159], v[144:147]
  s_waitcnt vmcnt(12)
  v_mfma_f32_16x16x32_bf16 v[76:79], v[232:235], a[144:147], v[76:79]
  v_mfma_f32_16x16x32_bf16 v[100:103], v[232:235], a[148:151], v[100:103]
  buffer_load_dwordx4 v[228:231], v1, s[4:7], s85 offen offset:3072 sc1
  v_mfma_f32_16x16x32_bf16 v[124:127], v[232:235], a[152:155], v[124:127]
  v_mfma_f32_16x16x32_bf16 v[148:151], v[232:235], a[156:159], v[148:151]
  s_waitcnt vmcnt(12)
  v_mfma_f32_16x16x32_bf16 v[80:83], v[236:239], a[144:147], v[80:83]
  v_mfma_f32_16x16x32_bf16 v[104:107], v[236:239], a[148:151], v[104:107]
  buffer_load_dwordx4 v[232:235], v1, s[4:7], s86 offen offset:0 sc1
  v_mfma_f32_16x16x32_bf16 v[128:131], v[236:239], a[152:155], v[128:131]
  v_mfma_f32_16x16x32_bf16 v[152:155], v[236:239], a[156:159], v[152:155]
  s_waitcnt vmcnt(12)
  v_mfma_f32_16x16x32_bf16 v[84:87], v[240:243], a[144:147], v[84:87]
  v_mfma_f32_16x16x32_bf16 v[108:111], v[240:243], a[148:151], v[108:111]
  buffer_load_dwordx4 v[236:239], v1, s[4:7], s86 offen offset:1024 sc1
  v_mfma_f32_16x16x32_bf16 v[132:135], v[240:243], a[152:155], v[132:135]
  v_mfma_f32_16x16x32_bf16 v[156:159], v[240:243], a[156:159], v[156:159]
  s_waitcnt vmcnt(12)
  v_mfma_f32_16x16x32_bf16 v[88:91], v[244:247], a[144:147], v[88:91]
  v_mfma_f32_16x16x32_bf16 v[112:115], v[244:247], a[148:151], v[112:115]
  s_add_u32 s85, s21, 12107776
  s_add_u32 s86, s85, 4096
  buffer_load_dwordx4 v[240:243], v1, s[4:7], s85 offen offset:0 sc1
  v_mfma_f32_16x16x32_bf16 v[136:139], v[244:247], a[152:155], v[136:139]
  v_mfma_f32_16x16x32_bf16 v[160:163], v[244:247], a[156:159], v[160:163]
  s_waitcnt vmcnt(12)
  v_mfma_f32_16x16x32_bf16 v[68:71], v[248:251], a[160:163], v[68:71]
  v_mfma_f32_16x16x32_bf16 v[92:95], v[248:251], a[164:167], v[92:95]
  buffer_load_dwordx4 v[244:247], v1, s[4:7], s85 offen offset:1024 sc1
  v_mfma_f32_16x16x32_bf16 v[116:119], v[248:251], a[168:171], v[116:119]
  s_mul_i32 s100, s41, 3072
  s_add_u32 s100, s100, s53
  buffer_load_dword v222, v43, s[4:7], s100 offen sc1
  v_mfma_f32_16x16x32_bf16 v[140:143], v[248:251], a[172:175], v[140:143]
  s_waitcnt vmcnt(13)
  v_mfma_f32_16x16x32_bf16 v[72:75], v[252:255], a[160:163], v[72:75]
  v_mfma_f32_16x16x32_bf16 v[96:99], v[252:255], a[164:167], v[96:99]
  buffer_load_dwordx4 v[248:251], v1, s[4:7], s85 offen offset:2048 sc1
  v_mfma_f32_16x16x32_bf16 v[120:123], v[252:255], a[168:171], v[120:123]
  v_mfma_f32_16x16x32_bf16 v[144:147], v[252:255], a[172:175], v[144:147]
  s_waitcnt vmcnt(13)
  v_mfma_f32_16x16x32_bf16 v[76:79], v[164:167], a[160:163], v[76:79]
  v_mfma_f32_16x16x32_bf16 v[100:103], v[164:167], a[164:167], v[100:103]
  buffer_load_dwordx4 v[252:255], v1, s[4:7], s85 offen offset:3072 sc1
  v_mfma_f32_16x16x32_bf16 v[124:127], v[164:167], a[168:171], v[124:127]
  v_mfma_f32_16x16x32_bf16 v[148:151], v[164:167], a[172:175], v[148:151]
  s_waitcnt vmcnt(13)
  v_mfma_f32_16x16x32_bf16 v[80:83], v[168:171], a[160:163], v[80:83]
  v_mfma_f32_16x16x32_bf16 v[104:107], v[168:171], a[164:167], v[104:107]
  buffer_load_dwordx4 v[164:167], v1, s[4:7], s86 offen offset:0 sc1
  v_mfma_f32_16x16x32_bf16 v[128:131], v[168:171], a[168:171], v[128:131]
  v_mfma_f32_16x16x32_bf16 v[152:155], v[168:171], a[172:175], v[152:155]
  s_waitcnt vmcnt(13)
  v_mfma_f32_16x16x32_bf16 v[84:87], v[172:175], a[160:163], v[84:87]
  v_mfma_f32_16x16x32_bf16 v[108:111], v[172:175], a[164:167], v[108:111]
  buffer_load_dwordx4 v[168:171], v1, s[4:7], s86 offen offset:1024 sc1
  v_mfma_f32_16x16x32_bf16 v[132:135], v[172:175], a[168:171], v[132:135]
  v_mfma_f32_16x16x32_bf16 v[156:159], v[172:175], a[172:175], v[156:159]
  s_waitcnt vmcnt(13)
  v_mfma_f32_16x16x32_bf16 v[88:91], v[176:179], a[160:163], v[88:91]
  v_mfma_f32_16x16x32_bf16 v[112:115], v[176:179], a[164:167], v[112:115]
  s_add_u32 s85, s21, 12113920
  s_add_u32 s86, s85, 4096
  buffer_load_dwordx4 v[172:175], v1, s[4:7], s85 offen offset:0 sc1
  v_mfma_f32_16x16x32_bf16 v[136:139], v[176:179], a[168:171], v[136:139]
  v_mfma_f32_16x16x32_bf16 v[160:163], v[176:179], a[172:175], v[160:163]
  s_waitcnt vmcnt(13)
  v_mfma_f32_16x16x32_bf16 v[68:71], v[180:183], a[176:179], v[68:71]
  v_mfma_f32_16x16x32_bf16 v[92:95], v[180:183], a[180:183], v[92:95]
  buffer_load_dwordx4 v[176:179], v1, s[4:7], s85 offen offset:1024 sc1
  v_mfma_f32_16x16x32_bf16 v[116:119], v[180:183], a[184:187], v[116:119]
  v_mfma_f32_16x16x32_bf16 v[140:143], v[180:183], a[188:191], v[140:143]
  s_waitcnt vmcnt(13)
  v_mfma_f32_16x16x32_bf16 v[72:75], v[184:187], a[176:179], v[72:75]
  v_mfma_f32_16x16x32_bf16 v[96:99], v[184:187], a[180:183], v[96:99]
  buffer_load_dwordx4 v[180:183], v1, s[4:7], s85 offen offset:2048 sc1
  v_mfma_f32_16x16x32_bf16 v[120:123], v[184:187], a[184:187], v[120:123]
  v_mfma_f32_16x16x32_bf16 v[144:147], v[184:187], a[188:191], v[144:147]
  s_waitcnt vmcnt(13)
  v_mfma_f32_16x16x32_bf16 v[76:79], v[224:227], a[176:179], v[76:79]
  v_mfma_f32_16x16x32_bf16 v[100:103], v[224:227], a[180:183], v[100:103]
  buffer_load_dwordx4 v[184:187], v1, s[4:7], s85 offen offset:3072 sc1
  v_mfma_f32_16x16x32_bf16 v[124:127], v[224:227], a[184:187], v[124:127]
  v_mfma_f32_16x16x32_bf16 v[148:151], v[224:227], a[188:191], v[148:151]
  s_waitcnt vmcnt(13)
  v_mfma_f32_16x16x32_bf16 v[80:83], v[228:231], a[176:179], v[80:83]
  v_mfma_f32_16x16x32_bf16 v[104:107], v[228:231], a[180:183], v[104:107]
  buffer_load_dwordx4 v[224:227], v1, s[4:7], s86 offen offset:0 sc1
  v_mfma_f32_16x16x32_bf16 v[128:131], v[228:231], a[184:187], v[128:131]
  v_mfma_f32_16x16x32_bf16 v[152:155], v[228:231], a[188:191], v[152:155]
  s_waitcnt vmcnt(13)
  v_mfma_f32_16x16x32_bf16 v[84:87], v[232:235], a[176:179], v[84:87]
  v_mfma_f32_16x16x32_bf16 v[108:111], v[232:235], a[180:183], v[108:111]
  buffer_load_dwordx4 v[228:231], v1, s[4:7], s86 offen offset:1024 sc1
  v_mfma_f32_16x16x32_bf16 v[132:135], v[232:235], a[184:187], v[132:135]
  v_mfma_f32_16x16x32_bf16 v[156:159], v[232:235], a[188:191], v[156:159]
  s_waitcnt vmcnt(13)
  v_mfma_f32_16x16x32_bf16 v[88:91], v[236:239], a[176:179], v[88:91]
  v_mfma_f32_16x16x32_bf16 v[112:115], v[236:239], a[180:183], v[112:115]
  s_add_u32 s85, s22, 12107776
  s_add_u32 s86, s85, 4096
  buffer_load_dwordx4 v[232:235], v1, s[4:7], s85 offen offset:0 sc1
  v_mfma_f32_16x16x32_bf16 v[136:139], v[236:239], a[184:187], v[136:139]
  v_mfma_f32_16x16x32_bf16 v[160:163], v[236:239], a[188:191], v[160:163]
  s_waitcnt vmcnt(13)
  v_mfma_f32_16x16x32_bf16 v[68:71], v[240:243], a[192:195], v[68:71]
  v_mfma_f32_16x16x32_bf16 v[92:95], v[240:243], a[196:199], v[92:95]
  buffer_load_dwordx4 v[236:239], v1, s[4:7], s85 offen offset:1024 sc1
  v_mfma_f32_16x16x32_bf16 v[116:119], v[240:243], a[200:203], v[116:119]
  v_mfma_f32_16x16x32_bf16 v[140:143], v[240:243], a[204:207], v[140:143]
  s_waitcnt vmcnt(13)
  v_mfma_f32_16x16x32_bf16 v[72:75], v[244:247], a[192:195], v[72:75]
  v_mfma_f32_16x16x32_bf16 v[96:99], v[244:247], a[196:199], v[96:99]
  buffer_load_dwordx4 v[240:243], v1, s[4:7], s85 offen offset:2048 sc1
  v_mfma_f32_16x16x32_bf16 v[120:123], v[244:247], a[200:203], v[120:123]
  v_mfma_f32_16x16x32_bf16 v[144:147], v[244:247], a[204:207], v[144:147]
  s_waitcnt vmcnt(12)
  v_mfma_f32_16x16x32_bf16 v[76:79], v[248:251], a[192:195], v[76:79]
  v_mfma_f32_16x16x32_bf16 v[100:103], v[248:251], a[196:199], v[100:103]
  buffer_load_dwordx4 v[244:247], v1, s[4:7], s85 offen offset:3072 sc1
  v_mfma_f32_16x16x32_bf16 v[124:127], v[248:251], a[200:203], v[124:127]
  v_mfma_f32_16x16x32_bf16 v[148:151], v[248:251], a[204:207], v[148:151]
  s_waitcnt vmcnt(12)
  v_mfma_f32_16x16x32_bf16 v[80:83], v[252:255], a[192:195], v[80:83]
  v_mfma_f32_16x16x32_bf16 v[104:107], v[252:255], a[196:199], v[104:107]
  buffer_load_dwordx4 v[248:251], v1, s[4:7], s86 offen offset:0 sc1
  v_mfma_f32_16x16x32_bf16 v[128:131], v[252:255], a[200:203], v[128:131]
  v_mfma_f32_16x16x32_bf16 v[152:155], v[252:255], a[204:207], v[152:155]
  s_waitcnt vmcnt(12)
  v_mfma_f32_16x16x32_bf16 v[84:87], v[164:167], a[192:195], v[84:87]
  v_mfma_f32_16x16x32_bf16 v[108:111], v[164:167], a[196:199], v[108:111]
  buffer_load_dwordx4 v[252:255], v1, s[4:7], s86 offen offset:1024 sc1
  v_mfma_f32_16x16x32_bf16 v[132:135], v[164:167], a[200:203], v[132:135]
  v_mfma_f32_16x16x32_bf16 v[156:159], v[164:167], a[204:207], v[156:159]
  s_waitcnt vmcnt(12)
  v_mfma_f32_16x16x32_bf16 v[88:91], v[168:171], a[192:195], v[88:91]
  v_mfma_f32_16x16x32_bf16 v[112:115], v[168:171], a[196:199], v[112:115]
  s_add_u32 s85, s22, 12113920
  s_add_u32 s86, s85, 4096
  buffer_load_dwordx4 v[164:167], v1, s[4:7], s85 offen offset:0 sc1
  v_mfma_f32_16x16x32_bf16 v[136:139], v[168:171], a[200:203], v[136:139]
  v_mfma_f32_16x16x32_bf16 v[160:163], v[168:171], a[204:207], v[160:163]
  s_waitcnt vmcnt(12)
  v_mfma_f32_16x16x32_bf16 v[68:71], v[172:175], a[208:211], v[68:71]
  v_mfma_f32_16x16x32_bf16 v[92:95], v[172:175], a[212:215], v[92:95]
  buffer_load_dwordx4 v[168:171], v1, s[4:7], s85 offen offset:1024 sc1
  v_mfma_f32_16x16x32_bf16 v[116:119], v[172:175], a[216:219], v[116:119]
  v_mfma_f32_16x16x32_bf16 v[140:143], v[172:175], a[220:223], v[140:143]
  s_waitcnt vmcnt(12)
  v_mfma_f32_16x16x32_bf16 v[72:75], v[176:179], a[208:211], v[72:75]
  v_mfma_f32_16x16x32_bf16 v[96:99], v[176:179], a[212:215], v[96:99]
  buffer_load_dwordx4 v[172:175], v1, s[4:7], s85 offen offset:2048 sc1
  v_mfma_f32_16x16x32_bf16 v[120:123], v[176:179], a[216:219], v[120:123]
  v_mfma_f32_16x16x32_bf16 v[144:147], v[176:179], a[220:223], v[144:147]
  s_waitcnt vmcnt(12)
  v_mfma_f32_16x16x32_bf16 v[76:79], v[180:183], a[208:211], v[76:79]
  v_mfma_f32_16x16x32_bf16 v[100:103], v[180:183], a[212:215], v[100:103]
  buffer_load_dwordx4 v[176:179], v1, s[4:7], s85 offen offset:3072 sc1
  v_mfma_f32_16x16x32_bf16 v[124:127], v[180:183], a[216:219], v[124:127]
  v_mfma_f32_16x16x32_bf16 v[148:151], v[180:183], a[220:223], v[148:151]
  s_waitcnt vmcnt(12)
  v_mfma_f32_16x16x32_bf16 v[80:83], v[184:187], a[208:211], v[80:83]
  v_mfma_f32_16x16x32_bf16 v[104:107], v[184:187], a[212:215], v[104:107]
  buffer_load_dwordx4 v[180:183], v1, s[4:7], s86 offen offset:0 sc1
  v_mfma_f32_16x16x32_bf16 v[128:131], v[184:187], a[216:219], v[128:131]
  v_mfma_f32_16x16x32_bf16 v[152:155], v[184:187], a[220:223], v[152:155]
  s_waitcnt vmcnt(12)
  v_mfma_f32_16x16x32_bf16 v[84:87], v[224:227], a[208:211], v[84:87]
  v_mfma_f32_16x16x32_bf16 v[108:111], v[224:227], a[212:215], v[108:111]
  buffer_load_dwordx4 v[184:187], v1, s[4:7], s86 offen offset:1024 sc1
  v_mfma_f32_16x16x32_bf16 v[132:135], v[224:227], a[216:219], v[132:135]
  v_mfma_f32_16x16x32_bf16 v[156:159], v[224:227], a[220:223], v[156:159]
  s_waitcnt vmcnt(12)
  v_mfma_f32_16x16x32_bf16 v[88:91], v[228:231], a[208:211], v[88:91]
  v_mfma_f32_16x16x32_bf16 v[112:115], v[228:231], a[212:215], v[112:115]
  s_add_u32 s82, s82, 4096
  s_add_u32 m0, m0, 4096
  v_mfma_f32_16x16x32_bf16 v[136:139], v[228:231], a[216:219], v[136:139]
  buffer_load_dwordx4 v1, s[4:7], s82 offen offset:0 lds
  v_mfma_f32_16x16x32_bf16 v[160:163], v[228:231], a[220:223], v[160:163]
  s_waitcnt vmcnt(12)
  v_mfma_f32_16x16x32_bf16 v[68:71], v[232:235], a[224:227], v[68:71]
  v_mfma_f32_16x16x32_bf16 v[92:95], v[232:235], a[228:231], v[92:95]
  s_add_u32 s82, s75, 786432
  s_add_u32 m0, s43, 20480
  v_mfma_f32_16x16x32_bf16 v[116:119], v[232:235], a[232:235], v[116:119]
  buffer_load_dwordx4 v1, s[4:7], s82 offen offset:0 lds
  v_mfma_f32_16x16x32_bf16 v[140:143], v[232:235], a[236:239], v[140:143]
  s_waitcnt vmcnt(12)
  v_mfma_f32_16x16x32_bf16 v[72:75], v[236:239], a[224:227], v[72:75]
  v_mfma_f32_16x16x32_bf16 v[96:99], v[236:239], a[228:231], v[96:99]
  v_mfma_f32_16x16x32_bf16 v[120:123], v[236:239], a[232:235], v[120:123]
  buffer_load_dwordx4 v1, s[4:7], s82 offen offset:1024 lds
  v_mfma_f32_16x16x32_bf16 v[144:147], v[236:239], a[236:239], v[144:147]
  s_waitcnt vmcnt(12)
  v_mfma_f32_16x16x32_bf16 v[76:79], v[240:243], a[224:227], v[76:79]
  v_mfma_f32_16x16x32_bf16 v[100:103], v[240:243], a[228:231], v[100:103]
  v_mfma_f32_16x16x32_bf16 v[124:127], v[240:243], a[232:235], v[124:127]
  buffer_load_dwordx4 v1, s[4:7], s82 offen offset:2048 lds
  v_mfma_f32_16x16x32_bf16 v[148:151], v[240:243], a[236:239], v[148:151]
  s_waitcnt vmcnt(12)
  v_mfma_f32_16x16x32_bf16 v[80:83], v[244:247], a[224:227], v[80:83]
  v_mfma_f32_16x16x32_bf16 v[104:107], v[244:247], a[228:231], v[104:107]
  v_mfma_f32_16x16x32_bf16 v[128:131], v[244:247], a[232:235], v[128:131]
  buffer_load_dwordx4 v1, s[4:7], s82 offen offset:3072 lds
  v_mfma_f32_16x16x32_bf16 v[152:155], v[244:247], a[236:239], v[152:155]
  s_waitcnt vmcnt(12)
  v_mfma_f32_16x16x32_bf16 v[84:87], v[248:251], a[224:227], v[84:87]
  v_mfma_f32_16x16x32_bf16 v[108:111], v[248:251], a[228:231], v[108:111]
  s_add_u32 s82, s82, 4096
  s_add_u32 m0, m0, 4096
  v_mfma_f32_16x16x32_bf16 v[132:135], v[248:251], a[232:235], v[132:135]
  buffer_load_dwordx4 v1, s[4:7], s82 offen offset:0 lds
  v_mfma_f32_16x16x32_bf16 v[156:159], v[248:251], a[236:239], v[156:159]
  s_waitcnt vmcnt(12)
  v_mfma_f32_16x16x32_bf16 v[88:91], v[252:255], a[224:227], v[88:91]
  v_mfma_f32_16x16x32_bf16 v[112:115], v[252:255], a[228:231], v[112:115]
  s_add_u32 s82, s75, 811008
  s_add_u32 m0, s43, 69632
  v_mfma_f32_16x16x32_bf16 v[136:139], v[252:255], a[232:235], v[136:139]
  buffer_load_dwordx4 v1, s[4:7], s82 offen offset:0 lds
  v_mfma_f32_16x16x32_bf16 v[160:163], v[252:255], a[236:239], v[160:163]
  s_waitcnt vmcnt(12)
  v_mfma_f32_16x16x32_bf16 v[116:119], v[164:167], a[248:251], v[116:119]
  v_mfma_f32_16x16x32_bf16 v[140:143], v[164:167], a[252:255], v[140:143]
  v_mfma_f32_16x16x32_bf16 v[92:95], v[164:167], a[244:247], v[92:95]
  buffer_load_dwordx4 v1, s[4:7], s82 offen offset:1024 lds
  v_mfma_f32_16x16x32_bf16 v[68:71], v[164:167], a[240:243], v[68:71]
  s_waitcnt vmcnt(12)
  v_mfma_f32_16x16x32_bf16 v[120:123], v[168:171], a[248:251], v[120:123]
  v_mfma_f32_16x16x32_bf16 v[144:147], v[168:171], a[252:255], v[144:147]
  v_mfma_f32_16x16x32_bf16 v[96:99], v[168:171], a[244:247], v[96:99]
  ds_write_b128 v212, v[116:119] offset:0
  ds_write_b128 v212, v[140:143] offset:6144
  v_mfma_f32_16x16x32_bf16 v[72:75], v[168:171], a[240:243], v[72:75]
  s_waitcnt vmcnt(11)
  v_mfma_f32_16x16x32_bf16 v[124:127], v[172:175], a[248:251], v[124:127]
  v_mfma_f32_16x16x32_bf16 v[148:151], v[172:175], a[252:255], v[148:151]
  v_mfma_f32_16x16x32_bf16 v[100:103], v[172:175], a[244:247], v[100:103]
  ds_write_b128 v212, v[120:123] offset:1024
  ds_write_b128 v212, v[144:147] offset:7168
  v_mfma_f32_16x16x32_bf16 v[76:79], v[172:175], a[240:243], v[76:79]
  s_waitcnt vmcnt(10)
  v_mfma_f32_16x16x32_bf16 v[128:131], v[176:179], a[248:251], v[128:131]
  v_mfma_f32_16x16x32_bf16 v[152:155], v[176:179], a[252:255], v[152:155]
  v_mfma_f32_16x16x32_bf16 v[104:107], v[176:179], a[244:247], v[104:107]
  ds_write_b128 v212, v[124:127] offset:2048
  ds_write_b128 v212, v[148:151] offset:8192
  v_mfma_f32_16x16x32_bf16 v[80:83], v[176:179], a[240:243], v[80:83]
  s_waitcnt vmcnt(9)
  v_mfma_f32_16x16x32_bf16 v[132:135], v[180:183], a[248:251], v[132:135]
  v_mfma_f32_16x16x32_bf16 v[156:159], v[180:183], a[252:255], v[156:159]
  v_mfma_f32_16x16x32_bf16 v[108:111], v[180:183], a[244:247], v[108:111]
  ds_write_b128 v212, v[128:131] offset:3072
  ds_write_b128 v212, v[152:155] offset:9216
  v_mfma_f32_16x16x32_bf16 v[84:87], v[180:183], a[240:243], v[84:87]
  s_waitcnt vmcnt(8)
  v_mfma_f32_16x16x32_bf16 v[136:139], v[184:187], a[248:251], v[136:139]
  v_mfma_f32_16x16x32_bf16 v[160:163], v[184:187], a[252:255], v[160:163]
  v_mfma_f32_16x16x32_bf16 v[112:115], v[184:187], a[244:247], v[112:115]
  ds_write_b128 v212, v[132:135] offset:4096
  ds_write_b128 v212, v[156:159] offset:10240
  v_mfma_f32_16x16x32_bf16 v[88:91], v[184:187], a[240:243], v[88:91]
  s_nop 2
  ds_write_b128 v212, v[136:139] offset:5120
  ds_write_b128 v212, v[160:163] offset:11264
  s_waitcnt lgkmcnt(0)
  s_barrier
  ds_read_b128 v[140:143], v213 offset:6144
  ds_read_b128 v[144:147], v213 offset:7168
  ds_read_b128 v[148:151], v213 offset:8192
  ds_read_b128 v[152:155], v213 offset:9216
  ds_read_b128 v[156:159], v213 offset:10240
  ds_read_b128 v[160:163], v213 offset:11264
  ds_read_b128 v[116:119], v213 offset:0
  ds_read_b128 v[120:123], v213 offset:1024
  ds_read_b128 v[124:127], v213 offset:2048
  ds_read_b128 v[128:131], v213 offset:3072
  ds_read_b128 v[132:135], v213 offset:4096
  ds_read_b128 v[136:139], v213 offset:5120
  s_waitcnt lgkmcnt(11)
  v_pk_add_f32 v[92:93], v[92:93], v[140:141]
  buffer_load_dwordx4 v1, s[4:7], s82 offen offset:2048 lds
  v_pk_add_f32 v[94:95], v[94:95], v[142:143]
  ds_write_b128 v213, v[92:95] offset:6144
  s_waitcnt lgkmcnt(11)
  v_pk_add_f32 v[96:97], v[96:97], v[144:145]
  v_pk_add_f32 v[98:99], v[98:99], v[146:147]
  ds_write_b128 v213, v[96:99] offset:7168
  s_waitcnt lgkmcnt(11)
  v_pk_add_f32 v[100:101], v[100:101], v[148:149]
  buffer_load_dwordx4 v1, s[4:7], s82 offen offset:3072 lds
  v_pk_add_f32 v[102:103], v[102:103], v[150:151]
  ds_write_b128 v213, v[100:103] offset:8192
  s_waitcnt lgkmcnt(11)
  v_pk_add_f32 v[104:105], v[104:105], v[152:153]
  v_pk_add_f32 v[106:107], v[106:107], v[154:155]
  ds_write_b128 v213, v[104:107] offset:9216
  s_waitcnt lgkmcnt(11)
  v_pk_add_f32 v[108:109], v[108:109], v[156:157]
  v_pk_add_f32 v[110:111], v[110:111], v[158:159]
  ds_write_b128 v213, v[108:111] offset:10240
  s_waitcnt lgkmcnt(11)
  v_pk_add_f32 v[112:113], v[112:113], v[160:161]
  v_pk_add_f32 v[114:115], v[114:115], v[162:163]
  s_add_u32 s82, s82, 4096
  s_add_u32 m0, m0, 4096
  s_nop 0
  buffer_load_dwordx4 v1, s[4:7], s82 offen offset:0 lds
  ds_write_b128 v213, v[112:115] offset:11264
  s_waitcnt lgkmcnt(11)
  v_pk_add_f32 v[68:69], v[68:69], v[116:117]
  v_pk_add_f32 v[70:71], v[70:71], v[118:119]
  s_waitcnt lgkmcnt(10)
  v_pk_add_f32 v[72:73], v[72:73], v[120:121]
  v_pk_add_f32 v[74:75], v[74:75], v[122:123]
  s_waitcnt lgkmcnt(9)
  v_pk_add_f32 v[76:77], v[76:77], v[124:125]
  v_pk_add_f32 v[78:79], v[78:79], v[126:127]
  s_waitcnt lgkmcnt(8)
  v_pk_add_f32 v[80:81], v[80:81], v[128:129]
  v_pk_add_f32 v[82:83], v[82:83], v[130:131]
  s_waitcnt lgkmcnt(7)
  v_pk_add_f32 v[84:85], v[84:85], v[132:133]
  v_pk_add_f32 v[86:87], v[86:87], v[134:135]
  s_waitcnt lgkmcnt(6)
  v_pk_add_f32 v[88:89], v[88:89], v[136:137]
  v_pk_add_f32 v[90:91], v[90:91], v[138:139]
  s_waitcnt lgkmcnt(0)
  s_barrier
  ds_read_b128 v[92:95], v214 offset:6144
  ds_read_b128 v[96:99], v214 offset:7168
  ds_read_b128 v[100:103], v214 offset:8192
  ds_read_b128 v[104:107], v214 offset:9216
  ds_read_b128 v[108:111], v214 offset:10240
  ds_read_b128 v[112:115], v214 offset:11264
  s_waitcnt lgkmcnt(5)
  v_pk_add_f32 v[68:69], v[68:69], v[92:93]
  v_pk_add_f32 v[70:71], v[70:71], v[94:95]
  s_waitcnt lgkmcnt(4)
  v_pk_add_f32 v[72:73], v[72:73], v[96:97]
  v_pk_add_f32 v[74:75], v[74:75], v[98:99]
  s_waitcnt lgkmcnt(3)
  v_pk_add_f32 v[76:77], v[76:77], v[100:101]
  v_pk_add_f32 v[78:79], v[78:79], v[102:103]
  s_waitcnt lgkmcnt(2)
  v_pk_add_f32 v[80:81], v[80:81], v[104:105]
  v_pk_add_f32 v[82:83], v[82:83], v[106:107]
  s_waitcnt lgkmcnt(1)
  v_pk_add_f32 v[84:85], v[84:85], v[108:109]
  v_pk_add_f32 v[86:87], v[86:87], v[110:111]
  s_waitcnt lgkmcnt(0)
  v_pk_add_f32 v[88:89], v[88:89], v[112:113]
  v_pk_add_f32 v[90:91], v[90:91], v[114:115]
  v_pk_mul_f32 v[68:69], v[68:69], v[188:189]
  v_cvt_pk_bf16_f32 v224, v68, v69
  v_pk_mul_f32 v[70:71], v[70:71], v[190:191]
  v_cvt_pk_bf16_f32 v225, v70, v71
  v_pk_mul_f32 v[72:73], v[72:73], v[192:193]
  v_cvt_pk_bf16_f32 v226, v72, v73
  v_pk_mul_f32 v[74:75], v[74:75], v[194:195]
  v_cvt_pk_bf16_f32 v227, v74, v75
  v_pk_mul_f32 v[76:77], v[76:77], v[196:197]
  v_cvt_pk_bf16_f32 v228, v76, v77
  v_pk_mul_f32 v[78:79], v[78:79], v[198:199]
  v_cvt_pk_bf16_f32 v229, v78, v79
  v_pk_mul_f32 v[80:81], v[80:81], v[200:201]
  v_cvt_pk_bf16_f32 v230, v80, v81
  v_pk_mul_f32 v[82:83], v[82:83], v[202:203]
  v_cvt_pk_bf16_f32 v231, v82, v83
  v_pk_mul_f32 v[84:85], v[84:85], v[204:205]
  v_cvt_pk_bf16_f32 v232, v84, v85
  v_pk_mul_f32 v[86:87], v[86:87], v[206:207]
  v_cvt_pk_bf16_f32 v233, v86, v87
  v_pk_mul_f32 v[88:89], v[88:89], v[208:209]
  v_cvt_pk_bf16_f32 v234, v88, v89
  v_pk_mul_f32 v[90:91], v[90:91], v[210:211]
  v_cvt_pk_bf16_f32 v235, v90, v91
  s_cmp_eq_u32 s48, 1
  s_cbranch_scc0 L_slow45
  buffer_store_dwordx4 v[224:227], v1, s[4:7], s16 offen offset:0
  buffer_store_dwordx4 v[228:231], v1, s[4:7], s16 offen offset:1024
  buffer_store_dwordx4 v[232:235], v1, s[4:7], s16 offen offset:2048
L_back46:
  s_barrier
  s_add_u32 s82, s75, 835584
  s_add_u32 m0, s43, 90112
  s_nop 0
  buffer_load_dwordx4 v1, s[4:7], s82 offen offset:0 lds
  buffer_load_dwordx4 v1, s[4:7], s82 offen offset:1024 lds
  buffer_load_dwordx4 v1, s[4:7], s82 offen offset:2048 lds
  buffer_load_dwordx4 v1, s[4:7], s82 offen offset:3072 lds
  s_add_u32 s82, s82, 4096
  s_add_u32 m0, m0, 4096
  s_nop 0
  buffer_load_dwordx4 v1, s[4:7], s82 offen offset:0 lds
  s_add_u32 s82, s75, 860160
  s_add_u32 m0, s43, 110592
  s_nop 0
  buffer_load_dwordx4 v1, s[4:7], s82 offen offset:0 lds
  s_waitcnt vmcnt(6)
  s_cmp_eq_u32 s48, 1
  s_cbranch_scc0 L_slow47
  buffer_store_dword v25, v13, s[4:7], s18 offen offset:64
L_back48:
L_ph_wout0:
  s_barrier
  s_add_u32 s86, s53, 0
  s_mov_b32 s88, 0
  buffer_load_dword v223, v14, s[4:7], s55 offen offset:64 sc1
  ds_read_b128 v[224:227], v1 offset:49152
  ds_read_b128 v[228:231], v1 offset:50176
  ds_read_b128 v[232:235], v1 offset:51200
  ds_read_b128 v[236:239], v1 offset:52224
  ds_read_b128 v[240:243], v1 offset:53248
  ds_read_b128 v[244:247], v1 offset:54272
  ds_read_b128 v[248:251], v1 offset:55296
  ds_read_b128 v[252:255], v1 offset:56320
  ds_read_b128 v[164:167], v1 offset:57344
  ds_read_b128 v[168:171], v1 offset:58368
  ds_read_b128 v[172:175], v1 offset:59392
  ds_read_b128 v[176:179], v1 offset:60416
L_poll49:
  buffer_load_dword v221, v14, s[4:7], s55 offen offset:64 sc1
  s_waitcnt vmcnt(1)
  v_cmp_ne_u32 vcc, s44, v223
  s_cbranch_vccz L_seen50
  buffer_load_dword v223, v14, s[4:7], s55 offen offset:64 sc1
  s_add_u32 s88, s88, 1
  s_cmp_gt_u32 s88, 65536
  s_cbranch_scc1 L_abort
  s_waitcnt vmcnt(1)
  v_cmp_ne_u32 vcc, s44, v221
  s_cbranch_vccnz L_poll49
L_seen50:
  buffer_load_dwordx4 v[68:71], v1, s[4:7], s86 offen offset:0 sc1
  buffer_load_dwordx4 v[72:75], v1, s[4:7], s86 offen offset:1024 sc1
  buffer_load_dwordx4 v[76:79], v1, s[4:7], s86 offen offset:2048 sc1
  buffer_load_dwordx4 v[80:83], v1, s[4:7], s86 offen offset:3072 sc1
  s_add_u32 s86, s86, 4096
  buffer_load_dwordx4 v[84:87], v1, s[4:7], s86 offen offset:0 sc1
  buffer_load_dwordx4 v[88:91], v1, s[4:7], s86 offen offset:1024 sc1
  buffer_load_dwordx4 v[92:95], v1, s[4:7], s86 offen offset:2048 sc1
  buffer_load_dwordx4 v[96:99], v1, s[4:7], s86 offen offset:3072 sc1
  s_waitcnt vmcnt(7) lgkmcnt(8)
  v_mfma_f32_16x16x32_bf16 v[48:51], v[224:227], v[68:71], v[48:51]
  ds_read_b128 v[224:227], v1 offset:61440
  v_mfma_f32_16x16x32_bf16 v[52:55], v[228:231], v[68:71], v[52:55]
  ds_read_b128 v[228:231], v1 offset:62464
  v_mfma_f32_16x16x32_bf16 v[56:59], v[232:235], v[68:71], v[56:59]
  ds_read_b128 v[232:235], v1 offset:63488
  v_mfma_f32_16x16x32_bf16 v[60:63], v[236:239], v[68:71], v[60:63]
  ds_read_b128 v[236:239], v1 offset:64512
  s_waitcnt lgkmcnt(8)
  v_mfma_f32_16x16x32_bf16 v[64:67], v[240:243], v[68:71], v[64:67]
  ds_read_b128 v[240:243], v2 offset:0
  s_waitcnt vmcnt(6)
  v_mfma_f32_16x16x32_bf16 v[48:51], v[244:247], v[72:75], v[48:51]
  ds_read_b128 v[244:247], v2 offset:1024
  s_add_u32 s100, s101, L_ph_kv1-L_base
  buffer_load_dword v222, v13, s[96:99], s100 offen
  v_mfma_f32_16x16x32_bf16 v[52:55], v[248:251], v[72:75], v[52:55]
  ds_read_b128 v[248:251], v2 offset:2048
  s_barrier
  v_mfma_f32_16x16x32_bf16 v[56:59], v[252:255], v[72:75], v[56:59]
  ds_read_b128 v[252:255], v2 offset:3072
  s_mul_i32 s100, s41, 2560
  s_add_u32 s100, s100, s53
  s_add_u32 s100, s100, 98304
  buffer_load_dword v222, v43, s[4:7], s100 offen sc1
  s_waitcnt lgkmcnt(8)
  v_mfma_f32_16x16x32_bf16 v[60:63], v[164:167], v[72:75], v[60:63]
  ds_read_b128 v[164:167], v1 offset:0
  v_mfma_f32_16x16x32_bf16 v[64:67], v[168:171], v[72:75], v[64:67]
  ds_read_b128 v[168:171], v1 offset:1024
  s_waitcnt vmcnt(7)
  v_mfma_f32_16x16x32_bf16 v[48:51], v[172:175], v[76:79], v[48:51]
  ds_read_b128 v[172:175], v1 offset:2048
  v_mfma_f32_16x16x32_bf16 v[52:55], v[176:179], v[76:79], v[52:55]
  ds_read_b128 v[176:179], v1 offset:3072
  s_waitcnt lgkmcnt(8)
  v_mfma_f32_16x16x32_bf16 v[56:59], v[224:227], v[76:79], v[56:59]
  ds_read_b128 v[224:227], v1 offset:4096
  v_mfma_f32_16x16x32_bf16 v[60:63], v[228:231], v[76:79], v[60:63]
  ds_read_b128 v[228:231], v1 offset:5120
  s_add_u32 s86, s86, 4096
  buffer_load_dwordx4 v[100:103], v1, s[4:7], s86 offen offset:0 sc1
  v_mfma_f32_16x16x32_bf16 v[64:67], v[232:235], v[76:79], v[64:67]
  ds_read_b128 v[232:235], v1 offset:6144
  s_waitcnt vmcnt(7)
  v_mfma_f32_16x16x32_bf16 v[48:51], v[236:239], v[80:83], v[48:51]
  ds_read_b128 v[236:239], v1 offset:7168
  s_waitcnt lgkmcnt(8)
  v_mfma_f32_16x16x32_bf16 v[52:55], v[240:243], v[80:83], v[52:55]
  ds_read_b128 v[240:243], v1 offset:8192
  v_mfma_f32_16x16x32_bf16 v[56:59], v[244:247], v[80:83], v[56:59]
  ds_read_b128 v[244:247], v1 offset:9216
  buffer_load_dwordx4 v[104:107], v1, s[4:7], s86 offen offset:1024 sc1
  v_mfma_f32_16x16x32_bf16 v[60:63], v[248:251], v[80:83], v[60:63]
  ds_read_b128 v[248:251], v1 offset:10240
  v_mfma_f32_16x16x32_bf16 v[64:67], v[252:255], v[80:83], v[64:67]
  ds_read_b128 v[252:255], v1 offset:11264
  s_waitcnt vmcnt(7) lgkmcnt(8)
  v_mfma_f32_16x16x32_bf16 v[48:51], v[164:167], v[84:87], v[48:51]
  ds_read_b128 v[164:167], v1 offset:12288
  buffer_load_dwordx4 v[108:111], v1, s[4:7], s86 offen offset:2048 sc1
  v_mfma_f32_16x16x32_bf16 v[52:55], v[168:171], v[84:87], v[52:55]
  ds_read_b128 v[168:171], v1 offset:13312
  v_mfma_f32_16x16x32_bf16 v[56:59], v[172:175], v[84:87], v[56:59]
  ds_read_b128 v[172:175], v1 offset:14336
  v_mfma_f32_16x16x32_bf16 v[60:63], v[176:179], v[84:87], v[60:63]
  ds_read_b128 v[176:179], v1 offset:15360
  s_waitcnt lgkmcnt(8)
  v_mfma_f32_16x16x32_bf16 v[64:67], v[224:227], v[84:87], v[64:67]
  ds_read_b128 v[224:227], v1 offset:16384
  buffer_load_dwordx4 v1, s[4:7], s82 offen offset:1024 lds
  s_waitcnt vmcnt(8)
  v_mfma_f32_16x16x32_bf16 v[48:51], v[228:231], v[88:91], v[48:51]
  ds_read_b128 v[228:231], v1 offset:17408
  v_mfma_f32_16x16x32_bf16 v[52:55], v[232:235], v[88:91], v[52:55]
  ds_read_b128 v[232:235], v1 offset:18432
  s_barrier
  v_mfma_f32_16x16x32_bf16 v[56:59], v[236:239], v[88:91], v[56:59]
  ds_read_b128 v[236:239], v1 offset:19456
  buffer_load_dwordx4 v[112:115], v1, s[4:7], s86 offen offset:3072 sc1
  s_waitcnt lgkmcnt(8)
  v_mfma_f32_16x16x32_bf16 v[60:63], v[240:243], v[88:91], v[60:63]
  ds_read_b128 v[240:243], v1 offset:20480
  buffer_load_dwordx4 v1, s[4:7], s82 offen offset:2048 lds
  v_mfma_f32_16x16x32_bf16 v[64:67], v[244:247], v[88:91], v[64:67]
  ds_read_b128 v[244:247], v1 offset:21504
  s_waitcnt vmcnt(9)
  v_mfma_f32_16x16x32_bf16 v[48:51], v[248:251], v[92:95], v[48:51]
  ds_read_b128 v[248:251], v1 offset:22528
  v_mfma_f32_16x16x32_bf16 v[52:55], v[252:255], v[92:95], v[52:55]
  ds_read_b128 v[252:255], v1 offset:23552
  s_waitcnt lgkmcnt(8)
  v_mfma_f32_16x16x32_bf16 v[56:59], v[164:167], v[92:95], v[56:59]
  ds_read_b128 v[164:167], v1 offset:24576
  v_mfma_f32_16x16x32_bf16 v[60:63], v[168:171], v[92:95], v[60:63]
  ds_read_b128 v[168:171], v1 offset:25600
  buffer_load_dwordx4 v1, s[4:7], s82 offen offset:3072 lds
  v_mfma_f32_16x16x32_bf16 v[64:67], v[172:175], v[92:95], v[64:67]
  ds_read_b128 v[172:175], v1 offset:26624
  s_waitcnt vmcnt(9)
  v_mfma_f32_16x16x32_bf16 v[48:51], v[176:179], v[96:99], v[48:51]
  ds_read_b128 v[176:179], v1 offset:27648
  s_waitcnt lgkmcnt(8)
  v_mfma_f32_16x16x32_bf16 v[52:55], v[224:227], v[96:99], v[52:55]
  ds_read_b128 v[224:227], v1 offset:28672
  v_mfma_f32_16x16x32_bf16 v[56:59], v[228:231], v[96:99], v[56:59]
  ds_read_b128 v[228:231], v1 offset:29696
  v_mfma_f32_16x16x32_bf16 v[60:63], v[232:235], v[96:99], v[60:63]
  ds_read_b128 v[232:235], v1 offset:30720
  v_mfma_f32_16x16x32_bf16 v[64:67], v[236:239], v[96:99], v[64:67]
  ds_read_b128 v[236:239], v1 offset:31744
  s_waitcnt vmcnt(6) lgkmcnt(8)
  v_mfma_f32_16x16x32_bf16 v[48:51], v[240:243], v[100:103], v[48:51]
  ds_read_b128 v[240:243], v1 offset:32768
  s_add_u32 s86, s86, 4096
  buffer_load_dwordx4 v[116:119], v1, s[4:7], s86 offen offset:0 sc1
  v_mfma_f32_16x16x32_bf16 v[52:55], v[244:247], v[100:103], v[52:55]
  ds_read_b128 v[244:247], v1 offset:33792
  v_mfma_f32_16x16x32_bf16 v[56:59], v[248:251], v[100:103], v[56:59]
  ds_read_b128 v[248:251], v1 offset:34816
  v_mfma_f32_16x16x32_bf16 v[60:63], v[252:255], v[100:103], v[60:63]
  ds_read_b128 v[252:255], v1 offset:35840
  buffer_load_dwordx4 v[120:123], v1, s[4:7], s86 offen offset:1024 sc1
  s_waitcnt lgkmcnt(8)
  v_mfma_f32_16x16x32_bf16 v[64:67], v[164:167], v[100:103], v[64:67]
  ds_read_b128 v[164:167], v1 offset:36864
  s_waitcnt vmcnt(7)
  v_mfma_f32_16x16x32_bf16 v[48:51], v[168:171], v[104:107], v[48:51]
  ds_read_b128 v[168:171], v1 offset:37888
  v_mfma_f32_16x16x32_bf16 v[52:55], v[172:175], v[104:107], v[52:55]
  ds_read_b128 v[172:175], v1 offset:38912
  s_barrier
  v_mfma_f32_16x16x32_bf16 v[56:59], v[176:179], v[104:107], v[56:59]
  ds_read_b128 v[176:179], v1 offset:39936
  buffer_load_dwordx4 v[124:127], v1, s[4:7], s86 offen offset:2048 sc1
  s_waitcnt lgkmcnt(8)
  v_mfma_f32_16x16x32_bf16 v[60:63], v[224:227], v[104:107], v[60:63]
  ds_read_b128 v[224:227], v2 offset:4096
  v_mfma_f32_16x16x32_bf16 v[64:67], v[228:231], v[104:107], v[64:67]
  ds_read_b128 v[228:231], v2 offset:5120
  buffer_load_dwordx4 v[128:131], v1, s[4:7], s86 offen offset:3072 sc1
  s_waitcnt vmcnt(8)
  v_mfma_f32_16x16x32_bf16 v[48:51], v[232:235], v[108:111], v[48:51]
  ds_read_b128 v[232:235], v2 offset:6144
  v_mfma_f32_16x16x32_bf16 v[52:55], v[236:239], v[108:111], v[52:55]
  ds_read_b128 v[236:239], v2 offset:7168
  s_waitcnt lgkmcnt(8)
  v_mfma_f32_16x16x32_bf16 v[56:59], v[240:243], v[108:111], v[56:59]
  ds_read_b128 v[240:243], v2 offset:8192
  v_mfma_f32_16x16x32_bf16 v[60:63], v[244:247], v[108:111], v[60:63]
  ds_read_b128 v[244:247], v2 offset:9216
  s_add_u32 s86, s86, 4096
  buffer_load_dwordx4 v[132:135], v1, s[4:7], s86 offen offset:0 sc1
  v_mfma_f32_16x16x32_bf16 v[64:67], v[248:251], v[108:111], v[64:67]
  s_add_u32 s82, s82, 4096
  s_add_u32 m0, m0, 4096
  ds_read_b128 v[248:251], v2 offset:10240
  buffer_load_dwordx4 v1, s[4:7], s82 offen offset:0 lds
  s_waitcnt vmcnt(8)
  v_mfma_f32_16x16x32_bf16 v[48:51], v[252:255], v[112:115], v[48:51]
  ds_read_b128 v[252:255], v2 offset:11264
  s_waitcnt lgkmcnt(8)
  v_mfma_f32_16x16x32_bf16 v[52:55], v[164:167], v[112:115], v[52:55]
  ds_read_b128 v[164:167], v2 offset:12288
  v_mfma_f32_16x16x32_bf16 v[56:59], v[168:171], v[112:115], v[56:59]
  ds_read_b128 v[168:171], v2 offset:13312
  v_mfma_f32_16x16x32_bf16 v[60:63], v[172:175], v[112:115], v[60:63]
  ds_read_b128 v[172:175], v2 offset:14336
  v_mfma_f32_16x16x32_bf16 v[64:67], v[176:179], v[112:115], v[64:67]
  ds_read_b128 v[176:179], v2 offset:15360
  buffer_load_dwordx4 v[136:139], v1, s[4:7], s86 offen offset:1024 sc1
  s_waitcnt vmcnt(6) lgkmcnt(8)
  v_mfma_f32_16x16x32_bf16 v[48:51], v[224:227], v[116:119], v[48:51]
  ds_read_b128 v[224:227], v2 offset:16384
  buffer_load_dwordx4 v[140:143], v1, s[4:7], s86 offen offset:2048 sc1
  v_mfma_f32_16x16x32_bf16 v[52:55], v[228:231], v[116:119], v[52:55]
  ds_read_b128 v[228:231], v2 offset:17408
  v_mfma_f32_16x16x32_bf16 v[56:59], v[232:235], v[116:119], v[56:59]
  ds_read_b128 v[232:235], v2 offset:18432
  v_mfma_f32_16x16x32_bf16 v[60:63], v[236:239], v[116:119], v[60:63]
  s_add_u32 s82, s74, 0
  s_add_u32 m0, s43, 131072
  ds_read_b128 v[236:239], v2 offset:19456
  buffer_load_dwordx4 v1, s[4:7], s82 offen offset:0 lds
  s_waitcnt lgkmcnt(8)
  v_mfma_f32_16x16x32_bf16 v[64:67], v[240:243], v[116:119], v[64:67]
  ds_read_b128 v[240:243], v2 offset:20480
  s_waitcnt vmcnt(7)
  v_mfma_f32_16x16x32_bf16 v[48:51], v[244:247], v[120:123], v[48:51]
  ds_read_b128 v[244:247], v2 offset:21504
  buffer_load_dwordx4 v[144:147], v1, s[4:7], s86 offen offset:3072 sc1
  v_mfma_f32_16x16x32_bf16 v[52:55], v[248:251], v[120:123], v[52:55]
  ds_read_b128 v[248:251], v2 offset:22528
  s_barrier
  v_mfma_f32_16x16x32_bf16 v[56:59], v[252:255], v[120:123], v[56:59]
  ds_read_b128 v[252:255], v2 offset:23552
  buffer_load_dwordx4 v1, s[4:7], s82 offen offset:1024 lds
  s_waitcnt lgkmcnt(8)
  v_mfma_f32_16x16x32_bf16 v[60:63], v[164:167], v[120:123], v[60:63]
  ds_read_b128 v[164:167], v2 offset:24576
  v_mfma_f32_16x16x32_bf16 v[64:67], v[168:171], v[120:123], v[64:67]
  ds_read_b128 v[168:171], v2 offset:25600
  s_waitcnt vmcnt(8)
  v_mfma_f32_16x16x32_bf16 v[48:51], v[172:175], v[124:127], v[48:51]
  ds_read_b128 v[172:175], v2 offset:26624
  s_add_u32 s86, s86, 4096
  buffer_load_dwordx4 v[148:151], v1, s[4:7], s86 offen offset:0 sc1
  v_mfma_f32_16x16x32_bf16 v[52:55], v[176:179], v[124:127], v[52:55]
  ds_read_b128 v[176:179], v2 offset:27648
  s_waitcnt lgkmcnt(8)
  v_mfma_f32_16x16x32_bf16 v[56:59], v[224:227], v[124:127], v[56:59]
  ds_read_b128 v[224:227], v2 offset:28672
  v_mfma_f32_16x16x32_bf16 v[60:63], v[228:231], v[124:127], v[60:63]
  ds_read_b128 v[228:231], v2 offset:29696
  buffer_load_dwordx4 v1, s[4:7], s82 offen offset:2048 lds
  v_mfma_f32_16x16x32_bf16 v[64:67], v[232:235], v[124:127], v[64:67]
  ds_read_b128 v[232:235], v2 offset:30720
  s_waitcnt vmcnt(9)
  v_mfma_f32_16x16x32_bf16 v[48:51], v[236:239], v[128:131], v[48:51]
  ds_read_b128 v[236:239], v2 offset:31744
  s_waitcnt lgkmcnt(8)
  v_mfma_f32_16x16x32_bf16 v[52:55], v[240:243], v[128:131], v[52:55]
  ds_read_b128 v[240:243], v2 offset:32768
  buffer_load_dwordx4 v[152:155], v1, s[4:7], s86 offen offset:1024 sc1
  v_mfma_f32_16x16x32_bf16 v[56:59], v[244:247], v[128:131], v[56:59]
  ds_read_b128 v[244:247], v2 offset:33792
  v_mfma_f32_16x16x32_bf16 v[60:63], v[248:251], v[128:131], v[60:63]
  ds_read_b128 v[248:251], v2 offset:34816
  v_mfma_f32_16x16x32_bf16 v[64:67], v[252:255], v[128:131], v[64:67]
  ds_read_b128 v[252:255], v2 offset:35840
  s_waitcnt vmcnt(9) lgkmcnt(8)
  v_mfma_f32_16x16x32_bf16 v[48:51], v[164:167], v[132:135], v[48:51]
  ds_read_b128 v[164:167], v2 offset:36864
  buffer_load_dwordx4 v[156:159], v1, s[4:7], s86 offen offset:2048 sc1
  v_mfma_f32_16x16x32_bf16 v[52:55], v[168:171], v[132:135], v[52:55]
  ds_read_b128 v[168:171], v2 offset:37888
  v_mfma_f32_16x16x32_bf16 v[56:59], v[172:175], v[132:135], v[56:59]
  ds_read_b128 v[172:175], v2 offset:38912
  v_mfma_f32_16x16x32_bf16 v[60:63], v[176:179], v[132:135], v[60:63]
  ds_read_b128 v[176:179], v2 offset:39936
  buffer_load_dwordx4 v1, s[4:7], s82 offen offset:3072 lds
  s_waitcnt lgkmcnt(8)
  v_mfma_f32_16x16x32_bf16 v[64:67], v[224:227], v[132:135], v[64:67]
  ds_read_b128 v[224:227], v2 offset:40960
  s_waitcnt vmcnt(9)
  v_mfma_f32_16x16x32_bf16 v[48:51], v[228:231], v[136:139], v[48:51]
  ds_read_b128 v[228:231], v2 offset:41984
  v_mfma_f32_16x16x32_bf16 v[52:55], v[232:235], v[136:139], v[52:55]
  ds_read_b128 v[232:235], v2 offset:43008
  s_barrier
  v_mfma_f32_16x16x32_bf16 v[56:59], v[236:239], v[136:139], v[56:59]
  ds_read_b128 v[236:239], v2 offset:44032
  buffer_load_dwordx4 v[160:163], v1, s[4:7], s86 offen offset:3072 sc1
  s_waitcnt lgkmcnt(8)
  v_mfma_f32_16x16x32_bf16 v[60:63], v[240:243], v[136:139], v[60:63]
  ds_read_b128 v[240:243], v2 offset:45056
  v_mfma_f32_16x16x32_bf16 v[64:67], v[244:247], v[136:139], v[64:67]
  s_add_u32 s82, s82, 4096
  s_add_u32 m0, m0, 4096
  ds_read_b128 v[244:247], v2 offset:46080
  buffer_load_dwordx4 v1, s[4:7], s82 offen offset:0 lds
  s_waitcnt vmcnt(10)
  v_mfma_f32_16x16x32_bf16 v[48:51], v[248:251], v[140:143], v[48:51]
  ds_read_b128 v[248:251], v2 offset:47104
  v_mfma_f32_16x16x32_bf16 v[52:55], v[252:255], v[140:143], v[52:55]
  ds_read_b128 v[252:255], v2 offset:48128
  s_waitcnt lgkmcnt(8)
  v_mfma_f32_16x16x32_bf16 v[56:59], v[164:167], v[140:143], v[56:59]
  s_add_u32 s82, s74, 12288
  s_add_u32 m0, s43, 40960
  ds_read_b128 v[164:167], v2 offset:49152
  buffer_load_dwordx4 v1, s[4:7], s82 offen offset:0 lds
  v_mfma_f32_16x16x32_bf16 v[60:63], v[168:171], v[140:143], v[60:63]
  ds_read_b128 v[168:171], v2 offset:50176
  v_mfma_f32_16x16x32_bf16 v[64:67], v[172:175], v[140:143], v[64:67]
  ds_read_b128 v[172:175], v2 offset:51200
  s_waitcnt vmcnt(9)
  v_mfma_f32_16x16x32_bf16 v[48:51], v[176:179], v[144:147], v[48:51]
  ds_read_b128 v[176:179], v2 offset:52224
  buffer_load_dwordx4 v1, s[4:7], s82 offen offset:1024 lds
  s_waitcnt lgkmcnt(8)
  v_mfma_f32_16x16x32_bf16 v[52:55], v[224:227], v[144:147], v[52:55]
  ds_read_b128 v[224:227], v2 offset:53248
  v_mfma_f32_16x16x32_bf16 v[56:59], v[228:231], v[144:147], v[56:59]
  ds_read_b128 v[228:231], v2 offset:54272
  v_mfma_f32_16x16x32_bf16 v[60:63], v[232:235], v[144:147], v[60:63]
  ds_read_b128 v[232:235], v2 offset:55296
  buffer_load_dwordx4 v1, s[4:7], s82 offen offset:2048 lds
  v_mfma_f32_16x16x32_bf16 v[64:67], v[236:239], v[144:147], v[64:67]
  ds_read_b128 v[236:239], v2 offset:56320
  s_waitcnt vmcnt(9) lgkmcnt(8)
  v_mfma_f32_16x16x32_bf16 v[48:51], v[240:243], v[148:151], v[48:51]
  ds_read_b128 v[240:243], v2 offset:57344
  v_mfma_f32_16x16x32_bf16 v[52:55], v[244:247], v[148:151], v[52:55]
  ds_read_b128 v[244:247], v2 offset:58368
  v_mfma_f32_16x16x32_bf16 v[56:59], v[248:251], v[148:151], v[56:59]
  ds_read_b128 v[248:251], v2 offset:59392
  buffer_load_dwordx4 v1, s[4:7], s82 offen offset:3072 lds
  v_mfma_f32_16x16x32_bf16 v[60:63], v[252:255], v[148:151], v[60:63]
  ds_read_b128 v[252:255], v2 offset:60416
  s_waitcnt lgkmcnt(8)
  v_mfma_f32_16x16x32_bf16 v[64:67], v[164:167], v[148:151], v[64:67]
  ds_read_b128 v[164:167], v2 offset:61440
  s_waitcnt vmcnt(8)
  v_mfma_f32_16x16x32_bf16 v[48:51], v[168:171], v[152:155], v[48:51]
  s_add_u32 s82, s82, 4096
  s_add_u32 m0, m0, 4096
  ds_read_b128 v[168:171], v2 offset:62464
  buffer_load_dwordx4 v1, s[4:7], s82 offen offset:0 lds
  v_mfma_f32_16x16x32_bf16 v[52:55], v[172:175], v[152:155], v[52:55]
  ds_read_b128 v[172:175], v2 offset:63488
  s_barrier
  v_mfma_f32_16x16x32_bf16 v[56:59], v[176:179], v[152:155], v[56:59]
  s_add_u32 s82, s74, 24576
  s_add_u32 m0, s43, 0
  ds_read_b128 v[176:179], v2 offset:64512
  buffer_load_dwordx4 v1, s[4:7], s82 offen offset:0 lds
  s_waitcnt lgkmcnt(8)
  v_mfma_f32_16x16x32_bf16 v[60:63], v[224:227], v[152:155], v[60:63]
  v_mfma_f32_16x16x32_bf16 v[64:67], v[228:231], v[152:155], v[64:67]
  s_waitcnt vmcnt(9)
  v_mfma_f32_16x16x32_bf16 v[48:51], v[232:235], v[156:159], v[48:51]
  buffer_load_dwordx4 v1, s[4:7], s82 offen offset:1024 lds
  v_mfma_f32_16x16x32_bf16 v[52:55], v[236:239], v[156:159], v[52:55]
  s_waitcnt lgkmcnt(4)
  v_mfma_f32_16x16x32_bf16 v[56:59], v[240:243], v[156:159], v[56:59]
  v_mfma_f32_16x16x32_bf16 v[60:63], v[244:247], v[156:159], v[60:63]
  buffer_load_dwordx4 v1, s[4:7], s82 offen offset:2048 lds
  v_mfma_f32_16x16x32_bf16 v[64:67], v[248:251], v[156:159], v[64:67]
  s_waitcnt vmcnt(9)
  v_mfma_f32_16x16x32_bf16 v[48:51], v[252:255], v[160:163], v[48:51]
  s_waitcnt lgkmcnt(0)
  v_mfma_f32_16x16x32_bf16 v[52:55], v[164:167], v[160:163], v[52:55]
  v_mfma_f32_16x16x32_bf16 v[56:59], v[168:171], v[160:163], v[56:59]
  buffer_load_dwordx4 v1, s[4:7], s82 offen offset:3072 lds
  v_mfma_f32_16x16x32_bf16 v[60:63], v[172:175], v[160:163], v[60:63]
  v_mfma_f32_16x16x32_bf16 v[64:67], v[176:179], v[160:163], v[64:67]
  s_nop 1
  v_cvt_pk_bf16_f32 v224, v48, v49
  v_cvt_pk_bf16_f32 v225, v50, v51
  v_cvt_pk_bf16_f32 v226, v52, v53
  v_cvt_pk_bf16_f32 v227, v54, v55
  v_cvt_pk_bf16_f32 v228, v56, v57
  v_cvt_pk_bf16_f32 v229, v58, v59
  v_cvt_pk_bf16_f32 v230, v60, v61
  v_cvt_pk_bf16_f32 v231, v62, v63
  v_cvt_pk_bf16_f32 v232, v64, v65
  v_cvt_pk_bf16_f32 v233, v66, v67
  s_cmp_eq_u32 s48, 1
  s_cbranch_scc0 L_slow51
  buffer_store_dwordx4 v[224:227], v1, s[4:7], s14 offen
  buffer_store_dwordx4 v[228:231], v1, s[4:7], s14 offen offset:1024
  buffer_store_dwordx2 v[232:233], v1, s[4:7], s15 offen
L_back52:
  v_pk_add_f32 v[236:237], v[48:49], v[50:51]
  v_pk_mul_f32 v[238:239], v[48:49], v[48:49]
  v_pk_fma_f32 v[238:239], v[50:51], v[50:51], v[238:239]
  v_pk_add_f32 v[236:237], v[236:237], v[52:53]
  v_pk_fma_f32 v[238:239], v[52:53], v[52:53], v[238:239]
  v_pk_add_f32 v[236:237], v[236:237], v[54:55]
  v_pk_fma_f32 v[238:239], v[54:55], v[54:55], v[238:239]
  v_pk_add_f32 v[236:237], v[236:237], v[56:57]
  v_pk_fma_f32 v[238:239], v[56:57], v[56:57], v[238:239]
  v_pk_add_f32 v[236:237], v[236:237], v[58:59]
  v_pk_fma_f32 v[238:239], v[58:59], v[58:59], v[238:239]
  v_pk_add_f32 v[236:237], v[236:237], v[60:61]
  v_pk_fma_f32 v[238:239], v[60:61], v[60:61], v[238:239]
  v_pk_add_f32 v[236:237], v[236:237], v[62:63]
  v_pk_fma_f32 v[238:239], v[62:63], v[62:63], v[238:239]
  v_pk_add_f32 v[236:237], v[236:237], v[64:65]
  v_pk_fma_f32 v[238:239], v[64:65], v[64:65], v[238:239]
  v_pk_add_f32 v[236:237], v[236:237], v[66:67]
  v_pk_fma_f32 v[238:239], v[66:67], v[66:67], v[238:239]
  v_add_f32 v236, v236, v237
  v_add_f32 v238, v238, v239
  s_nop 1
  v_permlane32_swap_b32 v236, v238
  v_add_f32 v236, v236, v238
  v_mov_b32 v238, v236
  s_nop 1
  v_permlane16_swap_b32 v236, v238
  v_add_f32 v236, v236, v238
  s_cmp_eq_u32 s48, 1
  s_cbranch_scc0 L_slow53
  buffer_store_dword v236, v4, s[4:7], s17 offen
L_back54:
  s_barrier
  s_add_u32 s82, s82, 4096
  s_add_u32 m0, m0, 4096
  s_nop 0
  buffer_load_dwordx4 v1, s[4:7], s82 offen offset:0 lds
  s_add_u32 s82, s74, 36864
  s_add_u32 m0, s43, 20480
  s_nop 0
  buffer_load_dwordx4 v1, s[4:7], s82 offen offset:0 lds
  buffer_load_dwordx4 v1, s[4:7], s82 offen offset:1024 lds
  s_waitcnt vmcnt(3)
  s_cmp_eq_u32 s48, 1
  s_cbranch_scc0 L_slow55
  buffer_store_dword v25, v13, s[4:7], s18 offen offset:96
L_back56:
L_ph_kv1:
  s_add_u32 s86, s53, 98304
  s_barrier
  s_mov_b32 s88, 0
  buffer_load_dword v223, v14, s[4:7], s55 offen offset:96 sc1
  ds_read_b128 v[224:227], v3 offset:0
  ds_read_b128 v[228:231], v3 offset:1024
  ds_read_b128 v[232:235], v3 offset:2048
  ds_read_b128 v[236:239], v3 offset:3072
  ds_read_b128 v[240:243], v3 offset:4096
  ds_read_b128 v[244:247], v3 offset:10240
  ds_read_b128 v[248:251], v3 offset:11264
  ds_read_b128 v[252:255], v3 offset:12288
L_poll57:
  buffer_load_dword v221, v14, s[4:7], s55 offen offset:96 sc1
  s_waitcnt vmcnt(1)
  v_cmp_ne_u32 vcc, s44, v223
  s_cbranch_vccz L_seen58
  buffer_load_dword v223, v14, s[4:7], s55 offen offset:96 sc1
  s_add_u32 s88, s88, 1
  s_cmp_gt_u32 s88, 65536
  s_cbranch_scc1 L_abort
  s_waitcnt vmcnt(1)
  v_cmp_ne_u32 vcc, s44, v221
  s_cbranch_vccnz L_poll57
L_seen58:
  buffer_load_dwordx4 v[68:71], v1, s[4:7], s86 offen offset:0 sc1
  buffer_load_dwordx4 v[72:75], v1, s[4:7], s86 offen offset:1024 sc1
  buffer_load_dwordx4 v[76:79], v1, s[4:7], s86 offen offset:2048 sc1
  buffer_load_dwordx4 v[80:83], v1, s[4:7], s86 offen offset:3072 sc1
  s_add_u32 s86, s86, 4096
  buffer_load_dwordx4 v[84:87], v1, s[4:7], s86 offen offset:0 sc1
  buffer_load_dwordx4 v[88:91], v1, s[4:7], s86 offen offset:1024 sc1
  buffer_load_dwordx4 v[92:95], v1, s[4:7], s86 offen offset:2048 sc1
  buffer_load_dwordx4 v[96:99], v1, s[4:7], s86 offen offset:3072 sc1
  s_waitcnt vmcnt(7) lgkmcnt(6)
  v_mfma_f32_16x16x32_bf16 v[164:167], v[68:71], v[224:227], 0
  ds_read_b128 v[224:227], v3 offset:13312
  s_add_u32 s84, s53, 118784
  buffer_load_dwordx2 v[158:159], v5, s[4:7], s84 offen sc1
  buffer_load_dwordx2 v[160:161], v5, s[4:7], s84 offen offset:128 sc1
  v_mfma_f32_16x16x32_bf16 v[168:171], v[68:71], v[228:231], 0
  ds_read_b128 v[228:231], v3 offset:14336
  s_add_u32 s0, s2, s41
  s_cmp_eq_u32 s0, 0
  s_cselect_b32 s0, 0, 0x80000000
  buffer_store_dword v25, v13, s[4:7], s0 offen sc1
  s_xor_b32 s44, s44, 0x40000000
  s_lshr_b32 s47, s44, 24
  v_mov_b32 v25, s44
  s_waitcnt lgkmcnt(6)
  v_mfma_f32_16x16x32_bf16 v[172:175], v[68:71], v[232:235], 0
  ds_read_b128 v[232:235], v3 offset:5120
  v_mfma_f32_16x16x32_bf16 v[176:179], v[68:71], v[236:239], 0
  ds_read_b128 v[236:239], v3 offset:6144
  s_waitcnt lgkmcnt(6)
  v_mfma_f32_16x16x32_bf16 v[180:183], v[68:71], v[240:243], 0
  ds_read_b128 v[240:243], v3 offset:7168
  v_mfma_f32_16x16x32_bf16 v[184:187], v[68:71], v[244:247], 0
  ds_read_b128 v[244:247], v3 offset:8192
  s_waitcnt lgkmcnt(6)
  v_mfma_f32_16x16x32_bf16 v[188:191], v[68:71], v[248:251], 0
  ds_read_b128 v[248:251], v3 offset:9216
  s_add_u32 s100, s101, L_ph_q1-L_base
  buffer_load_dword v222, v13, s[96:99], s100 offen
  v_mfma_f32_16x16x32_bf16 v[192:195], v[68:71], v[252:255], 0
  ds_read_b128 v[252:255], v3 offset:15360
  buffer_load_dwordx4 v1, s[4:7], s82 offen offset:2048 lds
  s_waitcnt lgkmcnt(6)
  v_mfma_f32_16x16x32_bf16 v[196:199], v[68:71], v[224:227], 0
  ds_read_b128 v[224:227], v3 offset:16384
  s_barrier
  v_mfma_f32_16x16x32_bf16 v[200:203], v[68:71], v[228:231], 0
  ds_read_b128 v[228:231], v3 offset:17408
  buffer_load_dwordx4 v1, s[4:7], s82 offen offset:3072 lds
  s_waitcnt vmcnt(12) lgkmcnt(6)
  v_mfma_f32_16x16x32_bf16 v[164:167], v[72:75], v[232:235], v[164:167]
  ds_read_b128 v[232:235], v3 offset:18432
  v_mfma_f32_16x16x32_bf16 v[168:171], v[72:75], v[236:239], v[168:171]
  s_add_u32 s82, s82, 4096
  s_add_u32 m0, m0, 4096
  ds_read_b128 v[236:239], v3 offset:19456
  buffer_load_dwordx4 v1, s[4:7], s82 offen offset:0 lds
  s_waitcnt lgkmcnt(6)
  v_mfma_f32_16x16x32_bf16 v[172:175], v[72:75], v[240:243], v[172:175]
  ds_read_b128 v[240:243], v1 offset:40960
  v_mfma_f32_16x16x32_bf16 v[176:179], v[72:75], v[244:247], v[176:179]
  ds_read_b128 v[244:247], v1 offset:41984
  s_waitcnt lgkmcnt(6)
  v_mfma_f32_16x16x32_bf16 v[180:183], v[72:75], v[248:251], v[180:183]
  s_add_u32 s82, s74, 49152
  s_add_u32 m0, s43, 61440
  ds_read_b128 v[248:251], v1 offset:43008
  buffer_load_dwordx4 v1, s[4:7], s82 offen offset:0 lds
  v_mfma_f32_16x16x32_bf16 v[184:187], v[72:75], v[252:255], v[184:187]
  ds_read_b128 v[252:255], v1 offset:44032
  s_waitcnt lgkmcnt(6)
  v_mfma_f32_16x16x32_bf16 v[188:191], v[72:75], v[224:227], v[188:191]
  ds_read_b128 v[224:227], v1 offset:45056
  v_mfma_f32_16x16x32_bf16 v[192:195], v[72:75], v[228:231], v[192:195]
  ds_read_b128 v[228:231], v1 offset:51200
  buffer_load_dwordx4 v1, s[4:7], s82 offen offset:1024 lds
  s_waitcnt lgkmcnt(6)
  v_mfma_f32_16x16x32_bf16 v[196:199], v[72:75], v[232:235], v[196:199]
  ds_read_b128 v[232:235], v1 offset:52224
  v_mfma_f32_16x16x32_bf16 v[200:203], v[72:75], v[236:239], v[200:203]
  ds_read_b128 v[236:239], v1 offset:53248
  s_waitcnt vmcnt(14) lgkmcnt(6)
  v_mfma_f32_16x16x32_bf16 v[164:167], v[76:79], v[240:243], v[164:167]
  ds_read_b128 v[240:243], v1 offset:54272
  buffer_load_dwordx4 v1, s[4:7], s82 offen offset:2048 lds
  v_mfma_f32_16x16x32_bf16 v[168:171], v[76:79], v[244:247], v[168:171]
  ds_read_b128 v[244:247], v1 offset:55296
  s_waitcnt lgkmcnt(6)
  v_mfma_f32_16x16x32_bf16 v[172:175], v[76:79], v[248:251], v[172:175]
  ds_read_b128 v[248:251], v1 offset:46080
  v_mfma_f32_16x16x32_bf16 v[176:179], v[76:79], v[252:255], v[176:179]
  ds_read_b128 v[252:255], v1 offset:47104
  s_waitcnt lgkmcnt(6)
  v_mfma_f32_16x16x32_bf16 v[180:183], v[76:79], v[224:227], v[180:183]
  ds_read_b128 v[224:227], v1 offset:48128
  buffer_load_dwordx4 v1, s[4:7], s82 offen offset:3072 lds
  v_mfma_f32_16x16x32_bf16 v[184:187], v[76:79], v[228:231], v[184:187]
  ds_read_b128 v[228:231], v1 offset:49152
  s_waitcnt lgkmcnt(6)
  v_mfma_f32_16x16x32_bf16 v[188:191], v[76:79], v[232:235], v[188:191]
  ds_read_b128 v[232:235], v1 offset:50176
  v_mfma_f32_16x16x32_bf16 v[192:195], v[76:79], v[236:239], v[192:195]
  s_add_u32 s82, s82, 4096
  s_add_u32 m0, m0, 4096
  ds_read_b128 v[236:239], v1 offset:56320
  buffer_load_dwordx4 v1, s[4:7], s82 offen offset:0 lds
  s_waitcnt lgkmcnt(6)
  v_mfma_f32_16x16x32_bf16 v[196:199], v[76:79], v[240:243], v[196:199]
  ds_read_b128 v[240:243], v1 offset:57344
  s_barrier
  v_mfma_f32_16x16x32_bf16 v[200:203], v[76:79], v[244:247], v[200:203]
  s_add_u32 s82, s74, 61440
  s_add_u32 m0, s43, 81920
  ds_read_b128 v[244:247], v1 offset:58368
  buffer_load_dwordx4 v1, s[4:7], s82 offen offset:0 lds
  s_waitcnt vmcnt(17) lgkmcnt(6)
  v_mfma_f32_16x16x32_bf16 v[164:167], v[80:83], v[248:251], v[164:167]
  ds_read_b128 v[248:251], v1 offset:59392
  v_mfma_f32_16x16x32_bf16 v[168:171], v[80:83], v[252:255], v[168:171]
  ds_read_b128 v[252:255], v1 offset:60416
  s_waitcnt lgkmcnt(6)
  v_mfma_f32_16x16x32_bf16 v[172:175], v[80:83], v[224:227], v[172:175]
  ds_read_b128 v[224:227], v1 offset:0
  buffer_load_dwordx4 v1, s[4:7], s82 offen offset:1024 lds
  v_mfma_f32_16x16x32_bf16 v[176:179], v[80:83], v[228:231], v[176:179]
  ds_read_b128 v[228:231], v1 offset:1024
  s_waitcnt vmcnt(12)
  v_pk_add_f32 v[158:159], v[158:159], v[160:161]
  s_waitcnt lgkmcnt(6)
  v_mfma_f32_16x16x32_bf16 v[180:183], v[80:83], v[232:235], v[180:183]
  ds_read_b128 v[232:235], v1 offset:2048
  buffer_load_dwordx4 v1, s[4:7], s82 offen offset:2048 lds
  v_mfma_f32_16x16x32_bf16 v[184:187], v[80:83], v[236:239], v[184:187]
  ds_read_b128 v[236:239], v1 offset:3072
  v_mov_b32 v160, v158
  s_waitcnt lgkmcnt(6)
  v_mfma_f32_16x16x32_bf16 v[188:191], v[80:83], v[240:243], v[188:191]
  ds_read_b128 v[240:243], v1 offset:4096
  v_mov_b32 v161, v159
  v_mfma_f32_16x16x32_bf16 v[192:195], v[80:83], v[244:247], v[192:195]
  ds_read_b128 v[244:247], v1 offset:10240
  v_permlane32_swap_b32 v158, v160
  s_waitcnt lgkmcnt(6)
  v_mfma_f32_16x16x32_bf16 v[196:199], v[80:83], v[248:251], v[196:199]
  ds_read_b128 v[248:251], v1 offset:11264
  buffer_load_dwordx4 v1, s[4:7], s82 offen offset:3072 lds
  v_mfma_f32_16x16x32_bf16 v[200:203], v[80:83], v[252:255], v[200:203]
  ds_read_b128 v[252:255], v1 offset:12288
  v_permlane32_swap_b32 v159, v161
  s_waitcnt lgkmcnt(6)
  v_mfma_f32_16x16x32_bf16 v[164:167], v[84:87], v[224:227], v[164:167]
  ds_read_b128 v[224:227], v1 offset:13312
  s_add_u32 s86, s86, 4096
  buffer_load_dwordx4 v[100:103], v1, s[4:7], s86 offen offset:0 sc1
  v_mfma_f32_16x16x32_bf16 v[168:171], v[84:87], v[228:231], v[168:171]
  ds_read_b128 v[228:231], v1 offset:14336
  v_pk_add_f32 v[158:159], v[158:159], v[160:161]
  s_waitcnt lgkmcnt(6)
  v_mfma_f32_16x16x32_bf16 v[172:175], v[84:87], v[232:235], v[172:175]
  ds_read_b128 v[232:235], v1 offset:5120
  v_mov_b32 v160, v158
  v_mfma_f32_16x16x32_bf16 v[176:179], v[84:87], v[236:239], v[176:179]
  ds_read_b128 v[236:239], v1 offset:6144
  v_mov_b32 v161, v159
  s_waitcnt lgkmcnt(6)
  v_mfma_f32_16x16x32_bf16 v[180:183], v[84:87], v[240:243], v[180:183]
  s_add_u32 s82, s82, 4096
  s_add_u32 m0, m0, 4096
  ds_read_b128 v[240:243], v1 offset:7168
  buffer_load_dwordx4 v1, s[4:7], s82 offen offset:0 lds
  v_mfma_f32_16x16x32_bf16 v[184:187], v[84:87], v[244:247], v[184:187]
  ds_read_b128 v[244:247], v1 offset:8192
  v_permlane16_swap_b32 v158, v160
  s_waitcnt lgkmcnt(6)
  v_mfma_f32_16x16x32_bf16 v[188:191], v[84:87], v[248:251], v[188:191]
  s_add_u32 s82, s74, 73728
  s_add_u32 m0, s43, 102400
  ds_read_b128 v[248:251], v1 offset:9216
  buffer_load_dwordx4 v1, s[4:7], s82 offen offset:0 lds
  v_mfma_f32_16x16x32_bf16 v[192:195], v[84:87], v[252:255], v[192:195]
  ds_read_b128 v[252:255], v1 offset:15360
  v_permlane16_swap_b32 v159, v161
  s_waitcnt lgkmcnt(6)
  v_mfma_f32_16x16x32_bf16 v[196:199], v[84:87], v[224:227], v[196:199]
  ds_read_b128 v[224:227], v1 offset:16384
  s_waitcnt vmcnt(12)
  s_barrier
  v_mfma_f32_16x16x32_bf16 v[200:203], v[84:87], v[228:231], v[200:203]
  ds_read_b128 v[228:231], v1 offset:17408
  buffer_load_dwordx4 v1, s[4:7], s82 offen offset:1024 lds
  s_waitcnt lgkmcnt(6)
  v_mfma_f32_16x16x32_bf16 v[164:167], v[88:91], v[232:235], v[164:167]
  ds_read_b128 v[232:235], v1 offset:18432
  buffer_load_dwordx4 v[104:107], v1, s[4:7], s86 offen offset:1024 sc1
  v_mfma_f32_16x16x32_bf16 v[168:171], v[88:91], v[236:239], v[168:171]
  ds_read_b128 v[236:239], v1 offset:19456
  v_pk_add_f32 v[158:159], v[158:159], v[160:161]
  s_waitcnt lgkmcnt(6)
  v_mfma_f32_16x16x32_bf16 v[172:175], v[88:91], v[240:243], v[172:175]
  ds_read_b128 v[240:243], v1 offset:20480
  v_mul_f32 v158, 0xbacccccd, v158
  v_mfma_f32_16x16x32_bf16 v[176:179], v[88:91], v[244:247], v[176:179]
  ds_read_b128 v[244:247], v1 offset:21504
  v_mul_f32 v159, 0x3acccccd, v159
  s_waitcnt lgkmcnt(6)
  v_mfma_f32_16x16x32_bf16 v[180:183], v[88:91], v[248:251], v[180:183]
  ds_read_b128 v[248:251], v1 offset:22528
  buffer_load_dwordx4 v1, s[4:7], s82 offen offset:2048 lds
  v_mfma_f32_16x16x32_bf16 v[184:187], v[88:91], v[252:255], v[184:187]
  ds_read_b128 v[252:255], v1 offset:23552
  v_fma_f32 v159, -v158, v158, v159
  s_waitcnt lgkmcnt(6)
  v_mfma_f32_16x16x32_bf16 v[188:191], v[88:91], v[224:227], v[188:191]
  ds_read_b128 v[224:227], v1 offset:24576
  v_max_f32 v159, 0, v159
  v_mfma_f32_16x16x32_bf16 v[192:195], v[88:91], v[228:231], v[192:195]
  ds_read_b128 v[228:231], v1 offset:30720
  v_add_f32 v159, 0x3727c5ac, v159
  s_waitcnt lgkmcnt(6)
  v_mfma_f32_16x16x32_bf16 v[196:199], v[88:91], v[232:235], v[196:199]
  ds_read_b128 v[232:235], v1 offset:31744
  buffer_load_dwordx4 v1, s[4:7], s82 offen offset:3072 lds
  v_mfma_f32_16x16x32_bf16 v[200:203], v[88:91], v[236:239], v[200:203]
  ds_read_b128 v[236:239], v1 offset:32768
  v_rsq_f32 v156, v159
  s_waitcnt lgkmcnt(6)
  v_mfma_f32_16x16x32_bf16 v[164:167], v[92:95], v[240:243], v[164:167]
  ds_read_b128 v[240:243], v1 offset:33792
  buffer_load_dwordx4 v[108:111], v1, s[4:7], s86 offen offset:2048 sc1
  v_mfma_f32_16x16x32_bf16 v[168:171], v[92:95], v[244:247], v[168:171]
  ds_read_b128 v[244:247], v1 offset:34816
  v_mul_f32 v157, v158, v156
  s_waitcnt lgkmcnt(6)
  v_mfma_f32_16x16x32_bf16 v[172:175], v[92:95], v[248:251], v[172:175]
  ds_read_b128 v[248:251], v1 offset:25600
  ds_bpermute_b32 v148, v6, v156 offset:0
  v_mfma_f32_16x16x32_bf16 v[176:179], v[92:95], v[252:255], v[176:179]
  ds_read_b128 v[252:255], v1 offset:26624
  ds_bpermute_b32 v152, v6, v157 offset:0
  s_waitcnt lgkmcnt(8)
  v_mfma_f32_16x16x32_bf16 v[180:183], v[92:95], v[224:227], v[180:183]
  s_add_u32 s82, s82, 4096
  s_add_u32 m0, m0, 4096
  ds_read_b128 v[224:227], v1 offset:27648
  buffer_load_dwordx4 v1, s[4:7], s82 offen offset:0 lds
  v_mfma_f32_16x16x32_bf16 v[184:187], v[92:95], v[228:231], v[184:187]
  ds_read_b128 v[228:231], v1 offset:28672
  ds_bpermute_b32 v149, v6, v156 offset:4
  s_waitcnt lgkmcnt(9)
  v_mfma_f32_16x16x32_bf16 v[188:191], v[92:95], v[232:235], v[188:191]
  s_add_u32 s82, s74, 86016
  s_add_u32 m0, s43, 122880
  ds_read_b128 v[232:235], v1 offset:29696
  buffer_load_dwordx4 v1, s[4:7], s82 offen offset:0 lds
  v_mfma_f32_16x16x32_bf16 v[192:195], v[92:95], v[236:239], v[192:195]
  ds_read_b128 v[236:239], v1 offset:35840
  ds_bpermute_b32 v153, v6, v157 offset:4
  s_waitcnt lgkmcnt(10)
  v_mfma_f32_16x16x32_bf16 v[196:199], v[92:95], v[240:243], v[196:199]
  ds_read_b128 v[240:243], v1 offset:36864
  s_waitcnt vmcnt(14)
  s_barrier
  v_mfma_f32_16x16x32_bf16 v[200:203], v[92:95], v[244:247], v[200:203]
  ds_read_b128 v[244:247], v1 offset:37888
  buffer_load_dwordx4 v1, s[4:7], s82 offen offset:1024 lds
  s_waitcnt lgkmcnt(9)
  v_mfma_f32_16x16x32_bf16 v[164:167], v[96:99], v[248:251], v[164:167]
  ds_read_b128 v[248:251], v1 offset:38912
  buffer_load_dwordx4 v[112:115], v1, s[4:7], s86 offen offset:3072 sc1
  v_mfma_f32_16x16x32_bf16 v[168:171], v[96:99], v[252:255], v[168:171]
  ds_read_b128 v[252:255], v1 offset:39936
  ds_bpermute_b32 v150, v6, v156 offset:8
  s_waitcnt lgkmcnt(9)
  v_mfma_f32_16x16x32_bf16 v[172:175], v[96:99], v[224:227], v[172:175]
  ds_read_b128 v[224:227], v1 offset:61440
  ds_bpermute_b32 v154, v6, v157 offset:8
  v_mfma_f32_16x16x32_bf16 v[176:179], v[96:99], v[228:231], v[176:179]
  ds_read_b128 v[228:231], v1 offset:62464
  ds_bpermute_b32 v151, v6, v156 offset:12
  s_waitcnt lgkmcnt(10)
  v_mfma_f32_16x16x32_bf16 v[180:183], v[96:99], v[232:235], v[180:183]
  ds_read_b128 v[232:235], v1 offset:63488
  ds_bpermute_b32 v155, v6, v157 offset:12
  v_mfma_f32_16x16x32_bf16 v[184:187], v[96:99], v[236:239], v[184:187]
  ds_read_b128 v[236:239], v1 offset:64512
  buffer_load_dwordx4 v1, s[4:7], s82 offen offset:2048 lds
  s_waitcnt lgkmcnt(10)
  v_mfma_f32_16x16x32_bf16 v[188:191], v[96:99], v[240:243], v[188:191]
  ds_read_b128 v[240:243], v2 offset:0
  v_mfma_f32_16x16x32_bf16 v[192:195], v[96:99], v[244:247], v[192:195]
  ds_read_b128 v[244:247], v2 offset:6144
  s_waitcnt lgkmcnt(10)
  v_mfma_f32_16x16x32_bf16 v[196:199], v[96:99], v[248:251], v[196:199]
  ds_read_b128 v[248:251], v2 offset:7168
  v_mfma_f32_16x16x32_bf16 v[200:203], v[96:99], v[252:255], v[200:203]
  ds_read_b128 v[252:255], v2 offset:8192
  buffer_load_dwordx4 v1, s[4:7], s82 offen offset:3072 lds
  s_waitcnt vmcnt(13) lgkmcnt(8)
  v_mfma_f32_16x16x32_bf16 v[164:167], v[100:103], v[224:227], v[164:167]
  ds_read_b128 v[224:227], v2 offset:9216
  s_add_u32 s86, s86, 4096
  buffer_load_dwordx4 v[116:119], v1, s[4:7], s86 offen offset:0 sc1
  v_mfma_f32_16x16x32_bf16 v[168:171], v[100:103], v[228:231], v[168:171]
  ds_read_b128 v[228:231], v2 offset:10240
  s_waitcnt lgkmcnt(6)
  v_mfma_f32_16x16x32_bf16 v[172:175], v[100:103], v[232:235], v[172:175]
  ds_read_b128 v[232:235], v2 offset:1024
  v_mfma_f32_16x16x32_bf16 v[176:179], v[100:103], v[236:239], v[176:179]
  ds_read_b128 v[236:239], v2 offset:2048
  s_waitcnt lgkmcnt(6)
  v_mfma_f32_16x16x32_bf16 v[180:183], v[100:103], v[240:243], v[180:183]
  ds_read_b128 v[240:243], v2 offset:3072
  v_mfma_f32_16x16x32_bf16 v[184:187], v[100:103], v[244:247], v[184:187]
  s_add_u32 s82, s82, 4096
  s_add_u32 m0, m0, 4096
  ds_read_b128 v[244:247], v2 offset:4096
  buffer_load_dwordx4 v1, s[4:7], s82 offen offset:0 lds
  s_waitcnt lgkmcnt(6)
  v_mfma_f32_16x16x32_bf16 v[188:191], v[100:103], v[248:251], v[188:191]
  ds_read_b128 v[248:251], v2 offset:5120
  v_mfma_f32_16x16x32_bf16 v[192:195], v[100:103], v[252:255], v[192:195]
  ds_read_b128 v[252:255], v2 offset:11264
  s_waitcnt lgkmcnt(6)
  v_mfma_f32_16x16x32_bf16 v[196:199], v[100:103], v[224:227], v[196:199]
  ds_read_b128 v[224:227], v2 offset:12288
  s_waitcnt vmcnt(14)
  s_barrier
  v_mfma_f32_16x16x32_bf16 v[200:203], v[100:103], v[228:231], v[200:203]
  s_add_u32 s82, s74, 98304
  s_add_u32 m0, s43, 40960
  ds_read_b128 v[228:231], v2 offset:13312
  buffer_load_dwordx4 v1, s[4:7], s82 offen offset:0 lds
  s_waitcnt vmcnt(12) lgkmcnt(6)
  v_mfma_f32_16x16x32_bf16 v[164:167], v[104:107], v[232:235], v[164:167]
  ds_read_b128 v[232:235], v2 offset:14336
  buffer_load_dwordx4 v[120:123], v1, s[4:7], s86 offen offset:1024 sc1
  v_mfma_f32_16x16x32_bf16 v[168:171], v[104:107], v[236:239], v[168:171]
  ds_read_b128 v[236:239], v2 offset:15360
  s_waitcnt lgkmcnt(6)
  v_mfma_f32_16x16x32_bf16 v[172:175], v[104:107], v[240:243], v[172:175]
  ds_read_b128 v[240:243], v2 offset:16384
  v_mfma_f32_16x16x32_bf16 v[176:179], v[104:107], v[244:247], v[176:179]
  ds_read_b128 v[244:247], v2 offset:17408
  s_waitcnt lgkmcnt(6)
  v_mfma_f32_16x16x32_bf16 v[180:183], v[104:107], v[248:251], v[180:183]
  ds_read_b128 v[248:251], v2 offset:18432
  v_mfma_f32_16x16x32_bf16 v[184:187], v[104:107], v[252:255], v[184:187]
  ds_read_b128 v[252:255], v2 offset:19456
  buffer_load_dwordx4 v1, s[4:7], s82 offen offset:1024 lds
  s_waitcnt lgkmcnt(6)
  v_mfma_f32_16x16x32_bf16 v[188:191], v[104:107], v[224:227], v[188:191]
  ds_read_b128 v[224:227], v2 offset:20480
  v_mfma_f32_16x16x32_bf16 v[192:195], v[104:107], v[228:231], v[192:195]
  ds_read_b128 v[228:231], v2 offset:26624
  s_waitcnt lgkmcnt(6)
  v_mfma_f32_16x16x32_bf16 v[196:199], v[104:107], v[232:235], v[196:199]
  ds_read_b128 v[232:235], v2 offset:27648
  buffer_load_dwordx4 v1, s[4:7], s82 offen offset:2048 lds
  v_mfma_f32_16x16x32_bf16 v[200:203], v[104:107], v[236:239], v[200:203]
  ds_read_b128 v[236:239], v2 offset:28672
  s_waitcnt vmcnt(12) lgkmcnt(6)
  v_mfma_f32_16x16x32_bf16 v[164:167], v[108:111], v[240:243], v[164:167]
  ds_read_b128 v[240:243], v2 offset:29696
  buffer_load_dwordx4 v[124:127], v1, s[4:7], s86 offen offset:2048 sc1
  v_mfma_f32_16x16x32_bf16 v[168:171], v[108:111], v[244:247], v[168:171]
  ds_read_b128 v[244:247], v2 offset:30720
  s_waitcnt lgkmcnt(6)
  v_mfma_f32_16x16x32_bf16 v[172:175], v[108:111], v[248:251], v[172:175]
  ds_read_b128 v[248:251], v2 offset:21504
  v_mfma_f32_16x16x32_bf16 v[176:179], v[108:111], v[252:255], v[176:179]
  ds_read_b128 v[252:255], v2 offset:22528
  s_waitcnt lgkmcnt(6)
  v_mfma_f32_16x16x32_bf16 v[180:183], v[108:111], v[224:227], v[180:183]
  ds_read_b128 v[224:227], v2 offset:23552
  v_mfma_f32_16x16x32_bf16 v[184:187], v[108:111], v[228:231], v[184:187]
  ds_read_b128 v[228:231], v2 offset:24576
  s_waitcnt lgkmcnt(6)
  v_mfma_f32_16x16x32_bf16 v[188:191], v[108:111], v[232:235], v[188:191]
  ds_read_b128 v[232:235], v2 offset:25600
  buffer_load_dwordx4 v1, s[4:7], s82 offen offset:3072 lds
  v_mfma_f32_16x16x32_bf16 v[192:195], v[108:111], v[236:239], v[192:195]
  ds_read_b128 v[236:239], v2 offset:31744
  s_waitcnt lgkmcnt(6)
  v_mfma_f32_16x16x32_bf16 v[196:199], v[108:111], v[240:243], v[196:199]
  ds_read_b128 v[240:243], v2 offset:32768
  s_waitcnt vmcnt(13)
  s_barrier
  v_mfma_f32_16x16x32_bf16 v[200:203], v[108:111], v[244:247], v[200:203]
  s_add_u32 s82, s82, 4096
  s_add_u32 m0, m0, 4096
  ds_read_b128 v[244:247], v2 offset:33792
  buffer_load_dwordx4 v1, s[4:7], s82 offen offset:0 lds
  s_waitcnt vmcnt(11) lgkmcnt(6)
  v_mfma_f32_16x16x32_bf16 v[164:167], v[112:115], v[248:251], v[164:167]
  ds_read_b128 v[248:251], v2 offset:34816
  buffer_load_dwordx4 v[128:131], v1, s[4:7], s86 offen offset:3072 sc1
  v_mfma_f32_16x16x32_bf16 v[168:171], v[112:115], v[252:255], v[168:171]
  ds_read_b128 v[252:255], v2 offset:35840
  s_waitcnt lgkmcnt(6)
  v_mfma_f32_16x16x32_bf16 v[172:175], v[112:115], v[224:227], v[172:175]
  ds_read_b128 v[224:227], v2 offset:36864
  v_mfma_f32_16x16x32_bf16 v[176:179], v[112:115], v[228:231], v[176:179]
  ds_read_b128 v[228:231], v2 offset:37888
  s_waitcnt lgkmcnt(6)
  v_mfma_f32_16x16x32_bf16 v[180:183], v[112:115], v[232:235], v[180:183]
  ds_read_b128 v[232:235], v2 offset:38912
  v_mfma_f32_16x16x32_bf16 v[184:187], v[112:115], v[236:239], v[184:187]
  s_add_u32 s82, s74, 110592
  s_add_u32 m0, s43, 0
  ds_read_b128 v[236:239], v2 offset:39936
  buffer_load_dwordx4 v1, s[4:7], s82 offen offset:0 lds
  s_waitcnt lgkmcnt(6)
  v_mfma_f32_16x16x32_bf16 v[188:191], v[112:115], v[240:243], v[188:191]
  ds_read_b128 v[240:243], v2 offset:40960
  v_mfma_f32_16x16x32_bf16 v[192:195], v[112:115], v[244:247], v[192:195]
  ds_read_b128 v[244:247], v2 offset:47104
  s_waitcnt lgkmcnt(6)
  v_mfma_f32_16x16x32_bf16 v[196:199], v[112:115], v[248:251], v[196:199]
  ds_read_b128 v[248:251], v2 offset:48128
  buffer_load_dwordx4 v1, s[4:7], s82 offen offset:1024 lds
  v_mfma_f32_16x16x32_bf16 v[200:203], v[112:115], v[252:255], v[200:203]
  ds_read_b128 v[252:255], v2 offset:49152
  s_waitcnt vmcnt(11) lgkmcnt(6)
  v_mfma_f32_16x16x32_bf16 v[164:167], v[116:119], v[224:227], v[164:167]
  ds_read_b128 v[224:227], v2 offset:50176
  s_add_u32 s86, s86, 4096
  buffer_load_dwordx4 v[132:135], v1, s[4:7], s86 offen offset:0 sc1
  v_mfma_f32_16x16x32_bf16 v[168:171], v[116:119], v[228:231], v[168:171]
  ds_read_b128 v[228:231], v2 offset:51200
  s_waitcnt lgkmcnt(6)
  v_mfma_f32_16x16x32_bf16 v[172:175], v[116:119], v[232:235], v[172:175]
  ds_read_b128 v[232:235], v2 offset:41984
  ds_read_b32 v204, v27 offset:0
  v_mfma_f32_16x16x32_bf16 v[176:179], v[116:119], v[236:239], v[176:179]
  ds_read_b128 v[236:239], v2 offset:43008
  ds_read_b32 v205, v27 offset:64
  s_waitcnt lgkmcnt(8)
  v_mfma_f32_16x16x32_bf16 v[180:183], v[116:119], v[240:243], v[180:183]
  ds_read_b128 v[240:243], v2 offset:44032
  ds_read_b32 v206, v27 offset:128
  v_mfma_f32_16x16x32_bf16 v[184:187], v[116:119], v[244:247], v[184:187]
  ds_read_b128 v[244:247], v2 offset:45056
  ds_read_b32 v207, v27 offset:192
  s_waitcnt lgkmcnt(10)
  v_mfma_f32_16x16x32_bf16 v[188:191], v[116:119], v[248:251], v[188:191]
  ds_read_b128 v[248:251], v2 offset:46080
  buffer_load_dwordx4 v1, s[4:7], s82 offen offset:2048 lds
  v_mfma_f32_16x16x32_bf16 v[192:195], v[116:119], v[252:255], v[192:195]
  ds_read_b128 v[252:255], v2 offset:52224
  ds_read_b32 v208, v27 offset:256
  s_waitcnt lgkmcnt(11)
  v_mfma_f32_16x16x32_bf16 v[196:199], v[116:119], v[224:227], v[196:199]
  ds_read_b128 v[224:227], v2 offset:53248
  s_waitcnt vmcnt(12)
  s_barrier
  v_mfma_f32_16x16x32_bf16 v[200:203], v[116:119], v[228:231], v[200:203]
  ds_read_b128 v[228:231], v2 offset:54272
  buffer_load_dwordx4 v1, s[4:7], s82 offen offset:3072 lds
  s_waitcnt vmcnt(11) lgkmcnt(10)
  v_mfma_f32_16x16x32_bf16 v[164:167], v[120:123], v[232:235], v[164:167]
  ds_read_b128 v[232:235], v2 offset:55296
  buffer_load_dwordx4 v[136:139], v1, s[4:7], s86 offen offset:1024 sc1
  v_mfma_f32_16x16x32_bf16 v[168:171], v[120:123], v[236:239], v[168:171]
  ds_read_b128 v[236:239], v2 offset:56320
  ds_read_b32 v209, v27 offset:384
  s_waitcnt lgkmcnt(9)
  v_mfma_f32_16x16x32_bf16 v[172:175], v[120:123], v[240:243], v[172:175]
  ds_read_b128 v[240:243], v2 offset:57344
  ds_read_b32 v210, v27 offset:448
  v_mfma_f32_16x16x32_bf16 v[176:179], v[120:123], v[244:247], v[176:179]
  ds_read_b128 v[244:247], v2 offset:58368
  ds_read_b32 v211, v27 offset:512
  s_waitcnt lgkmcnt(10)
  v_mfma_f32_16x16x32_bf16 v[180:183], v[120:123], v[248:251], v[180:183]
  s_add_u32 s82, s82, 4096
  s_add_u32 m0, m0, 4096
  ds_read_b128 v[248:251], v2 offset:59392
  buffer_load_dwordx4 v1, s[4:7], s82 offen offset:0 lds
  v_mfma_f32_16x16x32_bf16 v[184:187], v[120:123], v[252:255], v[184:187]
  ds_read_b128 v[252:255], v2 offset:60416
  ds_read_b32 v162, v27 offset:576
  s_waitcnt lgkmcnt(10)
  v_mfma_f32_16x16x32_bf16 v[188:191], v[120:123], v[224:227], v[188:191]
  ds_read_b128 v[224:227], v2 offset:61440
  ds_read_b32 v163, v27 offset:640
  v_mfma_f32_16x16x32_bf16 v[192:195], v[120:123], v[228:231], v[192:195]
  s_add_u32 s82, s75, 245760
  s_add_u32 m0, s43, 20480
  ds_read_b128 v[228:231], v3 offset:2048
  buffer_load_dwordx4 v1, s[4:7], s82 offen offset:0 lds
  s_waitcnt lgkmcnt(11)
  v_mfma_f32_16x16x32_bf16 v[196:199], v[120:123], v[232:235], v[196:199]
  ds_read_b128 v[232:235], v3 offset:3072
  v_mfma_f32_16x16x32_bf16 v[200:203], v[120:123], v[236:239], v[200:203]
  ds_read_b128 v[236:239], v3 offset:4096
  s_waitcnt vmcnt(11) lgkmcnt(9)
  v_mfma_f32_16x16x32_bf16 v[164:167], v[124:127], v[240:243], v[164:167]
  ds_read_b128 v[240:243], v3 offset:5120
  buffer_load_dwordx4 v[140:143], v1, s[4:7], s86 offen offset:2048 sc1
  v_mfma_f32_16x16x32_bf16 v[168:171], v[124:127], v[244:247], v[168:171]
  ds_read_b128 v[244:247], v3 offset:6144
  s_waitcnt lgkmcnt(8)
  v_mfma_f32_16x16x32_bf16 v[172:175], v[124:127], v[248:251], v[172:175]
  ds_read_b128 v[248:251], v2 offset:62464
  v_mfma_f32_16x16x32_bf16 v[176:179], v[124:127], v[252:255], v[176:179]
  ds_read_b128 v[252:255], v2 offset:63488
  s_waitcnt lgkmcnt(6)
  v_mfma_f32_16x16x32_bf16 v[180:183], v[124:127], v[224:227], v[180:183]
  ds_read_b128 v[224:227], v2 offset:64512
  v_mfma_f32_16x16x32_bf16 v[184:187], v[124:127], v[228:231], v[184:187]
  ds_read_b128 v[228:231], v3 offset:0
  s_waitcnt lgkmcnt(6)
  v_mfma_f32_16x16x32_bf16 v[188:191], v[124:127], v[232:235], v[188:191]
  ds_read_b128 v[232:235], v3 offset:1024
  buffer_load_dwordx4 v1, s[4:7], s82 offen offset:1024 lds
  v_mfma_f32_16x16x32_bf16 v[192:195], v[124:127], v[236:239], v[192:195]
  ds_read_b128 v[236:239], v3 offset:7168
  s_waitcnt lgkmcnt(6)
  v_mfma_f32_16x16x32_bf16 v[196:199], v[124:127], v[240:243], v[196:199]
  ds_read_b128 v[240:243], v3 offset:8192
  s_waitcnt vmcnt(11)
  s_barrier
  v_mfma_f32_16x16x32_bf16 v[200:203], v[124:127], v[244:247], v[200:203]
  ds_read_b128 v[244:247], v3 offset:9216
  buffer_load_dwordx4 v1, s[4:7], s82 offen offset:2048 lds
  s_waitcnt vmcnt(11) lgkmcnt(6)
  v_mfma_f32_16x16x32_bf16 v[164:167], v[128:131], v[248:251], v[164:167]
  ds_read_b128 v[248:251], v3 offset:10240
  buffer_load_dwordx4 v[144:147], v1, s[4:7], s86 offen offset:3072 sc1
  v_mfma_f32_16x16x32_bf16 v[168:171], v[128:131], v[252:255], v[168:171]
  ds_read_b128 v[252:255], v3 offset:11264
  s_waitcnt lgkmcnt(6)
  v_mfma_f32_16x16x32_bf16 v[172:175], v[128:131], v[224:227], v[172:175]
  ds_read_b128 v[224:227], v1 offset:40960
  v_mfma_f32_16x16x32_bf16 v[176:179], v[128:131], v[228:231], v[176:179]
  ds_read_b128 v[228:231], v1 offset:41984
  s_waitcnt lgkmcnt(6)
  v_mfma_f32_16x16x32_bf16 v[180:183], v[128:131], v[232:235], v[180:183]
  ds_read_b128 v[232:235], v1 offset:43008
  v_mfma_f32_16x16x32_bf16 v[184:187], v[128:131], v[236:239], v[184:187]
  ds_read_b128 v[236:239], v1 offset:44032
  s_waitcnt lgkmcnt(6)
  v_mfma_f32_16x16x32_bf16 v[188:191], v[128:131], v[240:243], v[188:191]
  ds_read_b128 v[240:243], v1 offset:45056
  buffer_load_dwordx4 v1, s[4:7], s82 offen offset:3072 lds
  v_mfma_f32_16x16x32_bf16 v[192:195], v[128:131], v[244:247], v[192:195]
  ds_read_b128 v[244:247], v1 offset:51200
  s_waitcnt lgkmcnt(6)
  v_mfma_f32_16x16x32_bf16 v[196:199], v[128:131], v[248:251], v[196:199]
  ds_read_b128 v[248:251], v1 offset:52224
  v_mfma_f32_16x16x32_bf16 v[200:203], v[128:131], v[252:255], v[200:203]
  s_add_u32 s82, s82, 4096
  s_add_u32 m0, m0, 4096
  ds_read_b128 v[252:255], v1 offset:53248
  buffer_load_dwordx4 v1, s[4:7], s82 offen offset:0 lds
  s_waitcnt vmcnt(11) lgkmcnt(6)
  v_mfma_f32_16x16x32_bf16 v[164:167], v[132:135], v[224:227], v[164:167]
  ds_read_b128 v[224:227], v1 offset:54272
  v_mfma_f32_16x16x32_bf16 v[168:171], v[132:135], v[228:231], v[168:171]
  ds_read_b128 v[228:231], v1 offset:55296
  s_waitcnt lgkmcnt(6)
  v_mfma_f32_16x16x32_bf16 v[172:175], v[132:135], v[232:235], v[172:175]
  ds_read_b128 v[232:235], v1 offset:46080
  v_mfma_f32_16x16x32_bf16 v[176:179], v[132:135], v[236:239], v[176:179]
  s_add_u32 s82, s75, 270336
  s_add_u32 m0, s43, 84736
  ds_read_b128 v[236:239], v1 offset:47104
  buffer_load_dwordx4 v1, s[4:7], s82 offen offset:0 lds
  s_waitcnt lgkmcnt(6)
  v_mfma_f32_16x16x32_bf16 v[180:183], v[132:135], v[240:243], v[180:183]
  ds_read_b128 v[240:243], v1 offset:48128
  v_mfma_f32_16x16x32_bf16 v[184:187], v[132:135], v[244:247], v[184:187]
  ds_read_b128 v[244:247], v1 offset:49152
  s_waitcnt lgkmcnt(6)
  v_mfma_f32_16x16x32_bf16 v[188:191], v[132:135], v[248:251], v[188:191]
  ds_read_b128 v[248:251], v1 offset:50176
  v_mfma_f32_16x16x32_bf16 v[192:195], v[132:135], v[252:255], v[192:195]
  ds_read_b128 v[252:255], v1 offset:56320
  buffer_load_dwordx4 v1, s[4:7], s82 offen offset:1024 lds
  s_waitcnt lgkmcnt(6)
  v_mfma_f32_16x16x32_bf16 v[196:199], v[132:135], v[224:227], v[196:199]
  ds_read_b128 v[224:227], v1 offset:57344
  s_waitcnt vmcnt(9)
  s_barrier
  v_mfma_f32_16x16x32_bf16 v[200:203], v[132:135], v[228:231], v[200:203]
  ds_read_b128 v[228:231], v1 offset:58368
  buffer_load_dwordx4 v1, s[4:7], s82 offen offset:2048 lds
  s_waitcnt lgkmcnt(6)
  v_mfma_f32_16x16x32_bf16 v[164:167], v[136:139], v[232:235], v[164:167]
  ds_read_b128 v[232:235], v1 offset:59392
  v_mfma_f32_16x16x32_bf16 v[168:171], v[136:139], v[236:239], v[168:171]
  ds_read_b128 v[236:239], v1 offset:60416
  buffer_load_dwordx4 v1, s[4:7], s82 offen offset:3072 lds
  s_waitcnt lgkmcnt(6)
  v_mfma_f32_16x16x32_bf16 v[172:175], v[136:139], v[240:243], v[172:175]
  ds_read_b128 v[240:243], v1 offset:0
  v_mfma_f32_16x16x32_bf16 v[176:179], v[136:139], v[244:247], v[176:179]
  ds_read_b128 v[244:247], v1 offset:1024
  s_waitcnt lgkmcnt(6)
  v_mfma_f32_16x16x32_bf16 v[180:183], v[136:139], v[248:251], v[180:183]
  ds_read_b128 v[248:251], v1 offset:2048
  v_mfma_f32_16x16x32_bf16 v[184:187], v[136:139], v[252:255], v[184:187]
  s_add_u32 s82, s82, 4096
  s_add_u32 m0, m0, 4096
  ds_read_b128 v[252:255], v1 offset:3072
  buffer_load_dwordx4 v1, s[4:7], s82 offen offset:0 lds
  s_waitcnt lgkmcnt(6)
  v_mfma_f32_16x16x32_bf16 v[188:191], v[136:139], v[224:227], v[188:191]
  ds_read_b128 v[224:227], v1 offset:4096
  v_mfma_f32_16x16x32_bf16 v[192:195], v[136:139], v[228:231], v[192:195]
  s_add_u32 s82, s75, 294912
  s_add_u32 m0, s43, 105216
  ds_read_b128 v[228:231], v1 offset:10240
  buffer_load_dwordx4 v1, s[4:7], s82 offen offset:0 lds
  s_waitcnt lgkmcnt(6)
  v_mfma_f32_16x16x32_bf16 v[196:199], v[136:139], v[232:235], v[196:199]
  ds_read_b128 v[232:235], v1 offset:11264
  v_mfma_f32_16x16x32_bf16 v[200:203], v[136:139], v[236:239], v[200:203]
  ds_read_b128 v[236:239], v1 offset:12288
  s_waitcnt vmcnt(11) lgkmcnt(6)
  v_mfma_f32_16x16x32_bf16 v[164:167], v[140:143], v[240:243], v[164:167]
  ds_read_b128 v[240:243], v1 offset:13312
  buffer_load_dwordx4 v1, s[4:7], s82 offen offset:1024 lds
  v_mfma_f32_16x16x32_bf16 v[168:171], v[140:143], v[244:247], v[168:171]
  ds_read_b128 v[244:247], v1 offset:14336
  s_waitcnt lgkmcnt(6)
  v_mfma_f32_16x16x32_bf16 v[172:175], v[140:143], v[248:251], v[172:175]
  ds_read_b128 v[248:251], v1 offset:5120
  v_mfma_f32_16x16x32_bf16 v[176:179], v[140:143], v[252:255], v[176:179]
  ds_read_b128 v[252:255], v1 offset:6144
  s_waitcnt lgkmcnt(6)
  v_mfma_f32_16x16x32_bf16 v[180:183], v[140:143], v[224:227], v[180:183]
  ds_read_b128 v[224:227], v1 offset:7168
  buffer_load_dwordx4 v1, s[4:7], s82 offen offset:2048 lds
  v_mfma_f32_16x16x32_bf16 v[184:187], v[140:143], v[228:231], v[184:187]
  ds_read_b128 v[228:231], v1 offset:8192
  s_waitcnt lgkmcnt(6)
  v_mfma_f32_16x16x32_bf16 v[188:191], v[140:143], v[232:235], v[188:191]
  ds_read_b128 v[232:235], v1 offset:9216
  v_mfma_f32_16x16x32_bf16 v[192:195], v[140:143], v[236:239], v[192:195]
  ds_read_b128 v[236:239], v1 offset:15360
  buffer_load_dwordx4 v1, s[4:7], s82 offen offset:3072 lds
  s_waitcnt lgkmcnt(6)
  v_mfma_f32_16x16x32_bf16 v[196:199], v[140:143], v[240:243], v[196:199]
  ds_read_b128 v[240:243], v1 offset:16384
  s_barrier
  v_mfma_f32_16x16x32_bf16 v[200:203], v[140:143], v[244:247], v[200:203]
  s_add_u32 s82, s82, 4096
  s_add_u32 m0, m0, 4096
  ds_read_b128 v[244:247], v1 offset:17408
  buffer_load_dwordx4 v1, s[4:7], s82 offen offset:0 lds
  s_waitcnt vmcnt(12) lgkmcnt(6)
  v_mfma_f32_16x16x32_bf16 v[164:167], v[144:147], v[248:251], v[164:167]
  ds_read_b128 v[248:251], v1 offset:18432
  v_mfma_f32_16x16x32_bf16 v[168:171], v[144:147], v[252:255], v[168:171]
  s_add_u32 s82, s75, 319488
  s_add_u32 m0, s43, 125696
  ds_read_b128 v[252:255], v1 offset:19456
  buffer_load_dwordx4 v1, s[4:7], s82 offen offset:0 lds
  s_waitcnt lgkmcnt(6)
  v_mfma_f32_16x16x32_bf16 v[172:175], v[144:147], v[224:227], v[172:175]
  v_mfma_f32_16x16x32_bf16 v[176:179], v[144:147], v[228:231], v[176:179]
  s_waitcnt lgkmcnt(4)
  v_mfma_f32_16x16x32_bf16 v[180:183], v[144:147], v[232:235], v[180:183]
  buffer_load_dwordx4 v1, s[4:7], s82 offen offset:1024 lds
  v_mfma_f32_16x16x32_bf16 v[184:187], v[144:147], v[236:239], v[184:187]
  s_waitcnt lgkmcnt(2)
  v_mfma_f32_16x16x32_bf16 v[188:191], v[144:147], v[240:243], v[188:191]
  v_mfma_f32_16x16x32_bf16 v[192:195], v[144:147], v[244:247], v[192:195]
  s_waitcnt lgkmcnt(0)
  v_mfma_f32_16x16x32_bf16 v[196:199], v[144:147], v[248:251], v[196:199]
  v_mfma_f32_16x16x32_bf16 v[200:203], v[144:147], v[252:255], v[200:203]
  buffer_load_dwordx4 v1, s[4:7], s82 offen offset:2048 lds
  s_barrier
  v_add_u32 v220, 61440, v38
  v_mov_b32 v212, 0x358637bd
  v_mov_b32 v213, 0x3fb8aa3b
  buffer_load_dwordx4 v1, s[4:7], s82 offen offset:3072 lds
  v_pk_mul_f32 v[240:241], v[152:153], v[208:209] op_sel:[0,1] op_sel_hi:[1,1]
  v_pk_mul_f32 v[242:243], v[154:155], v[208:209] op_sel:[0,1] op_sel_hi:[1,1]
  v_pk_fma_f32 v[184:185], v[184:185], v[148:149], v[240:241]
  v_pk_fma_f32 v[186:187], v[186:187], v[150:151], v[242:243]
  v_cvt_pk_bf16_f32 v226, v184, v185
  v_cvt_pk_bf16_f32 v227, v186, v187
  ds_write_b64 v220, v[226:227] offset:11520
  v_pk_mul_f32 v[240:241], v[152:153], v[210:211] op_sel:[0,0] op_sel_hi:[1,0]
  v_pk_mul_f32 v[242:243], v[154:155], v[210:211] op_sel:[0,0] op_sel_hi:[1,0]
  v_pk_fma_f32 v[188:189], v[188:189], v[148:149], v[240:241]
  v_pk_fma_f32 v[190:191], v[190:191], v[150:151], v[242:243]
  v_cvt_pk_bf16_f32 v228, v188, v189
  v_cvt_pk_bf16_f32 v229, v190, v191
  ds_write_b64 v220, v[228:229] offset:13824
  v_pk_mul_f32 v[240:241], v[152:153], v[210:211] op_sel:[0,1] op_sel_hi:[1,1]
  v_pk_mul_f32 v[242:243], v[154:155], v[210:211] op_sel:[0,1] op_sel_hi:[1,1]
  v_pk_fma_f32 v[192:193], v[192:193], v[148:149], v[240:241]
  s_add_u32 s82, s82, 4096
  s_add_u32 m0, m0, 4096
  s_nop 0
  buffer_load_dwordx4 v1, s[4:7], s82 offen offset:0 lds
  v_pk_fma_f32 v[194:195], v[194:195], v[150:151], v[242:243]
  v_cvt_pk_bf16_f32 v230, v192, v193
  v_cvt_pk_bf16_f32 v231, v194, v195
  ds_write_b64 v220, v[230:231] offset:16128
  v_pk_mul_f32 v[240:241], v[152:153], v[162:163] op_sel:[0,0] op_sel_hi:[1,0]
  v_pk_mul_f32 v[242:243], v[154:155], v[162:163] op_sel:[0,0] op_sel_hi:[1,0]
  v_pk_fma_f32 v[196:197], v[196:197], v[148:149], v[240:241]
  v_pk_fma_f32 v[198:199], v[198:199], v[150:151], v[242:243]
  v_cvt_pk_bf16_f32 v224, v196, v197
  v_cvt_pk_bf16_f32 v225, v198, v199
  ds_write_b64 v220, v[224:225] offset:18432
  v_pk_mul_f32 v[240:241], v[152:153], v[162:163] op_sel:[0,1] op_sel_hi:[1,1]
  v_pk_mul_f32 v[242:243], v[154:155], v[162:163] op_sel:[0,1] op_sel_hi:[1,1]
  v_pk_fma_f32 v[200:201], v[200:201], v[148:149], v[240:241]
  s_add_u32 s82, s75, 344064
  s_add_u32 m0, s43, 40960
  s_nop 0
  buffer_load_dwordx4 v1, s[4:7], s82 offen offset:0 lds
  v_pk_fma_f32 v[202:203], v[202:203], v[150:151], v[242:243]
  v_cvt_pk_bf16_f32 v226, v200, v201
  v_cvt_pk_bf16_f32 v227, v202, v203
  ds_write_b64 v220, v[226:227] offset:20736
  v_pk_fma_f32 v[240:241], v[152:153], v[204:205], v[212:213] op_sel:[0,0,0] op_sel_hi:[1,0,0]
  v_pk_fma_f32 v[242:243], v[154:155], v[204:205], v[212:213] op_sel:[0,0,0] op_sel_hi:[1,0,0]
  v_pk_fma_f32 v[164:165], v[164:165], v[148:149], v[240:241]
  v_pk_fma_f32 v[166:167], v[166:167], v[150:151], v[242:243]
  v_pk_mul_f32 v[232:233], v[164:165], v[212:213] op_sel:[0,1] op_sel_hi:[1,1]
  v_pk_mul_f32 v[234:235], v[166:167], v[212:213] op_sel:[0,1] op_sel_hi:[1,1]
  v_exp_f32 v232, v232 clamp
  v_exp_f32 v233, v233 clamp
  v_exp_f32 v234, v234 clamp
  v_exp_f32 v235, v235 clamp
  buffer_load_dwordx4 v1, s[4:7], s82 offen offset:1024 lds
  v_max_f32 v164, v212, v164
  v_max_f32 v165, v212, v165
  v_max_f32 v166, v212, v166
  v_max_f32 v167, v212, v167
  v_pk_add_f32 v[164:165], v[164:165], v[232:233]
  v_pk_add_f32 v[166:167], v[166:167], v[234:235]
  v_cvt_pk_bf16_f32 v224, v164, v165
  v_cvt_pk_bf16_f32 v225, v166, v167
  ds_write_b64 v220, v[224:225] offset:0
  v_pk_fma_f32 v[240:241], v[152:153], v[204:205], v[212:213] op_sel:[0,1,0] op_sel_hi:[1,1,0]
  v_pk_fma_f32 v[242:243], v[154:155], v[204:205], v[212:213] op_sel:[0,1,0] op_sel_hi:[1,1,0]
  v_pk_fma_f32 v[168:169], v[168:169], v[148:149], v[240:241]
  v_pk_fma_f32 v[170:171], v[170:171], v[150:151], v[242:243]
  v_pk_mul_f32 v[236:237], v[168:169], v[212:213] op_sel:[0,1] op_sel_hi:[1,1]
  v_pk_mul_f32 v[238:239], v[170:171], v[212:213] op_sel:[0,1] op_sel_hi:[1,1]
  v_exp_f32 v236, v236 clamp
  v_exp_f32 v237, v237 clamp
  buffer_load_dwordx4 v1, s[4:7], s82 offen offset:2048 lds
  v_exp_f32 v238, v238 clamp
  v_exp_f32 v239, v239 clamp
  v_max_f32 v168, v212, v168
  v_max_f32 v169, v212, v169
  v_max_f32 v170, v212, v170
  v_max_f32 v171, v212, v171
  v_pk_add_f32 v[168:169], v[168:169], v[236:237]
  v_pk_add_f32 v[170:171], v[170:171], v[238:239]
  v_cvt_pk_bf16_f32 v226, v168, v169
  v_cvt_pk_bf16_f32 v227, v170, v171
  ds_write_b64 v220, v[226:227] offset:2304
  v_pk_fma_f32 v[240:241], v[152:153], v[206:207], v[212:213] op_sel:[0,0,0] op_sel_hi:[1,0,0]
  v_pk_fma_f32 v[242:243], v[154:155], v[206:207], v[212:213] op_sel:[0,0,0] op_sel_hi:[1,0,0]
  v_pk_fma_f32 v[172:173], v[172:173], v[148:149], v[240:241]
  v_pk_fma_f32 v[174:175], v[174:175], v[150:151], v[242:243]
  v_pk_mul_f32 v[232:233], v[172:173], v[212:213] op_sel:[0,1] op_sel_hi:[1,1]
  v_pk_mul_f32 v[234:235], v[174:175], v[212:213] op_sel:[0,1] op_sel_hi:[1,1]
  buffer_load_dwordx4 v1, s[4:7], s82 offen offset:3072 lds
  v_exp_f32 v232, v232 clamp
  v_exp_f32 v233, v233 clamp
  v_exp_f32 v234, v234 clamp
  v_exp_f32 v235, v235 clamp
  v_max_f32 v172, v212, v172
  v_max_f32 v173, v212, v173
  v_max_f32 v174, v212, v174
  v_max_f32 v175, v212, v175
  v_pk_add_f32 v[172:173], v[172:173], v[232:233]
  v_pk_add_f32 v[174:175], v[174:175], v[234:235]
  v_cvt_pk_bf16_f32 v228, v172, v173
  v_cvt_pk_bf16_f32 v229, v174, v175
  ds_write_b64 v220, v[228:229] offset:4608
  v_pk_fma_f32 v[240:241], v[152:153], v[206:207], v[212:213] op_sel:[0,1,0] op_sel_hi:[1,1,0]
  v_pk_fma_f32 v[242:243], v[154:155], v[206:207], v[212:213] op_sel:[0,1,0] op_sel_hi:[1,1,0]
  v_pk_fma_f32 v[176:177], v[176:177], v[148:149], v[240:241]
  v_pk_fma_f32 v[178:179], v[178:179], v[150:151], v[242:243]
  s_add_u32 s82, s82, 4096
  s_add_u32 m0, m0, 4096
  s_nop 0
  buffer_load_dwordx4 v1, s[4:7], s82 offen offset:0 lds
  v_pk_mul_f32 v[236:237], v[176:177], v[212:213] op_sel:[0,1] op_sel_hi:[1,1]
  v_pk_mul_f32 v[238:239], v[178:179], v[212:213] op_sel:[0,1] op_sel_hi:[1,1]
  v_exp_f32 v236, v236 clamp
  v_exp_f32 v237, v237 clamp
  v_exp_f32 v238, v238 clamp
  v_exp_f32 v239, v239 clamp
  v_max_f32 v176, v212, v176
  v_max_f32 v177, v212, v177
  v_max_f32 v178, v212, v178
  v_max_f32 v179, v212, v179
  v_pk_add_f32 v[176:177], v[176:177], v[236:237]
  v_pk_add_f32 v[178:179], v[178:179], v[238:239]
  v_cvt_pk_bf16_f32 v230, v176, v177
  v_cvt_pk_bf16_f32 v231, v178, v179
  s_add_u32 s82, s75, 368640
  s_add_u32 m0, s43, 0
  s_nop 0
  buffer_load_dwordx4 v1, s[4:7], s82 offen offset:0 lds
  ds_write_b64 v220, v[230:231] offset:6912
  v_pk_fma_f32 v[240:241], v[152:153], v[208:209], v[212:213] op_sel:[0,0,0] op_sel_hi:[1,0,0]
  v_pk_fma_f32 v[242:243], v[154:155], v[208:209], v[212:213] op_sel:[0,0,0] op_sel_hi:[1,0,0]
  v_pk_fma_f32 v[180:181], v[180:181], v[148:149], v[240:241]
  v_pk_fma_f32 v[182:183], v[182:183], v[150:151], v[242:243]
  v_pk_mul_f32 v[232:233], v[180:181], v[212:213] op_sel:[0,1] op_sel_hi:[1,1]
  v_pk_mul_f32 v[234:235], v[182:183], v[212:213] op_sel:[0,1] op_sel_hi:[1,1]
  v_exp_f32 v232, v232 clamp
  v_exp_f32 v233, v233 clamp
  v_exp_f32 v234, v234 clamp
  v_exp_f32 v235, v235 clamp
  v_max_f32 v180, v212, v180
  v_max_f32 v181, v212, v181
  v_max_f32 v182, v212, v182
  buffer_load_dwordx4 v1, s[4:7], s82 offen offset:1024 lds
  v_max_f32 v183, v212, v183
  v_pk_add_f32 v[180:181], v[180:181], v[232:233]
  v_pk_add_f32 v[182:183], v[182:183], v[234:235]
  v_cvt_pk_bf16_f32 v224, v180, v181
  v_cvt_pk_bf16_f32 v225, v182, v183
  ds_write_b64 v220, v[224:225] offset:9216
  s_mov_b32 exec_lo, 0x10001
  s_mov_b32 exec_hi, 0x10001
  ds_write_b64 v220, v[20:21] offset:23040
  s_mov_b64 exec, -1
  v_add_u32 v220, 61440, v39
  v_add_u32 v221, 61440, v40
  s_waitcnt lgkmcnt(0)
  s_barrier
  ds_read_b128 v[224:227], v220 offset:0
  ds_read_b128 v[228:231], v221 offset:0
  ds_read_b128 v[232:235], v220 offset:32
  ds_read_b128 v[236:239], v221 offset:32
  ds_read_b128 v[240:243], v220 offset:64
  ds_read_b128 v[244:247], v221 offset:64
  ds_read_b128 v[248:251], v220 offset:96
  ds_read_b128 v[252:255], v221 offset:96
  s_waitcnt lgkmcnt(6)
  v_mfma_f32_32x32x16_bf16 v[164:179], v[224:227], v[228:231], 0
  s_waitcnt lgkmcnt(4)
  v_mfma_f32_32x32x16_bf16 v[164:179], v[232:235], v[236:239], v[164:179]
  s_waitcnt lgkmcnt(2)
  v_mfma_f32_32x32x16_bf16 v[164:179], v[240:243], v[244:247], v[164:179]
  s_waitcnt lgkmcnt(0)
  v_mfma_f32_32x32x16_bf16 v[164:179], v[248:251], v[252:255], v[164:179]
  s_lshl_b32 s84, s41, 5
  s_add_u32 s84, s84, s42
  s_mul_i32 s84, s84, 6784
  s_mul_i32 s85, s40, 1680
  s_add_u32 s84, s84, s85
  s_add_u32 s84, s84, 1048576
  s_nop 5
  v_bfi_b32 v164, v15, s44, v164
  buffer_load_dwordx4 v1, s[4:7], s82 offen offset:2048 lds
  v_bfi_b32 v165, v15, s45, v165
  v_bfi_b32 v166, v15, s46, v166
  v_bfi_b32 v167, v15, s47, v167
  buffer_store_dwordx4 v[164:167], v34, s[4:7], s84 offen offset:0 sc1
  v_bfi_b32 v168, v15, s44, v168
  v_bfi_b32 v169, v15, s45, v169
  v_bfi_b32 v170, v15, s46, v170
  v_bfi_b32 v171, v15, s47, v171
  buffer_store_dwordx4 v[168:171], v34, s[4:7], s84 offen offset:672 sc1
  v_bfi_b32 v172, v15, s44, v172
  v_bfi_b32 v173, v15, s45, v173
  v_bfi_b32 v174, v15, s46, v174
  v_bfi_b32 v175, v15, s47, v175
  buffer_store_dwordx4 v[172:175], v35, s[4:7], s84 offen offset:1344 sc1
L_ph_q1:
  s_waitcnt vmcnt(26)
  s_barrier
  ds_read_b128 v[224:227], v1 offset:20480
  ds_read_b128 v[228:231], v1 offset:21504
  ds_read_b128 v[232:235], v1 offset:22528
  ds_read_b128 v[236:239], v1 offset:23552
  ds_read_b128 v[240:243], v1 offset:24576
  ds_read_b128 v[244:247], v1 offset:25600
  ds_read_b128 v[248:251], v1 offset:26624
  ds_read_b128 v[252:255], v1 offset:27648
  ds_read_b128 v[196:199], v1 offset:28672
  ds_read_b128 v[200:203], v1 offset:29696
  ds_read_b128 v[204:207], v1 offset:30720
  ds_read_b128 v[208:211], v1 offset:31744
  s_waitcnt lgkmcnt(8)
  v_mfma_f32_16x16x32_bf16 v[164:167], v[224:227], v[68:71], 0
  ds_read_b128 v[224:227], v1 offset:32768
  v_mfma_f32_16x16x32_bf16 v[168:171], v[228:231], v[68:71], 0
  ds_read_b128 v[228:231], v1 offset:33792
  v_mfma_f32_16x16x32_bf16 v[172:175], v[232:235], v[68:71], 0
  ds_read_b128 v[232:235], v1 offset:34816
  s_add_u32 s100, s101, L_ph_wo1-L_base
  buffer_load_dword v222, v13, s[96:99], s100 offen
  v_mfma_f32_16x16x32_bf16 v[176:179], v[236:239], v[68:71], 0
  ds_read_b128 v[236:239], v1 offset:35840
  buffer_load_dwordx4 v1, s[4:7], s82 offen offset:3072 lds
  s_waitcnt lgkmcnt(8)
  v_mfma_f32_16x16x32_bf16 v[180:183], v[240:243], v[68:71], 0
  ds_read_b128 v[240:243], v1 offset:36864
  v_mfma_f32_16x16x32_bf16 v[164:167], v[244:247], v[72:75], v[164:167]
  s_add_u32 s82, s82, 4096
  s_add_u32 m0, m0, 4096
  ds_read_b128 v[244:247], v1 offset:37888
  buffer_load_dwordx4 v1, s[4:7], s82 offen offset:0 lds
  v_mfma_f32_16x16x32_bf16 v[168:171], v[248:251], v[72:75], v[168:171]
  ds_read_b128 v[248:251], v1 offset:38912
  s_waitcnt vmcnt(24)
  s_barrier
  v_mfma_f32_16x16x32_bf16 v[172:175], v[252:255], v[72:75], v[172:175]
  s_add_u32 s82, s75, 393216
  s_add_u32 m0, s43, 61440
  ds_read_b128 v[252:255], v1 offset:39936
  buffer_load_dwordx4 v1, s[4:7], s82 offen offset:0 lds
  s_waitcnt lgkmcnt(8)
  v_mfma_f32_16x16x32_bf16 v[176:179], v[196:199], v[72:75], v[176:179]
  ds_read_b128 v[196:199], v2 offset:19200
  v_mfma_f32_16x16x32_bf16 v[180:183], v[200:203], v[72:75], v[180:183]
  ds_read_b128 v[200:203], v2 offset:20224
  buffer_load_dwordx4 v1, s[4:7], s82 offen offset:1024 lds
  v_mfma_f32_16x16x32_bf16 v[164:167], v[204:207], v[76:79], v[164:167]
  ds_read_b128 v[204:207], v2 offset:21248
  v_mfma_f32_16x16x32_bf16 v[168:171], v[208:211], v[76:79], v[168:171]
  ds_read_b128 v[208:211], v2 offset:22272
  s_waitcnt lgkmcnt(8)
  v_mfma_f32_16x16x32_bf16 v[172:175], v[224:227], v[76:79], v[172:175]
  ds_read_b128 v[224:227], v2 offset:23296
  v_mfma_f32_16x16x32_bf16 v[176:179], v[228:231], v[76:79], v[176:179]
  ds_read_b128 v[228:231], v2 offset:24320
  buffer_load_dwordx4 v1, s[4:7], s82 offen offset:2048 lds
  v_mfma_f32_16x16x32_bf16 v[180:183], v[232:235], v[76:79], v[180:183]
  ds_read_b128 v[232:235], v2 offset:25344
  v_mfma_f32_16x16x32_bf16 v[164:167], v[236:239], v[80:83], v[164:167]
  ds_read_b128 v[236:239], v2 offset:26368
  s_waitcnt lgkmcnt(8)
  v_mfma_f32_16x16x32_bf16 v[168:171], v[240:243], v[80:83], v[168:171]
  ds_read_b128 v[240:243], v2 offset:27392
  buffer_load_dwordx4 v1, s[4:7], s82 offen offset:3072 lds
  v_mfma_f32_16x16x32_bf16 v[172:175], v[244:247], v[80:83], v[172:175]
  ds_read_b128 v[244:247], v2 offset:28416
  v_mfma_f32_16x16x32_bf16 v[176:179], v[248:251], v[80:83], v[176:179]
  ds_read_b128 v[248:251], v2 offset:29440
  v_mfma_f32_16x16x32_bf16 v[180:183], v[252:255], v[80:83], v[180:183]
  ds_read_b128 v[252:255], v2 offset:30464
  s_waitcnt lgkmcnt(8)
  v_mfma_f32_16x16x32_bf16 v[164:167], v[196:199], v[84:87], v[164:167]
  s_add_u32 s82, s82, 4096
  s_add_u32 m0, m0, 4096
  ds_read_b128 v[196:199], v2 offset:31488
  buffer_load_dwordx4 v1, s[4:7], s82 offen offset:0 lds
  v_mfma_f32_16x16x32_bf16 v[168:171], v[200:203], v[84:87], v[168:171]
  ds_read_b128 v[200:203], v2 offset:32512
  v_mfma_f32_16x16x32_bf16 v[172:175], v[204:207], v[84:87], v[172:175]
  ds_read_b128 v[204:207], v2 offset:33536
  v_mfma_f32_16x16x32_bf16 v[176:179], v[208:211], v[84:87], v[176:179]
  ds_read_b128 v[208:211], v2 offset:34560
  s_waitcnt lgkmcnt(8)
  v_mfma_f32_16x16x32_bf16 v[180:183], v[224:227], v[84:87], v[180:183]
  ds_read_b128 v[224:227], v2 offset:35584
  v_mfma_f32_16x16x32_bf16 v[164:167], v[228:231], v[88:91], v[164:167]
  ds_read_b128 v[228:231], v2 offset:36608
  v_mfma_f32_16x16x32_bf16 v[168:171], v[232:235], v[88:91], v[168:171]
  ds_read_b128 v[232:235], v2 offset:37632
  s_waitcnt vmcnt(24)
  s_barrier
  v_mfma_f32_16x16x32_bf16 v[172:175], v[236:239], v[88:91], v[172:175]
  ds_read_b128 v[236:239], v2 offset:38656
  s_waitcnt lgkmcnt(8)
  v_mfma_f32_16x16x32_bf16 v[176:179], v[240:243], v[88:91], v[176:179]
  ds_read_b128 v[240:243], v2 offset:39680
  v_mfma_f32_16x16x32_bf16 v[180:183], v[244:247], v[88:91], v[180:183]
  ds_read_b128 v[244:247], v2 offset:40704
  v_mfma_f32_16x16x32_bf16 v[164:167], v[248:251], v[92:95], v[164:167]
  ds_read_b128 v[248:251], v2 offset:41728
  v_mfma_f32_16x16x32_bf16 v[168:171], v[252:255], v[92:95], v[168:171]
  ds_read_b128 v[252:255], v2 offset:42752
  s_waitcnt lgkmcnt(8)
  v_mfma_f32_16x16x32_bf16 v[172:175], v[196:199], v[92:95], v[172:175]
  ds_read_b128 v[196:199], v2 offset:43776
  v_mfma_f32_16x16x32_bf16 v[176:179], v[200:203], v[92:95], v[176:179]
  ds_read_b128 v[200:203], v2 offset:44800
  v_mfma_f32_16x16x32_bf16 v[180:183], v[204:207], v[92:95], v[180:183]
  ds_read_b128 v[204:207], v2 offset:45824
  v_mfma_f32_16x16x32_bf16 v[164:167], v[208:211], v[96:99], v[164:167]
  ds_read_b128 v[208:211], v2 offset:46848
  s_waitcnt lgkmcnt(8)
  v_mfma_f32_16x16x32_bf16 v[168:171], v[224:227], v[96:99], v[168:171]
  ds_read_b128 v[224:227], v2 offset:47872
  v_mfma_f32_16x16x32_bf16 v[172:175], v[228:231], v[96:99], v[172:175]
  ds_read_b128 v[228:231], v2 offset:48896
  v_mfma_f32_16x16x32_bf16 v[176:179], v[232:235], v[96:99], v[176:179]
  ds_read_b128 v[232:235], v2 offset:49920
  v_mfma_f32_16x16x32_bf16 v[180:183], v[236:239], v[96:99], v[180:183]
  ds_read_b128 v[236:239], v2 offset:50944
  s_waitcnt lgkmcnt(8)
  v_mfma_f32_16x16x32_bf16 v[164:167], v[240:243], v[100:103], v[164:167]
  ds_read_b128 v[240:243], v2 offset:51968
  v_mfma_f32_16x16x32_bf16 v[168:171], v[244:247], v[100:103], v[168:171]
  ds_read_b128 v[244:247], v2 offset:52992
  v_mfma_f32_16x16x32_bf16 v[172:175], v[248:251], v[100:103], v[172:175]
  ds_read_b128 v[248:251], v2 offset:54016
  v_mfma_f32_16x16x32_bf16 v[176:179], v[252:255], v[100:103], v[176:179]
  ds_read_b128 v[252:255], v2 offset:55040
  s_waitcnt lgkmcnt(8)
  v_mfma_f32_16x16x32_bf16 v[180:183], v[196:199], v[100:103], v[180:183]
  ds_read_b128 v[196:199], v2 offset:56064
  s_min_u32 s84, s2, 104
  s_lshl_b32 s84, s84, 6
  s_mul_i32 s85, s41, 217088
  s_add_u32 s85, s85, s84
  s_add_u32 s85, s85, 1048576
  s_add_u32 s86, s85, 108544
  buffer_load_dwordx4 v[184:187], v36, s[4:7], s85 offen sc1
  buffer_load_dwordx4 v[188:191], v36, s[4:7], s86 offen sc1
  s_mul_i32 s87, s41, 6784
  s_add_u32 s84, s84, s87
  s_add_u32 s84, s84, 917504
  s_cmp_gt_u32 s2, 104
  s_cselect_b32 s84, 0x80000000, s84
  s_mov_b32 s87, 0
  v_mfma_f32_16x16x32_bf16 v[164:167], v[200:203], v[104:107], v[164:167]
  ds_read_b128 v[200:203], v2 offset:57088
  v_mfma_f32_16x16x32_bf16 v[168:171], v[204:207], v[104:107], v[168:171]
  ds_read_b128 v[204:207], v2 offset:58112
  s_waitcnt vmcnt(21)
  s_barrier
  v_mfma_f32_16x16x32_bf16 v[172:175], v[208:211], v[104:107], v[172:175]
  s_add_u32 s82, s75, 417792
  s_add_u32 m0, s43, 20480
  ds_read_b128 v[208:211], v2 offset:59136
  buffer_load_dwordx4 v1, s[4:7], s82 offen offset:0 lds
  s_waitcnt lgkmcnt(8)
  v_mfma_f32_16x16x32_bf16 v[176:179], v[224:227], v[104:107], v[176:179]
  ds_read_b128 v[224:227], v2 offset:60160
  v_mfma_f32_16x16x32_bf16 v[180:183], v[228:231], v[104:107], v[180:183]
  ds_read_b128 v[228:231], v2 offset:61184
  buffer_load_dwordx4 v1, s[4:7], s82 offen offset:1024 lds
  v_mfma_f32_16x16x32_bf16 v[164:167], v[232:235], v[108:111], v[164:167]
  ds_read_b128 v[232:235], v2 offset:62208
  v_mfma_f32_16x16x32_bf16 v[168:171], v[236:239], v[108:111], v[168:171]
  ds_read_b128 v[236:239], v2 offset:63232
  s_waitcnt lgkmcnt(8)
  v_mfma_f32_16x16x32_bf16 v[172:175], v[240:243], v[108:111], v[172:175]
  ds_read_b128 v[240:243], v2 offset:64256
  v_mfma_f32_16x16x32_bf16 v[176:179], v[244:247], v[108:111], v[176:179]
  ds_read_b128 v[244:247], v2 offset:65280
  v_mfma_f32_16x16x32_bf16 v[180:183], v[248:251], v[108:111], v[180:183]
  ds_read_b128 v[248:251], v3 offset:768
  buffer_load_dwordx4 v1, s[4:7], s82 offen offset:2048 lds
  v_mfma_f32_16x16x32_bf16 v[164:167], v[252:255], v[112:115], v[164:167]
  ds_read_b128 v[252:255], v3 offset:1792
  s_waitcnt lgkmcnt(8)
  v_mfma_f32_16x16x32_bf16 v[168:171], v[196:199], v[112:115], v[168:171]
  ds_read_b128 v[196:199], v3 offset:2816
  v_mfma_f32_16x16x32_bf16 v[172:175], v[200:203], v[112:115], v[172:175]
  ds_read_b128 v[200:203], v3 offset:3840
  v_mfma_f32_16x16x32_bf16 v[176:179], v[204:207], v[112:115], v[176:179]
  ds_read_b128 v[204:207], v3 offset:4864
  buffer_load_dwordx4 v1, s[4:7], s82 offen offset:3072 lds
  v_mfma_f32_16x16x32_bf16 v[180:183], v[208:211], v[112:115], v[180:183]
  ds_read_b128 v[208:211], v3 offset:5888
  s_waitcnt lgkmcnt(8)
  v_mfma_f32_16x16x32_bf16 v[164:167], v[224:227], v[116:119], v[164:167]
  ds_read_b128 v[224:227], v3 offset:6912
  v_mfma_f32_16x16x32_bf16 v[168:171], v[228:231], v[116:119], v[168:171]
  ds_read_b128 v[228:231], v3 offset:7936
  v_mfma_f32_16x16x32_bf16 v[172:175], v[232:235], v[116:119], v[172:175]
  ds_read_b128 v[232:235], v3 offset:8960
  v_mfma_f32_16x16x32_bf16 v[176:179], v[236:239], v[116:119], v[176:179]
  s_add_u32 s82, s82, 4096
  s_add_u32 m0, m0, 4096
  ds_read_b128 v[236:239], v3 offset:9984
  buffer_load_dwordx4 v1, s[4:7], s82 offen offset:0 lds
  s_waitcnt lgkmcnt(8)
  v_mfma_f32_16x16x32_bf16 v[180:183], v[240:243], v[116:119], v[180:183]
  ds_read_b128 v[240:243], v3 offset:11008
  v_mfma_f32_16x16x32_bf16 v[164:167], v[244:247], v[120:123], v[164:167]
  ds_read_b128 v[244:247], v3 offset:12032
  v_mfma_f32_16x16x32_bf16 v[168:171], v[248:251], v[120:123], v[168:171]
  ds_read_b128 v[248:251], v3 offset:13056
  s_waitcnt vmcnt(21)
  s_barrier
  v_mfma_f32_16x16x32_bf16 v[172:175], v[252:255], v[120:123], v[172:175]
  s_add_u32 s82, s75, 442368
  s_add_u32 m0, s43, 81920
  ds_read_b128 v[252:255], v3 offset:14080
  buffer_load_dwordx4 v1, s[4:7], s82 offen offset:0 lds
  s_waitcnt lgkmcnt(8)
  v_mfma_f32_16x16x32_bf16 v[176:179], v[196:199], v[120:123], v[176:179]
  ds_read_b128 v[196:199], v1 offset:40960
  v_mfma_f32_16x16x32_bf16 v[180:183], v[200:203], v[120:123], v[180:183]
  ds_read_b128 v[200:203], v1 offset:41984
  buffer_load_dwordx4 v1, s[4:7], s82 offen offset:1024 lds
  v_mfma_f32_16x16x32_bf16 v[164:167], v[204:207], v[124:127], v[164:167]
  ds_read_b128 v[204:207], v1 offset:43008
  v_mfma_f32_16x16x32_bf16 v[168:171], v[208:211], v[124:127], v[168:171]
  ds_read_b128 v[208:211], v1 offset:44032
  s_waitcnt lgkmcnt(8)
  v_mfma_f32_16x16x32_bf16 v[172:175], v[224:227], v[124:127], v[172:175]
  ds_read_b128 v[224:227], v1 offset:45056
  v_mfma_f32_16x16x32_bf16 v[176:179], v[228:231], v[124:127], v[176:179]
  ds_read_b128 v[228:231], v1 offset:46080
  v_mfma_f32_16x16x32_bf16 v[180:183], v[232:235], v[124:127], v[180:183]
  ds_read_b128 v[232:235], v1 offset:47104
  v_mfma_f32_16x16x32_bf16 v[164:167], v[236:239], v[128:131], v[164:167]
  ds_read_b128 v[236:239], v1 offset:48128
  s_waitcnt lgkmcnt(8)
  v_mfma_f32_16x16x32_bf16 v[168:171], v[240:243], v[128:131], v[168:171]
  ds_read_b128 v[240:243], v1 offset:49152
  v_mfma_f32_16x16x32_bf16 v[172:175], v[244:247], v[128:131], v[172:175]
  ds_read_b128 v[244:247], v1 offset:50176
  v_mfma_f32_16x16x32_bf16 v[176:179], v[248:251], v[128:131], v[176:179]
  ds_read_b128 v[248:251], v1 offset:51200
  v_mfma_f32_16x16x32_bf16 v[180:183], v[252:255], v[128:131], v[180:183]
  ds_read_b128 v[252:255], v1 offset:52224
  s_waitcnt lgkmcnt(8)
  v_mfma_f32_16x16x32_bf16 v[164:167], v[196:199], v[132:135], v[164:167]
  ds_read_b128 v[196:199], v1 offset:53248
  v_mfma_f32_16x16x32_bf16 v[168:171], v[200:203], v[132:135], v[168:171]
  ds_read_b128 v[200:203], v1 offset:54272
  v_mfma_f32_16x16x32_bf16 v[172:175], v[204:207], v[132:135], v[172:175]
  ds_read_b128 v[204:207], v1 offset:55296
  v_mfma_f32_16x16x32_bf16 v[176:179], v[208:211], v[132:135], v[176:179]
  ds_read_b128 v[208:211], v1 offset:56320
  buffer_load_dwordx4 v1, s[4:7], s82 offen offset:2048 lds
  s_waitcnt lgkmcnt(8)
  v_mfma_f32_16x16x32_bf16 v[180:183], v[224:227], v[132:135], v[180:183]
  ds_read_b128 v[224:227], v1 offset:57344
  v_mfma_f32_16x16x32_bf16 v[164:167], v[228:231], v[136:139], v[164:167]
  ds_read_b128 v[228:231], v1 offset:58368
  buffer_load_dwordx4 v1, s[4:7], s82 offen offset:3072 lds
  v_mfma_f32_16x16x32_bf16 v[168:171], v[232:235], v[136:139], v[168:171]
  ds_read_b128 v[232:235], v1 offset:59392
  s_barrier
  v_mfma_f32_16x16x32_bf16 v[172:175], v[236:239], v[136:139], v[172:175]
  ds_read_b128 v[236:239], v1 offset:60416
  s_waitcnt lgkmcnt(8)
  v_mfma_f32_16x16x32_bf16 v[176:179], v[240:243], v[136:139], v[176:179]
  v_mfma_f32_16x16x32_bf16 v[180:183], v[244:247], v[136:139], v[180:183]
  v_mfma_f32_16x16x32_bf16 v[164:167], v[248:251], v[140:143], v[164:167]
  v_mfma_f32_16x16x32_bf16 v[168:171], v[252:255], v[140:143], v[168:171]
  s_waitcnt lgkmcnt(4)
  v_mfma_f32_16x16x32_bf16 v[172:175], v[196:199], v[140:143], v[172:175]
  v_mfma_f32_16x16x32_bf16 v[176:179], v[200:203], v[140:143], v[176:179]
  v_mfma_f32_16x16x32_bf16 v[180:183], v[204:207], v[140:143], v[180:183]
  v_mfma_f32_16x16x32_bf16 v[164:167], v[208:211], v[144:147], v[164:167]
  s_cmp_eq_u32 s87, 1
  s_cbranch_scc1 L_skip59
  s_waitcnt vmcnt(10)
  v_perm_b32 v192, v185, v184, s56
  v_perm_b32 v193, v187, v186, s57
  v_or_b32 v192, v192, v193
  v_cmp_ne_u32 s[94:95], s44, v192
  s_waitcnt vmcnt(9)
  v_perm_b32 v194, v189, v188, s56
  v_perm_b32 v195, v191, v190, s57
  v_or_b32 v194, v194, v195
  v_cmp_ne_u32 vcc, s44, v194
  s_nop 0
  s_or_b64 vcc, vcc, s[94:95]
  s_cbranch_vccnz L_again60
  v_and_b32 v184, 0xffffff00, v184
  v_and_b32 v185, 0xffffff00, v185
  v_and_b32 v186, 0xffffff00, v186
  v_and_b32 v187, 0xffffff00, v187
  v_and_b32 v188, 0xffffff00, v188
  v_and_b32 v189, 0xffffff00, v189
  v_and_b32 v190, 0xffffff00, v190
  v_and_b32 v191, 0xffffff00, v191
  v_pk_add_f32 v[184:185], v[184:185], v[188:189]
  v_pk_add_f32 v[186:187], v[186:187], v[190:191]
  s_nop 0
  v_add_f32_dpp v184, v184, v184 row_ror:8 row_mask:0xf bank_mask:0xf
  v_add_f32_dpp v185, v185, v185 row_ror:8 row_mask:0xf bank_mask:0xf
  v_add_f32_dpp v186, v186, v186 row_ror:8 row_mask:0xf bank_mask:0xf
  v_add_f32_dpp v187, v187, v187 row_ror:8 row_mask:0xf bank_mask:0xf
  v_add_f32_dpp v184, v184, v184 row_ror:4 row_mask:0xf bank_mask:0xf
  v_add_f32_dpp v185, v185, v185 row_ror:4 row_mask:0xf bank_mask:0xf
  v_add_f32_dpp v186, v186, v186 row_ror:4 row_mask:0xf bank_mask:0xf
  v_add_f32_dpp v187, v187, v187 row_ror:4 row_mask:0xf bank_mask:0xf
  v_pk_mov_b32 v[188:189], v[184:185], v[184:185] op_sel:[0,1]
  v_pk_mov_b32 v[190:191], v[186:187], v[186:187] op_sel:[0,1]
  s_nop 0
  v_permlane32_swap_b32 v184, v188
  v_permlane32_swap_b32 v185, v189
  v_permlane32_swap_b32 v186, v190
  v_permlane32_swap_b32 v187, v191
  v_pk_add_f32 v[184:185], v[184:185], v[188:189]
  v_pk_add_f32 v[186:187], v[186:187], v[190:191]
  v_pk_mov_b32 v[188:189], v[184:185], v[184:185] op_sel:[0,1]
  v_pk_mov_b32 v[190:191], v[186:187], v[186:187] op_sel:[0,1]
  s_nop 0
  v_permlane16_swap_b32 v184, v188
  v_permlane16_swap_b32 v185, v189
  v_permlane16_swap_b32 v186, v190
  v_permlane16_swap_b32 v187, v191
  v_pk_add_f32 v[184:185], v[184:185], v[188:189]
  v_pk_add_f32 v[186:187], v[186:187], v[190:191]
  v_bfi_b32 v184, v15, s44, v184
  v_bfi_b32 v185, v15, s45, v185
  v_bfi_b32 v186, v15, s46, v186
  v_bfi_b32 v187, v15, s47, v187
  buffer_store_dwordx4 v[184:187], v37, s[4:7], s84 offen sc1
  s_mov_b32 s87, 1
  s_branch L_skip59
L_again60:
  buffer_load_dwordx4 v[184:187], v36, s[4:7], s85 offen sc1
  buffer_load_dwordx4 v[188:191], v36, s[4:7], s86 offen sc1
L_skip59:
  s_nop 1
  s_waitcnt lgkmcnt(0)
  s_add_u32 s82, s82, 4096
  s_add_u32 m0, m0, 4096
  v_mfma_f32_16x16x32_bf16 v[168:171], v[224:227], v[144:147], v[168:171]
  buffer_load_dwordx4 v1, s[4:7], s82 offen offset:0 lds
  v_mfma_f32_16x16x32_bf16 v[172:175], v[228:231], v[144:147], v[172:175]
  v_mfma_f32_16x16x32_bf16 v[176:179], v[232:235], v[144:147], v[176:179]
  s_add_u32 s82, s75, 466944
  s_add_u32 m0, s43, 102400
  v_mfma_f32_16x16x32_bf16 v[180:183], v[236:239], v[144:147], v[180:183]
  buffer_load_dwordx4 v1, s[4:7], s82 offen offset:0 lds
  s_barrier
  s_cmp_eq_u32 s87, 1
  s_cbranch_scc1 L_skip61
  s_waitcnt vmcnt(2)
  v_perm_b32 v192, v185, v184, s56
  v_perm_b32 v193, v187, v186, s57
  v_or_b32 v192, v192, v193
  v_cmp_ne_u32 s[94:95], s44, v192
  s_waitcnt vmcnt(2)
  v_perm_b32 v194, v189, v188, s56
  v_perm_b32 v195, v191, v190, s57
  v_or_b32 v194, v194, v195
  v_cmp_ne_u32 vcc, s44, v194
  s_nop 0
  s_or_b64 vcc, vcc, s[94:95]
  s_cbranch_vccnz L_again62
  v_and_b32 v184, 0xffffff00, v184
  v_and_b32 v185, 0xffffff00, v185
  v_and_b32 v186, 0xffffff00, v186
  v_and_b32 v187, 0xffffff00, v187
  v_and_b32 v188, 0xffffff00, v188
  v_and_b32 v189, 0xffffff00, v189
  v_and_b32 v190, 0xffffff00, v190
  v_and_b32 v191, 0xffffff00, v191
  v_pk_add_f32 v[184:185], v[184:185], v[188:189]
  v_pk_add_f32 v[186:187], v[186:187], v[190:191]
  s_nop 0
  v_add_f32_dpp v184, v184, v184 row_ror:8 row_mask:0xf bank_mask:0xf
  v_add_f32_dpp v185, v185, v185 row_ror:8 row_mask:0xf bank_mask:0xf
  v_add_f32_dpp v186, v186, v186 row_ror:8 row_mask:0xf bank_mask:0xf
  v_add_f32_dpp v187, v187, v187 row_ror:8 row_mask:0xf bank_mask:0xf
  v_add_f32_dpp v184, v184, v184 row_ror:4 row_mask:0xf bank_mask:0xf
  v_add_f32_dpp v185, v185, v185 row_ror:4 row_mask:0xf bank_mask:0xf
  v_add_f32_dpp v186, v186, v186 row_ror:4 row_mask:0xf bank_mask:0xf
  v_add_f32_dpp v187, v187, v187 row_ror:4 row_mask:0xf bank_mask:0xf
  v_pk_mov_b32 v[188:189], v[184:185], v[184:185] op_sel:[0,1]
  v_pk_mov_b32 v[190:191], v[186:187], v[186:187] op_sel:[0,1]
  s_nop 0
  v_permlane32_swap_b32 v184, v188
  v_permlane32_swap_b32 v185, v189
  v_permlane32_swap_b32 v186, v190
  v_permlane32_swap_b32 v187, v191
  v_pk_add_f32 v[184:185], v[184:185], v[188:189]
  v_pk_add_f32 v[186:187], v[186:187], v[190:191]
  v_pk_mov_b32 v[188:189], v[184:185], v[184:185] op_sel:[0,1]
  v_pk_mov_b32 v[190:191], v[186:187], v[186:187] op_sel:[0,1]
  s_nop 0
  v_permlane16_swap_b32 v184, v188
  v_permlane16_swap_b32 v185, v189
  v_permlane16_swap_b32 v186, v190
  v_permlane16_swap_b32 v187, v191
  v_pk_add_f32 v[184:185], v[184:185], v[188:189]
  v_pk_add_f32 v[186:187], v[186:187], v[190:191]
  v_bfi_b32 v184, v15, s44, v184
  v_bfi_b32 v185, v15, s45, v185
  v_bfi_b32 v186, v15, s46, v186
  v_bfi_b32 v187, v15, s47, v187
  buffer_store_dwordx4 v[184:187], v37, s[4:7], s84 offen sc1
  s_mov_b32 s87, 1
  s_branch L_skip61
L_again62:
  buffer_load_dwordx4 v[184:187], v36, s[4:7], s85 offen sc1
  buffer_load_dwordx4 v[188:191], v36, s[4:7], s86 offen sc1
L_skip61:
  s_nop 1
  s_mul_i32 s0, s40, 1680
  s_mul_i32 s1, s41, 6784
  s_add_u32 s0, s0, s1
  s_add_u32 s90, s0, 917504
  v_mov_b32 v212, 0x358637bd
  s_mul_i32 s100, s41, 2560
  s_add_u32 s100, s100, s53
  buffer_load_dword v222, v43, s[4:7], s100 offen sc1
  v_mov_b32 v213, 0x3fb8aa3b
  ds_read_b128 v[224:227], v28 offset:768
  ds_read_b128 v[228:231], v28 offset:832
  ds_read_b128 v[232:235], v28 offset:896
  ds_read_b128 v[236:239], v28 offset:960
  ds_read_b128 v[240:243], v28 offset:1024
  s_waitcnt lgkmcnt(4)
  v_pk_fma_f32 v[224:225], v[224:225], v[156:157], v[212:213] op_sel:[0,1,0] op_sel_hi:[1,1,0]
  v_pk_fma_f32 v[226:227], v[226:227], v[156:157], v[212:213] op_sel:[0,1,0] op_sel_hi:[1,1,0]
  v_pk_fma_f32 v[164:165], v[164:165], v[156:157], v[224:225] op_sel_hi:[1,0,1]
  v_pk_fma_f32 v[166:167], v[166:167], v[156:157], v[226:227] op_sel_hi:[1,0,1]
  s_waitcnt lgkmcnt(3)
  v_pk_fma_f32 v[228:229], v[228:229], v[156:157], v[212:213] op_sel:[0,1,0] op_sel_hi:[1,1,0]
  v_pk_fma_f32 v[230:231], v[230:231], v[156:157], v[212:213] op_sel:[0,1,0] op_sel_hi:[1,1,0]
  v_pk_fma_f32 v[168:169], v[168:169], v[156:157], v[228:229] op_sel_hi:[1,0,1]
  v_pk_fma_f32 v[170:171], v[170:171], v[156:157], v[230:231] op_sel_hi:[1,0,1]
  s_waitcnt lgkmcnt(2)
  v_pk_fma_f32 v[232:233], v[232:233], v[156:157], v[212:213] op_sel:[0,1,0] op_sel_hi:[1,1,0]
  v_pk_fma_f32 v[234:235], v[234:235], v[156:157], v[212:213] op_sel:[0,1,0] op_sel_hi:[1,1,0]
  v_pk_fma_f32 v[172:173], v[172:173], v[156:157], v[232:233] op_sel_hi:[1,0,1]
  v_pk_fma_f32 v[174:175], v[174:175], v[156:157], v[234:235] op_sel_hi:[1,0,1]
  s_waitcnt lgkmcnt(1)
  v_pk_fma_f32 v[236:237], v[236:237], v[156:157], v[212:213] op_sel:[0,1,0] op_sel_hi:[1,1,0]
  v_pk_fma_f32 v[238:239], v[238:239], v[156:157], v[212:213] op_sel:[0,1,0] op_sel_hi:[1,1,0]
  buffer_load_dwordx4 v1, s[4:7], s82 offen offset:1024 lds
  v_pk_fma_f32 v[176:177], v[176:177], v[156:157], v[236:237] op_sel_hi:[1,0,1]
  v_pk_fma_f32 v[178:179], v[178:179], v[156:157], v[238:239] op_sel_hi:[1,0,1]
  s_waitcnt lgkmcnt(0)
  v_pk_fma_f32 v[240:241], v[240:241], v[156:157], v[212:213] op_sel:[0,1,0] op_sel_hi:[1,1,0]
  v_pk_fma_f32 v[242:243], v[242:243], v[156:157], v[212:213] op_sel:[0,1,0] op_sel_hi:[1,1,0]
  v_pk_fma_f32 v[180:181], v[180:181], v[156:157], v[240:241] op_sel_hi:[1,0,1]
  v_pk_fma_f32 v[182:183], v[182:183], v[156:157], v[242:243] op_sel_hi:[1,0,1]
  v_pk_mul_f32 v[224:225], v[164:165], v[212:213] op_sel:[0,1] op_sel_hi:[1,1]
  v_pk_mul_f32 v[226:227], v[166:167], v[212:213] op_sel:[0,1] op_sel_hi:[1,1]
  v_exp_f32 v224, v224 clamp
  v_exp_f32 v225, v225 clamp
  v_exp_f32 v226, v226 clamp
  v_exp_f32 v227, v227 clamp
  buffer_load_dwordx4 v1, s[4:7], s82 offen offset:2048 lds
  v_max_f32 v164, v212, v164
  v_max_f32 v165, v212, v165
  v_max_f32 v166, v212, v166
  v_max_f32 v167, v212, v167
  v_pk_add_f32 v[164:165], v[164:165], v[224:225]
  v_pk_add_f32 v[166:167], v[166:167], v[226:227]
  v_pk_mul_f32 v[228:229], v[168:169], v[212:213] op_sel:[0,1] op_sel_hi:[1,1]
  v_pk_mul_f32 v[230:231], v[170:171], v[212:213] op_sel:[0,1] op_sel_hi:[1,1]
  v_exp_f32 v228, v228 clamp
  v_exp_f32 v229, v229 clamp
  v_exp_f32 v230, v230 clamp
  v_exp_f32 v231, v231 clamp
  v_max_f32 v168, v212, v168
  buffer_load_dwordx4 v1, s[4:7], s82 offen offset:3072 lds
  v_max_f32 v169, v212, v169
  v_max_f32 v170, v212, v170
  v_max_f32 v171, v212, v171
  v_pk_add_f32 v[168:169], v[168:169], v[228:229]
  v_pk_add_f32 v[170:171], v[170:171], v[230:231]
  v_pk_mul_f32 v[224:225], v[172:173], v[212:213] op_sel:[0,1] op_sel_hi:[1,1]
  v_pk_mul_f32 v[226:227], v[174:175], v[212:213] op_sel:[0,1] op_sel_hi:[1,1]
  v_exp_f32 v224, v224 clamp
  v_exp_f32 v225, v225 clamp
  v_exp_f32 v226, v226 clamp
  v_exp_f32 v227, v227 clamp
  v_max_f32 v172, v212, v172
  v_max_f32 v173, v212, v173
  s_add_u32 s82, s82, 4096
  s_add_u32 m0, m0, 4096
  s_nop 0
  buffer_load_dwordx4 v1, s[4:7], s82 offen offset:0 lds
  v_max_f32 v174, v212, v174
  v_max_f32 v175, v212, v175
  v_pk_add_f32 v[172:173], v[172:173], v[224:225]
  v_pk_add_f32 v[174:175], v[174:175], v[226:227]
  v_pk_mul_f32 v[228:229], v[176:177], v[212:213] op_sel:[0,1] op_sel_hi:[1,1]
  v_pk_mul_f32 v[230:231], v[178:179], v[212:213] op_sel:[0,1] op_sel_hi:[1,1]
  v_exp_f32 v228, v228 clamp
  v_exp_f32 v229, v229 clamp
  v_exp_f32 v230, v230 clamp
  v_exp_f32 v231, v231 clamp
  s_add_u32 s82, s75, 491520
  s_add_u32 m0, s52, 122880
  s_nop 0
  buffer_load_dwordx4 v1, s[4:7], s82 offen offset:0 lds
  v_max_f32 v176, v212, v176
  v_max_f32 v177, v212, v177
  v_max_f32 v178, v212, v178
  v_max_f32 v179, v212, v179
  v_pk_add_f32 v[176:177], v[176:177], v[228:229]
  v_pk_add_f32 v[178:179], v[178:179], v[230:231]
  v_pk_mul_f32 v[224:225], v[180:181], v[212:213] op_sel:[0,1] op_sel_hi:[1,1]
  v_pk_mul_f32 v[226:227], v[182:183], v[212:213] op_sel:[0,1] op_sel_hi:[1,1]
  v_exp_f32 v224, v224 clamp
  v_exp_f32 v225, v225 clamp
  buffer_load_dwordx4 v1, s[4:7], s82 offen offset:1024 lds
  v_exp_f32 v226, v226 clamp
  v_exp_f32 v227, v227 clamp
  v_max_f32 v180, v212, v180
  v_max_f32 v181, v212, v181
  v_max_f32 v182, v212, v182
  v_max_f32 v183, v212, v183
  v_pk_add_f32 v[180:181], v[180:181], v[224:225]
  v_pk_add_f32 v[182:183], v[182:183], v[226:227]
  v_cvt_pk_bf16_f32 v196, v164, v165
  v_cvt_pk_bf16_f32 v197, v166, v167
  v_cvt_pk_bf16_f32 v198, v168, v169
  v_cvt_pk_bf16_f32 v199, v170, v171
  v_cvt_pk_bf16_f32 v200, v172, v173
  buffer_load_dwordx4 v1, s[4:7], s82 offen offset:2048 lds
  v_cvt_pk_bf16_f32 v201, v174, v175
  v_cvt_pk_bf16_f32 v202, v176, v177
  v_cvt_pk_bf16_f32 v203, v178, v179
  v_cvt_pk_bf16_f32 v204, v180, v181
  v_cvt_pk_bf16_f32 v205, v182, v183
  s_cmp_eq_u32 s87, 1
  s_cbranch_scc1 L_skip63
  s_waitcnt vmcnt(8)
  v_perm_b32 v192, v185, v184, s56
  v_perm_b32 v193, v187, v186, s57
  v_or_b32 v192, v192, v193
  v_cmp_ne_u32 s[94:95], s44, v192
  s_waitcnt vmcnt(8)
  v_perm_b32 v194, v189, v188, s56
  v_perm_b32 v195, v191, v190, s57
  v_or_b32 v194, v194, v195
  v_cmp_ne_u32 vcc, s44, v194
  s_nop 0
  s_or_b64 vcc, vcc, s[94:95]
  s_cbranch_vccnz L_spin65
L_back66:
  v_and_b32 v184, 0xffffff00, v184
  v_and_b32 v185, 0xffffff00, v185
  v_and_b32 v186, 0xffffff00, v186
  v_and_b32 v187, 0xffffff00, v187
  v_and_b32 v188, 0xffffff00, v188
  v_and_b32 v189, 0xffffff00, v189
  v_and_b32 v190, 0xffffff00, v190
  v_and_b32 v191, 0xffffff00, v191
  v_pk_add_f32 v[184:185], v[184:185], v[188:189]
  v_pk_add_f32 v[186:187], v[186:187], v[190:191]
  s_nop 0
  v_add_f32_dpp v184, v184, v184 row_ror:8 row_mask:0xf bank_mask:0xf
  v_add_f32_dpp v185, v185, v185 row_ror:8 row_mask:0xf bank_mask:0xf
  v_add_f32_dpp v186, v186, v186 row_ror:8 row_mask:0xf bank_mask:0xf
  v_add_f32_dpp v187, v187, v187 row_ror:8 row_mask:0xf bank_mask:0xf
  v_add_f32_dpp v184, v184, v184 row_ror:4 row_mask:0xf bank_mask:0xf
  v_add_f32_dpp v185, v185, v185 row_ror:4 row_mask:0xf bank_mask:0xf
  v_add_f32_dpp v186, v186, v186 row_ror:4 row_mask:0xf bank_mask:0xf
  v_add_f32_dpp v187, v187, v187 row_ror:4 row_mask:0xf bank_mask:0xf
  v_pk_mov_b32 v[188:189], v[184:185], v[184:185] op_sel:[0,1]
  v_pk_mov_b32 v[190:191], v[186:187], v[186:187] op_sel:[0,1]
  s_nop 0
  v_permlane32_swap_b32 v184, v188
  v_permlane32_swap_b32 v185, v189
  v_permlane32_swap_b32 v186, v190
  v_permlane32_swap_b32 v187, v191
  v_pk_add_f32 v[184:185], v[184:185], v[188:189]
  v_pk_add_f32 v[186:187], v[186:187], v[190:191]
  v_pk_mov_b32 v[188:189], v[184:185], v[184:185] op_sel:[0,1]
  v_pk_mov_b32 v[190:191], v[186:187], v[186:187] op_sel:[0,1]
  s_nop 0
  v_permlane16_swap_b32 v184, v188
  v_permlane16_swap_b32 v185, v189
  v_permlane16_swap_b32 v186, v190
  v_permlane16_swap_b32 v187, v191
  v_pk_add_f32 v[184:185], v[184:185], v[188:189]
  v_pk_add_f32 v[186:187], v[186:187], v[190:191]
  v_bfi_b32 v184, v15, s44, v184
  v_bfi_b32 v185, v15, s45, v185
  v_bfi_b32 v186, v15, s46, v186
  v_bfi_b32 v187, v15, s47, v187
  buffer_store_dwordx4 v[184:187], v37, s[4:7], s84 offen sc1
  s_mov_b32 s87, 1
L_skip63:
  s_nop 1
  s_mov_b32 s88, 0
L_poll68:
  buffer_load_dwordx4 v[124:127], v1, s[4:7], s90 offen sc1
  buffer_load_dwordx4 v[128:131], v1, s[4:7], s90 offen offset:1024 sc1
  s_add_u32 s88, s88, 1
  s_cmp_gt_u32 s88, 65536
  s_cbranch_scc1 L_abort
  s_waitcnt vmcnt(0)
  v_perm_b32 v132, v129, v128, s56
  v_perm_b32 v133, v131, v130, s57
  v_or_b32 v132, v132, v133
  v_cmp_ne_u32 s[94:95], s44, v132
  v_perm_b32 v134, v125, v124, s56
  v_perm_b32 v135, v127, v126, s57
  v_or_b32 v134, v134, v135
  v_cmp_ne_u32 vcc, s44, v134
  s_and_b64 s[94:95], s[94:95], s[72:73]
  s_or_b64 vcc, vcc, s[94:95]
  s_cbranch_vccnz L_poll68
  v_and_b32 v124, 0xffffff00, v124
  buffer_load_dwordx4 v1, s[4:7], s82 offen offset:3072 lds
  v_and_b32 v125, 0xffffff00, v125
  v_and_b32 v126, 0xffffff00, v126
  v_and_b32 v127, 0xffffff00, v127
  v_and_b32 v128, 0xffffff00, v128
  v_and_b32 v129, 0xffffff00, v129
  v_and_b32 v130, 0xffffff00, v130
  v_and_b32 v131, 0xffffff00, v131
  v_cvt_pk_bf16_f32 v124, v124, v125
  s_add_u32 s82, s82, 4096
  s_add_u32 m0, m0, 4096
  s_nop 0
  buffer_load_dwordx4 v1, s[4:7], s82 offen offset:0 lds
  v_cvt_pk_bf16_f32 v125, v126, v127
  ds_write_b64 v18, v[124:125]
  v_cvt_pk_bf16_f32 v128, v128, v129
  v_cvt_pk_bf16_f32 v129, v130, v131
  ds_write_b64 v19, v[128:129]
  s_waitcnt lgkmcnt(0)
  s_barrier
  ds_read_b64 v[68:69], v17 offset:0
  ds_read_b64 v[70:71], v17 offset:128
  ds_read_b64 v[72:73], v17 offset:256
  ds_read_b64 v[74:75], v17 offset:384
  ds_read_b64 v[76:77], v17 offset:512
  ds_read_b64 v[78:79], v16 offset:128
  ds_read_b64 v[80:81], v16 offset:1536
  ds_read_b64 v[82:83], v16 offset:256
  ds_read_b64 v[84:85], v16 offset:1664
  ds_read_b64 v[86:87], v16 offset:3072
  ds_read_b64 v[88:89], v16 offset:1792
  ds_read_b64 v[90:91], v16 offset:3200
  ds_read_b64 v[92:93], v16 offset:4608
  ds_read_b64 v[94:95], v16 offset:3328
  ds_read_b64 v[96:97], v16 offset:4736
  ds_read_b64 v[98:99], v16 offset:6144
  ds_read_b64 v[100:101], v16 offset:4864
  ds_read_b64 v[102:103], v16 offset:6272
  s_waitcnt lgkmcnt(15)
  v_mfma_f32_16x16x16_bf16 v[108:111], v[68:69], v[196:197], 0
  s_waitcnt lgkmcnt(15)
  v_mfma_f32_16x16x16_bf16 v[108:111], v[70:71], v[198:199], v[108:111]
  s_waitcnt lgkmcnt(15)
  v_mfma_f32_16x16x16_bf16 v[108:111], v[72:73], v[200:201], v[108:111]
  s_waitcnt lgkmcnt(14)
  v_mfma_f32_16x16x16_bf16 v[108:111], v[74:75], v[202:203], v[108:111]
  s_waitcnt lgkmcnt(13)
  v_mfma_f32_16x16x16_bf16 v[108:111], v[76:77], v[204:205], v[108:111]
  s_waitcnt lgkmcnt(12)
  v_mfma_f32_16x16x16_bf16 v[164:167], v[78:79], v[196:197], 0
  s_waitcnt lgkmcnt(11)
  v_mfma_f32_16x16x16_bf16 v[164:167], v[80:81], v[198:199], v[164:167]
  s_waitcnt lgkmcnt(10)
  v_mfma_f32_16x16x16_bf16 v[168:171], v[82:83], v[196:197], 0
  s_waitcnt lgkmcnt(9)
  v_mfma_f32_16x16x16_bf16 v[168:171], v[84:85], v[198:199], v[168:171]
  s_waitcnt lgkmcnt(8)
  v_mfma_f32_16x16x16_bf16 v[168:171], v[86:87], v[200:201], v[168:171]
  s_waitcnt lgkmcnt(7)
  v_mfma_f32_16x16x16_bf16 v[172:175], v[88:89], v[198:199], 0
  s_waitcnt lgkmcnt(6)
  v_mfma_f32_16x16x16_bf16 v[172:175], v[90:91], v[200:201], v[172:175]
  s_waitcnt lgkmcnt(5)
  v_mfma_f32_16x16x16_bf16 v[172:175], v[92:93], v[202:203], v[172:175]
  s_waitcnt lgkmcnt(4)
  v_mfma_f32_16x16x16_bf16 v[176:179], v[94:95], v[200:201], 0
  s_waitcnt lgkmcnt(3)
  v_mfma_f32_16x16x16_bf16 v[176:179], v[96:97], v[202:203], v[176:179]
  s_waitcnt lgkmcnt(2)
  v_mfma_f32_16x16x16_bf16 v[176:179], v[98:99], v[204:205], v[176:179]
  s_waitcnt lgkmcnt(1)
  v_mfma_f32_16x16x16_bf16 v[180:183], v[100:101], v[202:203], 0
  s_waitcnt lgkmcnt(0)
  v_mfma_f32_16x16x16_bf16 v[180:183], v[102:103], v[204:205], v[180:183]
  v_add_f32 v108, 0x358637bd, v108
  buffer_load_dwordx4 v1, s[4:7], s82 offen offset:1024 lds
  v_add_f32 v109, 0x358637bd, v109
  v_add_f32 v110, 0x358637bd, v110
  v_add_f32 v111, 0x358637bd, v111
  v_rcp_f32 v108, v108
  v_rcp_f32 v109, v109
  v_rcp_f32 v110, v110
  v_rcp_f32 v111, v111
  v_mov_b32 v112, v108
  v_cndmask_b32 v114, v108, v109, s[66:67]
  v_cndmask_b32 v116, v109, v110, s[68:69]
  v_cndmask_b32 v118, v110, v111, s[70:71]
  v_mov_b32 v120, v111
  v_pk_mul_f32 v[164:165], v[164:165], v[112:113] op_sel_hi:[1,0]
  v_pk_mul_f32 v[166:167], v[166:167], v[112:113] op_sel_hi:[1,0]
  v_pk_mul_f32 v[168:169], v[168:169], v[114:115] op_sel_hi:[1,0]
  v_pk_mul_f32 v[170:171], v[170:171], v[114:115] op_sel_hi:[1,0]
  v_pk_mul_f32 v[172:173], v[172:173], v[116:117] op_sel_hi:[1,0]
  v_pk_mul_f32 v[174:175], v[174:175], v[116:117] op_sel_hi:[1,0]
  v_pk_mul_f32 v[176:177], v[176:177], v[118:119] op_sel_hi:[1,0]
  v_pk_mul_f32 v[178:179], v[178:179], v[118:119] op_sel_hi:[1,0]
  v_pk_mul_f32 v[180:181], v[180:181], v[120:121] op_sel_hi:[1,0]
  v_pk_mul_f32 v[182:183], v[182:183], v[120:121] op_sel_hi:[1,0]
  v_cvt_pk_bf16_f32 v224, v164, v165
  v_cvt_pk_bf16_f32 v225, v166, v167
  v_cvt_pk_bf16_f32 v226, v168, v169
  v_cvt_pk_bf16_f32 v227, v170, v171
  v_cvt_pk_bf16_f32 v228, v172, v173
  v_cvt_pk_bf16_f32 v229, v174, v175
  v_cvt_pk_bf16_f32 v230, v176, v177
  v_cvt_pk_bf16_f32 v231, v178, v179
  v_cvt_pk_bf16_f32 v232, v180, v181
  v_cvt_pk_bf16_f32 v233, v182, v183
  s_cmp_eq_u32 s48, 1
  s_cbranch_scc0 L_slow69
  buffer_store_dwordx4 v[224:227], v1, s[4:7], s12 offen
  buffer_store_dwordx4 v[228:231], v1, s[4:7], s12 offen offset:1024
  buffer_store_dwordx2 v[232:233], v1, s[4:7], s13 offen
L_back70:
  s_waitcnt vmcnt(0)
  s_cmp_eq_u32 s48, 1
  s_cbranch_scc0 L_slow71
  buffer_store_dword v25, v13, s[4:7], s18 offen offset:128
L_back72:
L_ph_wo1:
  s_barrier
  s_add_u32 s86, s53, 0
  s_mov_b32 s88, 0
  buffer_load_dword v223, v14, s[4:7], s55 offen offset:128 sc1
  ds_read_b128 v[224:227], v1 offset:0
  ds_read_b128 v[228:231], v1 offset:1024
  ds_read_b128 v[232:235], v1 offset:2048
  ds_read_b128 v[236:239], v1 offset:3072
  ds_read_b128 v[240:243], v1 offset:4096
  ds_read_b128 v[244:247], v1 offset:5120
  ds_read_b128 v[248:251], v1 offset:6144
  ds_read_b128 v[252:255], v1 offset:7168
  ds_read_b128 v[164:167], v1 offset:8192
  ds_read_b128 v[168:171], v1 offset:9216
  ds_read_b128 v[172:175], v1 offset:10240
  ds_read_b128 v[176:179], v1 offset:11264
L_poll73:
  buffer_load_dword v221, v14, s[4:7], s55 offen offset:128 sc1
  s_waitcnt vmcnt(1)
  v_cmp_ne_u32 vcc, s44, v223
  s_cbranch_vccz L_seen74
  buffer_load_dword v223, v14, s[4:7], s55 offen offset:128 sc1
  s_add_u32 s88, s88, 1
  s_cmp_gt_u32 s88, 65536
  s_cbranch_scc1 L_abort
  s_waitcnt vmcnt(1)
  v_cmp_ne_u32 vcc, s44, v221
  s_cbranch_vccnz L_poll73
L_seen74:
  buffer_load_dwordx4 v[68:71], v1, s[4:7], s86 offen offset:0 sc1
  buffer_load_dwordx4 v[72:75], v1, s[4:7], s86 offen offset:1024 sc1
  buffer_load_dwordx4 v[76:79], v1, s[4:7], s86 offen offset:2048 sc1
  buffer_load_dwordx4 v[80:83], v1, s[4:7], s86 offen offset:3072 sc1
  s_add_u32 s86, s86, 4096
  buffer_load_dwordx4 v[84:87], v1, s[4:7], s86 offen offset:0 sc1
  buffer_load_dwordx4 v[88:91], v1, s[4:7], s86 offen offset:1024 sc1
  buffer_load_dwordx4 v[92:95], v1, s[4:7], s86 offen offset:2048 sc1
  buffer_load_dwordx4 v[96:99], v1, s[4:7], s86 offen offset:3072 sc1
  s_waitcnt vmcnt(7) lgkmcnt(8)
  v_mfma_f32_16x16x32_bf16 v[48:51], v[224:227], v[68:71], v[48:51]
  ds_read_b128 v[224:227], v1 offset:12288
  v_mfma_f32_16x16x32_bf16 v[52:55], v[228:231], v[68:71], v[52:55]
  ds_read_b128 v[228:231], v1 offset:13312
  v_mfma_f32_16x16x32_bf16 v[56:59], v[232:235], v[68:71], v[56:59]
  ds_read_b128 v[232:235], v1 offset:14336
  v_mfma_f32_16x16x32_bf16 v[60:63], v[236:239], v[68:71], v[60:63]
  ds_read_b128 v[236:239], v1 offset:15360
  s_waitcnt lgkmcnt(8)
  v_mfma_f32_16x16x32_bf16 v[64:67], v[240:243], v[68:71], v[64:67]
  ds_read_b128 v[240:243], v1 offset:16384
  s_waitcnt vmcnt(6)
  v_mfma_f32_16x16x32_bf16 v[48:51], v[244:247], v[72:75], v[48:51]
  ds_read_b128 v[244:247], v1 offset:17408
  s_add_u32 s86, s86, 4096
  buffer_load_dwordx4 v[100:103], v1, s[4:7], s86 offen offset:0 sc1
  v_mfma_f32_16x16x32_bf16 v[52:55], v[248:251], v[72:75], v[52:55]
  ds_read_b128 v[248:251], v1 offset:18432
  s_barrier
  v_mfma_f32_16x16x32_bf16 v[56:59], v[252:255], v[72:75], v[56:59]
  ds_read_b128 v[252:255], v1 offset:19456
  buffer_load_dwordx4 v[104:107], v1, s[4:7], s86 offen offset:1024 sc1
  s_waitcnt lgkmcnt(8)
  v_mfma_f32_16x16x32_bf16 v[60:63], v[164:167], v[72:75], v[60:63]
  ds_read_b128 v[164:167], v1 offset:61440
  v_mfma_f32_16x16x32_bf16 v[64:67], v[168:171], v[72:75], v[64:67]
  ds_read_b128 v[168:171], v1 offset:62464
  buffer_load_dwordx4 v[108:111], v1, s[4:7], s86 offen offset:2048 sc1
  s_waitcnt vmcnt(8)
  v_mfma_f32_16x16x32_bf16 v[48:51], v[172:175], v[76:79], v[48:51]
  ds_read_b128 v[172:175], v1 offset:63488
  v_mfma_f32_16x16x32_bf16 v[52:55], v[176:179], v[76:79], v[52:55]
  ds_read_b128 v[176:179], v1 offset:64512
  s_waitcnt lgkmcnt(8)
  v_mfma_f32_16x16x32_bf16 v[56:59], v[224:227], v[76:79], v[56:59]
  ds_read_b128 v[224:227], v2 offset:0
  v_mfma_f32_16x16x32_bf16 v[60:63], v[228:231], v[76:79], v[60:63]
  ds_read_b128 v[228:231], v2 offset:1024
  buffer_load_dwordx4 v[112:115], v1, s[4:7], s86 offen offset:3072 sc1
  v_mfma_f32_16x16x32_bf16 v[64:67], v[232:235], v[76:79], v[64:67]
  ds_read_b128 v[232:235], v2 offset:2048
  s_waitcnt vmcnt(8)
  v_mfma_f32_16x16x32_bf16 v[48:51], v[236:239], v[80:83], v[48:51]
  ds_read_b128 v[236:239], v2 offset:3072
  s_waitcnt lgkmcnt(8)
  v_mfma_f32_16x16x32_bf16 v[52:55], v[240:243], v[80:83], v[52:55]
  ds_read_b128 v[240:243], v2 offset:4096
  s_add_u32 s86, s86, 4096
  buffer_load_dwordx4 v[116:119], v1, s[4:7], s86 offen offset:0 sc1
  v_mfma_f32_16x16x32_bf16 v[56:59], v[244:247], v[80:83], v[56:59]
  ds_read_b128 v[244:247], v2 offset:5120
  v_mfma_f32_16x16x32_bf16 v[60:63], v[248:251], v[80:83], v[60:63]
  ds_read_b128 v[248:251], v2 offset:6144
  v_mfma_f32_16x16x32_bf16 v[64:67], v[252:255], v[80:83], v[64:67]
  ds_read_b128 v[252:255], v2 offset:7168
  buffer_load_dwordx4 v[120:123], v1, s[4:7], s86 offen offset:1024 sc1
  s_waitcnt vmcnt(9) lgkmcnt(8)
  v_mfma_f32_16x16x32_bf16 v[48:51], v[164:167], v[84:87], v[48:51]
  ds_read_b128 v[164:167], v2 offset:8192
  v_mfma_f32_16x16x32_bf16 v[52:55], v[168:171], v[84:87], v[52:55]
  ds_read_b128 v[168:171], v2 offset:9216
  v_mfma_f32_16x16x32_bf16 v[56:59], v[172:175], v[84:87], v[56:59]
  ds_read_b128 v[172:175], v2 offset:10240
  v_mfma_f32_16x16x32_bf16 v[60:63], v[176:179], v[84:87], v[60:63]
  ds_read_b128 v[176:179], v2 offset:11264
  buffer_load_dwordx4 v[124:127], v1, s[4:7], s86 offen offset:2048 sc1
  s_waitcnt lgkmcnt(8)
  v_mfma_f32_16x16x32_bf16 v[64:67], v[224:227], v[84:87], v[64:67]
  ds_read_b128 v[224:227], v2 offset:12288
  s_waitcnt vmcnt(9)
  v_mfma_f32_16x16x32_bf16 v[48:51], v[228:231], v[88:91], v[48:51]
  ds_read_b128 v[228:231], v2 offset:13312
  v_mfma_f32_16x16x32_bf16 v[52:55], v[232:235], v[88:91], v[52:55]
  ds_read_b128 v[232:235], v2 offset:14336
  s_barrier
  v_mfma_f32_16x16x32_bf16 v[56:59], v[236:239], v[88:91], v[56:59]
  ds_read_b128 v[236:239], v2 offset:15360
  buffer_load_dwordx4 v[128:131], v1, s[4:7], s86 offen offset:3072 sc1
  s_waitcnt lgkmcnt(8)
  v_mfma_f32_16x16x32_bf16 v[60:63], v[240:243], v[88:91], v[60:63]
  ds_read_b128 v[240:243], v1 offset:20480
  v_mfma_f32_16x16x32_bf16 v[64:67], v[244:247], v[88:91], v[64:67]
  ds_read_b128 v[244:247], v1 offset:21504
  s_add_u32 s86, s86, 4096
  buffer_load_dwordx4 v[132:135], v1, s[4:7], s86 offen offset:0 sc1
  s_waitcnt vmcnt(10)
  v_mfma_f32_16x16x32_bf16 v[48:51], v[248:251], v[92:95], v[48:51]
  ds_read_b128 v[248:251], v1 offset:22528
  v_mfma_f32_16x16x32_bf16 v[52:55], v[252:255], v[92:95], v[52:55]
  ds_read_b128 v[252:255], v1 offset:23552
  s_waitcnt lgkmcnt(8)
  v_mfma_f32_16x16x32_bf16 v[56:59], v[164:167], v[92:95], v[56:59]
  ds_read_b128 v[164:167], v1 offset:24576
  buffer_load_dwordx4 v[136:139], v1, s[4:7], s86 offen offset:1024 sc1
  v_mfma_f32_16x16x32_bf16 v[60:63], v[168:171], v[92:95], v[60:63]
  ds_read_b128 v[168:171], v1 offset:25600
  v_mfma_f32_16x16x32_bf16 v[64:67], v[172:175], v[92:95], v[64:67]
  ds_read_b128 v[172:175], v1 offset:26624
  s_waitcnt vmcnt(10)
  v_mfma_f32_16x16x32_bf16 v[48:51], v[176:179], v[96:99], v[48:51]
  ds_read_b128 v[176:179], v1 offset:27648
  s_waitcnt lgkmcnt(8)
  v_mfma_f32_16x16x32_bf16 v[52:55], v[224:227], v[96:99], v[52:55]
  ds_read_b128 v[224:227], v1 offset:28672
  buffer_load_dwordx4 v[140:143], v1, s[4:7], s86 offen offset:2048 sc1
  v_mfma_f32_16x16x32_bf16 v[56:59], v[228:231], v[96:99], v[56:59]
  ds_read_b128 v[228:231], v1 offset:29696
  v_mfma_f32_16x16x32_bf16 v[60:63], v[232:235], v[96:99], v[60:63]
  ds_read_b128 v[232:235], v1 offset:30720
  v_mfma_f32_16x16x32_bf16 v[64:67], v[236:239], v[96:99], v[64:67]
  ds_read_b128 v[236:239], v1 offset:31744
  buffer_load_dwordx4 v[144:147], v1, s[4:7], s86 offen offset:3072 sc1
  s_waitcnt vmcnt(11) lgkmcnt(8)
  v_mfma_f32_16x16x32_bf16 v[48:51], v[240:243], v[100:103], v[48:51]
  ds_read_b128 v[240:243], v1 offset:32768
  v_mfma_f32_16x16x32_bf16 v[52:55], v[244:247], v[100:103], v[52:55]
  ds_read_b128 v[244:247], v1 offset:33792
  v_mfma_f32_16x16x32_bf16 v[56:59], v[248:251], v[100:103], v[56:59]
  ds_read_b128 v[248:251], v1 offset:34816
  v_mfma_f32_16x16x32_bf16 v[60:63], v[252:255], v[100:103], v[60:63]
  ds_read_b128 v[252:255], v1 offset:35840
  s_add_u32 s100, s101, L_ph_z21-L_base
  buffer_load_dword v222, v13, s[96:99], s100 offen
  s_waitcnt lgkmcnt(8)
  v_mfma_f32_16x16x32_bf16 v[64:67], v[164:167], v[100:103], v[64:67]
  ds_read_b128 v[164:167], v1 offset:36864
  s_mul_i32 s100, s41, 2560
  s_add_u32 s100, s100, s53
  s_add_u32 s100, s100, 98304
  buffer_load_dword v222, v43, s[4:7], s100 offen sc1
  s_waitcnt vmcnt(12)
  v_mfma_f32_16x16x32_bf16 v[48:51], v[168:171], v[104:107], v[48:51]
  ds_read_b128 v[168:171], v1 offset:37888
  v_mfma_f32_16x16x32_bf16 v[52:55], v[172:175], v[104:107], v[52:55]
  ds_read_b128 v[172:175], v1 offset:38912
  s_barrier
  v_mfma_f32_16x16x32_bf16 v[56:59], v[176:179], v[104:107], v[56:59]
  ds_read_b128 v[176:179], v1 offset:39936
  s_waitcnt lgkmcnt(8)
  v_mfma_f32_16x16x32_bf16 v[60:63], v[224:227], v[104:107], v[60:63]
  ds_read_b128 v[224:227], v2 offset:16384
  s_lshl_b32 s100, s2, 11
  s_add_u32 s100, s100, 65536
  buffer_load_dword v222, v42, s[4:7], s100 offen sc1
  v_mfma_f32_16x16x32_bf16 v[64:67], v[228:231], v[104:107], v[64:67]
  ds_read_b128 v[228:231], v2 offset:17408
  s_waitcnt vmcnt(12)
  v_mfma_f32_16x16x32_bf16 v[48:51], v[232:235], v[108:111], v[48:51]
  ds_read_b128 v[232:235], v2 offset:18432
  v_mfma_f32_16x16x32_bf16 v[52:55], v[236:239], v[108:111], v[52:55]
  ds_read_b128 v[236:239], v2 offset:19456
  s_waitcnt lgkmcnt(8)
  v_mfma_f32_16x16x32_bf16 v[56:59], v[240:243], v[108:111], v[56:59]
  ds_read_b128 v[240:243], v2 offset:20480
  v_mfma_f32_16x16x32_bf16 v[60:63], v[244:247], v[108:111], v[60:63]
  ds_read_b128 v[244:247], v2 offset:21504
  v_mfma_f32_16x16x32_bf16 v[64:67], v[248:251], v[108:111], v[64:67]
  ds_read_b128 v[248:251], v2 offset:22528
  s_waitcnt vmcnt(11)
  v_mfma_f32_16x16x32_bf16 v[48:51], v[252:255], v[112:115], v[48:51]
  ds_read_b128 v[252:255], v2 offset:23552
  s_waitcnt lgkmcnt(8)
  v_mfma_f32_16x16x32_bf16 v[52:55], v[164:167], v[112:115], v[52:55]
  ds_read_b128 v[164:167], v2 offset:24576
  v_mfma_f32_16x16x32_bf16 v[56:59], v[168:171], v[112:115], v[56:59]
  ds_read_b128 v[168:171], v2 offset:25600
  v_mfma_f32_16x16x32_bf16 v[60:63], v[172:175], v[112:115], v[60:63]
  ds_read_b128 v[172:175], v2 offset:26624
  v_mfma_f32_16x16x32_bf16 v[64:67], v[176:179], v[112:115], v[64:67]
  ds_read_b128 v[176:179], v2 offset:27648
  s_waitcnt vmcnt(10) lgkmcnt(8)
  v_mfma_f32_16x16x32_bf16 v[48:51], v[224:227], v[116:119], v[48:51]
  ds_read_b128 v[224:227], v2 offset:28672
  v_mfma_f32_16x16x32_bf16 v[52:55], v[228:231], v[116:119], v[52:55]
  ds_read_b128 v[228:231], v2 offset:29696
  v_mfma_f32_16x16x32_bf16 v[56:59], v[232:235], v[116:119], v[56:59]
  ds_read_b128 v[232:235], v2 offset:30720
  v_mfma_f32_16x16x32_bf16 v[60:63], v[236:239], v[116:119], v[60:63]
  s_add_u32 s82, s75, 516096
  s_add_u32 m0, s52, 40960
  ds_read_b128 v[236:239], v2 offset:31744
  buffer_load_dwordx4 v1, s[4:7], s82 offen offset:0 lds
  s_waitcnt lgkmcnt(8)
  v_mfma_f32_16x16x32_bf16 v[64:67], v[240:243], v[116:119], v[64:67]
  ds_read_b128 v[240:243], v2 offset:32768
  s_waitcnt vmcnt(10)
  v_mfma_f32_16x16x32_bf16 v[48:51], v[244:247], v[120:123], v[48:51]
  ds_read_b128 v[244:247], v2 offset:33792
  v_mfma_f32_16x16x32_bf16 v[52:55], v[248:251], v[120:123], v[52:55]
  ds_read_b128 v[248:251], v2 offset:34816
  s_barrier
  v_mfma_f32_16x16x32_bf16 v[56:59], v[252:255], v[120:123], v[56:59]
  ds_read_b128 v[252:255], v2 offset:35840
  buffer_load_dwordx4 v1, s[4:7], s82 offen offset:1024 lds
  s_waitcnt lgkmcnt(8)
  v_mfma_f32_16x16x32_bf16 v[60:63], v[164:167], v[120:123], v[60:63]
  ds_read_b128 v[164:167], v2 offset:36864
  v_mfma_f32_16x16x32_bf16 v[64:67], v[168:171], v[120:123], v[64:67]
  ds_read_b128 v[168:171], v2 offset:37888
  buffer_load_dwordx4 v1, s[4:7], s82 offen offset:2048 lds
  s_waitcnt vmcnt(11)
  v_mfma_f32_16x16x32_bf16 v[48:51], v[172:175], v[124:127], v[48:51]
  ds_read_b128 v[172:175], v2 offset:38912
  v_mfma_f32_16x16x32_bf16 v[52:55], v[176:179], v[124:127], v[52:55]
  ds_read_b128 v[176:179], v2 offset:39936
  s_waitcnt lgkmcnt(8)
  v_mfma_f32_16x16x32_bf16 v[56:59], v[224:227], v[124:127], v[56:59]
  ds_read_b128 v[224:227], v2 offset:40960
  v_mfma_f32_16x16x32_bf16 v[60:63], v[228:231], v[124:127], v[60:63]
  ds_read_b128 v[228:231], v2 offset:41984
  buffer_load_dwordx4 v1, s[4:7], s82 offen offset:3072 lds
  v_mfma_f32_16x16x32_bf16 v[64:67], v[232:235], v[124:127], v[64:67]
  ds_read_b128 v[232:235], v2 offset:43008
  s_waitcnt vmcnt(11)
  v_mfma_f32_16x16x32_bf16 v[48:51], v[236:239], v[128:131], v[48:51]
  ds_read_b128 v[236:239], v2 offset:44032
  s_waitcnt lgkmcnt(8)
  v_mfma_f32_16x16x32_bf16 v[52:55], v[240:243], v[128:131], v[52:55]
  s_add_u32 s82, s82, 4096
  s_add_u32 m0, m0, 4096
  ds_read_b128 v[240:243], v2 offset:45056
  buffer_load_dwordx4 v1, s[4:7], s82 offen offset:0 lds
  v_mfma_f32_16x16x32_bf16 v[56:59], v[244:247], v[128:131], v[56:59]
  ds_read_b128 v[244:247], v2 offset:46080
  v_mfma_f32_16x16x32_bf16 v[60:63], v[248:251], v[128:131], v[60:63]
  ds_read_b128 v[248:251], v2 offset:47104
  v_mfma_f32_16x16x32_bf16 v[64:67], v[252:255], v[128:131], v[64:67]
  ds_read_b128 v[252:255], v2 offset:48128
  buffer_load_dwordx4 v1, s[4:7], s82 offen offset:1024 lds
  s_waitcnt vmcnt(12) lgkmcnt(8)
  v_mfma_f32_16x16x32_bf16 v[48:51], v[164:167], v[132:135], v[48:51]
  ds_read_b128 v[164:167], v2 offset:49152
  v_mfma_f32_16x16x32_bf16 v[52:55], v[168:171], v[132:135], v[52:55]
  ds_read_b128 v[168:171], v2 offset:50176
  v_mfma_f32_16x16x32_bf16 v[56:59], v[172:175], v[132:135], v[56:59]
  s_add_u32 s82, s75, 540672
  s_add_u32 m0, s52, 0
  ds_read_b128 v[172:175], v2 offset:51200
  buffer_load_dwordx4 v1, s[4:7], s82 offen offset:0 lds
  v_mfma_f32_16x16x32_bf16 v[60:63], v[176:179], v[132:135], v[60:63]
  ds_read_b128 v[176:179], v2 offset:52224
  s_waitcnt lgkmcnt(8)
  v_mfma_f32_16x16x32_bf16 v[64:67], v[224:227], v[132:135], v[64:67]
  ds_read_b128 v[224:227], v2 offset:53248
  s_waitcnt vmcnt(12)
  v_mfma_f32_16x16x32_bf16 v[48:51], v[228:231], v[136:139], v[48:51]
  ds_read_b128 v[228:231], v2 offset:54272
  v_mfma_f32_16x16x32_bf16 v[52:55], v[232:235], v[136:139], v[52:55]
  ds_read_b128 v[232:235], v2 offset:55296
  s_barrier
  v_mfma_f32_16x16x32_bf16 v[56:59], v[236:239], v[136:139], v[56:59]
  ds_read_b128 v[236:239], v2 offset:56320
  buffer_load_dwordx4 v1, s[4:7], s82 offen offset:1024 lds
  s_waitcnt lgkmcnt(8)
  v_mfma_f32_16x16x32_bf16 v[60:63], v[240:243], v[136:139], v[60:63]
  v_mfma_f32_16x16x32_bf16 v[64:67], v[244:247], v[136:139], v[64:67]
  s_waitcnt vmcnt(12)
  v_mfma_f32_16x16x32_bf16 v[48:51], v[248:251], v[140:143], v[48:51]
  buffer_load_dwordx4 v1, s[4:7], s82 offen offset:2048 lds
  v_mfma_f32_16x16x32_bf16 v[52:55], v[252:255], v[140:143], v[52:55]
  s_waitcnt lgkmcnt(4)
  v_mfma_f32_16x16x32_bf16 v[56:59], v[164:167], v[140:143], v[56:59]
  v_mfma_f32_16x16x32_bf16 v[60:63], v[168:171], v[140:143], v[60:63]
  buffer_load_dwordx4 v1, s[4:7], s82 offen offset:3072 lds
  v_mfma_f32_16x16x32_bf16 v[64:67], v[172:175], v[140:143], v[64:67]
  s_waitcnt vmcnt(13)
  v_mfma_f32_16x16x32_bf16 v[48:51], v[176:179], v[144:147], v[48:51]
  s_waitcnt lgkmcnt(0)
  v_mfma_f32_16x16x32_bf16 v[52:55], v[224:227], v[144:147], v[52:55]
  s_add_u32 s82, s82, 4096
  s_add_u32 m0, m0, 4096
  v_mfma_f32_16x16x32_bf16 v[56:59], v[228:231], v[144:147], v[56:59]
  buffer_load_dwordx4 v1, s[4:7], s82 offen offset:0 lds
  v_mfma_f32_16x16x32_bf16 v[60:63], v[232:235], v[144:147], v[60:63]
  v_mfma_f32_16x16x32_bf16 v[64:67], v[236:239], v[144:147], v[64:67]
  v_cvt_pk_bf16_f32 v224, v48, v49
  v_cvt_pk_bf16_f32 v225, v50, v51
  v_cvt_pk_bf16_f32 v226, v52, v53
  v_cvt_pk_bf16_f32 v227, v54, v55
  s_nop 0
  v_cvt_pk_bf16_f32 v228, v56, v57
  v_cvt_pk_bf16_f32 v229, v58, v59
  v_cvt_pk_bf16_f32 v230, v60, v61
  v_cvt_pk_bf16_f32 v231, v62, v63
  v_cvt_pk_bf16_f32 v232, v64, v65
  v_cvt_pk_bf16_f32 v233, v66, v67
  s_cmp_eq_u32 s48, 1
  s_cbranch_scc0 L_slow75
  buffer_store_dwordx4 v[224:227], v1, s[4:7], s14 offen
  buffer_store_dwordx4 v[228:231], v1, s[4:7], s14 offen offset:1024
  buffer_store_dwordx2 v[232:233], v1, s[4:7], s15 offen
L_back76:
  v_pk_add_f32 v[236:237], v[48:49], v[50:51]
  v_pk_mul_f32 v[238:239], v[48:49], v[48:49]
  v_pk_fma_f32 v[238:239], v[50:51], v[50:51], v[238:239]
  v_pk_add_f32 v[236:237], v[236:237], v[52:53]
  v_pk_fma_f32 v[238:239], v[52:53], v[52:53], v[238:239]
  v_pk_add_f32 v[236:237], v[236:237], v[54:55]
  v_pk_fma_f32 v[238:239], v[54:55], v[54:55], v[238:239]
  v_pk_add_f32 v[236:237], v[236:237], v[56:57]
  v_pk_fma_f32 v[238:239], v[56:57], v[56:57], v[238:239]
  v_pk_add_f32 v[236:237], v[236:237], v[58:59]
  v_pk_fma_f32 v[238:239], v[58:59], v[58:59], v[238:239]
  v_pk_add_f32 v[236:237], v[236:237], v[60:61]
  v_pk_fma_f32 v[238:239], v[60:61], v[60:61], v[238:239]
  v_pk_add_f32 v[236:237], v[236:237], v[62:63]
  v_pk_fma_f32 v[238:239], v[62:63], v[62:63], v[238:239]
  v_pk_add_f32 v[236:237], v[236:237], v[64:65]
  v_pk_fma_f32 v[238:239], v[64:65], v[64:65], v[238:239]
  v_pk_add_f32 v[236:237], v[236:237], v[66:67]
  v_pk_fma_f32 v[238:239], v[66:67], v[66:67], v[238:239]
  v_add_f32 v236, v236, v237
  v_add_f32 v238, v238, v239
  s_nop 1
  v_permlane32_swap_b32 v236, v238
  v_add_f32 v236, v236, v238
  v_mov_b32 v238, v236
  s_nop 1
  v_permlane16_swap_b32 v236, v238
  v_add_f32 v236, v236, v238
  s_cmp_eq_u32 s48, 1
  s_cbranch_scc0 L_slow77
  buffer_store_dword v236, v4, s[4:7], s17 offen
L_back78:
  s_barrier
  buffer_load_dwordx4 v1, s[4:7], s82 offen offset:1024 lds
  s_add_u32 s82, s75, 565248
  s_add_u32 m0, s52, 65536
  s_nop 0
  buffer_load_dwordx4 v1, s[4:7], s82 offen offset:0 lds
  s_waitcnt vmcnt(2)
  s_cmp_eq_u32 s48, 1
  s_cbranch_scc0 L_slow79
  buffer_store_dword v25, v13, s[4:7], s18 offen offset:160
L_back80:
L_ph_z21:
  s_barrier
  s_add_u32 s86, s53, 98304
  s_mov_b32 s88, 0
  buffer_load_dword v223, v14, s[4:7], s55 offen offset:160 sc1
  ds_read_b128 v[224:227], v2 offset:57344
  ds_read_b128 v[228:231], v2 offset:58368
  ds_read_b128 v[232:235], v2 offset:59392
  ds_read_b128 v[236:239], v2 offset:60416
  ds_read_b128 v[240:243], v2 offset:61440
  ds_read_b128 v[244:247], v2 offset:62464
  ds_read_b128 v[248:251], v2 offset:63488
  ds_read_b128 v[252:255], v2 offset:64512
  ds_read_b128 v[188:191], v3 offset:0
  ds_read_b128 v[192:195], v3 offset:1024
  ds_read_b128 v[196:199], v3 offset:2048
  ds_read_b128 v[200:203], v3 offset:3072
L_poll81:
  buffer_load_dword v221, v14, s[4:7], s55 offen offset:160 sc1
  s_waitcnt vmcnt(1)
  v_cmp_ne_u32 vcc, s44, v223
  s_cbranch_vccz L_seen82
  buffer_load_dword v223, v14, s[4:7], s55 offen offset:160 sc1
  s_add_u32 s88, s88, 1
  s_cmp_gt_u32 s88, 65536
  s_cbranch_scc1 L_abort
  s_waitcnt vmcnt(1)
  v_cmp_ne_u32 vcc, s44, v221
  s_cbranch_vccnz L_poll81
L_seen82:
  buffer_load_dwordx4 v[68:71], v1, s[4:7], s86 offen offset:0 sc1
  buffer_load_dwordx4 v[72:75], v1, s[4:7], s86 offen offset:1024 sc1
  buffer_load_dwordx4 v[76:79], v1, s[4:7], s86 offen offset:2048 sc1
  buffer_load_dwordx4 v[80:83], v1, s[4:7], s86 offen offset:3072 sc1
  s_add_u32 s86, s86, 4096
  buffer_load_dwordx4 v[84:87], v1, s[4:7], s86 offen offset:0 sc1
  buffer_load_dwordx4 v[88:91], v1, s[4:7], s86 offen offset:1024 sc1
  buffer_load_dwordx4 v[92:95], v1, s[4:7], s86 offen offset:2048 sc1
  buffer_load_dwordx4 v[96:99], v1, s[4:7], s86 offen offset:3072 sc1
  s_waitcnt vmcnt(7) lgkmcnt(8)
  v_mfma_f32_16x16x32_bf16 v[164:167], v[68:71], v[224:227], 0
  ds_read_b128 v[224:227], v3 offset:4096
  s_add_u32 s84, s53, 118784
  buffer_load_dwordx2 v[158:159], v5, s[4:7], s84 offen sc1
  buffer_load_dwordx2 v[160:161], v5, s[4:7], s84 offen offset:128 sc1
  v_mfma_f32_16x16x32_bf16 v[168:171], v[68:71], v[228:231], 0
  ds_read_b128 v[228:231], v3 offset:5120
  buffer_load_dwordx4 v1, s[4:7], s82 offen offset:1024 lds
  v_mfma_f32_16x16x32_bf16 v[172:175], v[68:71], v[232:235], 0
  ds_read_b128 v[232:235], v3 offset:6144
  v_mfma_f32_16x16x32_bf16 v[176:179], v[68:71], v[236:239], 0
  ds_read_b128 v[236:239], v3 offset:7168
  s_waitcnt lgkmcnt(8)
  v_mfma_f32_16x16x32_bf16 v[180:183], v[68:71], v[240:243], 0
  ds_read_b128 v[240:243], v3 offset:8192
  buffer_load_dwordx4 v1, s[4:7], s82 offen offset:2048 lds
  v_mfma_f32_16x16x32_bf16 v[184:187], v[68:71], v[244:247], 0
  ds_read_b128 v[244:247], v3 offset:9216
  s_waitcnt vmcnt(10)
  v_mfma_f32_16x16x32_bf16 v[164:167], v[72:75], v[248:251], v[164:167]
  ds_read_b128 v[248:251], v3 offset:10240
  buffer_load_dwordx4 v1, s[4:7], s82 offen offset:3072 lds
  v_mfma_f32_16x16x32_bf16 v[168:171], v[72:75], v[252:255], v[168:171]
  ds_read_b128 v[252:255], v3 offset:11264
  s_waitcnt lgkmcnt(8)
  v_mfma_f32_16x16x32_bf16 v[172:175], v[72:75], v[188:191], v[172:175]
  ds_read_b128 v[188:191], v3 offset:12288
  s_barrier
  v_mfma_f32_16x16x32_bf16 v[176:179], v[72:75], v[192:195], v[176:179]
  s_add_u32 s82, s82, 4096
  s_add_u32 m0, m0, 4096
  ds_read_b128 v[192:195], v3 offset:13312
  buffer_load_dwordx4 v1, s[4:7], s82 offen offset:0 lds
  v_mfma_f32_16x16x32_bf16 v[180:183], v[72:75], v[196:199], v[180:183]
  ds_read_b128 v[196:199], v3 offset:14336
  v_mfma_f32_16x16x32_bf16 v[184:187], v[72:75], v[200:203], v[184:187]
  ds_read_b128 v[200:203], v3 offset:15360
  s_waitcnt vmcnt(11) lgkmcnt(8)
  v_mfma_f32_16x16x32_bf16 v[164:167], v[76:79], v[224:227], v[164:167]
  ds_read_b128 v[224:227], v1 offset:40960
  buffer_load_dwordx4 v1, s[4:7], s82 offen offset:1024 lds
  v_mfma_f32_16x16x32_bf16 v[168:171], v[76:79], v[228:231], v[168:171]
  ds_read_b128 v[228:231], v1 offset:41984
  v_mfma_f32_16x16x32_bf16 v[172:175], v[76:79], v[232:235], v[172:175]
  ds_read_b128 v[232:235], v1 offset:43008
  v_mfma_f32_16x16x32_bf16 v[176:179], v[76:79], v[236:239], v[176:179]
  s_add_u32 s82, s75, 589824
  s_add_u32 m0, s52, 90112
  ds_read_b128 v[236:239], v1 offset:44032
  buffer_load_dwordx4 v1, s[4:7], s82 offen offset:0 lds
  s_waitcnt lgkmcnt(8)
  v_mfma_f32_16x16x32_bf16 v[180:183], v[76:79], v[240:243], v[180:183]
  ds_read_b128 v[240:243], v1 offset:45056
  v_mfma_f32_16x16x32_bf16 v[184:187], v[76:79], v[244:247], v[184:187]
  ds_read_b128 v[244:247], v1 offset:46080
  buffer_load_dwordx4 v1, s[4:7], s82 offen offset:1024 lds
  s_waitcnt vmcnt(13)
  v_mfma_f32_16x16x32_bf16 v[164:167], v[80:83], v[248:251], v[164:167]
  ds_read_b128 v[248:251], v1 offset:47104
  v_mfma_f32_16x16x32_bf16 v[168:171], v[80:83], v[252:255], v[168:171]
  ds_read_b128 v[252:255], v1 offset:48128
  s_waitcnt lgkmcnt(8)
  v_mfma_f32_16x16x32_bf16 v[172:175], v[80:83], v[188:191], v[172:175]
  ds_read_b128 v[188:191], v1 offset:49152
  v_mfma_f32_16x16x32_bf16 v[176:179], v[80:83], v[192:195], v[176:179]
  ds_read_b128 v[192:195], v1 offset:50176
  v_mfma_f32_16x16x32_bf16 v[180:183], v[80:83], v[196:199], v[180:183]
  ds_read_b128 v[196:199], v1 offset:51200
  v_mfma_f32_16x16x32_bf16 v[184:187], v[80:83], v[200:203], v[184:187]
  ds_read_b128 v[200:203], v1 offset:52224
  s_waitcnt vmcnt(12) lgkmcnt(8)
  v_mfma_f32_16x16x32_bf16 v[164:167], v[84:87], v[224:227], v[164:167]
  ds_read_b128 v[224:227], v1 offset:53248
  s_add_u32 s86, s86, 4096
  buffer_load_dwordx4 v[100:103], v1, s[4:7], s86 offen offset:0 sc1
  v_mfma_f32_16x16x32_bf16 v[168:171], v[84:87], v[228:231], v[168:171]
  ds_read_b128 v[228:231], v1 offset:54272
  v_mfma_f32_16x16x32_bf16 v[172:175], v[84:87], v[232:235], v[172:175]
  ds_read_b128 v[232:235], v1 offset:55296
  v_mfma_f32_16x16x32_bf16 v[176:179], v[84:87], v[236:239], v[176:179]
  ds_read_b128 v[236:239], v1 offset:56320
  s_waitcnt lgkmcnt(8)
  v_mfma_f32_16x16x32_bf16 v[180:183], v[84:87], v[240:243], v[180:183]
  ds_read_b128 v[240:243], v1 offset:57344
  buffer_load_dwordx4 v[104:107], v1, s[4:7], s86 offen offset:1024 sc1
  v_mfma_f32_16x16x32_bf16 v[184:187], v[84:87], v[244:247], v[184:187]
  ds_read_b128 v[244:247], v1 offset:58368
  buffer_load_dwordx4 v1, s[4:7], s82 offen offset:2048 lds
  s_waitcnt vmcnt(14)
  v_mfma_f32_16x16x32_bf16 v[164:167], v[88:91], v[248:251], v[164:167]
  ds_read_b128 v[248:251], v1 offset:59392
  v_mfma_f32_16x16x32_bf16 v[168:171], v[88:91], v[252:255], v[168:171]
  ds_read_b128 v[252:255], v1 offset:60416
  s_waitcnt lgkmcnt(8)
  v_mfma_f32_16x16x32_bf16 v[172:175], v[88:91], v[188:191], v[172:175]
  ds_read_b128 v[188:191], v1 offset:61440
  s_barrier
  v_mfma_f32_16x16x32_bf16 v[176:179], v[88:91], v[192:195], v[176:179]
  ds_read_b128 v[192:195], v1 offset:62464
  buffer_load_dwordx4 v[108:111], v1, s[4:7], s86 offen offset:2048 sc1
  v_mfma_f32_16x16x32_bf16 v[180:183], v[88:91], v[196:199], v[180:183]
  ds_read_b128 v[196:199], v1 offset:63488
  v_mfma_f32_16x16x32_bf16 v[184:187], v[88:91], v[200:203], v[184:187]
  ds_read_b128 v[200:203], v1 offset:64512
  buffer_load_dwordx4 v1, s[4:7], s82 offen offset:3072 lds
  s_waitcnt vmcnt(15) lgkmcnt(8)
  v_mfma_f32_16x16x32_bf16 v[164:167], v[92:95], v[224:227], v[164:167]
  ds_read_b128 v[224:227], v1 offset:0
  s_waitcnt vmcnt(12)
  v_pk_add_f32 v[158:159], v[158:159], v[160:161]
  v_mfma_f32_16x16x32_bf16 v[168:171], v[92:95], v[228:231], v[168:171]
  ds_read_b128 v[228:231], v1 offset:1024
  v_mov_b32 v160, v158
  v_mfma_f32_16x16x32_bf16 v[172:175], v[92:95], v[232:235], v[172:175]
  ds_read_b128 v[232:235], v1 offset:2048
  v_mov_b32 v161, v159
  v_mfma_f32_16x16x32_bf16 v[176:179], v[92:95], v[236:239], v[176:179]
  ds_read_b128 v[236:239], v1 offset:3072
  buffer_load_dwordx4 v[112:115], v1, s[4:7], s86 offen offset:3072 sc1
  s_waitcnt lgkmcnt(8)
  v_mfma_f32_16x16x32_bf16 v[180:183], v[92:95], v[240:243], v[180:183]
  s_add_u32 s82, s82, 4096
  s_add_u32 m0, m0, 4096
  ds_read_b128 v[240:243], v1 offset:4096
  buffer_load_dwordx4 v1, s[4:7], s82 offen offset:0 lds
  v_mfma_f32_16x16x32_bf16 v[184:187], v[92:95], v[244:247], v[184:187]
  ds_read_b128 v[244:247], v1 offset:5120
  v_permlane32_swap_b32 v158, v160
  v_mfma_f32_16x16x32_bf16 v[164:167], v[96:99], v[248:251], v[164:167]
  ds_read_b128 v[248:251], v1 offset:6144
  v_permlane32_swap_b32 v159, v161
  v_mfma_f32_16x16x32_bf16 v[168:171], v[96:99], v[252:255], v[168:171]
  ds_read_b128 v[252:255], v1 offset:7168
  v_pk_add_f32 v[158:159], v[158:159], v[160:161]
  s_waitcnt lgkmcnt(8)
  v_mfma_f32_16x16x32_bf16 v[172:175], v[96:99], v[188:191], v[172:175]
  ds_read_b128 v[188:191], v1 offset:8192
  v_mov_b32 v160, v158
  v_mfma_f32_16x16x32_bf16 v[176:179], v[96:99], v[192:195], v[176:179]
  ds_read_b128 v[192:195], v1 offset:9216
  buffer_load_dwordx4 v1, s[4:7], s82 offen offset:1024 lds
  v_mfma_f32_16x16x32_bf16 v[180:183], v[96:99], v[196:199], v[180:183]
  ds_read_b128 v[196:199], v1 offset:10240
  v_mov_b32 v161, v159
  v_mfma_f32_16x16x32_bf16 v[184:187], v[96:99], v[200:203], v[184:187]
  ds_read_b128 v[200:203], v1 offset:11264
  v_permlane16_swap_b32 v158, v160
  s_waitcnt vmcnt(7) lgkmcnt(8)
  v_mfma_f32_16x16x32_bf16 v[164:167], v[100:103], v[224:227], v[164:167]
  ds_read_b128 v[224:227], v1 offset:12288
  s_add_u32 s86, s86, 4096
  buffer_load_dwordx4 v[116:119], v1, s[4:7], s86 offen offset:0 sc1
  v_mfma_f32_16x16x32_bf16 v[168:171], v[100:103], v[228:231], v[168:171]
  ds_read_b128 v[228:231], v1 offset:13312
  v_permlane16_swap_b32 v159, v161
  v_mfma_f32_16x16x32_bf16 v[172:175], v[100:103], v[232:235], v[172:175]
  ds_read_b128 v[232:235], v1 offset:14336
  v_pk_add_f32 v[158:159], v[158:159], v[160:161]
  v_mfma_f32_16x16x32_bf16 v[176:179], v[100:103], v[236:239], v[176:179]
  ds_read_b128 v[236:239], v1 offset:15360
  buffer_load_dwordx4 v[120:123], v1, s[4:7], s86 offen offset:1024 sc1
  s_waitcnt lgkmcnt(8)
  v_mfma_f32_16x16x32_bf16 v[180:183], v[100:103], v[240:243], v[180:183]
  ds_read_b128 v[240:243], v1 offset:16384
  v_mfma_f32_16x16x32_bf16 v[184:187], v[100:103], v[244:247], v[184:187]
  ds_read_b128 v[244:247], v1 offset:17408
  v_mul_f32 v158, 0xbacccccd, v158
  s_waitcnt vmcnt(8)
  v_mfma_f32_16x16x32_bf16 v[164:167], v[104:107], v[248:251], v[164:167]
  ds_read_b128 v[248:251], v1 offset:18432
  buffer_load_dwordx4 v[124:127], v1, s[4:7], s86 offen offset:2048 sc1
  v_mfma_f32_16x16x32_bf16 v[168:171], v[104:107], v[252:255], v[168:171]
  ds_read_b128 v[252:255], v1 offset:19456
  v_mul_f32 v159, 0x3acccccd, v159
  s_waitcnt lgkmcnt(8)
  v_mfma_f32_16x16x32_bf16 v[172:175], v[104:107], v[188:191], v[172:175]
  ds_read_b128 v[188:191], v1 offset:20480
  s_barrier
  v_mfma_f32_16x16x32_bf16 v[176:179], v[104:107], v[192:195], v[176:179]
  ds_read_b128 v[192:195], v1 offset:21504
  s_add_u32 s100, s101, L_ph_z11-L_base
  buffer_load_dword v222, v13, s[96:99], s100 offen
  v_mfma_f32_16x16x32_bf16 v[180:183], v[104:107], v[196:199], v[180:183]
  s_add_u32 s82, s75, 614400
  s_add_u32 m0, s52, 114688
  ds_read_b128 v[196:199], v1 offset:22528
  buffer_load_dwordx4 v1, s[4:7], s82 offen offset:0 lds
  v_mfma_f32_16x16x32_bf16 v[184:187], v[104:107], v[200:203], v[184:187]
  ds_read_b128 v[200:203], v1 offset:23552
  v_fma_f32 v159, -v158, v158, v159
  s_waitcnt vmcnt(9) lgkmcnt(8)
  v_mfma_f32_16x16x32_bf16 v[164:167], v[108:111], v[224:227], v[164:167]
  ds_read_b128 v[224:227], v2 offset:0
  buffer_load_dwordx4 v[128:131], v1, s[4:7], s86 offen offset:3072 sc1
  v_mfma_f32_16x16x32_bf16 v[168:171], v[108:111], v[228:231], v[168:171]
  ds_read_b128 v[228:231], v2 offset:1024
  v_max_f32 v159, 0, v159
  v_mfma_f32_16x16x32_bf16 v[172:175], v[108:111], v[232:235], v[172:175]
  ds_read_b128 v[232:235], v2 offset:2048
  v_add_f32 v159, 0x3727c5ac, v159
  v_mfma_f32_16x16x32_bf16 v[176:179], v[108:111], v[236:239], v[176:179]
  ds_read_b128 v[236:239], v2 offset:3072
  v_rsq_f32 v156, v159
  s_waitcnt lgkmcnt(8)
  v_mfma_f32_16x16x32_bf16 v[180:183], v[108:111], v[240:243], v[180:183]
  ds_read_b128 v[240:243], v2 offset:4096
  buffer_load_dwordx4 v1, s[4:7], s82 offen offset:1024 lds
  v_mfma_f32_16x16x32_bf16 v[184:187], v[108:111], v[244:247], v[184:187]
  ds_read_b128 v[244:247], v2 offset:5120
  v_mul_f32 v157, v158, v156
  s_waitcnt vmcnt(9)
  v_mfma_f32_16x16x32_bf16 v[164:167], v[112:115], v[248:251], v[164:167]
  ds_read_b128 v[248:251], v2 offset:6144
  ds_bpermute_b32 v148, v6, v156 offset:0
  v_mfma_f32_16x16x32_bf16 v[168:171], v[112:115], v[252:255], v[168:171]
  ds_read_b128 v[252:255], v2 offset:7168
  s_add_u32 s86, s86, 4096
  buffer_load_dwordx4 v[132:135], v1, s[4:7], s86 offen offset:0 sc1
  s_waitcnt lgkmcnt(9)
  v_mfma_f32_16x16x32_bf16 v[172:175], v[112:115], v[188:191], v[172:175]
  ds_read_b128 v[188:191], v2 offset:8192
  ds_bpermute_b32 v152, v6, v157 offset:0
  v_mfma_f32_16x16x32_bf16 v[176:179], v[112:115], v[192:195], v[176:179]
  ds_read_b128 v[192:195], v2 offset:9216
  ds_bpermute_b32 v149, v6, v156 offset:4
  v_mfma_f32_16x16x32_bf16 v[180:183], v[112:115], v[196:199], v[180:183]
  ds_read_b128 v[196:199], v2 offset:10240
  buffer_load_dwordx4 v1, s[4:7], s82 offen offset:2048 lds
  v_mfma_f32_16x16x32_bf16 v[184:187], v[112:115], v[200:203], v[184:187]
  ds_read_b128 v[200:203], v2 offset:11264
  ds_bpermute_b32 v153, v6, v157 offset:4
  s_waitcnt vmcnt(8) lgkmcnt(12)
  v_mfma_f32_16x16x32_bf16 v[164:167], v[116:119], v[224:227], v[164:167]
  ds_read_b128 v[224:227], v2 offset:12288
  buffer_load_dwordx4 v[136:139], v1, s[4:7], s86 offen offset:1024 sc1
  v_mfma_f32_16x16x32_bf16 v[168:171], v[116:119], v[228:231], v[168:171]
  ds_read_b128 v[228:231], v2 offset:13312
  ds_bpermute_b32 v150, v6, v156 offset:8
  v_mfma_f32_16x16x32_bf16 v[172:175], v[116:119], v[232:235], v[172:175]
  ds_read_b128 v[232:235], v2 offset:14336
  ds_bpermute_b32 v154, v6, v157 offset:8
  v_mfma_f32_16x16x32_bf16 v[176:179], v[116:119], v[236:239], v[176:179]
  ds_read_b128 v[236:239], v2 offset:15360
  buffer_load_dwordx4 v1, s[4:7], s82 offen offset:3072 lds
  s_waitcnt lgkmcnt(13)
  v_mfma_f32_16x16x32_bf16 v[180:183], v[116:119], v[240:243], v[180:183]
  ds_read_b128 v[240:243], v2 offset:16384
  ds_bpermute_b32 v151, v6, v156 offset:12
  v_mfma_f32_16x16x32_bf16 v[184:187], v[116:119], v[244:247], v[184:187]
  ds_read_b128 v[244:247], v2 offset:17408
  ds_bpermute_b32 v155, v6, v157 offset:12
  s_waitcnt vmcnt(9)
  v_mfma_f32_16x16x32_bf16 v[164:167], v[120:123], v[248:251], v[164:167]
  ds_read_b128 v[248:251], v2 offset:18432
  buffer_load_dwordx4 v[140:143], v1, s[4:7], s86 offen offset:2048 sc1
  v_mfma_f32_16x16x32_bf16 v[168:171], v[120:123], v[252:255], v[168:171]
  ds_read_b128 v[252:255], v2 offset:19456
  ds_read_b32 v204, v27 offset:1536
  s_waitcnt lgkmcnt(14)
  v_mfma_f32_16x16x32_bf16 v[172:175], v[120:123], v[188:191], v[172:175]
  ds_read_b128 v[188:191], v2 offset:20480
  s_barrier
  v_mfma_f32_16x16x32_bf16 v[176:179], v[120:123], v[192:195], v[176:179]
  s_add_u32 s82, s82, 4096
  s_add_u32 m0, m0, 4096
  ds_read_b128 v[192:195], v2 offset:21504
  buffer_load_dwordx4 v1, s[4:7], s82 offen offset:0 lds
  v_mfma_f32_16x16x32_bf16 v[180:183], v[120:123], v[196:199], v[180:183]
  ds_read_b128 v[196:199], v2 offset:22528
  ds_read_b32 v205, v27 offset:1600
  v_mfma_f32_16x16x32_bf16 v[184:187], v[120:123], v[200:203], v[184:187]
  ds_read_b128 v[200:203], v2 offset:23552
  ds_read_b32 v206, v27 offset:1664
  s_waitcnt vmcnt(10) lgkmcnt(13)
  v_mfma_f32_16x16x32_bf16 v[164:167], v[124:127], v[224:227], v[164:167]
  ds_read_b128 v[224:227], v2 offset:24576
  buffer_load_dwordx4 v[144:147], v1, s[4:7], s86 offen offset:3072 sc1
  v_mfma_f32_16x16x32_bf16 v[168:171], v[124:127], v[228:231], v[168:171]
  ds_read_b128 v[228:231], v2 offset:25600
  ds_read_b32 v207, v27 offset:1728
  v_mfma_f32_16x16x32_bf16 v[172:175], v[124:127], v[232:235], v[172:175]
  ds_read_b128 v[232:235], v2 offset:26624
  ds_read_b32 v208, v27 offset:1792
  v_mfma_f32_16x16x32_bf16 v[176:179], v[124:127], v[236:239], v[176:179]
  ds_read_b128 v[236:239], v2 offset:27648
  buffer_load_dwordx4 v1, s[4:7], s82 offen offset:1024 lds
  s_waitcnt lgkmcnt(13)
  v_mfma_f32_16x16x32_bf16 v[180:183], v[124:127], v[240:243], v[180:183]
  ds_read_b128 v[240:243], v2 offset:28672
  ds_read_b32 v209, v27 offset:1856
  v_mfma_f32_16x16x32_bf16 v[184:187], v[124:127], v[244:247], v[184:187]
  ds_read_b128 v[244:247], v2 offset:29696
  s_waitcnt vmcnt(9)
  v_mfma_f32_16x16x32_bf16 v[164:167], v[128:131], v[248:251], v[164:167]
  s_add_u32 s82, s75, 638976
  s_add_u32 m0, s52, 24576
  ds_read_b128 v[248:251], v2 offset:30720
  buffer_load_dwordx4 v1, s[4:7], s82 offen offset:0 lds
  v_mfma_f32_16x16x32_bf16 v[168:171], v[128:131], v[252:255], v[168:171]
  ds_read_b128 v[252:255], v2 offset:31744
  s_waitcnt lgkmcnt(12)
  v_mfma_f32_16x16x32_bf16 v[172:175], v[128:131], v[188:191], v[172:175]
  ds_read_b128 v[188:191], v2 offset:32768
  v_mfma_f32_16x16x32_bf16 v[176:179], v[128:131], v[192:195], v[176:179]
  ds_read_b128 v[192:195], v2 offset:33792
  buffer_load_dwordx4 v1, s[4:7], s82 offen offset:1024 lds
  v_mfma_f32_16x16x32_bf16 v[180:183], v[128:131], v[196:199], v[180:183]
  ds_read_b128 v[196:199], v2 offset:34816
  v_mfma_f32_16x16x32_bf16 v[184:187], v[128:131], v[200:203], v[184:187]
  ds_read_b128 v[200:203], v2 offset:35840
  s_waitcnt vmcnt(9) lgkmcnt(9)
  v_mfma_f32_16x16x32_bf16 v[164:167], v[132:135], v[224:227], v[164:167]
  ds_read_b128 v[224:227], v2 offset:36864
  v_mfma_f32_16x16x32_bf16 v[168:171], v[132:135], v[228:231], v[168:171]
  ds_read_b128 v[228:231], v2 offset:37888
  buffer_load_dwordx4 v1, s[4:7], s82 offen offset:2048 lds
  v_mfma_f32_16x16x32_bf16 v[172:175], v[132:135], v[232:235], v[172:175]
  ds_read_b128 v[232:235], v2 offset:38912
  v_mfma_f32_16x16x32_bf16 v[176:179], v[132:135], v[236:239], v[176:179]
  ds_read_b128 v[236:239], v2 offset:39936
  s_waitcnt lgkmcnt(8)
  v_mfma_f32_16x16x32_bf16 v[180:183], v[132:135], v[240:243], v[180:183]
  ds_read_b128 v[240:243], v2 offset:40960
  buffer_load_dwordx4 v1, s[4:7], s82 offen offset:3072 lds
  v_mfma_f32_16x16x32_bf16 v[184:187], v[132:135], v[244:247], v[184:187]
  ds_read_b128 v[244:247], v2 offset:41984
  s_waitcnt vmcnt(9)
  v_mfma_f32_16x16x32_bf16 v[164:167], v[136:139], v[248:251], v[164:167]
  ds_read_b128 v[248:251], v2 offset:43008
  v_mfma_f32_16x16x32_bf16 v[168:171], v[136:139], v[252:255], v[168:171]
  ds_read_b128 v[252:255], v2 offset:44032
  s_waitcnt lgkmcnt(8)
  v_mfma_f32_16x16x32_bf16 v[172:175], v[136:139], v[188:191], v[172:175]
  ds_read_b128 v[188:191], v2 offset:45056
  s_barrier
  v_mfma_f32_16x16x32_bf16 v[176:179], v[136:139], v[192:195], v[176:179]
  s_add_u32 s82, s82, 4096
  s_add_u32 m0, m0, 4096
  ds_read_b128 v[192:195], v2 offset:46080
  buffer_load_dwordx4 v1, s[4:7], s82 offen offset:0 lds
  v_mfma_f32_16x16x32_bf16 v[180:183], v[136:139], v[196:199], v[180:183]
  ds_read_b128 v[196:199], v2 offset:47104
  v_mfma_f32_16x16x32_bf16 v[184:187], v[136:139], v[200:203], v[184:187]
  ds_read_b128 v[200:203], v2 offset:48128
  s_waitcnt vmcnt(8) lgkmcnt(8)
  v_mfma_f32_16x16x32_bf16 v[164:167], v[140:143], v[224:227], v[164:167]
  buffer_load_dwordx4 v1, s[4:7], s82 offen offset:1024 lds
  v_mfma_f32_16x16x32_bf16 v[168:171], v[140:143], v[228:231], v[168:171]
  v_mfma_f32_16x16x32_bf16 v[172:175], v[140:143], v[232:235], v[172:175]
  v_mfma_f32_16x16x32_bf16 v[176:179], v[140:143], v[236:239], v[176:179]
  s_waitcnt lgkmcnt(4)
  s_add_u32 s82, s75, 663552
  s_add_u32 m0, s52, 0
  v_mfma_f32_16x16x32_bf16 v[180:183], v[140:143], v[240:243], v[180:183]
  buffer_load_dwordx4 v1, s[4:7], s82 offen offset:0 lds
  v_mfma_f32_16x16x32_bf16 v[184:187], v[140:143], v[244:247], v[184:187]
  s_waitcnt vmcnt(8)
  v_mfma_f32_16x16x32_bf16 v[164:167], v[144:147], v[248:251], v[164:167]
  buffer_load_dwordx4 v1, s[4:7], s82 offen offset:1024 lds
  v_mfma_f32_16x16x32_bf16 v[168:171], v[144:147], v[252:255], v[168:171]
  s_waitcnt lgkmcnt(0)
  v_mfma_f32_16x16x32_bf16 v[172:175], v[144:147], v[188:191], v[172:175]
  v_mfma_f32_16x16x32_bf16 v[176:179], v[144:147], v[192:195], v[176:179]
  buffer_load_dwordx4 v1, s[4:7], s82 offen offset:2048 lds
  v_mfma_f32_16x16x32_bf16 v[180:183], v[144:147], v[196:199], v[180:183]
  v_mfma_f32_16x16x32_bf16 v[184:187], v[144:147], v[200:203], v[184:187]
  s_barrier
  v_pk_mul_f32 v[240:241], v[152:153], v[204:205] op_sel:[0,0] op_sel_hi:[1,0]
  buffer_load_dwordx4 v1, s[4:7], s82 offen offset:3072 lds
  v_pk_mul_f32 v[242:243], v[154:155], v[204:205] op_sel:[0,0] op_sel_hi:[1,0]
  v_pk_fma_f32 v[164:165], v[164:165], v[148:149], v[240:241]
  v_pk_fma_f32 v[166:167], v[166:167], v[150:151], v[242:243]
  v_pk_mul_f32 v[240:241], v[152:153], v[204:205] op_sel:[0,1] op_sel_hi:[1,1]
  v_pk_mul_f32 v[242:243], v[154:155], v[204:205] op_sel:[0,1] op_sel_hi:[1,1]
  v_pk_fma_f32 v[168:169], v[168:169], v[148:149], v[240:241]
  v_pk_fma_f32 v[170:171], v[170:171], v[150:151], v[242:243]
  v_pk_mul_f32 v[240:241], v[152:153], v[206:207] op_sel:[0,0] op_sel_hi:[1,0]
  s_add_u32 s82, s82, 4096
  s_add_u32 m0, m0, 4096
  s_nop 0
  buffer_load_dwordx4 v1, s[4:7], s82 offen offset:0 lds
  v_pk_mul_f32 v[242:243], v[154:155], v[206:207] op_sel:[0,0] op_sel_hi:[1,0]
  v_pk_fma_f32 v[172:173], v[172:173], v[148:149], v[240:241]
  v_pk_fma_f32 v[174:175], v[174:175], v[150:151], v[242:243]
  v_pk_mul_f32 v[240:241], v[152:153], v[206:207] op_sel:[0,1] op_sel_hi:[1,1]
  v_pk_mul_f32 v[242:243], v[154:155], v[206:207] op_sel:[0,1] op_sel_hi:[1,1]
  v_pk_fma_f32 v[176:177], v[176:177], v[148:149], v[240:241]
  v_pk_fma_f32 v[178:179], v[178:179], v[150:151], v[242:243]
  v_pk_mul_f32 v[240:241], v[152:153], v[208:209] op_sel:[0,0] op_sel_hi:[1,0]
  v_pk_mul_f32 v[242:243], v[154:155], v[208:209] op_sel:[0,0] op_sel_hi:[1,0]
  v_pk_fma_f32 v[180:181], v[180:181], v[148:149], v[240:241]
  buffer_load_dwordx4 v1, s[4:7], s82 offen offset:1024 lds
  v_pk_fma_f32 v[182:183], v[182:183], v[150:151], v[242:243]
  v_pk_mul_f32 v[240:241], v[152:153], v[208:209] op_sel:[0,1] op_sel_hi:[1,1]
  v_pk_mul_f32 v[242:243], v[154:155], v[208:209] op_sel:[0,1] op_sel_hi:[1,1]
  v_pk_fma_f32 v[184:185], v[184:185], v[148:149], v[240:241]
  v_pk_fma_f32 v[186:187], v[186:187], v[150:151], v[242:243]
  v_mov_b32 v212, 0xbdd2d3e8
  v_mov_b32 v213, 0xc0135761
  v_pk_mul_f32 v[224:225], v[164:165], v[164:165]
  v_pk_mul_f32 v[226:227], v[166:167], v[166:167]
  v_pk_mul_f32 v[228:229], v[168:169], v[168:169]
  v_pk_mul_f32 v[230:231], v[170:171], v[170:171]
  v_pk_fma_f32 v[224:225], v[224:225], v[212:213], v[212:213] op_sel:[0,0,1] op_sel_hi:[1,0,1]
  v_pk_fma_f32 v[226:227], v[226:227], v[212:213], v[212:213] op_sel:[0,0,1] op_sel_hi:[1,0,1]
  s_add_u32 s82, s75, 688128
  s_add_u32 m0, s52, 49152
  s_nop 0
  buffer_load_dwordx4 v1, s[4:7], s82 offen offset:0 lds
  v_pk_fma_f32 v[228:229], v[228:229], v[212:213], v[212:213] op_sel:[0,0,1] op_sel_hi:[1,0,1]
  v_pk_fma_f32 v[230:231], v[230:231], v[212:213], v[212:213] op_sel:[0,0,1] op_sel_hi:[1,0,1]
  v_pk_mul_f32 v[224:225], v[224:225], v[164:165]
  v_pk_mul_f32 v[226:227], v[226:227], v[166:167]
  v_pk_mul_f32 v[228:229], v[228:229], v[168:169]
  v_pk_mul_f32 v[230:231], v[230:231], v[170:171]
  v_exp_f32 v224, v224
  v_exp_f32 v225, v225
  v_exp_f32 v226, v226
  v_exp_f32 v227, v227
  buffer_load_dwordx4 v1, s[4:7], s82 offen offset:1024 lds
  v_exp_f32 v228, v228
  v_exp_f32 v229, v229
  v_exp_f32 v230, v230
  v_exp_f32 v231, v231
  v_pk_add_f32 v[224:225], v[224:225], 1.0 op_sel_hi:[1,0]
  v_pk_add_f32 v[226:227], v[226:227], 1.0 op_sel_hi:[1,0]
  v_pk_add_f32 v[228:229], v[228:229], 1.0 op_sel_hi:[1,0]
  v_pk_add_f32 v[230:231], v[230:231], 1.0 op_sel_hi:[1,0]
  v_rcp_f32 v224, v224
  v_rcp_f32 v225, v225
  v_rcp_f32 v226, v226
  buffer_load_dwordx4 v1, s[4:7], s82 offen offset:2048 lds
  v_rcp_f32 v227, v227
  v_rcp_f32 v228, v228
  v_rcp_f32 v229, v229
  v_rcp_f32 v230, v230
  v_rcp_f32 v231, v231
  v_pk_mul_f32 v[164:165], v[164:165], v[224:225]
  v_pk_mul_f32 v[166:167], v[166:167], v[226:227]
  buffer_load_dwordx4 v1, s[4:7], s82 offen offset:3072 lds
  v_pk_mul_f32 v[168:169], v[168:169], v[228:229]
  v_pk_mul_f32 v[170:171], v[170:171], v[230:231]
  v_pk_mul_f32 v[232:233], v[172:173], v[172:173]
  v_pk_mul_f32 v[234:235], v[174:175], v[174:175]
  v_pk_mul_f32 v[236:237], v[176:177], v[176:177]
  v_pk_mul_f32 v[238:239], v[178:179], v[178:179]
  v_pk_fma_f32 v[232:233], v[232:233], v[212:213], v[212:213] op_sel:[0,0,1] op_sel_hi:[1,0,1]
  v_pk_fma_f32 v[234:235], v[234:235], v[212:213], v[212:213] op_sel:[0,0,1] op_sel_hi:[1,0,1]
  v_pk_fma_f32 v[236:237], v[236:237], v[212:213], v[212:213] op_sel:[0,0,1] op_sel_hi:[1,0,1]
  v_pk_fma_f32 v[238:239], v[238:239], v[212:213], v[212:213] op_sel:[0,0,1] op_sel_hi:[1,0,1]
  v_pk_mul_f32 v[232:233], v[232:233], v[172:173]
  v_pk_mul_f32 v[234:235], v[234:235], v[174:175]
  v_pk_mul_f32 v[236:237], v[236:237], v[176:177]
  s_add_u32 s82, s82, 4096
  s_add_u32 m0, m0, 4096
  s_nop 0
  buffer_load_dwordx4 v1, s[4:7], s82 offen offset:0 lds
  v_pk_mul_f32 v[238:239], v[238:239], v[178:179]
  v_exp_f32 v232, v232
  v_exp_f32 v233, v233
  v_exp_f32 v234, v234
  v_exp_f32 v235, v235
  v_exp_f32 v236, v236
  v_exp_f32 v237, v237
  v_exp_f32 v238, v238
  v_exp_f32 v239, v239
  v_pk_add_f32 v[232:233], v[232:233], 1.0 op_sel_hi:[1,0]
  v_pk_add_f32 v[234:235], v[234:235], 1.0 op_sel_hi:[1,0]
  v_pk_add_f32 v[236:237], v[236:237], 1.0 op_sel_hi:[1,0]
  v_pk_add_f32 v[238:239], v[238:239], 1.0 op_sel_hi:[1,0]
  v_rcp_f32 v232, v232
  v_rcp_f32 v233, v233
  v_rcp_f32 v234, v234
  v_rcp_f32 v235, v235
  v_rcp_f32 v236, v236
  v_rcp_f32 v237, v237
  v_rcp_f32 v238, v238
  v_rcp_f32 v239, v239
  v_pk_mul_f32 v[172:173], v[172:173], v[232:233]
  v_pk_mul_f32 v[174:175], v[174:175], v[234:235]
  v_pk_mul_f32 v[176:177], v[176:177], v[236:237]
  v_pk_mul_f32 v[178:179], v[178:179], v[238:239]
  v_pk_mul_f32 v[224:225], v[180:181], v[180:181]
  v_pk_mul_f32 v[226:227], v[182:183], v[182:183]
  v_pk_mul_f32 v[228:229], v[184:185], v[184:185]
  v_pk_mul_f32 v[230:231], v[186:187], v[186:187]
  v_pk_fma_f32 v[224:225], v[224:225], v[212:213], v[212:213] op_sel:[0,0,1] op_sel_hi:[1,0,1]
  v_pk_fma_f32 v[226:227], v[226:227], v[212:213], v[212:213] op_sel:[0,0,1] op_sel_hi:[1,0,1]
  v_pk_fma_f32 v[228:229], v[228:229], v[212:213], v[212:213] op_sel:[0,0,1] op_sel_hi:[1,0,1]
  v_pk_fma_f32 v[230:231], v[230:231], v[212:213], v[212:213] op_sel:[0,0,1] op_sel_hi:[1,0,1]
  v_pk_mul_f32 v[224:225], v[224:225], v[180:181]
  v_pk_mul_f32 v[226:227], v[226:227], v[182:183]
  v_pk_mul_f32 v[228:229], v[228:229], v[184:185]
  v_pk_mul_f32 v[230:231], v[230:231], v[186:187]
  v_exp_f32 v224, v224
  v_exp_f32 v225, v225
  v_exp_f32 v226, v226
  v_exp_f32 v227, v227
  v_exp_f32 v228, v228
  v_exp_f32 v229, v229
  v_exp_f32 v230, v230
  v_exp_f32 v231, v231
  v_pk_add_f32 v[224:225], v[224:225], 1.0 op_sel_hi:[1,0]
  v_pk_add_f32 v[226:227], v[226:227], 1.0 op_sel_hi:[1,0]
  v_pk_add_f32 v[228:229], v[228:229], 1.0 op_sel_hi:[1,0]
  v_pk_add_f32 v[230:231], v[230:231], 1.0 op_sel_hi:[1,0]
  v_rcp_f32 v224, v224
  v_rcp_f32 v225, v225
  v_rcp_f32 v226, v226
  v_rcp_f32 v227, v227
  v_rcp_f32 v228, v228
  v_rcp_f32 v229, v229
  v_rcp_f32 v230, v230
  v_rcp_f32 v231, v231
  v_pk_mul_f32 v[180:181], v[180:181], v[224:225]
  v_pk_mul_f32 v[182:183], v[182:183], v[226:227]
  v_pk_mul_f32 v[184:185], v[184:185], v[228:229]
  v_pk_mul_f32 v[186:187], v[186:187], v[230:231]
  v_pk_add_f32 v[224:225], v[164:165], v[168:169]
  v_pk_mul_f32 v[228:229], v[164:165], v[164:165]
  v_pk_add_f32 v[226:227], v[166:167], v[170:171]
  v_pk_mul_f32 v[230:231], v[166:167], v[166:167]
  v_pk_fma_f32 v[228:229], v[168:169], v[168:169], v[228:229]
  v_pk_fma_f32 v[230:231], v[170:171], v[170:171], v[230:231]
  v_pk_add_f32 v[224:225], v[224:225], v[172:173]
  v_pk_fma_f32 v[228:229], v[172:173], v[172:173], v[228:229]
  v_pk_add_f32 v[226:227], v[226:227], v[174:175]
  v_pk_fma_f32 v[230:231], v[174:175], v[174:175], v[230:231]
  v_pk_add_f32 v[224:225], v[224:225], v[176:177]
  v_pk_fma_f32 v[228:229], v[176:177], v[176:177], v[228:229]
  v_pk_add_f32 v[226:227], v[226:227], v[178:179]
  v_pk_fma_f32 v[230:231], v[178:179], v[178:179], v[230:231]
  v_pk_add_f32 v[224:225], v[224:225], v[180:181]
  v_pk_fma_f32 v[228:229], v[180:181], v[180:181], v[228:229]
  v_pk_add_f32 v[226:227], v[226:227], v[182:183]
  v_pk_fma_f32 v[230:231], v[182:183], v[182:183], v[230:231]
  v_pk_add_f32 v[224:225], v[224:225], v[184:185]
  v_pk_fma_f32 v[228:229], v[184:185], v[184:185], v[228:229]
  v_pk_add_f32 v[226:227], v[226:227], v[186:187]
  v_pk_fma_f32 v[230:231], v[186:187], v[186:187], v[230:231]
  v_add_f32_dpp v236, v224, v224 row_ror:8 row_mask:0xf bank_mask:0x3
  v_add_f32_dpp v236, v226, v226 row_ror:8 row_mask:0xf bank_mask:0xc
  v_add_f32_dpp v237, v225, v225 row_ror:8 row_mask:0xf bank_mask:0x3
  v_add_f32_dpp v237, v227, v227 row_ror:8 row_mask:0xf bank_mask:0xc
  v_add_f32_dpp v238, v228, v228 row_ror:8 row_mask:0xf bank_mask:0x3
  v_add_f32_dpp v238, v230, v230 row_ror:8 row_mask:0xf bank_mask:0xc
  v_add_f32_dpp v239, v229, v229 row_ror:8 row_mask:0xf bank_mask:0x3
  v_add_f32_dpp v239, v231, v231 row_ror:8 row_mask:0xf bank_mask:0xc
  v_add_f32_dpp v232, v236, v236 row_shl:4 row_mask:0xf bank_mask:0x5
  v_add_f32_dpp v232, v237, v237 row_shr:4 row_mask:0xf bank_mask:0xa
  v_add_f32_dpp v233, v238, v238 row_shl:4 row_mask:0xf bank_mask:0x5
  v_add_f32_dpp v233, v239, v239 row_shr:4 row_mask:0xf bank_mask:0xa
  v_add_f32_dpp v232, v232, v232 quad_perm:[1,0,3,2] row_mask:0xf bank_mask:0xf
  s_nop 0
  v_add_f32_dpp v233, v233, v233 quad_perm:[1,0,3,2] row_mask:0xf bank_mask:0xf
  v_add_f32_dpp v232, v232, v232 quad_perm:[2,3,0,1] row_mask:0xf bank_mask:0xf
  s_nop 0
  v_add_f32_dpp v233, v233, v233 quad_perm:[2,3,0,1] row_mask:0xf bank_mask:0xf
  v_mov_b32 v234, s44
  s_lshl_b32 s84, s2, 11
  s_add_u32 s84, s84, 65536
  s_lshl_b32 s85, s41, 5
  s_add_u32 s85, s85, s84
  s_cmp_eq_u32 s48, 1
  s_cbranch_scc0 L_slow83
  buffer_store_dwordx4 v[232:235], v41, s[4:7], s85 offen
L_back84:
  s_mov_b32 s88, 0
L_poll85:
  buffer_load_dwordx4 v[212:215], v42, s[4:7], s84 offen sc1
  buffer_load_dwordx4 v[216:219], v42, s[4:7], s84 offen offset:16 sc1
  s_add_u32 s88, s88, 1
  s_cmp_gt_u32 s88, 65536
  s_cbranch_scc1 L_abort
  s_waitcnt vmcnt(0)
  v_cmp_ne_u32 s[94:95], s44, v214
  v_cmp_ne_u32 vcc, s44, v218
  s_nop 0
  s_or_b64 vcc, vcc, s[94:95]
  s_cbranch_vccnz L_poll85
  v_add_f32_dpp v212, v212, v212 quad_perm:[1,0,3,2] row_mask:0xf bank_mask:0xf
  buffer_load_dwordx4 v1, s[4:7], s82 offen offset:1024 lds
  v_add_f32_dpp v213, v213, v213 quad_perm:[1,0,3,2] row_mask:0xf bank_mask:0xf
  v_add_f32_dpp v216, v216, v216 quad_perm:[1,0,3,2] row_mask:0xf bank_mask:0xf
  v_add_f32_dpp v217, v217, v217 quad_perm:[1,0,3,2] row_mask:0xf bank_mask:0xf
  v_add_f32_dpp v212, v212, v212 quad_perm:[2,3,0,1] row_mask:0xf bank_mask:0xf
  v_add_f32_dpp v213, v213, v213 quad_perm:[2,3,0,1] row_mask:0xf bank_mask:0xf
  v_add_f32_dpp v216, v216, v216 quad_perm:[2,3,0,1] row_mask:0xf bank_mask:0xf
  v_add_f32_dpp v217, v217, v217 quad_perm:[2,3,0,1] row_mask:0xf bank_mask:0xf
  v_add_f32_dpp v212, v212, v212 row_half_mirror row_mask:0xf bank_mask:0xf
  s_add_u32 s82, s75, 712704
  s_add_u32 m0, s52, 73728
  s_nop 0
  buffer_load_dwordx4 v1, s[4:7], s82 offen offset:0 lds
  v_add_f32_dpp v213, v213, v213 row_half_mirror row_mask:0xf bank_mask:0xf
  v_add_f32_dpp v216, v216, v216 row_half_mirror row_mask:0xf bank_mask:0xf
  v_add_f32_dpp v217, v217, v217 row_half_mirror row_mask:0xf bank_mask:0xf
  v_mov_b32_dpp v158, v212 row_ror:8 row_mask:0xf bank_mask:0xf
  v_mov_b32_dpp v159, v213 row_ror:8 row_mask:0xf bank_mask:0xf
  v_mov_b32_dpp v160, v216 row_ror:8 row_mask:0xf bank_mask:0xf
  v_mov_b32_dpp v161, v217 row_ror:8 row_mask:0xf bank_mask:0xf
  v_cmp_gt_u32 vcc, 8, v47
  s_nop 1
  v_cndmask_b32 v148, v158, v212, vcc
  buffer_load_dwordx4 v1, s[4:7], s82 offen offset:1024 lds
  v_cndmask_b32 v150, v212, v158, vcc
  v_cndmask_b32 v152, v159, v213, vcc
  v_cndmask_b32 v154, v213, v159, vcc
  v_cndmask_b32 v149, v160, v216, vcc
  v_cndmask_b32 v151, v216, v160, vcc
  v_cndmask_b32 v153, v161, v217, vcc
  v_cndmask_b32 v155, v217, v161, vcc
  s_mov_b32 s87, 0x3aaaaaab
  v_mul_f32 v212, 0xbaaaaaab, v148
  v_mul_f32 v213, 0xbaaaaaab, v149
  v_mul_f32 v214, 0xbaaaaaab, v150
  v_mul_f32 v215, 0xbaaaaaab, v151
  buffer_load_dwordx4 v1, s[4:7], s82 offen offset:2048 lds
  v_mul_f32 v152, s87, v152
  v_mul_f32 v153, s87, v153
  v_mul_f32 v154, s87, v154
  v_mul_f32 v155, s87, v155
  v_fma_f32 v152, -v212, v212, v152
  v_fma_f32 v153, -v213, v213, v153
  v_fma_f32 v154, -v214, v214, v154
  v_fma_f32 v155, -v215, v215, v155
  v_max_f32 v152, 0, v152
  v_max_f32 v153, 0, v153
  v_max_f32 v154, 0, v154
  v_max_f32 v155, 0, v155
  v_add_f32 v152, 0x3727c5ac, v152
  buffer_load_dwordx4 v1, s[4:7], s82 offen offset:3072 lds
  v_add_f32 v153, 0x3727c5ac, v153
  v_add_f32 v154, 0x3727c5ac, v154
  v_add_f32 v155, 0x3727c5ac, v155
  v_rsq_f32 v148, v152
  v_rsq_f32 v149, v153
  v_rsq_f32 v150, v154
  v_rsq_f32 v151, v155
  v_mul_f32 v212, v212, v148
  v_mul_f32 v213, v213, v149
  s_add_u32 s82, s82, 4096
  s_add_u32 m0, m0, 4096
  s_nop 0
  buffer_load_dwordx4 v1, s[4:7], s82 offen offset:0 lds
  v_mul_f32 v214, v214, v150
  v_mul_f32 v215, v215, v151
  s_lshr_b32 s84, s2, 1
  s_mul_i32 s84, s84, 6144
  s_and_b32 s85, s40, 1
  s_lshl_b32 s85, s85, 9
  s_add_u32 s84, s84, s85
  s_mul_i32 s85, s41, 393216
  s_add_u32 s84, s84, s85
  s_add_u32 s84, s84, 15204352
  s_add_u32 s85, s84, 4096
  v_pk_fma_f32 v[164:165], v[164:165], v[148:149], v[212:213]
  buffer_load_dwordx4 v1, s[4:7], s82 offen offset:1024 lds
  v_pk_fma_f32 v[166:167], v[166:167], v[150:151], v[214:215]
  v_pk_fma_f32 v[168:169], v[168:169], v[148:149], v[212:213]
  v_pk_fma_f32 v[170:171], v[170:171], v[150:151], v[214:215]
  v_cvt_pk_bf16_f32 v164, v164, v165
  v_cvt_pk_bf16_f32 v165, v166, v167
  v_cvt_pk_bf16_f32 v166, v168, v169
  v_cvt_pk_bf16_f32 v167, v170, v171
  s_nop 0
  v_permlane16_swap_b32 v164, v166
  v_permlane16_swap_b32 v165, v167
  buffer_store_dwordx4 v[164:167], v26, s[4:7], s84 offen offset:0 sc1
  v_pk_fma_f32 v[172:173], v[172:173], v[148:149], v[212:213]
  v_pk_fma_f32 v[174:175], v[174:175], v[150:151], v[214:215]
  v_pk_fma_f32 v[176:177], v[176:177], v[148:149], v[212:213]
  v_pk_fma_f32 v[178:179], v[178:179], v[150:151], v[214:215]
  v_cvt_pk_bf16_f32 v172, v172, v173
  v_cvt_pk_bf16_f32 v173, v174, v175
  v_cvt_pk_bf16_f32 v174, v176, v177
  v_cvt_pk_bf16_f32 v175, v178, v179
  s_nop 0
  v_permlane16_swap_b32 v172, v174
  v_permlane16_swap_b32 v173, v175
  buffer_store_dwordx4 v[172:175], v26, s[4:7], s84 offen offset:2048 sc1
  v_pk_fma_f32 v[180:181], v[180:181], v[148:149], v[212:213]
  v_pk_fma_f32 v[182:183], v[182:183], v[150:151], v[214:215]
  v_pk_fma_f32 v[184:185], v[184:185], v[148:149], v[212:213]
  v_pk_fma_f32 v[186:187], v[186:187], v[150:151], v[214:215]
  v_cvt_pk_bf16_f32 v180, v180, v181
  v_cvt_pk_bf16_f32 v181, v182, v183
  v_cvt_pk_bf16_f32 v182, v184, v185
  v_cvt_pk_bf16_f32 v183, v186, v187
  s_nop 0
  v_permlane16_swap_b32 v180, v182
  v_permlane16_swap_b32 v181, v183
  buffer_store_dwordx4 v[180:183], v26, s[4:7], s85 offen offset:0 sc1
L_ph_z11:
  s_barrier
  ds_read_b128 v[224:227], v2 offset:49152
  ds_read_b128 v[228:231], v2 offset:50176
  ds_read_b128 v[232:235], v2 offset:51200
  ds_read_b128 v[236:239], v2 offset:52224
  ds_read_b128 v[240:243], v2 offset:53248
  ds_read_b128 v[244:247], v2 offset:54272
  ds_read_b128 v[248:251], v2 offset:55296
  ds_read_b128 v[252:255], v2 offset:56320
  ds_read_b128 v[168:171], v2 offset:57344
  ds_read_b128 v[176:179], v2 offset:58368
  ds_read_b128 v[184:187], v2 offset:59392
  s_waitcnt lgkmcnt(7)
  v_mfma_f32_16x16x32_bf16 v[188:191], v[224:227], v[68:71], 0
  ds_read_b128 v[224:227], v2 offset:60416
  s_add_u32 s100, s101, L_ph_sp1-L_base
  buffer_load_dword v222, v13, s[96:99], s100 offen
  v_mfma_f32_16x16x32_bf16 v[192:195], v[228:231], v[68:71], 0
  ds_read_b128 v[228:231], v2 offset:61440
  v_mfma_f32_16x16x32_bf16 v[196:199], v[232:235], v[68:71], 0
  ds_read_b128 v[232:235], v2 offset:62464
  v_mfma_f32_16x16x32_bf16 v[200:203], v[236:239], v[68:71], 0
  ds_read_b128 v[236:239], v2 offset:63488
  s_waitcnt lgkmcnt(7)
  v_mfma_f32_16x16x32_bf16 v[204:207], v[240:243], v[68:71], 0
  ds_read_b128 v[240:243], v2 offset:64512
  v_mfma_f32_16x16x32_bf16 v[208:211], v[244:247], v[68:71], 0
  ds_read_b128 v[244:247], v3 offset:0
  v_mfma_f32_16x16x32_bf16 v[188:191], v[248:251], v[72:75], v[188:191]
  ds_read_b128 v[248:251], v3 offset:1024
  v_mfma_f32_16x16x32_bf16 v[192:195], v[252:255], v[72:75], v[192:195]
  ds_read_b128 v[252:255], v3 offset:2048
  s_waitcnt lgkmcnt(7)
  v_mfma_f32_16x16x32_bf16 v[196:199], v[168:171], v[72:75], v[196:199]
  ds_read_b128 v[168:171], v3 offset:3072
  s_barrier
  v_mfma_f32_16x16x32_bf16 v[200:203], v[176:179], v[72:75], v[200:203]
  ds_read_b128 v[176:179], v3 offset:4096
  v_mfma_f32_16x16x32_bf16 v[204:207], v[184:187], v[72:75], v[204:207]
  ds_read_b128 v[184:187], v3 offset:5120
  v_mfma_f32_16x16x32_bf16 v[208:211], v[224:227], v[72:75], v[208:211]
  ds_read_b128 v[224:227], v3 offset:6144
  s_waitcnt lgkmcnt(7)
  v_mfma_f32_16x16x32_bf16 v[188:191], v[228:231], v[76:79], v[188:191]
  ds_read_b128 v[228:231], v3 offset:7168
  v_mfma_f32_16x16x32_bf16 v[192:195], v[232:235], v[76:79], v[192:195]
  ds_read_b128 v[232:235], v1 offset:24576
  v_mfma_f32_16x16x32_bf16 v[196:199], v[236:239], v[76:79], v[196:199]
  ds_read_b128 v[236:239], v1 offset:25600
  v_mfma_f32_16x16x32_bf16 v[200:203], v[240:243], v[76:79], v[200:203]
  ds_read_b128 v[240:243], v1 offset:26624
  s_waitcnt lgkmcnt(7)
  v_mfma_f32_16x16x32_bf16 v[204:207], v[244:247], v[76:79], v[204:207]
  ds_read_b128 v[244:247], v1 offset:27648
  v_mfma_f32_16x16x32_bf16 v[208:211], v[248:251], v[76:79], v[208:211]
  ds_read_b128 v[248:251], v1 offset:28672
  v_mfma_f32_16x16x32_bf16 v[188:191], v[252:255], v[80:83], v[188:191]
  ds_read_b128 v[252:255], v1 offset:29696
  v_mfma_f32_16x16x32_bf16 v[192:195], v[168:171], v[80:83], v[192:195]
  ds_read_b128 v[168:171], v1 offset:30720
  s_waitcnt lgkmcnt(7)
  v_mfma_f32_16x16x32_bf16 v[196:199], v[176:179], v[80:83], v[196:199]
  ds_read_b128 v[176:179], v1 offset:31744
  v_mfma_f32_16x16x32_bf16 v[200:203], v[184:187], v[80:83], v[200:203]
  ds_read_b128 v[184:187], v1 offset:32768
  v_mfma_f32_16x16x32_bf16 v[204:207], v[224:227], v[80:83], v[204:207]
  ds_read_b128 v[224:227], v1 offset:33792
  v_mfma_f32_16x16x32_bf16 v[208:211], v[228:231], v[80:83], v[208:211]
  ds_read_b128 v[228:231], v1 offset:34816
  s_waitcnt lgkmcnt(7)
  v_mfma_f32_16x16x32_bf16 v[188:191], v[232:235], v[84:87], v[188:191]
  ds_read_b128 v[232:235], v1 offset:35840
  v_mfma_f32_16x16x32_bf16 v[192:195], v[236:239], v[84:87], v[192:195]
  ds_read_b128 v[236:239], v1 offset:36864
  v_mfma_f32_16x16x32_bf16 v[196:199], v[240:243], v[84:87], v[196:199]
  ds_read_b128 v[240:243], v1 offset:37888
  v_mfma_f32_16x16x32_bf16 v[200:203], v[244:247], v[84:87], v[200:203]
  ds_read_b128 v[244:247], v1 offset:38912
  s_waitcnt lgkmcnt(7)
  v_mfma_f32_16x16x32_bf16 v[204:207], v[248:251], v[84:87], v[204:207]
  ds_read_b128 v[248:251], v1 offset:39936
  v_mfma_f32_16x16x32_bf16 v[208:211], v[252:255], v[84:87], v[208:211]
  ds_read_b128 v[252:255], v1 offset:40960
  v_mfma_f32_16x16x32_bf16 v[188:191], v[168:171], v[88:91], v[188:191]
  ds_read_b128 v[168:171], v1 offset:41984
  v_mfma_f32_16x16x32_bf16 v[192:195], v[176:179], v[88:91], v[192:195]
  ds_read_b128 v[176:179], v1 offset:43008
  s_waitcnt lgkmcnt(7)
  v_mfma_f32_16x16x32_bf16 v[196:199], v[184:187], v[88:91], v[196:199]
  ds_read_b128 v[184:187], v1 offset:44032
  s_barrier
  v_mfma_f32_16x16x32_bf16 v[200:203], v[224:227], v[88:91], v[200:203]
  s_add_u32 s82, s75, 737280
  s_add_u32 m0, s43, 98304
  ds_read_b128 v[224:227], v1 offset:45056
  buffer_load_dwordx4 v1, s[4:7], s82 offen offset:0 lds
  v_mfma_f32_16x16x32_bf16 v[204:207], v[228:231], v[88:91], v[204:207]
  ds_read_b128 v[228:231], v1 offset:46080
  v_mfma_f32_16x16x32_bf16 v[208:211], v[232:235], v[88:91], v[208:211]
  ds_read_b128 v[232:235], v1 offset:47104
  s_waitcnt lgkmcnt(7)
  v_mfma_f32_16x16x32_bf16 v[188:191], v[236:239], v[92:95], v[188:191]
  ds_read_b128 v[236:239], v1 offset:48128
  buffer_load_dwordx4 v1, s[4:7], s82 offen offset:1024 lds
  v_mfma_f32_16x16x32_bf16 v[192:195], v[240:243], v[92:95], v[192:195]
  ds_read_b128 v[240:243], v1 offset:0
  v_mfma_f32_16x16x32_bf16 v[196:199], v[244:247], v[92:95], v[196:199]
  ds_read_b128 v[244:247], v1 offset:1024
  v_mfma_f32_16x16x32_bf16 v[200:203], v[248:251], v[92:95], v[200:203]
  ds_read_b128 v[248:251], v1 offset:2048
  buffer_load_dwordx4 v1, s[4:7], s82 offen offset:2048 lds
  s_waitcnt lgkmcnt(7)
  v_mfma_f32_16x16x32_bf16 v[204:207], v[252:255], v[92:95], v[204:207]
  ds_read_b128 v[252:255], v1 offset:3072
  v_mfma_f32_16x16x32_bf16 v[208:211], v[168:171], v[92:95], v[208:211]
  ds_read_b128 v[168:171], v1 offset:4096
  v_mfma_f32_16x16x32_bf16 v[188:191], v[176:179], v[96:99], v[188:191]
  ds_read_b128 v[176:179], v1 offset:5120
  buffer_load_dwordx4 v1, s[4:7], s82 offen offset:3072 lds
  v_mfma_f32_16x16x32_bf16 v[192:195], v[184:187], v[96:99], v[192:195]
  ds_read_b128 v[184:187], v1 offset:6144
  s_waitcnt lgkmcnt(7)
  v_mfma_f32_16x16x32_bf16 v[196:199], v[224:227], v[96:99], v[196:199]
  ds_read_b128 v[224:227], v1 offset:7168
  v_mfma_f32_16x16x32_bf16 v[200:203], v[228:231], v[96:99], v[200:203]
  ds_read_b128 v[228:231], v1 offset:8192
  v_mfma_f32_16x16x32_bf16 v[204:207], v[232:235], v[96:99], v[204:207]
  s_add_u32 s82, s82, 4096
  s_add_u32 m0, m0, 4096
  ds_read_b128 v[232:235], v1 offset:9216
  buffer_load_dwordx4 v1, s[4:7], s82 offen offset:0 lds
  v_mfma_f32_16x16x32_bf16 v[208:211], v[236:239], v[96:99], v[208:211]
  ds_read_b128 v[236:239], v1 offset:10240
  s_waitcnt vmcnt(6)
  s_lshl_b32 s84, s41, 9
  s_lshl_b32 s85, s2, 2
  s_add_u32 s84, s84, s85
  s_add_u32 s84, s84, 61440
  buffer_store_dword v25, v13, s[4:7], s84 offen sc1
  s_waitcnt lgkmcnt(7)
  v_mfma_f32_16x16x32_bf16 v[188:191], v[240:243], v[100:103], v[188:191]
  ds_read_b128 v[240:243], v1 offset:11264
  v_mfma_f32_16x16x32_bf16 v[192:195], v[244:247], v[100:103], v[192:195]
  s_add_u32 s82, s75, 761856
  s_add_u32 m0, s43, 118784
  ds_read_b128 v[244:247], v1 offset:12288
  buffer_load_dwordx4 v1, s[4:7], s82 offen offset:0 lds
  v_mfma_f32_16x16x32_bf16 v[196:199], v[248:251], v[100:103], v[196:199]
  ds_read_b128 v[248:251], v1 offset:13312
  v_mfma_f32_16x16x32_bf16 v[200:203], v[252:255], v[100:103], v[200:203]
  ds_read_b128 v[252:255], v1 offset:14336
  s_waitcnt lgkmcnt(7)
  v_mfma_f32_16x16x32_bf16 v[204:207], v[168:171], v[100:103], v[204:207]
  ds_read_b128 v[168:171], v1 offset:15360
  buffer_load_dwordx4 v1, s[4:7], s82 offen offset:1024 lds
  v_mfma_f32_16x16x32_bf16 v[208:211], v[176:179], v[100:103], v[208:211]
  ds_read_b128 v[176:179], v1 offset:16384
  v_mfma_f32_16x16x32_bf16 v[188:191], v[184:187], v[104:107], v[188:191]
  ds_read_b128 v[184:187], v1 offset:17408
  v_mfma_f32_16x16x32_bf16 v[192:195], v[224:227], v[104:107], v[192:195]
  ds_read_b128 v[224:227], v1 offset:18432
  s_waitcnt lgkmcnt(7)
  v_mfma_f32_16x16x32_bf16 v[196:199], v[228:231], v[104:107], v[196:199]
  ds_read_b128 v[228:231], v1 offset:19456
  s_barrier
  v_mfma_f32_16x16x32_bf16 v[200:203], v[232:235], v[104:107], v[200:203]
  ds_read_b128 v[232:235], v1 offset:20480
  buffer_load_dwordx4 v1, s[4:7], s82 offen offset:2048 lds
  v_mfma_f32_16x16x32_bf16 v[204:207], v[236:239], v[104:107], v[204:207]
  ds_read_b128 v[236:239], v1 offset:21504
  v_mfma_f32_16x16x32_bf16 v[208:211], v[240:243], v[104:107], v[208:211]
  ds_read_b128 v[240:243], v1 offset:22528
  s_waitcnt lgkmcnt(7)
  v_mfma_f32_16x16x32_bf16 v[188:191], v[244:247], v[108:111], v[188:191]
  ds_read_b128 v[244:247], v1 offset:23552
  buffer_load_dwordx4 v1, s[4:7], s82 offen offset:3072 lds
  v_mfma_f32_16x16x32_bf16 v[192:195], v[248:251], v[108:111], v[192:195]
  ds_read_b128 v[248:251], v1 offset:49152
  v_mfma_f32_16x16x32_bf16 v[196:199], v[252:255], v[108:111], v[196:199]
  ds_read_b128 v[252:255], v1 offset:50176
  v_mfma_f32_16x16x32_bf16 v[200:203], v[168:171], v[108:111], v[200:203]
  s_add_u32 s82, s82, 4096
  s_add_u32 m0, m0, 4096
  ds_read_b128 v[168:171], v1 offset:51200
  buffer_load_dwordx4 v1, s[4:7], s82 offen offset:0 lds
  s_waitcnt lgkmcnt(7)
  v_mfma_f32_16x16x32_bf16 v[204:207], v[176:179], v[108:111], v[204:207]
  ds_read_b128 v[176:179], v1 offset:52224
  v_mfma_f32_16x16x32_bf16 v[208:211], v[184:187], v[108:111], v[208:211]
  ds_read_b128 v[184:187], v1 offset:53248
  v_mfma_f32_16x16x32_bf16 v[188:191], v[224:227], v[112:115], v[188:191]
  s_add_u32 s82, s75, 786432
  s_add_u32 m0, s43, 24576
  ds_read_b128 v[224:227], v1 offset:54272
  buffer_load_dwordx4 v1, s[4:7], s82 offen offset:0 lds
  v_mfma_f32_16x16x32_bf16 v[192:195], v[228:231], v[112:115], v[192:195]
  ds_read_b128 v[228:231], v1 offset:55296
  s_waitcnt lgkmcnt(7)
  v_mfma_f32_16x16x32_bf16 v[196:199], v[232:235], v[112:115], v[196:199]
  ds_read_b128 v[232:235], v1 offset:56320
  v_mfma_f32_16x16x32_bf16 v[200:203], v[236:239], v[112:115], v[200:203]
  ds_read_b128 v[236:239], v1 offset:57344
  buffer_load_dwordx4 v1, s[4:7], s82 offen offset:1024 lds
  v_mfma_f32_16x16x32_bf16 v[204:207], v[240:243], v[112:115], v[204:207]
  ds_read_b128 v[240:243], v1 offset:58368
  v_mfma_f32_16x16x32_bf16 v[208:211], v[244:247], v[112:115], v[208:211]
  ds_read_b128 v[244:247], v1 offset:59392
  s_waitcnt lgkmcnt(7)
  v_mfma_f32_16x16x32_bf16 v[188:191], v[248:251], v[116:119], v[188:191]
  ds_read_b128 v[248:251], v1 offset:60416
  buffer_load_dwordx4 v1, s[4:7], s82 offen offset:2048 lds
  v_mfma_f32_16x16x32_bf16 v[192:195], v[252:255], v[116:119], v[192:195]
  ds_read_b128 v[252:255], v1 offset:61440
  v_mfma_f32_16x16x32_bf16 v[196:199], v[168:171], v[116:119], v[196:199]
  ds_read_b128 v[168:171], v1 offset:62464
  v_mfma_f32_16x16x32_bf16 v[200:203], v[176:179], v[116:119], v[200:203]
  ds_read_b128 v[176:179], v1 offset:63488
  s_waitcnt lgkmcnt(7)
  v_mfma_f32_16x16x32_bf16 v[204:207], v[184:187], v[116:119], v[204:207]
  ds_read_b128 v[184:187], v1 offset:64512
  buffer_load_dwordx4 v1, s[4:7], s82 offen offset:3072 lds
  v_mfma_f32_16x16x32_bf16 v[208:211], v[224:227], v[116:119], v[208:211]
  ds_read_b128 v[224:227], v2 offset:0
  v_mfma_f32_16x16x32_bf16 v[188:191], v[228:231], v[120:123], v[188:191]
  ds_read_b128 v[228:231], v2 offset:1024
  v_mfma_f32_16x16x32_bf16 v[192:195], v[232:235], v[120:123], v[192:195]
  s_add_u32 s82, s82, 4096
  s_add_u32 m0, m0, 4096
  ds_read_b128 v[232:235], v2 offset:2048
  buffer_load_dwordx4 v1, s[4:7], s82 offen offset:0 lds
  s_waitcnt lgkmcnt(7)
  v_mfma_f32_16x16x32_bf16 v[196:199], v[236:239], v[120:123], v[196:199]
  ds_read_b128 v[236:239], v2 offset:3072
  s_barrier
  v_mfma_f32_16x16x32_bf16 v[200:203], v[240:243], v[120:123], v[200:203]
  ds_read_b128 v[240:243], v2 offset:4096
  v_mfma_f32_16x16x32_bf16 v[204:207], v[244:247], v[120:123], v[204:207]
  ds_read_b128 v[244:247], v2 offset:5120
  v_mfma_f32_16x16x32_bf16 v[208:211], v[248:251], v[120:123], v[208:211]
  ds_read_b128 v[248:251], v2 offset:6144
  s_waitcnt lgkmcnt(7)
  v_mfma_f32_16x16x32_bf16 v[188:191], v[252:255], v[124:127], v[188:191]
  ds_read_b128 v[252:255], v2 offset:7168
  v_mfma_f32_16x16x32_bf16 v[192:195], v[168:171], v[124:127], v[192:195]
  ds_read_b128 v[168:171], v2 offset:8192
  v_mfma_f32_16x16x32_bf16 v[196:199], v[176:179], v[124:127], v[196:199]
  ds_read_b128 v[176:179], v2 offset:9216
  v_mfma_f32_16x16x32_bf16 v[200:203], v[184:187], v[124:127], v[200:203]
  ds_read_b128 v[184:187], v2 offset:10240
  s_waitcnt lgkmcnt(7)
  v_mfma_f32_16x16x32_bf16 v[204:207], v[224:227], v[124:127], v[204:207]
  ds_read_b128 v[224:227], v2 offset:11264
  v_mfma_f32_16x16x32_bf16 v[208:211], v[228:231], v[124:127], v[208:211]
  ds_read_b128 v[228:231], v2 offset:12288
  v_mfma_f32_16x16x32_bf16 v[188:191], v[232:235], v[128:131], v[188:191]
  ds_read_b128 v[232:235], v2 offset:13312
  v_mfma_f32_16x16x32_bf16 v[192:195], v[236:239], v[128:131], v[192:195]
  ds_read_b128 v[236:239], v2 offset:14336
  s_waitcnt lgkmcnt(7)
  v_mfma_f32_16x16x32_bf16 v[196:199], v[240:243], v[128:131], v[196:199]
  ds_read_b128 v[240:243], v2 offset:15360
  v_mfma_f32_16x16x32_bf16 v[200:203], v[244:247], v[128:131], v[200:203]
  ds_read_b128 v[244:247], v2 offset:16384
  v_mfma_f32_16x16x32_bf16 v[204:207], v[248:251], v[128:131], v[204:207]
  ds_read_b128 v[248:251], v2 offset:17408
  v_mfma_f32_16x16x32_bf16 v[208:211], v[252:255], v[128:131], v[208:211]
  ds_read_b128 v[252:255], v2 offset:18432
  s_waitcnt lgkmcnt(7)
  v_mfma_f32_16x16x32_bf16 v[188:191], v[168:171], v[132:135], v[188:191]
  ds_read_b128 v[168:171], v2 offset:19456
  v_mfma_f32_16x16x32_bf16 v[192:195], v[176:179], v[132:135], v[192:195]
  ds_read_b128 v[176:179], v2 offset:20480
  v_mfma_f32_16x16x32_bf16 v[196:199], v[184:187], v[132:135], v[196:199]
  ds_read_b128 v[184:187], v2 offset:21504
  v_mfma_f32_16x16x32_bf16 v[200:203], v[224:227], v[132:135], v[200:203]
  ds_read_b128 v[224:227], v2 offset:22528
  s_waitcnt lgkmcnt(7)
  v_mfma_f32_16x16x32_bf16 v[204:207], v[228:231], v[132:135], v[204:207]
  ds_read_b128 v[228:231], v2 offset:23552
  v_mfma_f32_16x16x32_bf16 v[208:211], v[232:235], v[132:135], v[208:211]
  ds_read_b128 v[232:235], v2 offset:24576
  v_mfma_f32_16x16x32_bf16 v[188:191], v[236:239], v[136:139], v[188:191]
  ds_read_b128 v[236:239], v2 offset:25600
  v_mfma_f32_16x16x32_bf16 v[192:195], v[240:243], v[136:139], v[192:195]
  ds_read_b128 v[240:243], v2 offset:26624
  s_waitcnt lgkmcnt(7)
  v_mfma_f32_16x16x32_bf16 v[196:199], v[244:247], v[136:139], v[196:199]
  ds_read_b128 v[244:247], v2 offset:27648
  s_barrier
  v_mfma_f32_16x16x32_bf16 v[200:203], v[248:251], v[136:139], v[200:203]
  ds_read_b128 v[248:251], v2 offset:28672
  v_mfma_f32_16x16x32_bf16 v[204:207], v[252:255], v[136:139], v[204:207]
  ds_read_b128 v[252:255], v2 offset:29696
  v_mfma_f32_16x16x32_bf16 v[208:211], v[168:171], v[136:139], v[208:211]
  ds_read_b128 v[168:171], v2 offset:30720
  s_waitcnt lgkmcnt(7)
  v_mfma_f32_16x16x32_bf16 v[188:191], v[176:179], v[140:143], v[188:191]
  ds_read_b128 v[176:179], v2 offset:31744
  v_mfma_f32_16x16x32_bf16 v[192:195], v[184:187], v[140:143], v[192:195]
  v_mfma_f32_16x16x32_bf16 v[196:199], v[224:227], v[140:143], v[196:199]
  v_mfma_f32_16x16x32_bf16 v[200:203], v[228:231], v[140:143], v[200:203]
  s_waitcnt lgkmcnt(4)
  v_mfma_f32_16x16x32_bf16 v[204:207], v[232:235], v[140:143], v[204:207]
  v_mfma_f32_16x16x32_bf16 v[208:211], v[236:239], v[140:143], v[208:211]
  v_mfma_f32_16x16x32_bf16 v[188:191], v[240:243], v[144:147], v[188:191]
  s_add_u32 s82, s75, 811008
  s_add_u32 m0, s43, 0
  v_mfma_f32_16x16x32_bf16 v[192:195], v[244:247], v[144:147], v[192:195]
  buffer_load_dwordx4 v1, s[4:7], s82 offen offset:0 lds
  s_waitcnt lgkmcnt(0)
  v_mfma_f32_16x16x32_bf16 v[196:199], v[248:251], v[144:147], v[196:199]
  v_mfma_f32_16x16x32_bf16 v[200:203], v[252:255], v[144:147], v[200:203]
  v_mfma_f32_16x16x32_bf16 v[204:207], v[168:171], v[144:147], v[204:207]
  v_mfma_f32_16x16x32_bf16 v[208:211], v[176:179], v[144:147], v[208:211]
  buffer_load_dwordx4 v1, s[4:7], s82 offen offset:1024 lds
  s_barrier
  ds_read_b128 v[224:227], v28 offset:1920
  ds_read_b128 v[228:231], v28 offset:1984
  ds_read_b128 v[232:235], v28 offset:2048
  ds_read_b128 v[236:239], v28 offset:2112
  ds_read_b128 v[240:243], v28 offset:2176
  ds_read_b128 v[244:247], v28 offset:2240
  s_waitcnt lgkmcnt(5)
  v_pk_mul_f32 v[224:225], v[224:225], v[156:157] op_sel:[0,1] op_sel_hi:[1,1]
  buffer_load_dwordx4 v1, s[4:7], s82 offen offset:2048 lds
  v_pk_mul_f32 v[226:227], v[226:227], v[156:157] op_sel:[0,1] op_sel_hi:[1,1]
  v_pk_fma_f32 v[188:189], v[188:189], v[156:157], v[224:225] op_sel_hi:[1,0,1]
  v_pk_fma_f32 v[190:191], v[190:191], v[156:157], v[226:227] op_sel_hi:[1,0,1]
  s_waitcnt lgkmcnt(4)
  v_pk_mul_f32 v[228:229], v[228:229], v[156:157] op_sel:[0,1] op_sel_hi:[1,1]
  v_pk_mul_f32 v[230:231], v[230:231], v[156:157] op_sel:[0,1] op_sel_hi:[1,1]
  v_pk_fma_f32 v[192:193], v[192:193], v[156:157], v[228:229] op_sel_hi:[1,0,1]
  v_pk_fma_f32 v[194:195], v[194:195], v[156:157], v[230:231] op_sel_hi:[1,0,1]
  s_waitcnt lgkmcnt(3)
  v_pk_mul_f32 v[232:233], v[232:233], v[156:157] op_sel:[0,1] op_sel_hi:[1,1]
  v_pk_mul_f32 v[234:235], v[234:235], v[156:157] op_sel:[0,1] op_sel_hi:[1,1]
  v_pk_fma_f32 v[196:197], v[196:197], v[156:157], v[232:233] op_sel_hi:[1,0,1]
  buffer_load_dwordx4 v1, s[4:7], s82 offen offset:3072 lds
  v_pk_fma_f32 v[198:199], v[198:199], v[156:157], v[234:235] op_sel_hi:[1,0,1]
  s_waitcnt lgkmcnt(2)
  v_pk_mul_f32 v[236:237], v[236:237], v[156:157] op_sel:[0,1] op_sel_hi:[1,1]
  v_pk_mul_f32 v[238:239], v[238:239], v[156:157] op_sel:[0,1] op_sel_hi:[1,1]
  v_pk_fma_f32 v[200:201], v[200:201], v[156:157], v[236:237] op_sel_hi:[1,0,1]
  v_pk_fma_f32 v[202:203], v[202:203], v[156:157], v[238:239] op_sel_hi:[1,0,1]
  s_waitcnt lgkmcnt(1)
  v_pk_mul_f32 v[240:241], v[240:241], v[156:157] op_sel:[0,1] op_sel_hi:[1,1]
  v_pk_mul_f32 v[242:243], v[242:243], v[156:157] op_sel:[0,1] op_sel_hi:[1,1]
  v_pk_fma_f32 v[204:205], v[204:205], v[156:157], v[240:241] op_sel_hi:[1,0,1]
  v_pk_fma_f32 v[206:207], v[206:207], v[156:157], v[242:243] op_sel_hi:[1,0,1]
  s_waitcnt lgkmcnt(0)
  v_pk_mul_f32 v[244:245], v[244:245], v[156:157] op_sel:[0,1] op_sel_hi:[1,1]
  v_pk_mul_f32 v[246:247], v[246:247], v[156:157] op_sel:[0,1] op_sel_hi:[1,1]
  v_pk_fma_f32 v[208:209], v[208:209], v[156:157], v[244:245] op_sel_hi:[1,0,1]
  v_pk_fma_f32 v[210:211], v[210:211], v[156:157], v[246:247] op_sel_hi:[1,0,1]
  v_mov_b32 v212, 0xbdd2d3e8
  s_add_u32 s82, s82, 4096
  s_add_u32 m0, m0, 4096
  s_nop 0
  buffer_load_dwordx4 v1, s[4:7], s82 offen offset:0 lds
  v_mov_b32 v213, 0xc0135761
  v_pk_mul_f32 v[224:225], v[188:189], v[188:189]
  v_pk_mul_f32 v[226:227], v[190:191], v[190:191]
  v_pk_mul_f32 v[228:229], v[192:193], v[192:193]
  v_pk_mul_f32 v[230:231], v[194:195], v[194:195]
  v_pk_fma_f32 v[224:225], v[224:225], v[212:213], v[212:213] op_sel:[0,0,1] op_sel_hi:[1,0,1]
  v_pk_fma_f32 v[226:227], v[226:227], v[212:213], v[212:213] op_sel:[0,0,1] op_sel_hi:[1,0,1]
  v_pk_fma_f32 v[228:229], v[228:229], v[212:213], v[212:213] op_sel:[0,0,1] op_sel_hi:[1,0,1]
  v_pk_fma_f32 v[230:231], v[230:231], v[212:213], v[212:213] op_sel:[0,0,1] op_sel_hi:[1,0,1]
  v_pk_mul_f32 v[224:225], v[224:225], v[188:189]
  v_pk_mul_f32 v[226:227], v[226:227], v[190:191]
  v_pk_mul_f32 v[228:229], v[228:229], v[192:193]
  v_pk_mul_f32 v[230:231], v[230:231], v[194:195]
  v_exp_f32 v224, v224
  v_exp_f32 v225, v225
  v_exp_f32 v226, v226
  v_exp_f32 v227, v227
  v_exp_f32 v228, v228
  v_exp_f32 v229, v229
  v_exp_f32 v230, v230
  v_exp_f32 v231, v231
  v_pk_add_f32 v[224:225], v[224:225], 1.0 op_sel_hi:[1,0]
  v_pk_add_f32 v[226:227], v[226:227], 1.0 op_sel_hi:[1,0]
  v_pk_add_f32 v[228:229], v[228:229], 1.0 op_sel_hi:[1,0]
  v_pk_add_f32 v[230:231], v[230:231], 1.0 op_sel_hi:[1,0]
  v_rcp_f32 v224, v224
  v_rcp_f32 v225, v225
  v_rcp_f32 v226, v226
  v_rcp_f32 v227, v227
  v_rcp_f32 v228, v228
  v_rcp_f32 v229, v229
  v_rcp_f32 v230, v230
  v_rcp_f32 v231, v231
  v_pk_mul_f32 v[188:189], v[188:189], v[224:225]
  v_pk_mul_f32 v[190:191], v[190:191], v[226:227]
  v_pk_mul_f32 v[192:193], v[192:193], v[228:229]
  v_pk_mul_f32 v[194:195], v[194:195], v[230:231]
  v_pk_mul_f32 v[232:233], v[196:197], v[196:197]
  v_pk_mul_f32 v[234:235], v[198:199], v[198:199]
  v_pk_mul_f32 v[236:237], v[200:201], v[200:201]
  v_pk_mul_f32 v[238:239], v[202:203], v[202:203]
  v_pk_fma_f32 v[232:233], v[232:233], v[212:213], v[212:213] op_sel:[0,0,1] op_sel_hi:[1,0,1]
  v_pk_fma_f32 v[234:235], v[234:235], v[212:213], v[212:213] op_sel:[0,0,1] op_sel_hi:[1,0,1]
  v_pk_fma_f32 v[236:237], v[236:237], v[212:213], v[212:213] op_sel:[0,0,1] op_sel_hi:[1,0,1]
  v_pk_fma_f32 v[238:239], v[238:239], v[212:213], v[212:213] op_sel:[0,0,1] op_sel_hi:[1,0,1]
  v_pk_mul_f32 v[232:233], v[232:233], v[196:197]
  v_pk_mul_f32 v[234:235], v[234:235], v[198:199]
  v_pk_mul_f32 v[236:237], v[236:237], v[200:201]
  v_pk_mul_f32 v[238:239], v[238:239], v[202:203]
  v_exp_f32 v232, v232
  v_exp_f32 v233, v233
  v_exp_f32 v234, v234
  v_exp_f32 v235, v235
  v_exp_f32 v236, v236
  v_exp_f32 v237, v237
  v_exp_f32 v238, v238
  v_exp_f32 v239, v239
  v_pk_add_f32 v[232:233], v[232:233], 1.0 op_sel_hi:[1,0]
  v_pk_add_f32 v[234:235], v[234:235], 1.0 op_sel_hi:[1,0]
  v_pk_add_f32 v[236:237], v[236:237], 1.0 op_sel_hi:[1,0]
  v_pk_add_f32 v[238:239], v[238:239], 1.0 op_sel_hi:[1,0]
  v_rcp_f32 v232, v232
  v_rcp_f32 v233, v233
  v_rcp_f32 v234, v234
  v_rcp_f32 v235, v235
  v_rcp_f32 v236, v236
  v_rcp_f32 v237, v237
  v_rcp_f32 v238, v238
  v_rcp_f32 v239, v239
  v_pk_mul_f32 v[196:197], v[196:197], v[232:233]
  v_pk_mul_f32 v[198:199], v[198:199], v[234:235]
  v_pk_mul_f32 v[200:201], v[200:201], v[236:237]
  v_pk_mul_f32 v[202:203], v[202:203], v[238:239]
  v_pk_mul_f32 v[224:225], v[204:205], v[204:205]
  v_pk_mul_f32 v[226:227], v[206:207], v[206:207]
  v_pk_mul_f32 v[228:229], v[208:209], v[208:209]
  v_pk_mul_f32 v[230:231], v[210:211], v[210:211]
  v_pk_fma_f32 v[224:225], v[224:225], v[212:213], v[212:213] op_sel:[0,0,1] op_sel_hi:[1,0,1]
  v_pk_fma_f32 v[226:227], v[226:227], v[212:213], v[212:213] op_sel:[0,0,1] op_sel_hi:[1,0,1]
  v_pk_fma_f32 v[228:229], v[228:229], v[212:213], v[212:213] op_sel:[0,0,1] op_sel_hi:[1,0,1]
  v_pk_fma_f32 v[230:231], v[230:231], v[212:213], v[212:213] op_sel:[0,0,1] op_sel_hi:[1,0,1]
  v_pk_mul_f32 v[224:225], v[224:225], v[204:205]
  v_pk_mul_f32 v[226:227], v[226:227], v[206:207]
  v_pk_mul_f32 v[228:229], v[228:229], v[208:209]
  v_pk_mul_f32 v[230:231], v[230:231], v[210:211]
  v_exp_f32 v224, v224
  v_exp_f32 v225, v225
  v_exp_f32 v226, v226
  v_exp_f32 v227, v227
  v_exp_f32 v228, v228
  v_exp_f32 v229, v229
  v_exp_f32 v230, v230
  v_exp_f32 v231, v231
  v_pk_add_f32 v[224:225], v[224:225], 1.0 op_sel_hi:[1,0]
  v_pk_add_f32 v[226:227], v[226:227], 1.0 op_sel_hi:[1,0]
  v_pk_add_f32 v[228:229], v[228:229], 1.0 op_sel_hi:[1,0]
  v_pk_add_f32 v[230:231], v[230:231], 1.0 op_sel_hi:[1,0]
  v_rcp_f32 v224, v224
  v_rcp_f32 v225, v225
  v_rcp_f32 v226, v226
  v_rcp_f32 v227, v227
  v_rcp_f32 v228, v228
  v_rcp_f32 v229, v229
  v_rcp_f32 v230, v230
  v_rcp_f32 v231, v231
  v_pk_mul_f32 v[204:205], v[204:205], v[224:225]
  v_pk_mul_f32 v[206:207], v[206:207], v[226:227]
  v_pk_mul_f32 v[208:209], v[208:209], v[228:229]
  v_pk_mul_f32 v[210:211], v[210:211], v[230:231]
  s_lshl_b32 s84, s41, 9
  s_lshl_b32 s85, s40, 7
  s_add_u32 s84, s84, s85
  s_add_u32 s84, s84, 61440
  v_and_b32 v226, 31, v0
  v_lshlrev_b32 v226, 2, v226
  v_mov_b32 v228, v24
  v_mov_b32 v229, v24
  v_mov_b32 v230, v24
  v_mov_b32 v231, v24
  s_mov_b32 s88, 0
L_poll86:
  buffer_load_dword v224, v226, s[4:7], s84 offen sc1
  s_add_u32 s88, s88, 1
  s_cmp_gt_u32 s88, 65536
  s_cbranch_scc1 L_abort
  s_waitcnt vmcnt(0)
  v_cmp_ne_u32 vcc, s44, v224
  s_nop 0
  s_cbranch_vccnz L_poll86
L_ph_sp1:
  s_add_u32 s85, s19, 15204352
  s_add_u32 s86, s85, 4096
  buffer_load_dwordx4 v[232:235], v1, s[4:7], s85 offen offset:0 sc1
  buffer_load_dwordx4 v[236:239], v1, s[4:7], s85 offen offset:1024 sc1
  buffer_load_dwordx4 v[240:243], v1, s[4:7], s85 offen offset:2048 sc1
  buffer_load_dwordx4 v[244:247], v1, s[4:7], s85 offen offset:3072 sc1
  buffer_load_dwordx4 v[248:251], v1, s[4:7], s86 offen offset:0 sc1
  buffer_load_dwordx4 v[252:255], v1, s[4:7], s86 offen offset:1024 sc1
  s_add_u32 s85, s19, 15210496
  s_add_u32 s86, s85, 4096
  buffer_load_dwordx4 v[164:167], v1, s[4:7], s85 offen offset:0 sc1
  buffer_load_dwordx4 v[168:171], v1, s[4:7], s85 offen offset:1024 sc1
  buffer_load_dwordx4 v[172:175], v1, s[4:7], s85 offen offset:2048 sc1
  buffer_load_dwordx4 v[176:179], v1, s[4:7], s85 offen offset:3072 sc1
  buffer_load_dwordx4 v[180:183], v1, s[4:7], s86 offen offset:0 sc1
  buffer_load_dwordx4 v[184:187], v1, s[4:7], s86 offen offset:1024 sc1
  s_add_u32 s85, s20, 15204352
  s_add_u32 s86, s85, 4096
  buffer_load_dwordx4 v[224:227], v1, s[4:7], s85 offen offset:0 sc1
  s_and_b32 s0, s40, 1
  s_mul_i32 s0, s0, 12288
  s_cmp_ge_u32 s40, 2
  s_cselect_b32 s1, 106496, 0
  s_xor_b32 s3, s1, 69632
  s_xor_b32 s1, s1, 45056
  v_add3_u32 v212, v1, s0, 0
  v_add_u32 v213, s3, v212
  v_add_u32 v212, s1, v212
  s_sub_u32 s0, 12288, s0
  s_add_u32 s0, s0, s3
  v_add_u32 v214, s0, v1
  s_waitcnt vmcnt(12)
  v_mfma_f32_16x16x32_bf16 v[68:71], v[232:235], a[0:3], v[228:231]
  v_mfma_f32_16x16x32_bf16 v[92:95], v[232:235], a[4:7], 0
  v_mfma_f32_16x16x32_bf16 v[116:119], v[232:235], a[8:11], 0
  v_mfma_f32_16x16x32_bf16 v[140:143], v[232:235], a[12:15], 0
  s_waitcnt vmcnt(11)
  v_mfma_f32_16x16x32_bf16 v[72:75], v[236:239], a[0:3], v[228:231]
  v_mfma_f32_16x16x32_bf16 v[96:99], v[236:239], a[4:7], 0
  v_mfma_f32_16x16x32_bf16 v[120:123], v[236:239], a[8:11], 0
  s_add_u32 s100, s101, L_ph_wout1-L_base
  buffer_load_dword v222, v13, s[96:99], s100 offen
  v_mfma_f32_16x16x32_bf16 v[144:147], v[236:239], a[12:15], 0
  s_waitcnt vmcnt(11)
  v_mfma_f32_16x16x32_bf16 v[76:79], v[240:243], a[0:3], v[228:231]
  v_mfma_f32_16x16x32_bf16 v[100:103], v[240:243], a[4:7], 0
  v_mfma_f32_16x16x32_bf16 v[124:127], v[240:243], a[8:11], 0
  v_mfma_f32_16x16x32_bf16 v[148:151], v[240:243], a[12:15], 0
  s_waitcnt vmcnt(10)
  v_mfma_f32_16x16x32_bf16 v[80:83], v[244:247], a[0:3], v[228:231]
  v_mfma_f32_16x16x32_bf16 v[104:107], v[244:247], a[4:7], 0
  v_mfma_f32_16x16x32_bf16 v[128:131], v[244:247], a[8:11], 0
  v_mfma_f32_16x16x32_bf16 v[152:155], v[244:247], a[12:15], 0
  s_waitcnt vmcnt(9)
  v_mfma_f32_16x16x32_bf16 v[84:87], v[248:251], a[0:3], v[228:231]
  v_mfma_f32_16x16x32_bf16 v[108:111], v[248:251], a[4:7], 0
  v_mfma_f32_16x16x32_bf16 v[132:135], v[248:251], a[8:11], 0
  v_mfma_f32_16x16x32_bf16 v[156:159], v[248:251], a[12:15], 0
  s_waitcnt vmcnt(8)
  v_mfma_f32_16x16x32_bf16 v[88:91], v[252:255], a[0:3], v[228:231]
  v_mfma_f32_16x16x32_bf16 v[112:115], v[252:255], a[4:7], 0
  s_nop 1
  buffer_load_dwordx4 v[228:231], v1, s[4:7], s85 offen offset:1024 sc1
  buffer_load_dwordx4 v[232:235], v1, s[4:7], s85 offen offset:2048 sc1
  buffer_load_dwordx4 v[236:239], v1, s[4:7], s85 offen offset:3072 sc1
  buffer_load_dwordx4 v[240:243], v1, s[4:7], s86 offen offset:0 sc1
  buffer_load_dwordx4 v[244:247], v1, s[4:7], s86 offen offset:1024 sc1
  s_add_u32 s85, s20, 15210496
  s_add_u32 s86, s85, 4096
  buffer_load_dwordx4 v[248:251], v1, s[4:7], s85 offen offset:0 sc1
  v_mfma_f32_16x16x32_bf16 v[136:139], v[252:255], a[8:11], 0
  v_mfma_f32_16x16x32_bf16 v[160:163], v[252:255], a[12:15], 0
  s_waitcnt vmcnt(13)
  v_mfma_f32_16x16x32_bf16 v[68:71], v[164:167], a[16:19], v[68:71]
  v_mfma_f32_16x16x32_bf16 v[92:95], v[164:167], a[20:23], v[92:95]
  buffer_load_dwordx4 v[252:255], v1, s[4:7], s85 offen offset:1024 sc1
  v_mfma_f32_16x16x32_bf16 v[116:119], v[164:167], a[24:27], v[116:119]
  v_mfma_f32_16x16x32_bf16 v[140:143], v[164:167], a[28:31], v[140:143]
  s_waitcnt vmcnt(13)
  v_mfma_f32_16x16x32_bf16 v[72:75], v[168:171], a[16:19], v[72:75]
  v_mfma_f32_16x16x32_bf16 v[96:99], v[168:171], a[20:23], v[96:99]
  buffer_load_dwordx4 v[164:167], v1, s[4:7], s85 offen offset:2048 sc1
  v_mfma_f32_16x16x32_bf16 v[120:123], v[168:171], a[24:27], v[120:123]
  v_mfma_f32_16x16x32_bf16 v[144:147], v[168:171], a[28:31], v[144:147]
  s_waitcnt vmcnt(13)
  v_mfma_f32_16x16x32_bf16 v[76:79], v[172:175], a[16:19], v[76:79]
  v_mfma_f32_16x16x32_bf16 v[100:103], v[172:175], a[20:23], v[100:103]
  buffer_load_dwordx4 v[168:171], v1, s[4:7], s85 offen offset:3072 sc1
  v_mfma_f32_16x16x32_bf16 v[124:127], v[172:175], a[24:27], v[124:127]
  v_mfma_f32_16x16x32_bf16 v[148:151], v[172:175], a[28:31], v[148:151]
  s_waitcnt vmcnt(13)
  v_mfma_f32_16x16x32_bf16 v[80:83], v[176:179], a[16:19], v[80:83]
  v_mfma_f32_16x16x32_bf16 v[104:107], v[176:179], a[20:23], v[104:107]
  buffer_load_dwordx4 v[172:175], v1, s[4:7], s86 offen offset:0 sc1
  v_mfma_f32_16x16x32_bf16 v[128:131], v[176:179], a[24:27], v[128:131]
  v_mfma_f32_16x16x32_bf16 v[152:155], v[176:179], a[28:31], v[152:155]
  s_waitcnt vmcnt(13)
  v_mfma_f32_16x16x32_bf16 v[84:87], v[180:183], a[16:19], v[84:87]
  v_mfma_f32_16x16x32_bf16 v[108:111], v[180:183], a[20:23], v[108:111]
  buffer_load_dwordx4 v[176:179], v1, s[4:7], s86 offen offset:1024 sc1
  v_mfma_f32_16x16x32_bf16 v[132:135], v[180:183], a[24:27], v[132:135]
  v_mfma_f32_16x16x32_bf16 v[156:159], v[180:183], a[28:31], v[156:159]
  s_waitcnt vmcnt(13)
  v_mfma_f32_16x16x32_bf16 v[88:91], v[184:187], a[16:19], v[88:91]
  v_mfma_f32_16x16x32_bf16 v[112:115], v[184:187], a[20:23], v[112:115]
  s_add_u32 s85, s21, 15204352
  s_add_u32 s86, s85, 4096
  buffer_load_dwordx4 v[180:183], v1, s[4:7], s85 offen offset:0 sc1
  v_mfma_f32_16x16x32_bf16 v[136:139], v[184:187], a[24:27], v[136:139]
  v_mfma_f32_16x16x32_bf16 v[160:163], v[184:187], a[28:31], v[160:163]
  s_waitcnt vmcnt(13)
  v_mfma_f32_16x16x32_bf16 v[68:71], v[224:227], a[32:35], v[68:71]
  v_mfma_f32_16x16x32_bf16 v[92:95], v[224:227], a[36:39], v[92:95]
  buffer_load_dwordx4 v[184:187], v1, s[4:7], s85 offen offset:1024 sc1
  v_mfma_f32_16x16x32_bf16 v[116:119], v[224:227], a[40:43], v[116:119]
  v_mfma_f32_16x16x32_bf16 v[140:143], v[224:227], a[44:47], v[140:143]
  s_waitcnt vmcnt(12)
  v_mfma_f32_16x16x32_bf16 v[72:75], v[228:231], a[32:35], v[72:75]
  v_mfma_f32_16x16x32_bf16 v[96:99], v[228:231], a[36:39], v[96:99]
  buffer_load_dwordx4 v[224:227], v1, s[4:7], s85 offen offset:2048 sc1
  v_mfma_f32_16x16x32_bf16 v[120:123], v[228:231], a[40:43], v[120:123]
  v_mfma_f32_16x16x32_bf16 v[144:147], v[228:231], a[44:47], v[144:147]
  s_waitcnt vmcnt(12)
  v_mfma_f32_16x16x32_bf16 v[76:79], v[232:235], a[32:35], v[76:79]
  v_mfma_f32_16x16x32_bf16 v[100:103], v[232:235], a[36:39], v[100:103]
  buffer_load_dwordx4 v[228:231], v1, s[4:7], s85 offen offset:3072 sc1
  v_mfma_f32_16x16x32_bf16 v[124:127], v[232:235], a[40:43], v[124:127]
  v_mfma_f32_16x16x32_bf16 v[148:151], v[232:235], a[44:47], v[148:151]
  s_waitcnt vmcnt(12)
  v_mfma_f32_16x16x32_bf16 v[80:83], v[236:239], a[32:35], v[80:83]
  v_mfma_f32_16x16x32_bf16 v[104:107], v[236:239], a[36:39], v[104:107]
  buffer_load_dwordx4 v[232:235], v1, s[4:7], s86 offen offset:0 sc1
  v_mfma_f32_16x16x32_bf16 v[128:131], v[236:239], a[40:43], v[128:131]
  v_mfma_f32_16x16x32_bf16 v[152:155], v[236:239], a[44:47], v[152:155]
  s_waitcnt vmcnt(12)
  v_mfma_f32_16x16x32_bf16 v[84:87], v[240:243], a[32:35], v[84:87]
  v_mfma_f32_16x16x32_bf16 v[108:111], v[240:243], a[36:39], v[108:111]
  buffer_load_dwordx4 v[236:239], v1, s[4:7], s86 offen offset:1024 sc1
  v_mfma_f32_16x16x32_bf16 v[132:135], v[240:243], a[40:43], v[132:135]
  v_mfma_f32_16x16x32_bf16 v[156:159], v[240:243], a[44:47], v[156:159]
  s_waitcnt vmcnt(12)
  v_mfma_f32_16x16x32_bf16 v[88:91], v[244:247], a[32:35], v[88:91]
  v_mfma_f32_16x16x32_bf16 v[112:115], v[244:247], a[36:39], v[112:115]
  s_add_u32 s85, s21, 15210496
  s_add_u32 s86, s85, 4096
  buffer_load_dwordx4 v[240:243], v1, s[4:7], s85 offen offset:0 sc1
  v_mfma_f32_16x16x32_bf16 v[136:139], v[244:247], a[40:43], v[136:139]
  v_mfma_f32_16x16x32_bf16 v[160:163], v[244:247], a[44:47], v[160:163]
  s_waitcnt vmcnt(12)
  v_mfma_f32_16x16x32_bf16 v[68:71], v[248:251], a[48:51], v[68:71]
  v_mfma_f32_16x16x32_bf16 v[92:95], v[248:251], a[52:55], v[92:95]
  buffer_load_dwordx4 v[244:247], v1, s[4:7], s85 offen offset:1024 sc1
  v_mfma_f32_16x16x32_bf16 v[116:119], v[248:251], a[56:59], v[116:119]
  v_mfma_f32_16x16x32_bf16 v[140:143], v[248:251], a[60:63], v[140:143]
  s_waitcnt vmcnt(12)
  v_mfma_f32_16x16x32_bf16 v[72:75], v[252:255], a[48:51], v[72:75]
  v_mfma_f32_16x16x32_bf16 v[96:99], v[252:255], a[52:55], v[96:99]
  buffer_load_dwordx4 v[248:251], v1, s[4:7], s85 offen offset:2048 sc1
  v_mfma_f32_16x16x32_bf16 v[120:123], v[252:255], a[56:59], v[120:123]
  v_mfma_f32_16x16x32_bf16 v[144:147], v[252:255], a[60:63], v[144:147]
  s_waitcnt vmcnt(12)
  v_mfma_f32_16x16x32_bf16 v[76:79], v[164:167], a[48:51], v[76:79]
  v_mfma_f32_16x16x32_bf16 v[100:103], v[164:167], a[52:55], v[100:103]
  buffer_load_dwordx4 v[252:255], v1, s[4:7], s85 offen offset:3072 sc1
  v_mfma_f32_16x16x32_bf16 v[124:127], v[164:167], a[56:59], v[124:127]
  v_mfma_f32_16x16x32_bf16 v[148:151], v[164:167], a[60:63], v[148:151]
  s_waitcnt vmcnt(12)
  v_mfma_f32_16x16x32_bf16 v[80:83], v[168:171], a[48:51], v[80:83]
  v_mfma_f32_16x16x32_bf16 v[104:107], v[168:171], a[52:55], v[104:107]
  buffer_load_dwordx4 v[164:167], v1, s[4:7], s86 offen offset:0 sc1
  v_mfma_f32_16x16x32_bf16 v[128:131], v[168:171], a[56:59], v[128:131]
  v_mfma_f32_16x16x32_bf16 v[152:155], v[168:171], a[60:63], v[152:155]
  s_waitcnt vmcnt(12)
  v_mfma_f32_16x16x32_bf16 v[84:87], v[172:175], a[48:51], v[84:87]
  v_mfma_f32_16x16x32_bf16 v[108:111], v[172:175], a[52:55], v[108:111]
  buffer_load_dwordx4 v[168:171], v1, s[4:7], s86 offen offset:1024 sc1
  v_mfma_f32_16x16x32_bf16 v[132:135], v[172:175], a[56:59], v[132:135]
  v_mfma_f32_16x16x32_bf16 v[156:159], v[172:175], a[60:63], v[156:159]
  s_waitcnt vmcnt(12)
  v_mfma_f32_16x16x32_bf16 v[88:91], v[176:179], a[48:51], v[88:91]
  v_mfma_f32_16x16x32_bf16 v[112:115], v[176:179], a[52:55], v[112:115]
  s_add_u32 s85, s22, 15204352
  s_add_u32 s86, s85, 4096
  buffer_load_dwordx4 v[172:175], v1, s[4:7], s85 offen offset:0 sc1
  v_mfma_f32_16x16x32_bf16 v[136:139], v[176:179], a[56:59], v[136:139]
  v_mfma_f32_16x16x32_bf16 v[160:163], v[176:179], a[60:63], v[160:163]
  s_waitcnt vmcnt(12)
  v_mfma_f32_16x16x32_bf16 v[68:71], v[180:183], a[64:67], v[68:71]
  v_mfma_f32_16x16x32_bf16 v[92:95], v[180:183], a[68:71], v[92:95]
  buffer_load_dwordx4 v[176:179], v1, s[4:7], s85 offen offset:1024 sc1
  v_mfma_f32_16x16x32_bf16 v[116:119], v[180:183], a[72:75], v[116:119]
  v_mfma_f32_16x16x32_bf16 v[140:143], v[180:183], a[76:79], v[140:143]
  s_waitcnt vmcnt(12)
  v_mfma_f32_16x16x32_bf16 v[72:75], v[184:187], a[64:67], v[72:75]
  v_mfma_f32_16x16x32_bf16 v[96:99], v[184:187], a[68:71], v[96:99]
  buffer_load_dwordx4 v[180:183], v1, s[4:7], s85 offen offset:2048 sc1
  v_mfma_f32_16x16x32_bf16 v[120:123], v[184:187], a[72:75], v[120:123]
  v_mfma_f32_16x16x32_bf16 v[144:147], v[184:187], a[76:79], v[144:147]
  s_waitcnt vmcnt(12)
  v_mfma_f32_16x16x32_bf16 v[76:79], v[224:227], a[64:67], v[76:79]
  v_mfma_f32_16x16x32_bf16 v[100:103], v[224:227], a[68:71], v[100:103]
  buffer_load_dwordx4 v[184:187], v1, s[4:7], s85 offen offset:3072 sc1
  v_mfma_f32_16x16x32_bf16 v[124:127], v[224:227], a[72:75], v[124:127]
  v_mfma_f32_16x16x32_bf16 v[148:151], v[224:227], a[76:79], v[148:151]
  s_waitcnt vmcnt(12)
  v_mfma_f32_16x16x32_bf16 v[80:83], v[228:231], a[64:67], v[80:83]
  v_mfma_f32_16x16x32_bf16 v[104:107], v[228:231], a[68:71], v[104:107]
  buffer_load_dwordx4 v[224:227], v1, s[4:7], s86 offen offset:0 sc1
  v_mfma_f32_16x16x32_bf16 v[128:131], v[228:231], a[72:75], v[128:131]
  v_mfma_f32_16x16x32_bf16 v[152:155], v[228:231], a[76:79], v[152:155]
  s_waitcnt vmcnt(12)
  v_mfma_f32_16x16x32_bf16 v[84:87], v[232:235], a[64:67], v[84:87]
  v_mfma_f32_16x16x32_bf16 v[108:111], v[232:235], a[68:71], v[108:111]
  buffer_load_dwordx4 v[228:231], v1, s[4:7], s86 offen offset:1024 sc1
  v_mfma_f32_16x16x32_bf16 v[132:135], v[232:235], a[72:75], v[132:135]
  v_mfma_f32_16x16x32_bf16 v[156:159], v[232:235], a[76:79], v[156:159]
  s_waitcnt vmcnt(12)
  v_mfma_f32_16x16x32_bf16 v[88:91], v[236:239], a[64:67], v[88:91]
  v_mfma_f32_16x16x32_bf16 v[112:115], v[236:239], a[68:71], v[112:115]
  s_add_u32 s85, s22, 15210496
  s_add_u32 s86, s85, 4096
  buffer_load_dwordx4 v[232:235], v1, s[4:7], s85 offen offset:0 sc1
  v_mfma_f32_16x16x32_bf16 v[136:139], v[236:239], a[72:75], v[136:139]
  v_mfma_f32_16x16x32_bf16 v[160:163], v[236:239], a[76:79], v[160:163]
  s_waitcnt vmcnt(12)
  v_mfma_f32_16x16x32_bf16 v[68:71], v[240:243], a[80:83], v[68:71]
  v_mfma_f32_16x16x32_bf16 v[92:95], v[240:243], a[84:87], v[92:95]
  buffer_load_dwordx4 v[236:239], v1, s[4:7], s85 offen offset:1024 sc1
  v_mfma_f32_16x16x32_bf16 v[116:119], v[240:243], a[88:91], v[116:119]
  v_mfma_f32_16x16x32_bf16 v[140:143], v[240:243], a[92:95], v[140:143]
  s_waitcnt vmcnt(12)
  v_mfma_f32_16x16x32_bf16 v[72:75], v[244:247], a[80:83], v[72:75]
  v_mfma_f32_16x16x32_bf16 v[96:99], v[244:247], a[84:87], v[96:99]
  buffer_load_dwordx4 v[240:243], v1, s[4:7], s85 offen offset:2048 sc1
  v_mfma_f32_16x16x32_bf16 v[120:123], v[244:247], a[88:91], v[120:123]
  v_mfma_f32_16x16x32_bf16 v[144:147], v[244:247], a[92:95], v[144:147]
  s_waitcnt vmcnt(12)
  v_mfma_f32_16x16x32_bf16 v[76:79], v[248:251], a[80:83], v[76:79]
  v_mfma_f32_16x16x32_bf16 v[100:103], v[248:251], a[84:87], v[100:103]
  buffer_load_dwordx4 v[244:247], v1, s[4:7], s85 offen offset:3072 sc1
  v_mfma_f32_16x16x32_bf16 v[124:127], v[248:251], a[88:91], v[124:127]
  v_mfma_f32_16x16x32_bf16 v[148:151], v[248:251], a[92:95], v[148:151]
  s_waitcnt vmcnt(12)
  v_mfma_f32_16x16x32_bf16 v[80:83], v[252:255], a[80:83], v[80:83]
  v_mfma_f32_16x16x32_bf16 v[104:107], v[252:255], a[84:87], v[104:107]
  buffer_load_dwordx4 v[248:251], v1, s[4:7], s86 offen offset:0 sc1
  v_mfma_f32_16x16x32_bf16 v[128:131], v[252:255], a[88:91], v[128:131]
  v_mfma_f32_16x16x32_bf16 v[152:155], v[252:255], a[92:95], v[152:155]
  s_waitcnt vmcnt(12)
  v_mfma_f32_16x16x32_bf16 v[84:87], v[164:167], a[80:83], v[84:87]
  v_mfma_f32_16x16x32_bf16 v[108:111], v[164:167], a[84:87], v[108:111]
  buffer_load_dwordx4 v[252:255], v1, s[4:7], s86 offen offset:1024 sc1
  v_mfma_f32_16x16x32_bf16 v[132:135], v[164:167], a[88:91], v[132:135]
  v_mfma_f32_16x16x32_bf16 v[156:159], v[164:167], a[92:95], v[156:159]
  s_waitcnt vmcnt(12)
  v_mfma_f32_16x16x32_bf16 v[88:91], v[168:171], a[80:83], v[88:91]
  v_mfma_f32_16x16x32_bf16 v[112:115], v[168:171], a[84:87], v[112:115]
  s_add_u32 s85, s19, 15253504
  s_add_u32 s86, s85, 4096
  buffer_load_dwordx4 v[164:167], v1, s[4:7], s85 offen offset:0 sc1
  v_mfma_f32_16x16x32_bf16 v[136:139], v[168:171], a[88:91], v[136:139]
  v_mfma_f32_16x16x32_bf16 v[160:163], v[168:171], a[92:95], v[160:163]
  s_waitcnt vmcnt(12)
  v_mfma_f32_16x16x32_bf16 v[68:71], v[172:175], a[96:99], v[68:71]
  v_mfma_f32_16x16x32_bf16 v[92:95], v[172:175], a[100:103], v[92:95]
  buffer_load_dwordx4 v[168:171], v1, s[4:7], s85 offen offset:1024 sc1
  v_mfma_f32_16x16x32_bf16 v[116:119], v[172:175], a[104:107], v[116:119]
  v_mfma_f32_16x16x32_bf16 v[140:143], v[172:175], a[108:111], v[140:143]
  s_waitcnt vmcnt(12)
  v_mfma_f32_16x16x32_bf16 v[72:75], v[176:179], a[96:99], v[72:75]
  v_mfma_f32_16x16x32_bf16 v[96:99], v[176:179], a[100:103], v[96:99]
  buffer_load_dwordx4 v[172:175], v1, s[4:7], s85 offen offset:2048 sc1
  v_mfma_f32_16x16x32_bf16 v[120:123], v[176:179], a[104:107], v[120:123]
  v_mfma_f32_16x16x32_bf16 v[144:147], v[176:179], a[108:111], v[144:147]
  s_waitcnt vmcnt(12)
  v_mfma_f32_16x16x32_bf16 v[76:79], v[180:183], a[96:99], v[76:79]
  v_mfma_f32_16x16x32_bf16 v[100:103], v[180:183], a[100:103], v[100:103]
  buffer_load_dwordx4 v[176:179], v1, s[4:7], s85 offen offset:3072 sc1
  v_mfma_f32_16x16x32_bf16 v[124:127], v[180:183], a[104:107], v[124:127]
  v_mfma_f32_16x16x32_bf16 v[148:151], v[180:183], a[108:111], v[148:151]
  s_waitcnt vmcnt(12)
  v_mfma_f32_16x16x32_bf16 v[80:83], v[184:187], a[96:99], v[80:83]
  v_mfma_f32_16x16x32_bf16 v[104:107], v[184:187], a[100:103], v[104:107]
  buffer_load_dwordx4 v[180:183], v1, s[4:7], s86 offen offset:0 sc1
  v_mfma_f32_16x16x32_bf16 v[128:131], v[184:187], a[104:107], v[128:131]
  v_mfma_f32_16x16x32_bf16 v[152:155], v[184:187], a[108:111], v[152:155]
  s_waitcnt vmcnt(12)
  v_mfma_f32_16x16x32_bf16 v[84:87], v[224:227], a[96:99], v[84:87]
  v_mfma_f32_16x16x32_bf16 v[108:111], v[224:227], a[100:103], v[108:111]
  buffer_load_dwordx4 v[184:187], v1, s[4:7], s86 offen offset:1024 sc1
  v_mfma_f32_16x16x32_bf16 v[132:135], v[224:227], a[104:107], v[132:135]
  v_mfma_f32_16x16x32_bf16 v[156:159], v[224:227], a[108:111], v[156:159]
  s_waitcnt vmcnt(12)
  v_mfma_f32_16x16x32_bf16 v[88:91], v[228:231], a[96:99], v[88:91]
  v_mfma_f32_16x16x32_bf16 v[112:115], v[228:231], a[100:103], v[112:115]
  s_add_u32 s85, s19, 15259648
  s_add_u32 s86, s85, 4096
  buffer_load_dwordx4 v[224:227], v1, s[4:7], s85 offen offset:0 sc1
  v_mfma_f32_16x16x32_bf16 v[136:139], v[228:231], a[104:107], v[136:139]
  v_mfma_f32_16x16x32_bf16 v[160:163], v[228:231], a[108:111], v[160:163]
  s_waitcnt vmcnt(12)
  v_mfma_f32_16x16x32_bf16 v[68:71], v[232:235], a[112:115], v[68:71]
  v_mfma_f32_16x16x32_bf16 v[92:95], v[232:235], a[116:119], v[92:95]
  buffer_load_dwordx4 v[228:231], v1, s[4:7], s85 offen offset:1024 sc1
  v_mfma_f32_16x16x32_bf16 v[116:119], v[232:235], a[120:123], v[116:119]
  v_mfma_f32_16x16x32_bf16 v[140:143], v[232:235], a[124:127], v[140:143]
  s_waitcnt vmcnt(12)
  v_mfma_f32_16x16x32_bf16 v[72:75], v[236:239], a[112:115], v[72:75]
  v_mfma_f32_16x16x32_bf16 v[96:99], v[236:239], a[116:119], v[96:99]
  buffer_load_dwordx4 v[232:235], v1, s[4:7], s85 offen offset:2048 sc1
  v_mfma_f32_16x16x32_bf16 v[120:123], v[236:239], a[120:123], v[120:123]
  v_mfma_f32_16x16x32_bf16 v[144:147], v[236:239], a[124:127], v[144:147]
  s_waitcnt vmcnt(12)
  v_mfma_f32_16x16x32_bf16 v[76:79], v[240:243], a[112:115], v[76:79]
  v_mfma_f32_16x16x32_bf16 v[100:103], v[240:243], a[116:119], v[100:103]
  buffer_load_dwordx4 v[236:239], v1, s[4:7], s85 offen offset:3072 sc1
  v_mfma_f32_16x16x32_bf16 v[124:127], v[240:243], a[120:123], v[124:127]
  v_mfma_f32_16x16x32_bf16 v[148:151], v[240:243], a[124:127], v[148:151]
  s_waitcnt vmcnt(12)
  v_mfma_f32_16x16x32_bf16 v[80:83], v[244:247], a[112:115], v[80:83]
  v_mfma_f32_16x16x32_bf16 v[104:107], v[244:247], a[116:119], v[104:107]
  buffer_load_dwordx4 v[240:243], v1, s[4:7], s86 offen offset:0 sc1
  v_mfma_f32_16x16x32_bf16 v[128:131], v[244:247], a[120:123], v[128:131]
  v_mfma_f32_16x16x32_bf16 v[152:155], v[244:247], a[124:127], v[152:155]
  s_waitcnt vmcnt(12)
  v_mfma_f32_16x16x32_bf16 v[84:87], v[248:251], a[112:115], v[84:87]
  v_mfma_f32_16x16x32_bf16 v[108:111], v[248:251], a[116:119], v[108:111]
  buffer_load_dwordx4 v[244:247], v1, s[4:7], s86 offen offset:1024 sc1
  v_mfma_f32_16x16x32_bf16 v[132:135], v[248:251], a[120:123], v[132:135]
  v_mfma_f32_16x16x32_bf16 v[156:159], v[248:251], a[124:127], v[156:159]
  s_waitcnt vmcnt(12)
  v_mfma_f32_16x16x32_bf16 v[88:91], v[252:255], a[112:115], v[88:91]
  v_mfma_f32_16x16x32_bf16 v[112:115], v[252:255], a[116:119], v[112:115]
  s_add_u32 s85, s20, 15253504
  s_add_u32 s86, s85, 4096
  buffer_load_dwordx4 v[248:251], v1, s[4:7], s85 offen offset:0 sc1
  v_mfma_f32_16x16x32_bf16 v[136:139], v[252:255], a[120:123], v[136:139]
  v_mfma_f32_16x16x32_bf16 v[160:163], v[252:255], a[124:127], v[160:163]
  s_waitcnt vmcnt(12)
  v_mfma_f32_16x16x32_bf16 v[68:71], v[164:167], a[128:131], v[68:71]
  v_mfma_f32_16x16x32_bf16 v[92:95], v[164:167], a[132:135], v[92:95]
  buffer_load_dwordx4 v[252:255], v1, s[4:7], s85 offen offset:1024 sc1
  v_mfma_f32_16x16x32_bf16 v[116:119], v[164:167], a[136:139], v[116:119]
  v_mfma_f32_16x16x32_bf16 v[140:143], v[164:167], a[140:143], v[140:143]
  s_waitcnt vmcnt(12)
  v_mfma_f32_16x16x32_bf16 v[72:75], v[168:171], a[128:131], v[72:75]
  v_mfma_f32_16x16x32_bf16 v[96:99], v[168:171], a[132:135], v[96:99]
  buffer_load_dwordx4 v[164:167], v1, s[4:7], s85 offen offset:2048 sc1
  v_mfma_f32_16x16x32_bf16 v[120:123], v[168:171], a[136:139], v[120:123]
  v_mfma_f32_16x16x32_bf16 v[144:147], v[168:171], a[140:143], v[144:147]
  s_waitcnt vmcnt(12)
  v_mfma_f32_16x16x32_bf16 v[76:79], v[172:175], a[128:131], v[76:79]
  v_mfma_f32_16x16x32_bf16 v[100:103], v[172:175], a[132:135], v[100:103]
  buffer_load_dwordx4 v[168:171], v1, s[4:7], s85 offen offset:3072 sc1
  v_mfma_f32_16x16x32_bf16 v[124:127], v[172:175], a[136:139], v[124:127]
  v_mfma_f32_16x16x32_bf16 v[148:151], v[172:175], a[140:143], v[148:151]
  s_waitcnt vmcnt(12)
  v_mfma_f32_16x16x32_bf16 v[80:83], v[176:179], a[128:131], v[80:83]
  v_mfma_f32_16x16x32_bf16 v[104:107], v[176:179], a[132:135], v[104:107]
  buffer_load_dwordx4 v[172:175], v1, s[4:7], s86 offen offset:0 sc1
  v_mfma_f32_16x16x32_bf16 v[128:131], v[176:179], a[136:139], v[128:131]
  v_mfma_f32_16x16x32_bf16 v[152:155], v[176:179], a[140:143], v[152:155]
  s_waitcnt vmcnt(12)
  v_mfma_f32_16x16x32_bf16 v[84:87], v[180:183], a[128:131], v[84:87]
  v_mfma_f32_16x16x32_bf16 v[108:111], v[180:183], a[132:135], v[108:111]
  buffer_load_dwordx4 v[176:179], v1, s[4:7], s86 offen offset:1024 sc1
  v_mfma_f32_16x16x32_bf16 v[132:135], v[180:183], a[136:139], v[132:135]
  v_mfma_f32_16x16x32_bf16 v[156:159], v[180:183], a[140:143], v[156:159]
  s_waitcnt vmcnt(12)
  v_mfma_f32_16x16x32_bf16 v[88:91], v[184:187], a[128:131], v[88:91]
  v_mfma_f32_16x16x32_bf16 v[112:115], v[184:187], a[132:135], v[112:115]
  s_add_u32 s85, s20, 15259648
  s_add_u32 s86, s85, 4096
  buffer_load_dwordx4 v[180:183], v1, s[4:7], s85 offen offset:0 sc1
  v_mfma_f32_16x16x32_bf16 v[136:139], v[184:187], a[136:139], v[136:139]
  v_mfma_f32_16x16x32_bf16 v[160:163], v[184:187], a[140:143], v[160:163]
  s_waitcnt vmcnt(12)
  v_mfma_f32_16x16x32_bf16 v[68:71], v[224:227], a[144:147], v[68:71]
  v_mfma_f32_16x16x32_bf16 v[92:95], v[224:227], a[148:151], v[92:95]
  buffer_load_dwordx4 v[184:187], v1, s[4:7], s85 offen offset:1024 sc1
  v_mfma_f32_16x16x32_bf16 v[116:119], v[224:227], a[152:155], v[116:119]
  v_mfma_f32_16x16x32_bf16 v[140:143], v[224:227], a[156:159], v[140:143]
  s_waitcnt vmcnt(12)
  v_mfma_f32_16x16x32_bf16 v[72:75], v[228:231], a[144:147], v[72:75]
  v_mfma_f32_16x16x32_bf16 v[96:99], v[228:231], a[148:151], v[96:99]
  buffer_load_dwordx4 v[224:227], v1, s[4:7], s85 offen offset:2048 sc1
  v_mfma_f32_16x16x32_bf16 v[120:123], v[228:231], a[152:155], v[120:123]
  v_mfma_f32_16x16x32_bf16 v[144:147], v[228:231], a[156:159], v[144:147]
  s_waitcnt vmcnt(12)
  v_mfma_f32_16x16x32_bf16 v[76:79], v[232:235], a[144:147], v[76:79]
  v_mfma_f32_16x16x32_bf16 v[100:103], v[232:235], a[148:151], v[100:103]
  buffer_load_dwordx4 v[228:231], v1, s[4:7], s85 offen offset:3072 sc1
  v_mfma_f32_16x16x32_bf16 v[124:127], v[232:235], a[152:155], v[124:127]
  v_mfma_f32_16x16x32_bf16 v[148:151], v[232:235], a[156:159], v[148:151]
  s_waitcnt vmcnt(12)
  v_mfma_f32_16x16x32_bf16 v[80:83], v[236:239], a[144:147], v[80:83]
  v_mfma_f32_16x16x32_bf16 v[104:107], v[236:239], a[148:151], v[104:107]
  buffer_load_dwordx4 v[232:235], v1, s[4:7], s86 offen offset:0 sc1
  v_mfma_f32_16x16x32_bf16 v[128:131], v[236:239], a[152:155], v[128:131]
  v_mfma_f32_16x16x32_bf16 v[152:155], v[236:239], a[156:159], v[152:155]
  s_waitcnt vmcnt(12)
  v_mfma_f32_16x16x32_bf16 v[84:87], v[240:243], a[144:147], v[84:87]
  v_mfma_f32_16x16x32_bf16 v[108:111], v[240:243], a[148:151], v[108:111]
  buffer_load_dwordx4 v[236:239], v1, s[4:7], s86 offen offset:1024 sc1
  v_mfma_f32_16x16x32_bf16 v[132:135], v[240:243], a[152:155], v[132:135]
  v_mfma_f32_16x16x32_bf16 v[156:159], v[240:243], a[156:159], v[156:159]
  s_waitcnt vmcnt(12)
  v_mfma_f32_16x16x32_bf16 v[88:91], v[244:247], a[144:147], v[88:91]
  v_mfma_f32_16x16x32_bf16 v[112:115], v[244:247], a[148:151], v[112:115]
  s_add_u32 s85, s21, 15253504
  s_add_u32 s86, s85, 4096
  buffer_load_dwordx4 v[240:243], v1, s[4:7], s85 offen offset:0 sc1
  v_mfma_f32_16x16x32_bf16 v[136:139], v[244:247], a[152:155], v[136:139]
  v_mfma_f32_16x16x32_bf16 v[160:163], v[244:247], a[156:159], v[160:163]
  s_waitcnt vmcnt(12)
  v_mfma_f32_16x16x32_bf16 v[68:71], v[248:251], a[160:163], v[68:71]
  v_mfma_f32_16x16x32_bf16 v[92:95], v[248:251], a[164:167], v[92:95]
  buffer_load_dwordx4 v[244:247], v1, s[4:7], s85 offen offset:1024 sc1
  v_mfma_f32_16x16x32_bf16 v[116:119], v[248:251], a[168:171], v[116:119]
  s_mul_i32 s100, s41, 3072
  s_add_u32 s100, s100, s53
  buffer_load_dword v222, v43, s[4:7], s100 offen sc1
  v_mfma_f32_16x16x32_bf16 v[140:143], v[248:251], a[172:175], v[140:143]
  s_waitcnt vmcnt(13)
  v_mfma_f32_16x16x32_bf16 v[72:75], v[252:255], a[160:163], v[72:75]
  v_mfma_f32_16x16x32_bf16 v[96:99], v[252:255], a[164:167], v[96:99]
  buffer_load_dwordx4 v[248:251], v1, s[4:7], s85 offen offset:2048 sc1
  v_mfma_f32_16x16x32_bf16 v[120:123], v[252:255], a[168:171], v[120:123]
  v_mfma_f32_16x16x32_bf16 v[144:147], v[252:255], a[172:175], v[144:147]
  s_waitcnt vmcnt(13)
  v_mfma_f32_16x16x32_bf16 v[76:79], v[164:167], a[160:163], v[76:79]
  v_mfma_f32_16x16x32_bf16 v[100:103], v[164:167], a[164:167], v[100:103]
  buffer_load_dwordx4 v[252:255], v1, s[4:7], s85 offen offset:3072 sc1
  v_mfma_f32_16x16x32_bf16 v[124:127], v[164:167], a[168:171], v[124:127]
  v_mfma_f32_16x16x32_bf16 v[148:151], v[164:167], a[172:175], v[148:151]
  s_waitcnt vmcnt(13)
  v_mfma_f32_16x16x32_bf16 v[80:83], v[168:171], a[160:163], v[80:83]
  v_mfma_f32_16x16x32_bf16 v[104:107], v[168:171], a[164:167], v[104:107]
  buffer_load_dwordx4 v[164:167], v1, s[4:7], s86 offen offset:0 sc1
  v_mfma_f32_16x16x32_bf16 v[128:131], v[168:171], a[168:171], v[128:131]
  v_mfma_f32_16x16x32_bf16 v[152:155], v[168:171], a[172:175], v[152:155]
  s_waitcnt vmcnt(13)
  v_mfma_f32_16x16x32_bf16 v[84:87], v[172:175], a[160:163], v[84:87]
  v_mfma_f32_16x16x32_bf16 v[108:111], v[172:175], a[164:167], v[108:111]
  buffer_load_dwordx4 v[168:171], v1, s[4:7], s86 offen offset:1024 sc1
  v_mfma_f32_16x16x32_bf16 v[132:135], v[172:175], a[168:171], v[132:135]
  v_mfma_f32_16x16x32_bf16 v[156:159], v[172:175], a[172:175], v[156:159]
  s_waitcnt vmcnt(13)
  v_mfma_f32_16x16x32_bf16 v[88:91], v[176:179], a[160:163], v[88:91]
  v_mfma_f32_16x16x32_bf16 v[112:115], v[176:179], a[164:167], v[112:115]
  s_add_u32 s85, s21, 15259648
  s_add_u32 s86, s85, 4096
  buffer_load_dwordx4 v[172:175], v1, s[4:7], s85 offen offset:0 sc1
  v_mfma_f32_16x16x32_bf16 v[136:139], v[176:179], a[168:171], v[136:139]
  v_mfma_f32_16x16x32_bf16 v[160:163], v[176:179], a[172:175], v[160:163]
  s_waitcnt vmcnt(13)
  v_mfma_f32_16x16x32_bf16 v[68:71], v[180:183], a[176:179], v[68:71]
  v_mfma_f32_16x16x32_bf16 v[92:95], v[180:183], a[180:183], v[92:95]
  buffer_load_dwordx4 v[176:179], v1, s[4:7], s85 offen offset:1024 sc1
  v_mfma_f32_16x16x32_bf16 v[116:119], v[180:183], a[184:187], v[116:119]
  v_mfma_f32_16x16x32_bf16 v[140:143], v[180:183], a[188:191], v[140:143]
  s_waitcnt vmcnt(13)
  v_mfma_f32_16x16x32_bf16 v[72:75], v[184:187], a[176:179], v[72:75]
  v_mfma_f32_16x16x32_bf16 v[96:99], v[184:187], a[180:183], v[96:99]
  buffer_load_dwordx4 v[180:183], v1, s[4:7], s85 offen offset:2048 sc1
  v_mfma_f32_16x16x32_bf16 v[120:123], v[184:187], a[184:187], v[120:123]
  v_mfma_f32_16x16x32_bf16 v[144:147], v[184:187], a[188:191], v[144:147]
  s_waitcnt vmcnt(13)
  v_mfma_f32_16x16x32_bf16 v[76:79], v[224:227], a[176:179], v[76:79]
  v_mfma_f32_16x16x32_bf16 v[100:103], v[224:227], a[180:183], v[100:103]
  buffer_load_dwordx4 v[184:187], v1, s[4:7], s85 offen offset:3072 sc1
  v_mfma_f32_16x16x32_bf16 v[124:127], v[224:227], a[184:187], v[124:127]
  v_mfma_f32_16x16x32_bf16 v[148:151], v[224:227], a[188:191], v[148:151]
  s_waitcnt vmcnt(13)
  v_mfma_f32_16x16x32_bf16 v[80:83], v[228:231], a[176:179], v[80:83]
  v_mfma_f32_16x16x32_bf16 v[104:107], v[228:231], a[180:183], v[104:107]
  buffer_load_dwordx4 v[224:227], v1, s[4:7], s86 offen offset:0 sc1
  v_mfma_f32_16x16x32_bf16 v[128:131], v[228:231], a[184:187], v[128:131]
  v_mfma_f32_16x16x32_bf16 v[152:155], v[228:231], a[188:191], v[152:155]
  s_waitcnt vmcnt(13)
  v_mfma_f32_16x16x32_bf16 v[84:87], v[232:235], a[176:179], v[84:87]
  v_mfma_f32_16x16x32_bf16 v[108:111], v[232:235], a[180:183], v[108:111]
  buffer_load_dwordx4 v[228:231], v1, s[4:7], s86 offen offset:1024 sc1
  v_mfma_f32_16x16x32_bf16 v[132:135], v[232:235], a[184:187], v[132:135]
  v_mfma_f32_16x16x32_bf16 v[156:159], v[232:235], a[188:191], v[156:159]
  s_waitcnt vmcnt(13)
  v_mfma_f32_16x16x32_bf16 v[88:91], v[236:239], a[176:179], v[88:91]
  v_mfma_f32_16x16x32_bf16 v[112:115], v[236:239], a[180:183], v[112:115]
  s_add_u32 s85, s22, 15253504
  s_add_u32 s86, s85, 4096
  buffer_load_dwordx4 v[232:235], v1, s[4:7], s85 offen offset:0 sc1
  v_mfma_f32_16x16x32_bf16 v[136:139], v[236:239], a[184:187], v[136:139]
  v_mfma_f32_16x16x32_bf16 v[160:163], v[236:239], a[188:191], v[160:163]
  s_waitcnt vmcnt(13)
  v_mfma_f32_16x16x32_bf16 v[68:71], v[240:243], a[192:195], v[68:71]
  v_mfma_f32_16x16x32_bf16 v[92:95], v[240:243], a[196:199], v[92:95]
  buffer_load_dwordx4 v[236:239], v1, s[4:7], s85 offen offset:1024 sc1
  v_mfma_f32_16x16x32_bf16 v[116:119], v[240:243], a[200:203], v[116:119]
  v_mfma_f32_16x16x32_bf16 v[140:143], v[240:243], a[204:207], v[140:143]
  s_waitcnt vmcnt(13)
  v_mfma_f32_16x16x32_bf16 v[72:75], v[244:247], a[192:195], v[72:75]
  v_mfma_f32_16x16x32_bf16 v[96:99], v[244:247], a[196:199], v[96:99]
  buffer_load_dwordx4 v[240:243], v1, s[4:7], s85 offen offset:2048 sc1
  v_mfma_f32_16x16x32_bf16 v[120:123], v[244:247], a[200:203], v[120:123]
  v_mfma_f32_16x16x32_bf16 v[144:147], v[244:247], a[204:207], v[144:147]
  s_waitcnt vmcnt(12)
  v_mfma_f32_16x16x32_bf16 v[76:79], v[248:251], a[192:195], v[76:79]
  v_mfma_f32_16x16x32_bf16 v[100:103], v[248:251], a[196:199], v[100:103]
  buffer_load_dwordx4 v[244:247], v1, s[4:7], s85 offen offset:3072 sc1
  v_mfma_f32_16x16x32_bf16 v[124:127], v[248:251], a[200:203], v[124:127]
  v_mfma_f32_16x16x32_bf16 v[148:151], v[248:251], a[204:207], v[148:151]
  s_waitcnt vmcnt(12)
  v_mfma_f32_16x16x32_bf16 v[80:83], v[252:255], a[192:195], v[80:83]
  v_mfma_f32_16x16x32_bf16 v[104:107], v[252:255], a[196:199], v[104:107]
  buffer_load_dwordx4 v[248:251], v1, s[4:7], s86 offen offset:0 sc1
  v_mfma_f32_16x16x32_bf16 v[128:131], v[252:255], a[200:203], v[128:131]
  v_mfma_f32_16x16x32_bf16 v[152:155], v[252:255], a[204:207], v[152:155]
  s_waitcnt vmcnt(12)
  v_mfma_f32_16x16x32_bf16 v[84:87], v[164:167], a[192:195], v[84:87]
  v_mfma_f32_16x16x32_bf16 v[108:111], v[164:167], a[196:199], v[108:111]
  buffer_load_dwordx4 v[252:255], v1, s[4:7], s86 offen offset:1024 sc1
  v_mfma_f32_16x16x32_bf16 v[132:135], v[164:167], a[200:203], v[132:135]
  v_mfma_f32_16x16x32_bf16 v[156:159], v[164:167], a[204:207], v[156:159]
  s_waitcnt vmcnt(12)
  v_mfma_f32_16x16x32_bf16 v[88:91], v[168:171], a[192:195], v[88:91]
  v_mfma_f32_16x16x32_bf16 v[112:115], v[168:171], a[196:199], v[112:115]
  s_add_u32 s85, s22, 15259648
  s_add_u32 s86, s85, 4096
  buffer_load_dwordx4 v[164:167], v1, s[4:7], s85 offen offset:0 sc1
  v_mfma_f32_16x16x32_bf16 v[136:139], v[168:171], a[200:203], v[136:139]
  v_mfma_f32_16x16x32_bf16 v[160:163], v[168:171], a[204:207], v[160:163]
  s_waitcnt vmcnt(12)
  v_mfma_f32_16x16x32_bf16 v[68:71], v[172:175], a[208:211], v[68:71]
  v_mfma_f32_16x16x32_bf16 v[92:95], v[172:175], a[212:215], v[92:95]
  buffer_load_dwordx4 v[168:171], v1, s[4:7], s85 offen offset:1024 sc1
  v_mfma_f32_16x16x32_bf16 v[116:119], v[172:175], a[216:219], v[116:119]
  v_mfma_f32_16x16x32_bf16 v[140:143], v[172:175], a[220:223], v[140:143]
  s_waitcnt vmcnt(12)
  v_mfma_f32_16x16x32_bf16 v[72:75], v[176:179], a[208:211], v[72:75]
  v_mfma_f32_16x16x32_bf16 v[96:99], v[176:179], a[212:215], v[96:99]
  buffer_load_dwordx4 v[172:175], v1, s[4:7], s85 offen offset:2048 sc1
  v_mfma_f32_16x16x32_bf16 v[120:123], v[176:179], a[216:219], v[120:123]
  v_mfma_f32_16x16x32_bf16 v[144:147], v[176:179], a[220:223], v[144:147]
  s_waitcnt vmcnt(12)
  v_mfma_f32_16x16x32_bf16 v[76:79], v[180:183], a[208:211], v[76:79]
  v_mfma_f32_16x16x32_bf16 v[100:103], v[180:183], a[212:215], v[100:103]
  buffer_load_dwordx4 v[176:179], v1, s[4:7], s85 offen offset:3072 sc1
  v_mfma_f32_16x16x32_bf16 v[124:127], v[180:183], a[216:219], v[124:127]
  v_mfma_f32_16x16x32_bf16 v[148:151], v[180:183], a[220:223], v[148:151]
  s_waitcnt vmcnt(12)
  v_mfma_f32_16x16x32_bf16 v[80:83], v[184:187], a[208:211], v[80:83]
  v_mfma_f32_16x16x32_bf16 v[104:107], v[184:187], a[212:215], v[104:107]
  buffer_load_dwordx4 v[180:183], v1, s[4:7], s86 offen offset:0 sc1
  v_mfma_f32_16x16x32_bf16 v[128:131], v[184:187], a[216:219], v[128:131]
  v_mfma_f32_16x16x32_bf16 v[152:155], v[184:187], a[220:223], v[152:155]
  s_waitcnt vmcnt(12)
  v_mfma_f32_16x16x32_bf16 v[84:87], v[224:227], a[208:211], v[84:87]
  v_mfma_f32_16x16x32_bf16 v[108:111], v[224:227], a[212:215], v[108:111]
  buffer_load_dwordx4 v[184:187], v1, s[4:7], s86 offen offset:1024 sc1
  v_mfma_f32_16x16x32_bf16 v[132:135], v[224:227], a[216:219], v[132:135]
  v_mfma_f32_16x16x32_bf16 v[156:159], v[224:227], a[220:223], v[156:159]
  s_waitcnt vmcnt(12)
  v_mfma_f32_16x16x32_bf16 v[88:91], v[228:231], a[208:211], v[88:91]
  v_mfma_f32_16x16x32_bf16 v[112:115], v[228:231], a[212:215], v[112:115]
  v_mfma_f32_16x16x32_bf16 v[136:139], v[228:231], a[216:219], v[136:139]
  v_mfma_f32_16x16x32_bf16 v[160:163], v[228:231], a[220:223], v[160:163]
  s_waitcnt vmcnt(11)
  v_mfma_f32_16x16x32_bf16 v[68:71], v[232:235], a[224:227], v[68:71]
  v_mfma_f32_16x16x32_bf16 v[92:95], v[232:235], a[228:231], v[92:95]
  v_mfma_f32_16x16x32_bf16 v[116:119], v[232:235], a[232:235], v[116:119]
  v_mfma_f32_16x16x32_bf16 v[140:143], v[232:235], a[236:239], v[140:143]
  s_waitcnt vmcnt(10)
  v_mfma_f32_16x16x32_bf16 v[72:75], v[236:239], a[224:227], v[72:75]
  v_mfma_f32_16x16x32_bf16 v[96:99], v[236:239], a[228:231], v[96:99]
  v_mfma_f32_16x16x32_bf16 v[120:123], v[236:239], a[232:235], v[120:123]
  v_mfma_f32_16x16x32_bf16 v[144:147], v[236:239], a[236:239], v[144:147]
  s_waitcnt vmcnt(9)
  v_mfma_f32_16x16x32_bf16 v[76:79], v[240:243], a[224:227], v[76:79]
  v_mfma_f32_16x16x32_bf16 v[100:103], v[240:243], a[228:231], v[100:103]
  v_mfma_f32_16x16x32_bf16 v[124:127], v[240:243], a[232:235], v[124:127]
  v_mfma_f32_16x16x32_bf16 v[148:151], v[240:243], a[236:239], v[148:151]
  s_waitcnt vmcnt(8)
  v_mfma_f32_16x16x32_bf16 v[80:83], v[244:247], a[224:227], v[80:83]
  v_mfma_f32_16x16x32_bf16 v[104:107], v[244:247], a[228:231], v[104:107]
  v_mfma_f32_16x16x32_bf16 v[128:131], v[244:247], a[232:235], v[128:131]
  v_mfma_f32_16x16x32_bf16 v[152:155], v[244:247], a[236:239], v[152:155]
  s_waitcnt vmcnt(7)
  v_mfma_f32_16x16x32_bf16 v[84:87], v[248:251], a[224:227], v[84:87]
  v_mfma_f32_16x16x32_bf16 v[108:111], v[248:251], a[228:231], v[108:111]
  v_mfma_f32_16x16x32_bf16 v[132:135], v[248:251], a[232:235], v[132:135]
  v_mfma_f32_16x16x32_bf16 v[156:159], v[248:251], a[236:239], v[156:159]
  s_waitcnt vmcnt(6)
  v_mfma_f32_16x16x32_bf16 v[88:91], v[252:255], a[224:227], v[88:91]
  v_mfma_f32_16x16x32_bf16 v[112:115], v[252:255], a[228:231], v[112:115]
  v_mfma_f32_16x16x32_bf16 v[136:139], v[252:255], a[232:235], v[136:139]
  v_mfma_f32_16x16x32_bf16 v[160:163], v[252:255], a[236:239], v[160:163]
  s_waitcnt vmcnt(5)
  v_mfma_f32_16x16x32_bf16 v[116:119], v[164:167], a[248:251], v[116:119]
  v_mfma_f32_16x16x32_bf16 v[140:143], v[164:167], a[252:255], v[140:143]
  v_mfma_f32_16x16x32_bf16 v[92:95], v[164:167], a[244:247], v[92:95]
  v_mfma_f32_16x16x32_bf16 v[68:71], v[164:167], a[240:243], v[68:71]
  s_waitcnt vmcnt(4)
  v_mfma_f32_16x16x32_bf16 v[120:123], v[168:171], a[248:251], v[120:123]
  v_mfma_f32_16x16x32_bf16 v[144:147], v[168:171], a[252:255], v[144:147]
  v_mfma_f32_16x16x32_bf16 v[96:99], v[168:171], a[244:247], v[96:99]
  s_nop 0
  ds_write_b128 v212, v[116:119] offset:0
  ds_write_b128 v212, v[140:143] offset:6144
  v_mfma_f32_16x16x32_bf16 v[72:75], v[168:171], a[240:243], v[72:75]
  s_waitcnt vmcnt(3)
  v_mfma_f32_16x16x32_bf16 v[124:127], v[172:175], a[248:251], v[124:127]
  v_mfma_f32_16x16x32_bf16 v[148:151], v[172:175], a[252:255], v[148:151]
  v_mfma_f32_16x16x32_bf16 v[100:103], v[172:175], a[244:247], v[100:103]
  ds_write_b128 v212, v[120:123] offset:1024
  ds_write_b128 v212, v[144:147] offset:7168
  v_mfma_f32_16x16x32_bf16 v[76:79], v[172:175], a[240:243], v[76:79]
  s_waitcnt vmcnt(2)
  v_mfma_f32_16x16x32_bf16 v[128:131], v[176:179], a[248:251], v[128:131]
  v_mfma_f32_16x16x32_bf16 v[152:155], v[176:179], a[252:255], v[152:155]
  v_mfma_f32_16x16x32_bf16 v[104:107], v[176:179], a[244:247], v[104:107]
  ds_write_b128 v212, v[124:127] offset:2048
  ds_write_b128 v212, v[148:151] offset:8192
  v_mfma_f32_16x16x32_bf16 v[80:83], v[176:179], a[240:243], v[80:83]
  s_waitcnt vmcnt(1)
  v_mfma_f32_16x16x32_bf16 v[132:135], v[180:183], a[248:251], v[132:135]
  v_mfma_f32_16x16x32_bf16 v[156:159], v[180:183], a[252:255], v[156:159]
  v_mfma_f32_16x16x32_bf16 v[108:111], v[180:183], a[244:247], v[108:111]
  ds_write_b128 v212, v[128:131] offset:3072
  ds_write_b128 v212, v[152:155] offset:9216
  v_mfma_f32_16x16x32_bf16 v[84:87], v[180:183], a[240:243], v[84:87]
  s_waitcnt vmcnt(0)
  v_mfma_f32_16x16x32_bf16 v[136:139], v[184:187], a[248:251], v[136:139]
  v_mfma_f32_16x16x32_bf16 v[160:163], v[184:187], a[252:255], v[160:163]
  v_mfma_f32_16x16x32_bf16 v[112:115], v[184:187], a[244:247], v[112:115]
  ds_write_b128 v212, v[132:135] offset:4096
  ds_write_b128 v212, v[156:159] offset:10240
  v_mfma_f32_16x16x32_bf16 v[88:91], v[184:187], a[240:243], v[88:91]
  s_nop 2
  ds_write_b128 v212, v[136:139] offset:5120
  ds_write_b128 v212, v[160:163] offset:11264
  s_waitcnt lgkmcnt(0)
  s_barrier
  ds_read_b128 v[140:143], v213 offset:6144
  ds_read_b128 v[144:147], v213 offset:7168
  ds_read_b128 v[148:151], v213 offset:8192
  ds_read_b128 v[152:155], v213 offset:9216
  ds_read_b128 v[156:159], v213 offset:10240
  ds_read_b128 v[160:163], v213 offset:11264
  ds_read_b128 v[116:119], v213 offset:0
  ds_read_b128 v[120:123], v213 offset:1024
  ds_read_b128 v[124:127], v213 offset:2048
  ds_read_b128 v[128:131], v213 offset:3072
  ds_read_b128 v[132:135], v213 offset:4096
  ds_read_b128 v[136:139], v213 offset:5120
  s_waitcnt lgkmcnt(11)
  v_pk_add_f32 v[92:93], v[92:93], v[140:141]
  v_pk_add_f32 v[94:95], v[94:95], v[142:143]
  ds_write_b128 v213, v[92:95] offset:6144
  s_waitcnt lgkmcnt(11)
  v_pk_add_f32 v[96:97], v[96:97], v[144:145]
  v_pk_add_f32 v[98:99], v[98:99], v[146:147]
  ds_write_b128 v213, v[96:99] offset:7168
  s_waitcnt lgkmcnt(11)
  v_pk_add_f32 v[100:101], v[100:101], v[148:149]
  v_pk_add_f32 v[102:103], v[102:103], v[150:151]
  ds_write_b128 v213, v[100:103] offset:8192
  s_waitcnt lgkmcnt(11)
  v_pk_add_f32 v[104:105], v[104:105], v[152:153]
  v_pk_add_f32 v[106:107], v[106:107], v[154:155]
  ds_write_b128 v213, v[104:107] offset:9216
  s_waitcnt lgkmcnt(11)
  v_pk_add_f32 v[108:109], v[108:109], v[156:157]
  v_pk_add_f32 v[110:111], v[110:111], v[158:159]
  ds_write_b128 v213, v[108:111] offset:10240
  s_waitcnt lgkmcnt(11)
  v_pk_add_f32 v[112:113], v[112:113], v[160:161]
  v_pk_add_f32 v[114:115], v[114:115], v[162:163]
  ds_write_b128 v213, v[112:115] offset:11264
  s_waitcnt lgkmcnt(11)
  v_pk_add_f32 v[68:69], v[68:69], v[116:117]
  v_pk_add_f32 v[70:71], v[70:71], v[118:119]
  s_waitcnt lgkmcnt(10)
  v_pk_add_f32 v[72:73], v[72:73], v[120:121]
  v_pk_add_f32 v[74:75], v[74:75], v[122:123]
  s_waitcnt lgkmcnt(9)
  v_pk_add_f32 v[76:77], v[76:77], v[124:125]
  v_pk_add_f32 v[78:79], v[78:79], v[126:127]
  s_waitcnt lgkmcnt(8)
  v_pk_add_f32 v[80:81], v[80:81], v[128:129]
  v_pk_add_f32 v[82:83], v[82:83], v[130:131]
  s_waitcnt lgkmcnt(7)
  v_pk_add_f32 v[84:85], v[84:85], v[132:133]
  v_pk_add_f32 v[86:87], v[86:87], v[134:135]
  s_waitcnt lgkmcnt(6)
  v_pk_add_f32 v[88:89], v[88:89], v[136:137]
  v_pk_add_f32 v[90:91], v[90:91], v[138:139]
  s_waitcnt lgkmcnt(0)
  s_barrier
  ds_read_b128 v[92:95], v214 offset:6144
  ds_read_b128 v[96:99], v214 offset:7168
  ds_read_b128 v[100:103], v214 offset:8192
  ds_read_b128 v[104:107], v214 offset:9216
  ds_read_b128 v[108:111], v214 offset:10240
  ds_read_b128 v[112:115], v214 offset:11264
  s_waitcnt lgkmcnt(5)
  v_pk_add_f32 v[68:69], v[68:69], v[92:93]
  v_pk_add_f32 v[70:71], v[70:71], v[94:95]
  s_waitcnt lgkmcnt(4)
  v_pk_add_f32 v[72:73], v[72:73], v[96:97]
  v_pk_add_f32 v[74:75], v[74:75], v[98:99]
  s_waitcnt lgkmcnt(3)
  v_pk_add_f32 v[76:77], v[76:77], v[100:101]
  v_pk_add_f32 v[78:79], v[78:79], v[102:103]
  s_waitcnt lgkmcnt(2)
  v_pk_add_f32 v[80:81], v[80:81], v[104:105]
  v_pk_add_f32 v[82:83], v[82:83], v[106:107]
  s_waitcnt lgkmcnt(1)
  v_pk_add_f32 v[84:85], v[84:85], v[108:109]
  v_pk_add_f32 v[86:87], v[86:87], v[110:111]
  s_waitcnt lgkmcnt(0)
  v_pk_add_f32 v[88:89], v[88:89], v[112:113]
  v_pk_add_f32 v[90:91], v[90:91], v[114:115]
  v_pk_mul_f32 v[68:69], v[68:69], v[188:189]
  v_cvt_pk_bf16_f32 v224, v68, v69
  v_pk_mul_f32 v[70:71], v[70:71], v[190:191]
  v_cvt_pk_bf16_f32 v225, v70, v71
  v_pk_mul_f32 v[72:73], v[72:73], v[192:193]
  v_cvt_pk_bf16_f32 v226, v72, v73
  v_pk_mul_f32 v[74:75], v[74:75], v[194:195]
  v_cvt_pk_bf16_f32 v227, v74, v75
  v_pk_mul_f32 v[76:77], v[76:77], v[196:197]
  v_cvt_pk_bf16_f32 v228, v76, v77
  v_pk_mul_f32 v[78:79], v[78:79], v[198:199]
  v_cvt_pk_bf16_f32 v229, v78, v79
  v_pk_mul_f32 v[80:81], v[80:81], v[200:201]
  v_cvt_pk_bf16_f32 v230, v80, v81
  v_pk_mul_f32 v[82:83], v[82:83], v[202:203]
  v_cvt_pk_bf16_f32 v231, v82, v83
  v_pk_mul_f32 v[84:85], v[84:85], v[204:205]
  v_cvt_pk_bf16_f32 v232, v84, v85
  v_pk_mul_f32 v[86:87], v[86:87], v[206:207]
  v_cvt_pk_bf16_f32 v233, v86, v87
  v_pk_mul_f32 v[88:89], v[88:89], v[208:209]
  v_cvt_pk_bf16_f32 v234, v88, v89
  v_pk_mul_f32 v[90:91], v[90:91], v[210:211]
  v_cvt_pk_bf16_f32 v235, v90, v91
  s_cmp_eq_u32 s48, 1
  s_cbranch_scc0 L_slow87
  buffer_store_dwordx4 v[224:227], v1, s[4:7], s16 offen offset:0
  buffer_store_dwordx4 v[228:231], v1, s[4:7], s16 offen offset:1024
  buffer_store_dwordx4 v[232:235], v1, s[4:7], s16 offen offset:2048
L_back88:
  s_barrier
  s_add_u32 s82, s75, 835584
  s_add_u32 m0, s43, 45056
  s_nop 0
  buffer_load_dwordx4 v1, s[4:7], s82 offen offset:0 lds
  buffer_load_dwordx4 v1, s[4:7], s82 offen offset:1024 lds
  buffer_load_dwordx4 v1, s[4:7], s82 offen offset:2048 lds
  buffer_load_dwordx4 v1, s[4:7], s82 offen offset:3072 lds
  s_add_u32 s82, s82, 4096
  s_add_u32 m0, m0, 4096
  s_nop 0
  buffer_load_dwordx4 v1, s[4:7], s82 offen offset:0 lds
  s_add_u32 s82, s75, 860160
  s_add_u32 m0, s43, 65536
  s_nop 0
  buffer_load_dwordx4 v1, s[4:7], s82 offen offset:0 lds
  s_waitcnt vmcnt(6)
  s_cmp_eq_u32 s48, 1
  s_cbranch_scc0 L_slow89
  buffer_store_dword v25, v13, s[4:7], s18 offen offset:192
L_back90:
L_ph_wout1:
  s_barrier
  s_add_u32 s86, s53, 0
  s_mov_b32 s88, 0
  buffer_load_dword v223, v14, s[4:7], s55 offen offset:192 sc1
  ds_read_b128 v[224:227], v2 offset:32768
  ds_read_b128 v[228:231], v2 offset:33792
  ds_read_b128 v[232:235], v2 offset:34816
  ds_read_b128 v[236:239], v2 offset:35840
  ds_read_b128 v[240:243], v2 offset:36864
  ds_read_b128 v[244:247], v2 offset:37888
  ds_read_b128 v[248:251], v2 offset:38912
  ds_read_b128 v[252:255], v2 offset:39936
  ds_read_b128 v[164:167], v2 offset:40960
  ds_read_b128 v[168:171], v2 offset:41984
  ds_read_b128 v[172:175], v2 offset:43008
  ds_read_b128 v[176:179], v2 offset:44032
L_poll91:
  buffer_load_dword v221, v14, s[4:7], s55 offen offset:192 sc1
  s_waitcnt vmcnt(1)
  v_cmp_ne_u32 vcc, s44, v223
  s_cbranch_vccz L_seen92
  buffer_load_dword v223, v14, s[4:7], s55 offen offset:192 sc1
  s_add_u32 s88, s88, 1
  s_cmp_gt_u32 s88, 65536
  s_cbranch_scc1 L_abort
  s_waitcnt vmcnt(1)
  v_cmp_ne_u32 vcc, s44, v221
  s_cbranch_vccnz L_poll91
L_seen92:
  buffer_load_dwordx4 v[68:71], v1, s[4:7], s86 offen offset:0 sc1
  buffer_load_dwordx4 v[72:75], v1, s[4:7], s86 offen offset:1024 sc1
  buffer_load_dwordx4 v[76:79], v1, s[4:7], s86 offen offset:2048 sc1
  buffer_load_dwordx4 v[80:83], v1, s[4:7], s86 offen offset:3072 sc1
  s_add_u32 s86, s86, 4096
  buffer_load_dwordx4 v[84:87], v1, s[4:7], s86 offen offset:0 sc1
  buffer_load_dwordx4 v[88:91], v1, s[4:7], s86 offen offset:1024 sc1
  buffer_load_dwordx4 v[92:95], v1, s[4:7], s86 offen offset:2048 sc1
  buffer_load_dwordx4 v[96:99], v1, s[4:7], s86 offen offset:3072 sc1
  s_waitcnt vmcnt(7) lgkmcnt(8)
  v_mfma_f32_16x16x32_bf16 v[48:51], v[224:227], v[68:71], v[48:51]
  ds_read_b128 v[224:227], v2 offset:45056
  v_mfma_f32_16x16x32_bf16 v[52:55], v[228:231], v[68:71], v[52:55]
  ds_read_b128 v[228:231], v2 offset:46080
  v_mfma_f32_16x16x32_bf16 v[56:59], v[232:235], v[68:71], v[56:59]
  ds_read_b128 v[232:235], v2 offset:47104
  v_mfma_f32_16x16x32_bf16 v[60:63], v[236:239], v[68:71], v[60:63]
  ds_read_b128 v[236:239], v2 offset:48128
  s_waitcnt lgkmcnt(8)
  v_mfma_f32_16x16x32_bf16 v[64:67], v[240:243], v[68:71], v[64:67]
  ds_read_b128 v[240:243], v2 offset:49152
  s_waitcnt vmcnt(6)
  v_mfma_f32_16x16x32_bf16 v[48:51], v[244:247], v[72:75], v[48:51]
  ds_read_b128 v[244:247], v2 offset:50176
  buffer_load_dwordx4 v1, s[4:7], s82 offen offset:1024 lds
  v_mfma_f32_16x16x32_bf16 v[52:55], v[248:251], v[72:75], v[52:55]
  ds_read_b128 v[248:251], v2 offset:51200
  s_barrier
  v_mfma_f32_16x16x32_bf16 v[56:59], v[252:255], v[72:75], v[56:59]
  ds_read_b128 v[252:255], v2 offset:52224
  buffer_load_dwordx4 v1, s[4:7], s82 offen offset:2048 lds
  s_waitcnt lgkmcnt(8)
  v_mfma_f32_16x16x32_bf16 v[60:63], v[164:167], v[72:75], v[60:63]
  ds_read_b128 v[164:167], v2 offset:53248
  v_mfma_f32_16x16x32_bf16 v[64:67], v[168:171], v[72:75], v[64:67]
  ds_read_b128 v[168:171], v2 offset:54272
  buffer_load_dwordx4 v1, s[4:7], s82 offen offset:3072 lds
  s_waitcnt vmcnt(8)
  v_mfma_f32_16x16x32_bf16 v[48:51], v[172:175], v[76:79], v[48:51]
  ds_read_b128 v[172:175], v2 offset:55296
  v_mfma_f32_16x16x32_bf16 v[52:55], v[176:179], v[76:79], v[52:55]
  ds_read_b128 v[176:179], v2 offset:56320
  s_waitcnt lgkmcnt(8)
  v_mfma_f32_16x16x32_bf16 v[56:59], v[224:227], v[76:79], v[56:59]
  ds_read_b128 v[224:227], v2 offset:57344
  v_mfma_f32_16x16x32_bf16 v[60:63], v[228:231], v[76:79], v[60:63]
  ds_read_b128 v[228:231], v2 offset:58368
  s_add_u32 s86, s86, 4096
  buffer_load_dwordx4 v[100:103], v1, s[4:7], s86 offen offset:0 sc1
  v_mfma_f32_16x16x32_bf16 v[64:67], v[232:235], v[76:79], v[64:67]
  ds_read_b128 v[232:235], v2 offset:59392
  s_waitcnt vmcnt(8)
  v_mfma_f32_16x16x32_bf16 v[48:51], v[236:239], v[80:83], v[48:51]
  ds_read_b128 v[236:239], v2 offset:60416
  s_waitcnt lgkmcnt(8)
  v_mfma_f32_16x16x32_bf16 v[52:55], v[240:243], v[80:83], v[52:55]
  ds_read_b128 v[240:243], v2 offset:61440
  buffer_load_dwordx4 v[104:107], v1, s[4:7], s86 offen offset:1024 sc1
  v_mfma_f32_16x16x32_bf16 v[56:59], v[244:247], v[80:83], v[56:59]
  ds_read_b128 v[244:247], v2 offset:62464
  v_mfma_f32_16x16x32_bf16 v[60:63], v[248:251], v[80:83], v[60:63]
  ds_read_b128 v[248:251], v2 offset:63488
  v_mfma_f32_16x16x32_bf16 v[64:67], v[252:255], v[80:83], v[64:67]
  s_add_u32 s82, s82, 4096
  s_add_u32 m0, m0, 4096
  ds_read_b128 v[252:255], v2 offset:64512
  buffer_load_dwordx4 v1, s[4:7], s82 offen offset:0 lds
  s_waitcnt vmcnt(9) lgkmcnt(8)
  v_mfma_f32_16x16x32_bf16 v[48:51], v[164:167], v[84:87], v[48:51]
  ds_read_b128 v[164:167], v3 offset:0
  v_mfma_f32_16x16x32_bf16 v[52:55], v[168:171], v[84:87], v[52:55]
  ds_read_b128 v[168:171], v3 offset:1024
  v_mfma_f32_16x16x32_bf16 v[56:59], v[172:175], v[84:87], v[56:59]
  ds_read_b128 v[172:175], v3 offset:2048
  buffer_load_dwordx4 v[108:111], v1, s[4:7], s86 offen offset:2048 sc1
  v_mfma_f32_16x16x32_bf16 v[60:63], v[176:179], v[84:87], v[60:63]
  ds_read_b128 v[176:179], v3 offset:3072
  s_waitcnt lgkmcnt(8)
  v_mfma_f32_16x16x32_bf16 v[64:67], v[224:227], v[84:87], v[64:67]
  ds_read_b128 v[224:227], v3 offset:4096
  s_waitcnt vmcnt(9)
  v_mfma_f32_16x16x32_bf16 v[48:51], v[228:231], v[88:91], v[48:51]
  ds_read_b128 v[228:231], v3 offset:5120
  v_mfma_f32_16x16x32_bf16 v[52:55], v[232:235], v[88:91], v[52:55]
  ds_read_b128 v[232:235], v3 offset:6144
  s_barrier
  v_mfma_f32_16x16x32_bf16 v[56:59], v[236:239], v[88:91], v[56:59]
  ds_read_b128 v[236:239], v3 offset:7168
  buffer_load_dwordx4 v[112:115], v1, s[4:7], s86 offen offset:3072 sc1
  s_waitcnt lgkmcnt(8)
  v_mfma_f32_16x16x32_bf16 v[60:63], v[240:243], v[88:91], v[60:63]
  ds_read_b128 v[240:243], v1 offset:24576
  v_mfma_f32_16x16x32_bf16 v[64:67], v[244:247], v[88:91], v[64:67]
  ds_read_b128 v[244:247], v1 offset:25600
  s_add_u32 s86, s86, 4096
  buffer_load_dwordx4 v[116:119], v1, s[4:7], s86 offen offset:0 sc1
  s_waitcnt vmcnt(10)
  v_mfma_f32_16x16x32_bf16 v[48:51], v[248:251], v[92:95], v[48:51]
  ds_read_b128 v[248:251], v1 offset:26624
  s_mul_i32 s84, s40, 3072
  s_add_u32 s84, s84, 86016
  v_mul_u32_u24 v212, 176, v47
  v_mfma_f32_16x16x32_bf16 v[52:55], v[252:255], v[92:95], v[52:55]
  ds_read_b128 v[252:255], v1 offset:27648
  v_lshrrev_b32 v213, 4, v0
  s_waitcnt lgkmcnt(8)
  v_mfma_f32_16x16x32_bf16 v[56:59], v[164:167], v[92:95], v[56:59]
  ds_read_b128 v[164:167], v1 offset:28672
  buffer_load_dwordx4 v[120:123], v1, s[4:7], s86 offen offset:1024 sc1
  v_mfma_f32_16x16x32_bf16 v[60:63], v[168:171], v[92:95], v[60:63]
  ds_read_b128 v[168:171], v1 offset:29696
  v_lshl_add_u32 v212, v213, 3, v212
  v_mfma_f32_16x16x32_bf16 v[64:67], v[172:175], v[92:95], v[64:67]
  ds_read_b128 v[172:175], v1 offset:30720
  v_add_u32 v212, s84, v212
  s_waitcnt vmcnt(10)
  v_mfma_f32_16x16x32_bf16 v[48:51], v[176:179], v[96:99], v[48:51]
  ds_read_b128 v[176:179], v1 offset:31744
  buffer_load_dwordx4 v[124:127], v1, s[4:7], s86 offen offset:2048 sc1
  s_waitcnt lgkmcnt(8)
  v_mfma_f32_16x16x32_bf16 v[52:55], v[224:227], v[96:99], v[52:55]
  ds_read_b128 v[224:227], v1 offset:32768
  s_mul_i32 s85, s2, 20480
  s_mul_i32 s0, s41, 160
  s_add_u32 s85, s85, s0
  v_add_u32 v188, 0, v0
  v_mfma_f32_16x16x32_bf16 v[56:59], v[228:231], v[96:99], v[56:59]
  ds_read_b128 v[228:231], v1 offset:33792
  buffer_load_dwordx4 v[128:131], v1, s[4:7], s86 offen offset:3072 sc1
  v_mfma_f32_16x16x32_bf16 v[60:63], v[232:235], v[96:99], v[60:63]
  ds_read_b128 v[232:235], v1 offset:34816
  v_mul_u32_u24 v189, 6554, v188
  v_mfma_f32_16x16x32_bf16 v[64:67], v[236:239], v[96:99], v[64:67]
  ds_read_b128 v[236:239], v1 offset:35840
  v_lshrrev_b32 v189, 16, v189
  s_waitcnt vmcnt(8) lgkmcnt(8)
  v_mfma_f32_16x16x32_bf16 v[48:51], v[240:243], v[100:103], v[48:51]
  ds_read_b128 v[240:243], v1 offset:36864
  s_add_u32 s86, s86, 4096
  buffer_load_dwordx4 v[132:135], v1, s[4:7], s86 offen offset:0 sc1
  v_mfma_f32_16x16x32_bf16 v[52:55], v[244:247], v[100:103], v[52:55]
  ds_read_b128 v[244:247], v1 offset:37888
  v_mul_u32_u24 v190, 10, v189
  v_mfma_f32_16x16x32_bf16 v[56:59], v[248:251], v[100:103], v[56:59]
  ds_read_b128 v[248:251], v1 offset:38912
  v_sub_u32 v190, v188, v190
  v_mfma_f32_16x16x32_bf16 v[60:63], v[252:255], v[100:103], v[60:63]
  ds_read_b128 v[252:255], v1 offset:39936
  buffer_load_dwordx4 v[136:139], v1, s[4:7], s86 offen offset:1024 sc1
  s_waitcnt lgkmcnt(8)
  v_mfma_f32_16x16x32_bf16 v[64:67], v[164:167], v[100:103], v[64:67]
  ds_read_b128 v[164:167], v1 offset:40960
  v_lshlrev_b32 v190, 4, v190
  s_waitcnt vmcnt(9)
  v_mfma_f32_16x16x32_bf16 v[48:51], v[168:171], v[104:107], v[48:51]
  ds_read_b128 v[168:171], v1 offset:41984
  v_mul_u32_u24 v191, 176, v189
  v_mfma_f32_16x16x32_bf16 v[52:55], v[172:175], v[104:107], v[52:55]
  ds_read_b128 v[172:175], v1 offset:43008
  s_barrier
  v_mfma_f32_16x16x32_bf16 v[56:59], v[176:179], v[104:107], v[56:59]
  ds_read_b128 v[176:179], v1 offset:44032
  buffer_load_dwordx4 v[140:143], v1, s[4:7], s86 offen offset:2048 sc1
  s_waitcnt lgkmcnt(8)
  v_mfma_f32_16x16x32_bf16 v[60:63], v[224:227], v[104:107], v[60:63]
  ds_read_b128 v[224:227], v1 offset:0
  v_add3_u32 v191, v191, v190, s84
  v_mfma_f32_16x16x32_bf16 v[64:67], v[228:231], v[104:107], v[64:67]
  ds_read_b128 v[228:231], v1 offset:1024
  buffer_load_dwordx4 v[144:147], v1, s[4:7], s86 offen offset:3072 sc1
  s_waitcnt vmcnt(9)
  v_mfma_f32_16x16x32_bf16 v[48:51], v[232:235], v[108:111], v[48:51]
  ds_read_b128 v[232:235], v1 offset:2048
  v_mul_u32_u24 v192, 1280, v189
  v_mfma_f32_16x16x32_bf16 v[52:55], v[236:239], v[108:111], v[52:55]
  ds_read_b128 v[236:239], v1 offset:3072
  v_add_u32 v192, v192, v190
  s_waitcnt lgkmcnt(8)
  v_mfma_f32_16x16x32_bf16 v[56:59], v[240:243], v[108:111], v[56:59]
  ds_read_b128 v[240:243], v1 offset:4096
  s_add_u32 s86, s86, 4096
  buffer_load_dwordx4 v[148:151], v1, s[4:7], s86 offen offset:0 sc1
  v_mfma_f32_16x16x32_bf16 v[60:63], v[244:247], v[108:111], v[60:63]
  ds_read_b128 v[244:247], v1 offset:5120
  v_add_u32 v196, 64, v0
  v_mfma_f32_16x16x32_bf16 v[64:67], v[248:251], v[108:111], v[64:67]
  ds_read_b128 v[248:251], v1 offset:6144
  v_mul_u32_u24 v197, 6554, v196
  s_waitcnt vmcnt(9)
  v_mfma_f32_16x16x32_bf16 v[48:51], v[252:255], v[112:115], v[48:51]
  ds_read_b128 v[252:255], v1 offset:7168
  buffer_load_dwordx4 v[152:155], v1, s[4:7], s86 offen offset:1024 sc1
  s_waitcnt lgkmcnt(8)
  v_mfma_f32_16x16x32_bf16 v[52:55], v[164:167], v[112:115], v[52:55]
  ds_read_b128 v[164:167], v1 offset:8192
  v_lshrrev_b32 v197, 16, v197
  v_mfma_f32_16x16x32_bf16 v[56:59], v[168:171], v[112:115], v[56:59]
  ds_read_b128 v[168:171], v1 offset:9216
  v_mul_u32_u24 v198, 10, v197
  v_mfma_f32_16x16x32_bf16 v[60:63], v[172:175], v[112:115], v[60:63]
  ds_read_b128 v[172:175], v1 offset:10240
  v_sub_u32 v198, v196, v198
  v_mfma_f32_16x16x32_bf16 v[64:67], v[176:179], v[112:115], v[64:67]
  ds_read_b128 v[176:179], v1 offset:11264
  buffer_load_dwordx4 v[156:159], v1, s[4:7], s86 offen offset:2048 sc1
  s_waitcnt vmcnt(10) lgkmcnt(8)
  v_mfma_f32_16x16x32_bf16 v[48:51], v[224:227], v[116:119], v[48:51]
  ds_read_b128 v[224:227], v1 offset:12288
  v_lshlrev_b32 v198, 4, v198
  v_mfma_f32_16x16x32_bf16 v[52:55], v[228:231], v[116:119], v[52:55]
  ds_read_b128 v[228:231], v1 offset:13312
  v_mul_u32_u24 v199, 176, v197
  v_mfma_f32_16x16x32_bf16 v[56:59], v[232:235], v[116:119], v[56:59]
  ds_read_b128 v[232:235], v1 offset:14336
  buffer_load_dwordx4 v[160:163], v1, s[4:7], s86 offen offset:3072 sc1
  v_mfma_f32_16x16x32_bf16 v[60:63], v[236:239], v[116:119], v[60:63]
  ds_read_b128 v[236:239], v1 offset:15360
  v_add3_u32 v199, v199, v198, s84
  s_waitcnt lgkmcnt(8)
  v_mfma_f32_16x16x32_bf16 v[64:67], v[240:243], v[116:119], v[64:67]
  ds_read_b128 v[240:243], v1 offset:16384
  v_mul_u32_u24 v200, 1280, v197
  s_waitcnt vmcnt(10)
  v_mfma_f32_16x16x32_bf16 v[48:51], v[244:247], v[120:123], v[48:51]
  ds_read_b128 v[244:247], v1 offset:17408
  v_add_u32 v200, v200, v198
  v_mfma_f32_16x16x32_bf16 v[52:55], v[248:251], v[120:123], v[52:55]
  ds_read_b128 v[248:251], v1 offset:18432
  s_barrier
  v_mfma_f32_16x16x32_bf16 v[56:59], v[252:255], v[120:123], v[56:59]
  ds_read_b128 v[252:255], v1 offset:19456
  v_add_u32 v204, 128, v0
  s_waitcnt lgkmcnt(8)
  v_mfma_f32_16x16x32_bf16 v[60:63], v[164:167], v[120:123], v[60:63]
  ds_read_b128 v[164:167], v1 offset:45056
  v_mul_u32_u24 v205, 6554, v204
  v_mfma_f32_16x16x32_bf16 v[64:67], v[168:171], v[120:123], v[64:67]
  ds_read_b128 v[168:171], v1 offset:46080
  v_lshrrev_b32 v205, 16, v205
  s_waitcnt vmcnt(9)
  v_mfma_f32_16x16x32_bf16 v[48:51], v[172:175], v[124:127], v[48:51]
  ds_read_b128 v[172:175], v1 offset:47104
  v_mul_u32_u24 v206, 10, v205
  v_mfma_f32_16x16x32_bf16 v[52:55], v[176:179], v[124:127], v[52:55]
  ds_read_b128 v[176:179], v1 offset:48128
  v_sub_u32 v206, v204, v206
  s_waitcnt lgkmcnt(8)
  v_mfma_f32_16x16x32_bf16 v[56:59], v[224:227], v[124:127], v[56:59]
  ds_read_b128 v[224:227], v1 offset:49152
  v_lshlrev_b32 v206, 4, v206
  v_mfma_f32_16x16x32_bf16 v[60:63], v[228:231], v[124:127], v[60:63]
  ds_read_b128 v[228:231], v1 offset:50176
  v_mul_u32_u24 v207, 176, v205
  v_mfma_f32_16x16x32_bf16 v[64:67], v[232:235], v[124:127], v[64:67]
  ds_read_b128 v[232:235], v1 offset:51200
  v_add3_u32 v207, v207, v206, s84
  s_waitcnt vmcnt(8)
  v_mfma_f32_16x16x32_bf16 v[48:51], v[236:239], v[128:131], v[48:51]
  ds_read_b128 v[236:239], v1 offset:52224
  v_mul_u32_u24 v208, 1280, v205
  s_waitcnt lgkmcnt(8)
  v_mfma_f32_16x16x32_bf16 v[52:55], v[240:243], v[128:131], v[52:55]
  ds_read_b128 v[240:243], v1 offset:53248
  v_add_u32 v208, v208, v206
  v_mfma_f32_16x16x32_bf16 v[56:59], v[244:247], v[128:131], v[56:59]
  ds_read_b128 v[244:247], v1 offset:54272
  v_lshlrev_b32 v204, 31, v33
  v_mfma_f32_16x16x32_bf16 v[60:63], v[248:251], v[128:131], v[60:63]
  ds_read_b128 v[248:251], v1 offset:55296
  v_or_b32 v208, v208, v204
  v_mfma_f32_16x16x32_bf16 v[64:67], v[252:255], v[128:131], v[64:67]
  ds_read_b128 v[252:255], v1 offset:56320
  s_waitcnt vmcnt(7) lgkmcnt(8)
  v_mfma_f32_16x16x32_bf16 v[48:51], v[164:167], v[132:135], v[48:51]
  ds_read_b128 v[164:167], v1 offset:57344
  v_mfma_f32_16x16x32_bf16 v[52:55], v[168:171], v[132:135], v[52:55]
  ds_read_b128 v[168:171], v1 offset:58368
  v_mfma_f32_16x16x32_bf16 v[56:59], v[172:175], v[132:135], v[56:59]
  ds_read_b128 v[172:175], v1 offset:59392
  v_mfma_f32_16x16x32_bf16 v[60:63], v[176:179], v[132:135], v[60:63]
  ds_read_b128 v[176:179], v1 offset:60416
  s_waitcnt lgkmcnt(8)
  v_mfma_f32_16x16x32_bf16 v[64:67], v[224:227], v[132:135], v[64:67]
  ds_read_b128 v[224:227], v1 offset:61440
  s_waitcnt vmcnt(6)
  v_mfma_f32_16x16x32_bf16 v[48:51], v[228:231], v[136:139], v[48:51]
  ds_read_b128 v[228:231], v1 offset:62464
  v_mfma_f32_16x16x32_bf16 v[52:55], v[232:235], v[136:139], v[52:55]
  ds_read_b128 v[232:235], v1 offset:63488
  s_barrier
  v_mfma_f32_16x16x32_bf16 v[56:59], v[236:239], v[136:139], v[56:59]
  ds_read_b128 v[236:239], v1 offset:64512
  s_waitcnt lgkmcnt(8)
  v_mfma_f32_16x16x32_bf16 v[60:63], v[240:243], v[136:139], v[60:63]
  ds_read_b128 v[240:243], v2 offset:0
  v_mfma_f32_16x16x32_bf16 v[64:67], v[244:247], v[136:139], v[64:67]
  ds_read_b128 v[244:247], v2 offset:1024
  s_waitcnt vmcnt(5)
  v_mfma_f32_16x16x32_bf16 v[48:51], v[248:251], v[140:143], v[48:51]
  ds_read_b128 v[248:251], v2 offset:2048
  v_mfma_f32_16x16x32_bf16 v[52:55], v[252:255], v[140:143], v[52:55]
  ds_read_b128 v[252:255], v2 offset:3072
  s_waitcnt lgkmcnt(8)
  v_mfma_f32_16x16x32_bf16 v[56:59], v[164:167], v[140:143], v[56:59]
  ds_read_b128 v[164:167], v2 offset:4096
  v_mfma_f32_16x16x32_bf16 v[60:63], v[168:171], v[140:143], v[60:63]
  ds_read_b128 v[168:171], v2 offset:5120
  v_mfma_f32_16x16x32_bf16 v[64:67], v[172:175], v[140:143], v[64:67]
  ds_read_b128 v[172:175], v2 offset:6144
  s_waitcnt vmcnt(4)
  v_mfma_f32_16x16x32_bf16 v[48:51], v[176:179], v[144:147], v[48:51]
  ds_read_b128 v[176:179], v2 offset:7168
  s_waitcnt lgkmcnt(8)
  v_mfma_f32_16x16x32_bf16 v[52:55], v[224:227], v[144:147], v[52:55]
  ds_read_b128 v[224:227], v2 offset:8192
  v_mfma_f32_16x16x32_bf16 v[56:59], v[228:231], v[144:147], v[56:59]
  ds_read_b128 v[228:231], v2 offset:9216
  v_mfma_f32_16x16x32_bf16 v[60:63], v[232:235], v[144:147], v[60:63]
  ds_read_b128 v[232:235], v2 offset:10240
  v_mfma_f32_16x16x32_bf16 v[64:67], v[236:239], v[144:147], v[64:67]
  ds_read_b128 v[236:239], v2 offset:11264
  s_waitcnt vmcnt(3) lgkmcnt(8)
  v_mfma_f32_16x16x32_bf16 v[48:51], v[240:243], v[148:151], v[48:51]
  ds_read_b128 v[240:243], v2 offset:12288
  v_mfma_f32_16x16x32_bf16 v[52:55], v[244:247], v[148:151], v[52:55]
  ds_read_b128 v[244:247], v2 offset:13312
  v_mfma_f32_16x16x32_bf16 v[56:59], v[248:251], v[148:151], v[56:59]
  ds_read_b128 v[248:251], v2 offset:14336
  v_mfma_f32_16x16x32_bf16 v[60:63], v[252:255], v[148:151], v[60:63]
  ds_read_b128 v[252:255], v2 offset:15360
  s_waitcnt lgkmcnt(8)
  v_mfma_f32_16x16x32_bf16 v[64:67], v[164:167], v[148:151], v[64:67]
  ds_read_b128 v[164:167], v2 offset:16384
  s_waitcnt vmcnt(2)
  v_mfma_f32_16x16x32_bf16 v[48:51], v[168:171], v[152:155], v[48:51]
  ds_read_b128 v[168:171], v2 offset:17408
  v_mfma_f32_16x16x32_bf16 v[52:55], v[172:175], v[152:155], v[52:55]
  ds_read_b128 v[172:175], v2 offset:18432
  s_barrier
  v_mfma_f32_16x16x32_bf16 v[56:59], v[176:179], v[152:155], v[56:59]
  ds_read_b128 v[176:179], v2 offset:19456
  s_waitcnt lgkmcnt(8)
  v_mfma_f32_16x16x32_bf16 v[60:63], v[224:227], v[152:155], v[60:63]
  v_mfma_f32_16x16x32_bf16 v[64:67], v[228:231], v[152:155], v[64:67]
  s_waitcnt vmcnt(1)
  v_mfma_f32_16x16x32_bf16 v[48:51], v[232:235], v[156:159], v[48:51]
  v_mfma_f32_16x16x32_bf16 v[52:55], v[236:239], v[156:159], v[52:55]
  s_waitcnt lgkmcnt(4)
  v_mfma_f32_16x16x32_bf16 v[56:59], v[240:243], v[156:159], v[56:59]
  v_mfma_f32_16x16x32_bf16 v[60:63], v[244:247], v[156:159], v[60:63]
  v_mfma_f32_16x16x32_bf16 v[64:67], v[248:251], v[156:159], v[64:67]
  s_waitcnt vmcnt(0)
  v_mfma_f32_16x16x32_bf16 v[48:51], v[252:255], v[160:163], v[48:51]
  s_waitcnt lgkmcnt(0)
  v_mfma_f32_16x16x32_bf16 v[52:55], v[164:167], v[160:163], v[52:55]
  v_mfma_f32_16x16x32_bf16 v[56:59], v[168:171], v[160:163], v[56:59]
  v_mfma_f32_16x16x32_bf16 v[60:63], v[172:175], v[160:163], v[60:63]
  v_mfma_f32_16x16x32_bf16 v[64:67], v[176:179], v[160:163], v[64:67]
  s_nop 2
  v_cvt_pk_bf16_f32 v224, v48, v49
  v_cvt_pk_bf16_f32 v225, v50, v51
  ds_write_b64 v212, v[224:225] offset:0
  v_cvt_pk_bf16_f32 v226, v52, v53
  v_cvt_pk_bf16_f32 v227, v54, v55
  ds_write_b64 v212, v[226:227] offset:32
  v_cvt_pk_bf16_f32 v228, v56, v57
  v_cvt_pk_bf16_f32 v229, v58, v59
  ds_write_b64 v212, v[228:229] offset:64
  v_cvt_pk_bf16_f32 v230, v60, v61
  v_cvt_pk_bf16_f32 v231, v62, v63
  ds_write_b64 v212, v[230:231] offset:96
  v_cvt_pk_bf16_f32 v232, v64, v65
  v_cvt_pk_bf16_f32 v233, v66, v67
  ds_write_b64 v212, v[232:233] offset:128
  ds_read_b128 v[236:239], v191
  ds_read_b128 v[240:243], v199
  ds_read_b128 v[244:247], v207
  s_waitcnt lgkmcnt(2)
  buffer_store_dwordx4 v[236:239], v192, s[32:35], s85 offen
  s_waitcnt lgkmcnt(1)
  buffer_store_dwordx4 v[240:243], v200, s[32:35], s85 offen
  s_waitcnt lgkmcnt(0)
  buffer_store_dwordx4 v[244:247], v208, s[32:35], s85 offen
L_abort:
  s_endpgm
L_spin8:
  s_mov_b32 s88, 0
  L_poll10:
  buffer_load_dword v235, v234, s[4:7], s89 offen sc1
  s_add_u32 s88, s88, 1
  s_cmp_gt_u32 s88, 65536
  s_cbranch_scc1 L_abort
  s_waitcnt vmcnt(0)
  v_cmp_ne_u32 vcc, s44, v235
  s_nop 0
  s_cbranch_vccnz L_poll10
  s_nop 1
  s_branch L_back9
L_spin16:
  s_mov_b32 s88, 0
  L_poll18:
  buffer_load_dwordx2 v[158:159], v162, s[4:7], s89 offen offset:256 sc1
  buffer_load_dwordx2 v[160:161], v163, s[4:7], s91 offen sc1
  s_add_u32 s88, s88, 1
  s_cmp_gt_u32 s88, 65536
  s_cbranch_scc1 L_abort
  s_waitcnt vmcnt(0)
  v_cmp_ne_u32 s[94:95], s44, v158
  v_cmp_ne_u32 vcc, s44, v159
  s_nop 0
  s_or_b64 s[94:95], vcc, s[94:95]
  v_cmp_ne_u32 vcc, s44, v160
  s_nop 0
  s_or_b64 vcc, vcc, s[94:95]
  s_cbranch_vccnz L_poll18
  s_nop 1
  s_branch L_back17
L_spin23:
  s_mov_b32 s88, 0
  L_poll25:
  buffer_load_dwordx4 v[184:187], v36, s[4:7], s85 offen sc1
  buffer_load_dwordx4 v[188:191], v36, s[4:7], s86 offen sc1
  s_add_u32 s88, s88, 1
  s_cmp_gt_u32 s88, 65536
  s_cbranch_scc1 L_abort
  s_waitcnt vmcnt(0)
  v_perm_b32 v192, v185, v184, s56
  v_perm_b32 v193, v187, v186, s57
  v_or_b32 v192, v192, v193
  v_cmp_ne_u32 s[94:95], s44, v192
  v_perm_b32 v194, v189, v188, s56
  v_perm_b32 v195, v191, v190, s57
  v_or_b32 v194, v194, v195
  v_cmp_ne_u32 vcc, s44, v194
  s_nop 0
  s_or_b64 vcc, vcc, s[94:95]
  s_cbranch_vccnz L_poll25
  s_nop 1
  s_branch L_back24
L_slow27:
  buffer_store_dwordx4 v[224:227], v1, s[4:7], s12 offen sc1
  buffer_store_dwordx4 v[228:231], v1, s[4:7], s12 offen offset:1024 sc1
  buffer_store_dwordx2 v[232:233], v1, s[4:7], s13 offen sc1
  s_branch L_back28
L_slow29:
  buffer_store_dword v25, v13, s[4:7], s18 offen offset:0 sc1
  s_branch L_back30
L_slow33:
  buffer_store_dwordx4 v[224:227], v1, s[4:7], s14 offen sc1
  buffer_store_dwordx4 v[228:231], v1, s[4:7], s14 offen offset:1024 sc1
  buffer_store_dwordx2 v[232:233], v1, s[4:7], s15 offen sc1
  s_branch L_back34
L_slow35:
  buffer_store_dword v236, v4, s[4:7], s17 offen sc1
  s_branch L_back36
L_slow37:
  buffer_store_dword v25, v13, s[4:7], s18 offen offset:32 sc1
  s_branch L_back38
L_slow41:
  buffer_store_dwordx4 v[232:235], v41, s[4:7], s85 offen sc1
  s_branch L_back42
L_slow45:
  buffer_store_dwordx4 v[224:227], v1, s[4:7], s16 offen offset:0 sc1
  buffer_store_dwordx4 v[228:231], v1, s[4:7], s16 offen offset:1024 sc1
  buffer_store_dwordx4 v[232:235], v1, s[4:7], s16 offen offset:2048 sc1
  s_branch L_back46
L_slow47:
  buffer_store_dword v25, v13, s[4:7], s18 offen offset:64 sc1
  s_branch L_back48
L_slow51:
  buffer_store_dwordx4 v[224:227], v1, s[4:7], s14 offen sc1
  buffer_store_dwordx4 v[228:231], v1, s[4:7], s14 offen offset:1024 sc1
  buffer_store_dwordx2 v[232:233], v1, s[4:7], s15 offen sc1
  s_branch L_back52
L_slow53:
  buffer_store_dword v236, v4, s[4:7], s17 offen sc1
  s_branch L_back54
L_slow55:
  buffer_store_dword v25, v13, s[4:7], s18 offen offset:96 sc1
  s_branch L_back56
L_spin65:
  s_mov_b32 s88, 0
  L_poll67:
  buffer_load_dwordx4 v[184:187], v36, s[4:7], s85 offen sc1
  buffer_load_dwordx4 v[188:191], v36, s[4:7], s86 offen sc1
  s_add_u32 s88, s88, 1
  s_cmp_gt_u32 s88, 65536
  s_cbranch_scc1 L_abort
  s_waitcnt vmcnt(0)
  v_perm_b32 v192, v185, v184, s56
  v_perm_b32 v193, v187, v186, s57
  v_or_b32 v192, v192, v193
  v_cmp_ne_u32 s[94:95], s44, v192
  v_perm_b32 v194, v189, v188, s56
  v_perm_b32 v195, v191, v190, s57
  v_or_b32 v194, v194, v195
  v_cmp_ne_u32 vcc, s44, v194
  s_nop 0
  s_or_b64 vcc, vcc, s[94:95]
  s_cbranch_vccnz L_poll67
  s_nop 1
  s_branch L_back66
L_slow69:
  buffer_store_dwordx4 v[224:227], v1, s[4:7], s12 offen sc1
  buffer_store_dwordx4 v[228:231], v1, s[4:7], s12 offen offset:1024 sc1
  buffer_store_dwordx2 v[232:233], v1, s[4:7], s13 offen sc1
  s_branch L_back70
L_slow71:
  buffer_store_dword v25, v13, s[4:7], s18 offen offset:128 sc1
  s_branch L_back72
L_slow75:
  buffer_store_dwordx4 v[224:227], v1, s[4:7], s14 offen sc1
  buffer_store_dwordx4 v[228:231], v1, s[4:7], s14 offen offset:1024 sc1
  buffer_store_dwordx2 v[232:233], v1, s[4:7], s15 offen sc1
  s_branch L_back76
L_slow77:
  buffer_store_dword v236, v4, s[4:7], s17 offen sc1
  s_branch L_back78
L_slow79:
  buffer_store_dword v25, v13, s[4:7], s18 offen offset:160 sc1
  s_branch L_back80
L_slow83:
  buffer_store_dwordx4 v[232:235], v41, s[4:7], s85 offen sc1
  s_branch L_back84
L_slow87:
  buffer_store_dwordx4 v[224:227], v1, s[4:7], s16 offen offset:0 sc1
  buffer_store_dwordx4 v[228:231], v1, s[4:7], s16 offen offset:1024 sc1
  buffer_store_dwordx4 v[232:235], v1, s[4:7], s16 offen offset:2048 sc1
  s_branch L_back88
L_slow89:
  buffer_store_dword v25, v13, s[4:7], s18 offen offset:192 sc1
  s_branch L_back90
L_codeend:
.section .rodata,"a"
.p2align 6
.amdhsa_kernel interleave_layers__linear_attn_block__mixer_gmlp__prompt_kernel
  .amdhsa_next_free_vgpr 512
  .amdhsa_next_free_sgpr 102
  .amdhsa_accum_offset 256
  .amdhsa_group_segment_fixed_size 0
  .amdhsa_kernarg_size 88
  .amdhsa_user_sgpr_count 2
  .amdhsa_user_sgpr_kernarg_segment_ptr 1
  .amdhsa_system_sgpr_workgroup_id_x 1
.end_amdhsa_kernel
```
